```python
import torch

def _softmax(x, axis=-1):
    return torch.softmax(x, dim=axis)
def _gelu(x):
    return torch.nn.functional.gelu(x, approximate="tanh")
def _silu(x):
    return torch.nn.functional.silu(x)
def _sigmoid(x):
    return torch.sigmoid(x)
def _layernorm(x, axis=-1, eps=1e-5):
    m = x.mean(dim=axis, keepdim=True)
    v = x.var(dim=axis, keepdim=True, unbiased=False)
    return (x - m) / torch.sqrt(v + eps)
def _scatter_add(tgt, idx, src, axis=0):
    return tgt.clone().index_add_(axis, idx, src)
def _segment_sum(src, seg, n):
    out = torch.zeros((n,) + src.shape[1:], dtype=src.dtype)
    return out.index_add_(0, seg, src)
def _pad(x, pw):
    flat = tuple(v for pair in reversed(pw) for v in pair)
    return torch.nn.functional.pad(x, flat)

kernel_name = 'gated_mix__compressed_kv_cla__dense_activation_mish__prompt'

def setup_inputs():

    _w = (lambda a: (lambda t: t.to(torch.bfloat16) if t.is_floating_point() else t)(torch.as_tensor(a)))
    def _A_setup():
        B, H, Sq, Sk, D, M = 1, 32, 2048, 2048, 128, 512
        Dc = 4 * D
        return {
            "x": _w((lambda *s: torch.randn(*s, dtype=torch.bfloat16) * 0.05)(B, Sq, M)),
            "c_kv": _w((lambda *s: torch.randn(*s, dtype=torch.bfloat16) * 0.2)(B, Sk, Dc)),
            "w_q": _w((lambda *s: torch.randn(*s, dtype=torch.bfloat16) * 12.8)(M, H, D) * (M ** -0.5)),
            "w_uk": _w((lambda *s: torch.randn(*s, dtype=torch.bfloat16) * 12.8)(Dc, H, D) * (Dc ** -0.5)),
            "w_uv": _w((lambda *s: torch.randn(*s, dtype=torch.bfloat16) * 0.2)(Dc, H, D) * (Dc ** -0.5)),
            "w_o": _w((lambda *s: torch.randn(*s, dtype=torch.bfloat16) * 0.2)(H, D, M) * ((H * D) ** -0.5)),
        }
    _A_in = _A_setup()

    def _B_setup():
        B, S, D, F = 1, 2048, 512, 1792
        return {
            "x": _w((lambda *s: torch.randn(*s, dtype=torch.bfloat16) * 0.05)(B, S, D)),
            "w1": _w((lambda *s: torch.randn(*s, dtype=torch.bfloat16) * 6.4)(D, F) * (D ** -0.5)),
            "b1": _w((lambda *s: torch.randn(*s, dtype=torch.bfloat16) * 0.05)(F)),
            "w2": _w((lambda *s: torch.randn(*s, dtype=torch.bfloat16) * 0.05)(F, D) * (F ** -0.5)),
        }
    _B_in = _B_setup()

    return {
        "A_x": _A_in["x"],
        "A_c_kv": _A_in["c_kv"],
        "A_w_q": _A_in["w_q"],
        "A_w_uk": _A_in["w_uk"],
        "A_w_uv": _A_in["w_uv"],
        "A_w_o": _A_in["w_o"],
        "B_x": _B_in["x"],
        "B_w1": _B_in["w1"],
        "B_b1": _B_in["b1"],
        "B_w2": _B_in["w2"],
        "gate_w": _w((lambda *s: torch.randn(*s, dtype=torch.bfloat16) * 0.05)(512) * 16.0),
    }

def reference(A_x, A_c_kv, A_w_q, A_w_uk, A_w_uv, A_w_o, B_x, B_w1, B_b1, B_w2, gate_w):
    def _A_ref(x, c_kv, w_q, w_uk, w_uv, w_o):
        B, Sq, M = x.shape[0], x.shape[1], x.shape[2]
        Sk = c_kv.shape[1]
        H, D = w_q.shape[1], w_q.shape[2]
        q = torch.einsum("bqm,mhd->bhqd", x, w_q)
        k = torch.einsum("bkc,chd->bhkd", c_kv, w_uk)
        v = torch.einsum("bkc,chd->bhkd", c_kv, w_uv)
        scores = torch.einsum("bhqd,bhkd->bhqk", q, k) * (D ** -0.5)
        off = Sk - Sq
        qi = torch.arange(Sq)[:, None]
        kj = torch.arange(Sk)[None, :]
        cmask = kj <= (qi + off)
        scores = torch.where(cmask[None, None], scores, -1e9)
        p = _softmax(scores, axis=-1)
        ctx = torch.einsum("bhqk,bhkd->bhqd", p, v)
        return torch.einsum("bhqd,hdm->bqm", ctx, w_o)

    def _B_ref(x, w1, b1, w2):
        h = torch.einsum("bsd,df->bsf", x, w1) + b1
        sp = torch.log1p(torch.exp(-torch.abs(h))) + torch.where(h > 0, h, torch.zeros_like(h))
        act = h * torch.tanh(sp)
        return torch.einsum("bsf,fd->bsd", act, w2)

    x = A_x
    g = _sigmoid((x * gate_w).sum(-1, keepdims=True))
    a = _A_ref(x, A_c_kv, A_w_q, A_w_uk, A_w_uv, A_w_o)
    b = _B_ref(x, B_w1, B_b1, B_w2)
    return g * a + (1 - g) * b
```

```asm
; @launch grid=(256,1,1) block=(256,1,1) lds=163840
.amdgcn_target "amdgcn-amd-amdhsa--gfx950"
.text
.globl gated_mix__compressed_kv_cla__dense_activation_mish__prompt_kernel
.p2align 8
.type gated_mix__compressed_kv_cla__dense_activation_mish__prompt_kernel,@function
gated_mix__compressed_kv_cla__dense_activation_mish__prompt_kernel:
  s_cmp_ge_u32 s2, 256
  s_cbranch_scc1 Lend
  s_load_dwordx16 s[36:51], s[0:1], 0
  s_load_dwordx8 s[52:59], s[0:1], 64
  s_load_dwordx4 s[96:99], s[0:1], 96
  s_getpc_b64 s[4:5]
Lpc:
  s_lshr_b32 s3, s2, 3
  s_lshl_b32 s3, s3, 8
  v_add_lshl_u32 v26, s3, v0, 4
  v_min_u32 v26, Lcodeend-Lpc-4, v26
  global_load_dword v26, v26, s[4:5]
  v_lshrrev_b32 v27, 6, v0
  v_and_b32 v0, 63, v0
  v_readfirstlane_b32 s60, v27
  s_brev_b32 s60, s60
  s_lshr_b32 s60, s60, 30
  s_mov_b32 s14, 0x200000
  s_mov_b32 s15, 0x20000
  s_mov_b32 s22, 0x400000
  s_mov_b32 s23, 0x20000
  s_mov_b32 s26, 0x400000
  s_mov_b32 s27, 0x20000
  s_and_b32 s61, s2, 7
  s_lshl_b32 s61, s61, 2
  s_bfe_u32 s63, s2, 0x20003
  s_add_u32 s61, s61, s63
  s_lshr_b32 s62, s2, 5
  s_lshl_b32 s93, s63, 1
  s_add_u32 s93, s93, s62
  s_and_b32 s63, s2, 1
  s_add_u32 s93, s93, s63
  s_lshl_b32 s78, s60, 12
  s_lshl_b32 s84, s60, 14
  s_add_u32 s84, s84, 65536
  s_lshl_b32 s63, s62, 2
  s_add_u32 s63, s63, s60
  s_lshl_b32 s68, s63, 15
  s_add_u32 s69, s68, 16384
  s_add_u32 s70, s68, 1048576
  s_add_u32 s71, s68, 1064960
  s_lshl_b32 s63, s60, 17
  s_lshl_b32 s64, s61, 8
  s_add_u32 s76, s63, s64
  v_lshrrev_b32 v22, 4, v0
  v_and_b32 v23, 15, v0
  v_lshlrev_b32 v24, 1, v22
  v_xor_b32 v24, v23, v24
  v_lshlrev_b32 v24, 4, v24
  v_lshl_add_u32 v2, v22, 13, v24
  v_add_u32 v3, 31744, v2
  v_xor_b32 v24, 128, v2
  v_add_u32 v4, 63488, v24
  v_add_u32 v5, 95232, v24
  v_lshrrev_b32 v25, 3, v0
  v_and_b32 v34, 7, v0
  v_xor_b32 v24, v34, v22
  v_lshlrev_b32 v24, 4, v24
  v_lshl_add_u32 v20, v25, 10, v24
  v_xor_b32 v24, 64, v20
  v_add_u32 v21, 7168, v24
  s_waitcnt lgkmcnt(0)
  s_mov_b64 s[12:13], s[38:39]
  s_mov_b64 s[20:21], s[42:43]
  s_mov_b64 s[24:25], s[44:45]
  s_mov_b64 s[8:9], s[36:37]
  s_mov_b64 s[16:17], s[40:41]
  s_mov_b64 s[28:29], s[46:47]
  s_mov_b64 s[32:33], s[50:51]
  s_mov_b64 s[36:37], s[54:55]
  s_mov_b64 s[44:45], s[58:59]
  s_mov_b64 s[48:49], s[96:97]
  s_mov_b64 s[40:41], s[98:99]
  s_add_u32 s65, s68, 0
  s_add_u32 m0, s84, 0
  s_nop 0
  buffer_load_dwordx4 v20, s[12:15], s65 offen offset:0 lds
  buffer_load_dwordx4 v21, s[12:15], s65 offen offset:1024 lds
  s_add_u32 s65, s69, 0
  s_add_u32 m0, s84, 2048
  s_nop 0
  buffer_load_dwordx4 v20, s[12:15], s65 offen offset:0 lds
  buffer_load_dwordx4 v21, s[12:15], s65 offen offset:1024 lds
  s_add_u32 s65, s70, 0
  s_add_u32 m0, s84, 4096
  s_nop 0
  buffer_load_dwordx4 v20, s[12:15], s65 offen offset:0 lds
  buffer_load_dwordx4 v21, s[12:15], s65 offen offset:1024 lds
  s_add_u32 s65, s71, 0
  s_add_u32 m0, s84, 6144
  s_nop 0
  buffer_load_dwordx4 v20, s[12:15], s65 offen offset:0 lds
  buffer_load_dwordx4 v21, s[12:15], s65 offen offset:1024 lds
  s_add_u32 s65, s76, 0
  s_add_u32 m0, s78, 131072
  s_nop 0
  buffer_load_dwordx4 v2, s[20:23], s65 offen offset:0 lds
  buffer_load_dwordx4 v3, s[20:23], s65 offen offset:1024 lds
  buffer_load_dwordx4 v4, s[20:23], s65 offen offset:2048 lds
  buffer_load_dwordx4 v5, s[20:23], s65 offen offset:3072 lds
  s_add_u32 m0, s78, 147456
  s_nop 0
  buffer_load_dwordx4 v2, s[24:27], s65 offen offset:0 lds
  buffer_load_dwordx4 v3, s[24:27], s65 offen offset:1024 lds
  buffer_load_dwordx4 v4, s[24:27], s65 offen offset:2048 lds
  buffer_load_dwordx4 v5, s[24:27], s65 offen offset:3072 lds
  s_mov_b32 s10, 0x200000
  s_mov_b32 s11, 0x20000
  s_mov_b32 s18, 0x400000
  s_mov_b32 s19, 0x20000
  s_mov_b32 s30, 0x400000
  s_mov_b32 s31, 0x20000
  s_mov_b32 s34, 0x1c0000
  s_mov_b32 s35, 0x20000
  s_mov_b32 s38, 0x1c0000
  s_mov_b32 s39, 0x20000
  s_mov_b32 s42, 0x6000000
  s_mov_b32 s43, 0x20000
  s_mov_b32 s46, 0x200000
  s_mov_b32 s47, 0x20000
  s_mov_b32 s50, 0x100
  s_mov_b32 s51, 0x20000
  s_mov_b32 s54, 0xe00
  s_mov_b32 s55, 0x20000
  s_mov_b32 s58, 0x400
  s_mov_b32 s59, 0x20000
  s_cmp_ge_u32 s61, 28
  s_cselect_b32 s54, 0, s54
  s_lshl_b32 s79, s60, 11
  s_lshl_b32 s64, s60, 15
  s_and_b32 s63, s60, 1
  s_mul_i32 s63, s63, 3
  s_lshr_b32 s65, s60, 1
  s_xor_b32 s65, s65, s63
  s_lshl_b32 s65, s65, 15
  s_sub_u32 s63, 15, s62
  s_lshl_b32 s63, s63, 17
  s_add_u32 s72, s63, s65
  s_add_u32 s73, s72, 16384
  s_lshl_b32 s63, s62, 17
  s_add_u32 s74, s63, s64
  s_add_u32 s75, s74, 16384
  s_lshl_b32 s63, s61, 19
  s_lshr_b32 s64, s68, 2
  s_add_u32 s85, s63, s64
  s_mul_i32 s63, s60, 57344
  s_lshl_b32 s64, s61, 7
  s_add_u32 s77, s63, s64
  v_lshlrev_b32 v1, 4, v0
  v_mul_u32_u24 v25, 3584, v25
  v_and_b32 v27, 1, v22
  v_lshlrev_b32 v24, 1, v27
  v_xor_b32 v24, v34, v24
  v_lshl_add_u32 v6, v24, 4, v25
  v_xor_b32 v24, 4, v24
  v_lshl_add_u32 v24, v24, 4, v25
  v_add_u32 v7, 27648, v24
  v_lshrrev_b32 v24, 1, v23
  v_xor_b32 v24, v22, v24
  v_lshlrev_b32 v24, 4, v24
  v_lshl_add_u32 v24, v23, 7, v24
  v_add_u32 v28, s84, v24
  v_xor_b32 v29, 64, v28
  v_lshrrev_b32 v25, 2, v23
  v_and_b32 v34, 3, v0
  v_lshl_add_u32 v32, v22, 3, v25
  v_lshl_or_b32 v33, v27, 2, v25
  v_lshlrev_b32 v23, 8, v32
  v_lshl_add_u32 v23, v34, 3, v23
  v_add_u32 v23, 131072, v23
  v_xor_b32 v24, 0, v33
  v_lshl_add_u32 v8, v24, 5, v23
  v_xor_b32 v24, 1, v33
  v_lshl_add_u32 v9, v24, 5, v23
  v_xor_b32 v24, 2, v33
  v_lshl_add_u32 v10, v24, 5, v23
  v_xor_b32 v24, 3, v33
  v_lshl_add_u32 v11, v24, 5, v23
  v_xor_b32 v24, 4, v33
  v_lshl_add_u32 v12, v24, 5, v23
  v_xor_b32 v24, 5, v33
  v_lshl_add_u32 v13, v24, 5, v23
  v_xor_b32 v24, 6, v33
  v_lshl_add_u32 v14, v24, 5, v23
  v_xor_b32 v24, 7, v33
  v_lshl_add_u32 v15, v24, 5, v23
  v_lshrrev_b32 v33, 1, v25
  v_lshl_or_b32 v33, v27, 1, v33
  v_lshlrev_b32 v23, 7, v32
  v_lshl_add_u32 v23, v34, 3, v23
  v_xor_b32 v24, 0, v33
  v_lshl_add_u32 v16, v24, 5, v23
  v_xor_b32 v24, 1, v33
  v_lshl_add_u32 v17, v24, 5, v23
  v_xor_b32 v24, 2, v33
  v_lshl_add_u32 v18, v24, 5, v23
  v_xor_b32 v24, 3, v33
  v_lshl_add_u32 v19, v24, 5, v23
  v_lshlrev_b32 v0, 2, v0
  s_lshl_b32 s66, s61, 7
  s_add_u32 s66, s66, 58785792
  s_lshl_b32 s82, s62, 8
  s_add_u32 s82, s82, 58789888
  s_and_b32 s0, s2, 3
  s_bfe_u32 s63, s2, 0x30003
  s_xor_b32 s65, s63, 7
  s_bitcmp1_b32 s2, 2
  s_cselect_b32 s63, s65, s63
  s_lshl_b32 s83, s63, 8
  s_add_u32 s83, s83, 58789888
  s_cmp_eq_u32 s60, 0
  s_cselect_b32 s94, 1, 0
  s_mov_b32 s95, 0
  v_mov_b32 v27, 1
  s_or_b32 s63, s2, s60
  s_cbranch_scc1 Lnoinit
  v_mov_b32 v32, 0
  v_mov_b32 v33, 0
  v_mov_b32 v34, 0
  v_mov_b32 v35, 0
  s_mov_b32 s63, 58785792
  buffer_store_dwordx4 v[32:35], v1, s[40:43], s63 offen offset:0 sc1
  buffer_store_dwordx4 v[32:35], v1, s[40:43], s63 offen offset:1024 sc1
  buffer_store_dwordx4 v[32:35], v1, s[40:43], s63 offen offset:2048 sc1
  buffer_store_dwordx4 v[32:35], v1, s[40:43], s63 offen offset:3072 sc1
  s_mov_b32 s63, 58789888
  buffer_store_dwordx4 v[32:35], v1, s[40:43], s63 offen offset:0 sc1
  buffer_store_dwordx4 v[32:35], v1, s[40:43], s63 offen offset:1024 sc1
  buffer_store_dwordx4 v[32:35], v1, s[40:43], s63 offen offset:2048 sc1
  buffer_store_dwordx4 v[32:35], v1, s[40:43], s63 offen offset:3072 sc1
  s_mov_b32 s63, 58793984
  buffer_store_dwordx4 v[32:35], v1, s[40:43], s63 offen offset:0 sc1
  buffer_store_dwordx4 v[32:35], v1, s[40:43], s63 offen offset:1024 sc1
Lnoinit:
  s_lshl_b32 s63, s2, 2
  s_add_u32 s63, s63, s60
  s_lshl_b32 s63, s63, 10
  v_add_u32 v23, s63, v1
  s_lshl_b32 s63, s63, 3
  s_mov_b64 s[88:89], s[8:9]
  s_mov_b32 s92, s10
  s_mov_b32 s64, 0
  s_cmp_ge_u32 s63, 2097152
  s_cselect_b64 s[88:89], s[16:17], s[88:89]
  s_cselect_b32 s92, s18, s92
  s_cselect_b32 s64, 2097152, s64
  s_cmp_ge_u32 s63, 6291456
  s_cselect_b64 s[88:89], s[32:33], s[88:89]
  s_cselect_b32 s92, s34, s92
  s_cselect_b32 s64, 6291456, s64
  s_sub_u32 s63, s63, s64
  s_mov_b32 s91, 0x20000
  v_lshlrev_b32 v24, 3, v1
  v_add_u32 v24, s63, v24
  s_lshr_b32 s1, s2, 3
  s_and_b32 s1, s1, 7
  s_waitcnt vmcnt(0)
  s_barrier
  ds_read_b128 a[0:3], v28 offset:0
  ds_read_b128 a[4:7], v28 offset:2048
  ds_read_b128 a[8:11], v28 offset:4096
  ds_read_b128 a[12:15], v28 offset:6144
  ds_read_b128 a[16:19], v29 offset:0
  ds_read_b128 a[20:23], v29 offset:2048
  ds_read_b128 a[24:27], v29 offset:4096
  ds_read_b128 a[28:31], v29 offset:6144
  s_waitcnt lgkmcnt(0)
  ds_read_b64_tr_b16 a[64:65], v8 offset:0
  ds_read_b64_tr_b16 a[66:67], v8 offset:1024
  ds_read_b64_tr_b16 a[68:69], v8 offset:8192
  ds_read_b64_tr_b16 a[70:71], v8 offset:9216
  ds_read_b64_tr_b16 a[72:73], v9 offset:0
  ds_read_b64_tr_b16 a[74:75], v9 offset:1024
  ds_read_b64_tr_b16 a[76:77], v9 offset:8192
  ds_read_b64_tr_b16 a[78:79], v9 offset:9216
  s_waitcnt lgkmcnt(4)
  v_mfma_f32_16x16x32_bf16 v[32:35], a[64:67], a[0:3], 0
  ds_read_b64_tr_b16 a[80:81], v10 offset:0
  s_add_u32 s65, s68, 128
  v_mfma_f32_16x16x32_bf16 v[32:35], a[68:71], a[16:19], v[32:35]
  ds_read_b64_tr_b16 a[82:83], v10 offset:1024
  s_add_u32 m0, s84, 8192
  v_mfma_f32_16x16x32_bf16 v[36:39], a[68:71], a[20:23], 0
  buffer_load_dwordx4 v20, s[12:15], s65 offen offset:0 lds
  v_mfma_f32_16x16x32_bf16 v[36:39], a[64:67], a[4:7], v[36:39]
  v_mfma_f32_16x16x32_bf16 v[40:43], a[64:67], a[8:11], 0
  ds_read_b64_tr_b16 a[84:85], v10 offset:8192
  v_mfma_f32_16x16x32_bf16 v[40:43], a[68:71], a[24:27], v[40:43]
  ds_read_b64_tr_b16 a[86:87], v10 offset:9216
  v_mfma_f32_16x16x32_bf16 v[44:47], a[68:71], a[28:31], 0
  buffer_load_dwordx4 v21, s[12:15], s65 offen offset:1024 lds
  v_mfma_f32_16x16x32_bf16 v[44:47], a[64:67], a[12:15], v[44:47]
  s_waitcnt lgkmcnt(4)
  v_mfma_f32_16x16x32_bf16 v[48:51], a[72:75], a[0:3], 0
  ds_read_b64_tr_b16 a[88:89], v11 offset:0
  s_add_u32 s65, s69, 128
  v_mfma_f32_16x16x32_bf16 v[48:51], a[76:79], a[16:19], v[48:51]
  ds_read_b64_tr_b16 a[90:91], v11 offset:1024
  s_add_u32 m0, s84, 10240
  v_mfma_f32_16x16x32_bf16 v[52:55], a[76:79], a[20:23], 0
  buffer_load_dwordx4 v20, s[12:15], s65 offen offset:0 lds
  v_mfma_f32_16x16x32_bf16 v[52:55], a[72:75], a[4:7], v[52:55]
  v_mfma_f32_16x16x32_bf16 v[56:59], a[72:75], a[8:11], 0
  ds_read_b64_tr_b16 a[92:93], v11 offset:8192
  v_mfma_f32_16x16x32_bf16 v[56:59], a[76:79], a[24:27], v[56:59]
  ds_read_b64_tr_b16 a[94:95], v11 offset:9216
  v_mfma_f32_16x16x32_bf16 v[60:63], a[76:79], a[28:31], 0
  buffer_load_dwordx4 v21, s[12:15], s65 offen offset:1024 lds
  v_mfma_f32_16x16x32_bf16 v[60:63], a[72:75], a[12:15], v[60:63]
  s_waitcnt lgkmcnt(4)
  v_mfma_f32_16x16x32_bf16 v[64:67], a[80:83], a[0:3], 0
  ds_read_b64_tr_b16 a[64:65], v12 offset:0
  s_add_u32 s65, s70, 128
  v_mfma_f32_16x16x32_bf16 v[64:67], a[84:87], a[16:19], v[64:67]
  ds_read_b64_tr_b16 a[66:67], v12 offset:1024
  s_add_u32 m0, s84, 12288
  v_mfma_f32_16x16x32_bf16 v[68:71], a[84:87], a[20:23], 0
  buffer_load_dwordx4 v20, s[12:15], s65 offen offset:0 lds
  v_mfma_f32_16x16x32_bf16 v[68:71], a[80:83], a[4:7], v[68:71]
  v_mfma_f32_16x16x32_bf16 v[72:75], a[80:83], a[8:11], 0
  ds_read_b64_tr_b16 a[68:69], v12 offset:8192
  v_mfma_f32_16x16x32_bf16 v[72:75], a[84:87], a[24:27], v[72:75]
  ds_read_b64_tr_b16 a[70:71], v12 offset:9216
  v_mfma_f32_16x16x32_bf16 v[76:79], a[84:87], a[28:31], 0
  buffer_load_dwordx4 v21, s[12:15], s65 offen offset:1024 lds
  v_mfma_f32_16x16x32_bf16 v[76:79], a[80:83], a[12:15], v[76:79]
  s_waitcnt lgkmcnt(4)
  v_mfma_f32_16x16x32_bf16 v[80:83], a[88:91], a[0:3], 0
  ds_read_b64_tr_b16 a[72:73], v13 offset:0
  s_add_u32 s65, s71, 128
  v_mfma_f32_16x16x32_bf16 v[80:83], a[92:95], a[16:19], v[80:83]
  ds_read_b64_tr_b16 a[74:75], v13 offset:1024
  s_add_u32 m0, s84, 14336
  v_mfma_f32_16x16x32_bf16 v[84:87], a[92:95], a[20:23], 0
  buffer_load_dwordx4 v20, s[12:15], s65 offen offset:0 lds
  v_mfma_f32_16x16x32_bf16 v[84:87], a[88:91], a[4:7], v[84:87]
  v_mfma_f32_16x16x32_bf16 v[88:91], a[88:91], a[8:11], 0
  ds_read_b64_tr_b16 a[76:77], v13 offset:8192
  v_mfma_f32_16x16x32_bf16 v[88:91], a[92:95], a[24:27], v[88:91]
  ds_read_b64_tr_b16 a[78:79], v13 offset:9216
  v_mfma_f32_16x16x32_bf16 v[92:95], a[92:95], a[28:31], 0
  buffer_load_dwordx4 v21, s[12:15], s65 offen offset:1024 lds
  v_mfma_f32_16x16x32_bf16 v[92:95], a[88:91], a[12:15], v[92:95]
  s_waitcnt lgkmcnt(4)
  v_mfma_f32_16x16x32_bf16 v[96:99], a[64:67], a[0:3], 0
  ds_read_b64_tr_b16 a[80:81], v14 offset:0
  s_add_u32 s65, s76, 524288
  v_mfma_f32_16x16x32_bf16 v[96:99], a[68:71], a[16:19], v[96:99]
  ds_read_b64_tr_b16 a[82:83], v14 offset:1024
  s_add_u32 m0, s78, 0
  v_mfma_f32_16x16x32_bf16 v[100:103], a[68:71], a[20:23], 0
  buffer_load_dwordx4 v2, s[20:23], s65 offen offset:0 lds
  v_mfma_f32_16x16x32_bf16 v[100:103], a[64:67], a[4:7], v[100:103]
  v_mfma_f32_16x16x32_bf16 v[104:107], a[64:67], a[8:11], 0
  ds_read_b64_tr_b16 a[84:85], v14 offset:8192
  v_mfma_f32_16x16x32_bf16 v[104:107], a[68:71], a[24:27], v[104:107]
  ds_read_b64_tr_b16 a[86:87], v14 offset:9216
  v_mfma_f32_16x16x32_bf16 v[108:111], a[68:71], a[28:31], 0
  buffer_load_dwordx4 v3, s[20:23], s65 offen offset:1024 lds
  v_mfma_f32_16x16x32_bf16 v[108:111], a[64:67], a[12:15], v[108:111]
  s_waitcnt lgkmcnt(4)
  v_mfma_f32_16x16x32_bf16 v[112:115], a[72:75], a[0:3], 0
  ds_read_b64_tr_b16 a[88:89], v15 offset:0
  v_mfma_f32_16x16x32_bf16 v[112:115], a[76:79], a[16:19], v[112:115]
  ds_read_b64_tr_b16 a[90:91], v15 offset:1024
  v_mfma_f32_16x16x32_bf16 v[116:119], a[76:79], a[20:23], 0
  buffer_load_dwordx4 v4, s[20:23], s65 offen offset:2048 lds
  v_mfma_f32_16x16x32_bf16 v[116:119], a[72:75], a[4:7], v[116:119]
  v_mfma_f32_16x16x32_bf16 v[120:123], a[72:75], a[8:11], 0
  ds_read_b64_tr_b16 a[92:93], v15 offset:8192
  v_mfma_f32_16x16x32_bf16 v[120:123], a[76:79], a[24:27], v[120:123]
  ds_read_b64_tr_b16 a[94:95], v15 offset:9216
  v_mfma_f32_16x16x32_bf16 v[124:127], a[76:79], a[28:31], 0
  v_mfma_f32_16x16x32_bf16 v[124:127], a[72:75], a[12:15], v[124:127]
  s_waitcnt lgkmcnt(4)
  v_mfma_f32_16x16x32_bf16 v[128:131], a[80:83], a[0:3], 0
  ds_read_b64_tr_b16 a[64:65], v8 offset:16384
  v_mfma_f32_16x16x32_bf16 v[128:131], a[84:87], a[16:19], v[128:131]
  ds_read_b64_tr_b16 a[66:67], v8 offset:17408
  v_mfma_f32_16x16x32_bf16 v[132:135], a[84:87], a[20:23], 0
  buffer_load_dwordx4 v5, s[20:23], s65 offen offset:3072 lds
  v_mfma_f32_16x16x32_bf16 v[132:135], a[80:83], a[4:7], v[132:135]
  v_mfma_f32_16x16x32_bf16 v[136:139], a[80:83], a[8:11], 0
  ds_read_b64_tr_b16 a[68:69], v8 offset:24576
  v_mfma_f32_16x16x32_bf16 v[136:139], a[84:87], a[24:27], v[136:139]
  ds_read_b64_tr_b16 a[70:71], v8 offset:25600
  s_add_u32 m0, s78, 16384
  v_mfma_f32_16x16x32_bf16 v[140:143], a[84:87], a[28:31], 0
  buffer_load_dwordx4 v2, s[24:27], s65 offen offset:0 lds
  v_mfma_f32_16x16x32_bf16 v[140:143], a[80:83], a[12:15], v[140:143]
  s_waitcnt lgkmcnt(4)
  v_mfma_f32_16x16x32_bf16 v[144:147], a[88:91], a[0:3], 0
  ds_read_b64_tr_b16 a[72:73], v9 offset:16384
  v_mfma_f32_16x16x32_bf16 v[144:147], a[92:95], a[16:19], v[144:147]
  ds_read_b64_tr_b16 a[74:75], v9 offset:17408
  v_mfma_f32_16x16x32_bf16 v[148:151], a[92:95], a[20:23], 0
  buffer_load_dwordx4 v3, s[24:27], s65 offen offset:1024 lds
  v_mfma_f32_16x16x32_bf16 v[148:151], a[88:91], a[4:7], v[148:151]
  v_mfma_f32_16x16x32_bf16 v[152:155], a[88:91], a[8:11], 0
  ds_read_b64_tr_b16 a[76:77], v9 offset:24576
  v_mfma_f32_16x16x32_bf16 v[152:155], a[92:95], a[24:27], v[152:155]
  ds_read_b64_tr_b16 a[78:79], v9 offset:25600
  v_mfma_f32_16x16x32_bf16 v[156:159], a[92:95], a[28:31], 0
  buffer_load_dwordx4 v4, s[24:27], s65 offen offset:2048 lds
  v_mfma_f32_16x16x32_bf16 v[156:159], a[88:91], a[12:15], v[156:159]
  s_waitcnt lgkmcnt(4)
  v_mfma_f32_16x16x32_bf16 v[160:163], a[0:3], a[64:67], 0
  ds_read_b64_tr_b16 a[80:81], v10 offset:16384
  v_mfma_f32_16x16x32_bf16 v[160:163], a[16:19], a[68:71], v[160:163]
  ds_read_b64_tr_b16 a[82:83], v10 offset:17408
  v_mfma_f32_16x16x32_bf16 v[164:167], a[20:23], a[68:71], 0
  buffer_load_dwordx4 v5, s[24:27], s65 offen offset:3072 lds
  v_mfma_f32_16x16x32_bf16 v[164:167], a[4:7], a[64:67], v[164:167]
  v_mfma_f32_16x16x32_bf16 v[168:171], a[8:11], a[64:67], 0
  ds_read_b64_tr_b16 a[84:85], v10 offset:24576
  s_add_u32 s65, s68, 256
  v_mfma_f32_16x16x32_bf16 v[168:171], a[24:27], a[68:71], v[168:171]
  ds_read_b64_tr_b16 a[86:87], v10 offset:25600
  s_add_u32 m0, s84, 0
  v_mfma_f32_16x16x32_bf16 v[172:175], a[28:31], a[68:71], 0
  buffer_load_dwordx4 v20, s[12:15], s65 offen offset:0 lds
  v_mfma_f32_16x16x32_bf16 v[172:175], a[12:15], a[64:67], v[172:175]
  s_waitcnt lgkmcnt(4)
  v_mfma_f32_16x16x32_bf16 v[176:179], a[0:3], a[72:75], 0
  ds_read_b64_tr_b16 a[88:89], v11 offset:16384
  v_mfma_f32_16x16x32_bf16 v[176:179], a[16:19], a[76:79], v[176:179]
  ds_read_b64_tr_b16 a[90:91], v11 offset:17408
  v_mfma_f32_16x16x32_bf16 v[180:183], a[20:23], a[76:79], 0
  buffer_load_dwordx4 v21, s[12:15], s65 offen offset:1024 lds
  v_mfma_f32_16x16x32_bf16 v[180:183], a[4:7], a[72:75], v[180:183]
  s_waitcnt vmcnt(10)
  v_mfma_f32_16x16x32_bf16 v[184:187], a[8:11], a[72:75], 0
  ds_read_b64_tr_b16 a[92:93], v11 offset:24576
  s_add_u32 s65, s69, 256
  v_mfma_f32_16x16x32_bf16 v[184:187], a[24:27], a[76:79], v[184:187]
  ds_read_b64_tr_b16 a[94:95], v11 offset:25600
  s_add_u32 m0, s84, 2048
  v_mfma_f32_16x16x32_bf16 v[188:191], a[28:31], a[76:79], 0
  buffer_load_dwordx4 v20, s[12:15], s65 offen offset:0 lds
  v_mfma_f32_16x16x32_bf16 v[188:191], a[12:15], a[72:75], v[188:191]
  ds_read_b128 a[32:35], v28 offset:8192
  s_waitcnt lgkmcnt(5)
  v_mfma_f32_16x16x32_bf16 v[192:195], a[0:3], a[80:83], 0
  ds_read_b64_tr_b16 a[64:65], v12 offset:16384
  v_mfma_f32_16x16x32_bf16 v[192:195], a[16:19], a[84:87], v[192:195]
  ds_read_b64_tr_b16 a[66:67], v12 offset:17408
  v_mfma_f32_16x16x32_bf16 v[196:199], a[20:23], a[84:87], 0
  buffer_load_dwordx4 v21, s[12:15], s65 offen offset:1024 lds
  v_mfma_f32_16x16x32_bf16 v[196:199], a[4:7], a[80:83], v[196:199]
  ds_read_b128 a[36:39], v28 offset:10240
  v_mfma_f32_16x16x32_bf16 v[200:203], a[8:11], a[80:83], 0
  ds_read_b64_tr_b16 a[68:69], v12 offset:24576
  s_add_u32 s65, s70, 256
  v_mfma_f32_16x16x32_bf16 v[200:203], a[24:27], a[84:87], v[200:203]
  ds_read_b64_tr_b16 a[70:71], v12 offset:25600
  s_add_u32 m0, s84, 4096
  v_mfma_f32_16x16x32_bf16 v[204:207], a[28:31], a[84:87], 0
  buffer_load_dwordx4 v20, s[12:15], s65 offen offset:0 lds
  v_mfma_f32_16x16x32_bf16 v[204:207], a[12:15], a[80:83], v[204:207]
  ds_read_b128 a[40:43], v28 offset:12288
  s_waitcnt lgkmcnt(7)
  v_mfma_f32_16x16x32_bf16 v[208:211], a[0:3], a[88:91], 0
  ds_read_b64_tr_b16 a[72:73], v13 offset:16384
  v_mfma_f32_16x16x32_bf16 v[208:211], a[16:19], a[92:95], v[208:211]
  ds_read_b64_tr_b16 a[74:75], v13 offset:17408
  v_mfma_f32_16x16x32_bf16 v[212:215], a[20:23], a[92:95], 0
  buffer_load_dwordx4 v21, s[12:15], s65 offen offset:1024 lds
  v_mfma_f32_16x16x32_bf16 v[212:215], a[4:7], a[88:91], v[212:215]
  ds_read_b128 a[44:47], v28 offset:14336
  v_mfma_f32_16x16x32_bf16 v[216:219], a[8:11], a[88:91], 0
  ds_read_b64_tr_b16 a[76:77], v13 offset:24576
  v_mfma_f32_16x16x32_bf16 v[216:219], a[24:27], a[92:95], v[216:219]
  ds_read_b64_tr_b16 a[78:79], v13 offset:25600
  v_mfma_f32_16x16x32_bf16 v[220:223], a[28:31], a[92:95], 0
  v_mfma_f32_16x16x32_bf16 v[220:223], a[12:15], a[88:91], v[220:223]
  ds_read_b128 a[48:51], v29 offset:8192
  s_waitcnt lgkmcnt(7)
  v_mfma_f32_16x16x32_bf16 v[224:227], a[0:3], a[64:67], 0
  ds_read_b64_tr_b16 a[80:81], v14 offset:16384
  v_mfma_f32_16x16x32_bf16 v[224:227], a[16:19], a[68:71], v[224:227]
  ds_read_b64_tr_b16 a[82:83], v14 offset:17408
  v_mfma_f32_16x16x32_bf16 v[228:231], a[20:23], a[68:71], 0
  ds_read_b64_tr_b16 a[84:85], v14 offset:24576
  v_mfma_f32_16x16x32_bf16 v[228:231], a[4:7], a[64:67], v[228:231]
  ds_read_b64_tr_b16 a[86:87], v14 offset:25600
  ds_read_b128 a[52:55], v29 offset:10240
  v_mfma_f32_16x16x32_bf16 v[232:235], a[8:11], a[64:67], 0
  ds_read_b64_tr_b16 a[88:89], v15 offset:16384
  v_mfma_f32_16x16x32_bf16 v[232:235], a[24:27], a[68:71], v[232:235]
  ds_read_b64_tr_b16 a[90:91], v15 offset:17408
  v_mfma_f32_16x16x32_bf16 v[236:239], a[28:31], a[68:71], 0
  ds_read_b64_tr_b16 a[92:93], v15 offset:24576
  v_mfma_f32_16x16x32_bf16 v[236:239], a[12:15], a[64:67], v[236:239]
  ds_read_b64_tr_b16 a[94:95], v15 offset:25600
  ds_read_b128 a[56:59], v29 offset:12288
  s_waitcnt lgkmcnt(11)
  v_mfma_f32_16x16x32_bf16 v[240:243], a[0:3], a[72:75], 0
  s_add_u32 s65, s71, 256
  v_mfma_f32_16x16x32_bf16 v[240:243], a[16:19], a[76:79], v[240:243]
  s_add_u32 m0, s84, 6144
  v_mfma_f32_16x16x32_bf16 v[244:247], a[20:23], a[76:79], 0
  buffer_load_dwordx4 v20, s[12:15], s65 offen offset:0 lds
  v_mfma_f32_16x16x32_bf16 v[244:247], a[4:7], a[72:75], v[244:247]
  ds_read_b128 a[60:63], v29 offset:14336
  v_mfma_f32_16x16x32_bf16 v[248:251], a[8:11], a[72:75], 0
  v_mfma_f32_16x16x32_bf16 v[248:251], a[24:27], a[76:79], v[248:251]
  v_mfma_f32_16x16x32_bf16 v[252:255], a[28:31], a[76:79], 0
  buffer_load_dwordx4 v21, s[12:15], s65 offen offset:1024 lds
  v_mfma_f32_16x16x32_bf16 v[252:255], a[12:15], a[72:75], v[252:255]
  s_waitcnt lgkmcnt(7)
  v_add_u32 v8, 0xfffe0000, v8
  s_waitcnt vmcnt(8) lgkmcnt(0)
  s_barrier
  v_mfma_f32_16x16x32_bf16 a[128:131], a[0:3], a[80:83], 0
  ds_read_b64_tr_b16 a[64:65], v8 offset:0
  v_mfma_f32_16x16x32_bf16 a[128:131], a[16:19], a[84:87], a[128:131]
  ds_read_b64_tr_b16 a[66:67], v8 offset:1024
  v_mfma_f32_16x16x32_bf16 a[132:135], a[20:23], a[84:87], 0
  v_mfma_f32_16x16x32_bf16 a[132:135], a[4:7], a[80:83], a[132:135]
  v_mfma_f32_16x16x32_bf16 a[136:139], a[8:11], a[80:83], 0
  ds_read_b64_tr_b16 a[68:69], v8 offset:8192
  v_mfma_f32_16x16x32_bf16 a[136:139], a[24:27], a[84:87], a[136:139]
  ds_read_b64_tr_b16 a[70:71], v8 offset:9216
  v_mfma_f32_16x16x32_bf16 a[140:143], a[28:31], a[84:87], 0
  v_mfma_f32_16x16x32_bf16 a[140:143], a[12:15], a[80:83], a[140:143]
  v_add_u32 v9, 0xfffe0000, v9
  v_mfma_f32_16x16x32_bf16 a[144:147], a[0:3], a[88:91], 0
  ds_read_b64_tr_b16 a[72:73], v9 offset:0
  v_mfma_f32_16x16x32_bf16 a[144:147], a[16:19], a[92:95], a[144:147]
  ds_read_b64_tr_b16 a[74:75], v9 offset:1024
  v_mfma_f32_16x16x32_bf16 a[148:151], a[20:23], a[92:95], 0
  v_mfma_f32_16x16x32_bf16 a[148:151], a[4:7], a[88:91], a[148:151]
  v_mfma_f32_16x16x32_bf16 a[152:155], a[8:11], a[88:91], 0
  ds_read_b64_tr_b16 a[76:77], v9 offset:8192
  v_mfma_f32_16x16x32_bf16 a[152:155], a[24:27], a[92:95], a[152:155]
  ds_read_b64_tr_b16 a[78:79], v9 offset:9216
  v_mfma_f32_16x16x32_bf16 a[156:159], a[28:31], a[92:95], 0
  v_mfma_f32_16x16x32_bf16 a[156:159], a[12:15], a[88:91], a[156:159]
  s_waitcnt lgkmcnt(4)
  v_add_u32 v10, 0xfffe0000, v10
  v_mfma_f32_16x16x32_bf16 v[32:35], a[64:67], a[32:35], v[32:35]
  ds_read_b64_tr_b16 a[80:81], v10 offset:0
  s_add_u32 s65, s76, 1048576
  v_mfma_f32_16x16x32_bf16 v[32:35], a[68:71], a[48:51], v[32:35]
  ds_read_b64_tr_b16 a[82:83], v10 offset:1024
  s_add_u32 m0, s78, 32768
  v_mfma_f32_16x16x32_bf16 v[36:39], a[68:71], a[52:55], v[36:39]
  buffer_load_dwordx4 v2, s[20:23], s65 offen offset:0 lds
  v_mfma_f32_16x16x32_bf16 v[36:39], a[64:67], a[36:39], v[36:39]
  v_mfma_f32_16x16x32_bf16 v[40:43], a[64:67], a[40:43], v[40:43]
  ds_read_b64_tr_b16 a[84:85], v10 offset:8192
  v_mfma_f32_16x16x32_bf16 v[40:43], a[68:71], a[56:59], v[40:43]
  ds_read_b64_tr_b16 a[86:87], v10 offset:9216
  v_mfma_f32_16x16x32_bf16 v[44:47], a[68:71], a[60:63], v[44:47]
  buffer_load_dwordx4 v3, s[20:23], s65 offen offset:1024 lds
  v_mfma_f32_16x16x32_bf16 v[44:47], a[64:67], a[44:47], v[44:47]
  s_waitcnt lgkmcnt(4)
  v_add_u32 v11, 0xfffe0000, v11
  v_mfma_f32_16x16x32_bf16 v[48:51], a[72:75], a[32:35], v[48:51]
  ds_read_b64_tr_b16 a[88:89], v11 offset:0
  v_mfma_f32_16x16x32_bf16 v[48:51], a[76:79], a[48:51], v[48:51]
  ds_read_b64_tr_b16 a[90:91], v11 offset:1024
  v_mfma_f32_16x16x32_bf16 v[52:55], a[76:79], a[52:55], v[52:55]
  buffer_load_dwordx4 v4, s[20:23], s65 offen offset:2048 lds
  v_mfma_f32_16x16x32_bf16 v[52:55], a[72:75], a[36:39], v[52:55]
  v_mfma_f32_16x16x32_bf16 v[56:59], a[72:75], a[40:43], v[56:59]
  ds_read_b64_tr_b16 a[92:93], v11 offset:8192
  v_mfma_f32_16x16x32_bf16 v[56:59], a[76:79], a[56:59], v[56:59]
  ds_read_b64_tr_b16 a[94:95], v11 offset:9216
  v_mfma_f32_16x16x32_bf16 v[60:63], a[76:79], a[60:63], v[60:63]
  buffer_load_dwordx4 v5, s[20:23], s65 offen offset:3072 lds
  v_mfma_f32_16x16x32_bf16 v[60:63], a[72:75], a[44:47], v[60:63]
  s_waitcnt lgkmcnt(4)
  v_add_u32 v12, 0xfffe0000, v12
  v_mfma_f32_16x16x32_bf16 v[64:67], a[80:83], a[32:35], v[64:67]
  ds_read_b64_tr_b16 a[64:65], v12 offset:0
  v_mfma_f32_16x16x32_bf16 v[64:67], a[84:87], a[48:51], v[64:67]
  ds_read_b64_tr_b16 a[66:67], v12 offset:1024
  s_add_u32 m0, s78, 49152
  v_mfma_f32_16x16x32_bf16 v[68:71], a[84:87], a[52:55], v[68:71]
  buffer_load_dwordx4 v2, s[24:27], s65 offen offset:0 lds
  v_mfma_f32_16x16x32_bf16 v[68:71], a[80:83], a[36:39], v[68:71]
  v_mfma_f32_16x16x32_bf16 v[72:75], a[80:83], a[40:43], v[72:75]
  ds_read_b64_tr_b16 a[68:69], v12 offset:8192
  v_mfma_f32_16x16x32_bf16 v[72:75], a[84:87], a[56:59], v[72:75]
  ds_read_b64_tr_b16 a[70:71], v12 offset:9216
  v_mfma_f32_16x16x32_bf16 v[76:79], a[84:87], a[60:63], v[76:79]
  buffer_load_dwordx4 v3, s[24:27], s65 offen offset:1024 lds
  v_mfma_f32_16x16x32_bf16 v[76:79], a[80:83], a[44:47], v[76:79]
  s_waitcnt lgkmcnt(4)
  v_add_u32 v13, 0xfffe0000, v13
  v_mfma_f32_16x16x32_bf16 v[80:83], a[88:91], a[32:35], v[80:83]
  ds_read_b64_tr_b16 a[72:73], v13 offset:0
  v_mfma_f32_16x16x32_bf16 v[80:83], a[92:95], a[48:51], v[80:83]
  ds_read_b64_tr_b16 a[74:75], v13 offset:1024
  v_mfma_f32_16x16x32_bf16 v[84:87], a[92:95], a[52:55], v[84:87]
  buffer_load_dwordx4 v4, s[24:27], s65 offen offset:2048 lds
  v_mfma_f32_16x16x32_bf16 v[84:87], a[88:91], a[36:39], v[84:87]
  v_mfma_f32_16x16x32_bf16 v[88:91], a[88:91], a[40:43], v[88:91]
  ds_read_b64_tr_b16 a[76:77], v13 offset:8192
  v_mfma_f32_16x16x32_bf16 v[88:91], a[92:95], a[56:59], v[88:91]
  ds_read_b64_tr_b16 a[78:79], v13 offset:9216
  v_mfma_f32_16x16x32_bf16 v[92:95], a[92:95], a[60:63], v[92:95]
  buffer_load_dwordx4 v5, s[24:27], s65 offen offset:3072 lds
  v_mfma_f32_16x16x32_bf16 v[92:95], a[88:91], a[44:47], v[92:95]
  s_waitcnt lgkmcnt(4)
  v_add_u32 v14, 0xfffe0000, v14
  s_waitcnt vmcnt(8)
  v_mfma_f32_16x16x32_bf16 v[96:99], a[64:67], a[32:35], v[96:99]
  ds_read_b64_tr_b16 a[80:81], v14 offset:0
  s_add_u32 s65, s68, 384
  v_mfma_f32_16x16x32_bf16 v[96:99], a[68:71], a[48:51], v[96:99]
  ds_read_b64_tr_b16 a[82:83], v14 offset:1024
  s_add_u32 m0, s84, 8192
  v_mfma_f32_16x16x32_bf16 v[100:103], a[68:71], a[52:55], v[100:103]
  buffer_load_dwordx4 v20, s[12:15], s65 offen offset:0 lds
  s_cmp_eq_u32 s1, 0
  s_cselect_b32 s90, s92, 0
  v_mfma_f32_16x16x32_bf16 v[100:103], a[64:67], a[36:39], v[100:103]
  buffer_load_dword v26, v24, s[88:91], 0 offen
  ds_read_b128 a[0:3], v28 offset:0
  v_mfma_f32_16x16x32_bf16 v[104:107], a[64:67], a[40:43], v[104:107]
  ds_read_b64_tr_b16 a[84:85], v14 offset:8192
  v_mfma_f32_16x16x32_bf16 v[104:107], a[68:71], a[56:59], v[104:107]
  ds_read_b64_tr_b16 a[86:87], v14 offset:9216
  v_mfma_f32_16x16x32_bf16 v[108:111], a[68:71], a[60:63], v[108:111]
  buffer_load_dwordx4 v21, s[12:15], s65 offen offset:1024 lds
  v_mfma_f32_16x16x32_bf16 v[108:111], a[64:67], a[44:47], v[108:111]
  ds_read_b128 a[4:7], v28 offset:2048
  s_waitcnt lgkmcnt(6)
  v_add_u32 v15, 0xfffe0000, v15
  v_mfma_f32_16x16x32_bf16 v[112:115], a[72:75], a[32:35], v[112:115]
  ds_read_b64_tr_b16 a[88:89], v15 offset:0
  s_add_u32 s65, s69, 384
  v_mfma_f32_16x16x32_bf16 v[112:115], a[76:79], a[48:51], v[112:115]
  ds_read_b64_tr_b16 a[90:91], v15 offset:1024
  s_add_u32 m0, s84, 10240
  v_mfma_f32_16x16x32_bf16 v[116:119], a[76:79], a[52:55], v[116:119]
  buffer_load_dwordx4 v20, s[12:15], s65 offen offset:0 lds
  v_mfma_f32_16x16x32_bf16 v[116:119], a[72:75], a[36:39], v[116:119]
  ds_read_b128 a[8:11], v28 offset:4096
  v_mfma_f32_16x16x32_bf16 v[120:123], a[72:75], a[40:43], v[120:123]
  ds_read_b64_tr_b16 a[92:93], v15 offset:8192
  v_mfma_f32_16x16x32_bf16 v[120:123], a[76:79], a[56:59], v[120:123]
  ds_read_b64_tr_b16 a[94:95], v15 offset:9216
  v_mfma_f32_16x16x32_bf16 v[124:127], a[76:79], a[60:63], v[124:127]
  buffer_load_dwordx4 v21, s[12:15], s65 offen offset:1024 lds
  v_mfma_f32_16x16x32_bf16 v[124:127], a[72:75], a[44:47], v[124:127]
  ds_read_b128 a[12:15], v28 offset:6144
  s_waitcnt lgkmcnt(7)
  v_mfma_f32_16x16x32_bf16 v[128:131], a[80:83], a[32:35], v[128:131]
  ds_read_b64_tr_b16 a[64:65], v8 offset:16384
  s_add_u32 s65, s70, 384
  v_mfma_f32_16x16x32_bf16 v[128:131], a[84:87], a[48:51], v[128:131]
  ds_read_b64_tr_b16 a[66:67], v8 offset:17408
  s_add_u32 m0, s84, 12288
  v_mfma_f32_16x16x32_bf16 v[132:135], a[84:87], a[52:55], v[132:135]
  buffer_load_dwordx4 v20, s[12:15], s65 offen offset:0 lds
  v_mfma_f32_16x16x32_bf16 v[132:135], a[80:83], a[36:39], v[132:135]
  ds_read_b128 a[16:19], v29 offset:0
  v_mfma_f32_16x16x32_bf16 v[136:139], a[80:83], a[40:43], v[136:139]
  ds_read_b64_tr_b16 a[68:69], v8 offset:24576
  v_mfma_f32_16x16x32_bf16 v[136:139], a[84:87], a[56:59], v[136:139]
  ds_read_b64_tr_b16 a[70:71], v8 offset:25600
  v_mfma_f32_16x16x32_bf16 v[140:143], a[84:87], a[60:63], v[140:143]
  buffer_load_dwordx4 v21, s[12:15], s65 offen offset:1024 lds
  v_mfma_f32_16x16x32_bf16 v[140:143], a[80:83], a[44:47], v[140:143]
  ds_read_b128 a[20:23], v29 offset:2048
  s_waitcnt lgkmcnt(7)
  v_mfma_f32_16x16x32_bf16 v[144:147], a[88:91], a[32:35], v[144:147]
  ds_read_b64_tr_b16 a[72:73], v9 offset:16384
  s_add_u32 s65, s71, 384
  v_mfma_f32_16x16x32_bf16 v[144:147], a[92:95], a[48:51], v[144:147]
  ds_read_b64_tr_b16 a[74:75], v9 offset:17408
  s_add_u32 m0, s84, 14336
  v_mfma_f32_16x16x32_bf16 v[148:151], a[92:95], a[52:55], v[148:151]
  buffer_load_dwordx4 v20, s[12:15], s65 offen offset:0 lds
  v_mfma_f32_16x16x32_bf16 v[148:151], a[88:91], a[36:39], v[148:151]
  ds_read_b128 a[24:27], v29 offset:4096
  v_mfma_f32_16x16x32_bf16 v[152:155], a[88:91], a[40:43], v[152:155]
  ds_read_b64_tr_b16 a[76:77], v9 offset:24576
  v_mfma_f32_16x16x32_bf16 v[152:155], a[92:95], a[56:59], v[152:155]
  ds_read_b64_tr_b16 a[78:79], v9 offset:25600
  v_mfma_f32_16x16x32_bf16 v[156:159], a[92:95], a[60:63], v[156:159]
  buffer_load_dwordx4 v21, s[12:15], s65 offen offset:1024 lds
  v_mfma_f32_16x16x32_bf16 v[156:159], a[88:91], a[44:47], v[156:159]
  ds_read_b128 a[28:31], v29 offset:6144
  s_waitcnt lgkmcnt(7)
  v_mfma_f32_16x16x32_bf16 v[160:163], a[32:35], a[64:67], v[160:163]
  ds_read_b64_tr_b16 a[80:81], v10 offset:16384
  s_add_u32 s65, s76, 1572864
  v_mfma_f32_16x16x32_bf16 v[160:163], a[48:51], a[68:71], v[160:163]
  ds_read_b64_tr_b16 a[82:83], v10 offset:17408
  s_add_u32 m0, s78, 131072
  v_mfma_f32_16x16x32_bf16 v[164:167], a[52:55], a[68:71], v[164:167]
  buffer_load_dwordx4 v2, s[20:23], s65 offen offset:0 lds
  v_mfma_f32_16x16x32_bf16 v[164:167], a[36:39], a[64:67], v[164:167]
  v_mfma_f32_16x16x32_bf16 v[168:171], a[40:43], a[64:67], v[168:171]
  ds_read_b64_tr_b16 a[84:85], v10 offset:24576
  v_mfma_f32_16x16x32_bf16 v[168:171], a[56:59], a[68:71], v[168:171]
  ds_read_b64_tr_b16 a[86:87], v10 offset:25600
  v_mfma_f32_16x16x32_bf16 v[172:175], a[60:63], a[68:71], v[172:175]
  buffer_load_dwordx4 v3, s[20:23], s65 offen offset:1024 lds
  v_mfma_f32_16x16x32_bf16 v[172:175], a[44:47], a[64:67], v[172:175]
  s_waitcnt lgkmcnt(5)
  v_mfma_f32_16x16x32_bf16 v[176:179], a[32:35], a[72:75], v[176:179]
  ds_read_b64_tr_b16 a[88:89], v11 offset:16384
  v_mfma_f32_16x16x32_bf16 v[176:179], a[48:51], a[76:79], v[176:179]
  ds_read_b64_tr_b16 a[90:91], v11 offset:17408
  v_mfma_f32_16x16x32_bf16 v[180:183], a[52:55], a[76:79], v[180:183]
  buffer_load_dwordx4 v4, s[20:23], s65 offen offset:2048 lds
  v_mfma_f32_16x16x32_bf16 v[180:183], a[36:39], a[72:75], v[180:183]
  v_mfma_f32_16x16x32_bf16 v[184:187], a[40:43], a[72:75], v[184:187]
  ds_read_b64_tr_b16 a[92:93], v11 offset:24576
  v_mfma_f32_16x16x32_bf16 v[184:187], a[56:59], a[76:79], v[184:187]
  ds_read_b64_tr_b16 a[94:95], v11 offset:25600
  v_mfma_f32_16x16x32_bf16 v[188:191], a[60:63], a[76:79], v[188:191]
  buffer_load_dwordx4 v5, s[20:23], s65 offen offset:3072 lds
  v_mfma_f32_16x16x32_bf16 v[188:191], a[44:47], a[72:75], v[188:191]
  s_waitcnt lgkmcnt(4)
  v_mfma_f32_16x16x32_bf16 v[192:195], a[32:35], a[80:83], v[192:195]
  ds_read_b64_tr_b16 a[64:65], v12 offset:16384
  v_mfma_f32_16x16x32_bf16 v[192:195], a[48:51], a[84:87], v[192:195]
  ds_read_b64_tr_b16 a[66:67], v12 offset:17408
  s_add_u32 m0, s78, 147456
  v_mfma_f32_16x16x32_bf16 v[196:199], a[52:55], a[84:87], v[196:199]
  buffer_load_dwordx4 v2, s[24:27], s65 offen offset:0 lds
  v_mfma_f32_16x16x32_bf16 v[196:199], a[36:39], a[80:83], v[196:199]
  v_mfma_f32_16x16x32_bf16 v[200:203], a[40:43], a[80:83], v[200:203]
  ds_read_b64_tr_b16 a[68:69], v12 offset:24576
  v_mfma_f32_16x16x32_bf16 v[200:203], a[56:59], a[84:87], v[200:203]
  ds_read_b64_tr_b16 a[70:71], v12 offset:25600
  v_mfma_f32_16x16x32_bf16 v[204:207], a[60:63], a[84:87], v[204:207]
  buffer_load_dwordx4 v3, s[24:27], s65 offen offset:1024 lds
  v_mfma_f32_16x16x32_bf16 v[204:207], a[44:47], a[80:83], v[204:207]
  s_waitcnt lgkmcnt(4)
  v_mfma_f32_16x16x32_bf16 v[208:211], a[32:35], a[88:91], v[208:211]
  ds_read_b64_tr_b16 a[72:73], v13 offset:16384
  v_mfma_f32_16x16x32_bf16 v[208:211], a[48:51], a[92:95], v[208:211]
  ds_read_b64_tr_b16 a[74:75], v13 offset:17408
  v_mfma_f32_16x16x32_bf16 v[212:215], a[52:55], a[92:95], v[212:215]
  buffer_load_dwordx4 v4, s[24:27], s65 offen offset:2048 lds
  v_mfma_f32_16x16x32_bf16 v[212:215], a[36:39], a[88:91], v[212:215]
  v_mfma_f32_16x16x32_bf16 v[216:219], a[40:43], a[88:91], v[216:219]
  ds_read_b64_tr_b16 a[76:77], v13 offset:24576
  v_mfma_f32_16x16x32_bf16 v[216:219], a[56:59], a[92:95], v[216:219]
  ds_read_b64_tr_b16 a[78:79], v13 offset:25600
  v_mfma_f32_16x16x32_bf16 v[220:223], a[60:63], a[92:95], v[220:223]
  buffer_load_dwordx4 v5, s[24:27], s65 offen offset:3072 lds
  v_mfma_f32_16x16x32_bf16 v[220:223], a[44:47], a[88:91], v[220:223]
  s_waitcnt lgkmcnt(4)
  v_mfma_f32_16x16x32_bf16 v[224:227], a[32:35], a[64:67], v[224:227]
  ds_read_b64_tr_b16 a[80:81], v14 offset:16384
  s_add_u32 s65, s68, 512
  v_mfma_f32_16x16x32_bf16 v[224:227], a[48:51], a[68:71], v[224:227]
  ds_read_b64_tr_b16 a[82:83], v14 offset:17408
  s_add_u32 m0, s84, 0
  v_mfma_f32_16x16x32_bf16 v[228:231], a[52:55], a[68:71], v[228:231]
  ds_read_b64_tr_b16 a[84:85], v14 offset:24576
  buffer_load_dwordx4 v20, s[12:15], s65 offen offset:0 lds
  s_cmp_eq_u32 s1, 1
  s_cselect_b32 s90, s92, 0
  v_mfma_f32_16x16x32_bf16 v[228:231], a[36:39], a[64:67], v[228:231]
  ds_read_b64_tr_b16 a[86:87], v14 offset:25600
  buffer_load_dword v26, v24, s[88:91], 0 offen
  v_mfma_f32_16x16x32_bf16 v[232:235], a[40:43], a[64:67], v[232:235]
  ds_read_b64_tr_b16 a[88:89], v15 offset:16384
  v_mfma_f32_16x16x32_bf16 v[232:235], a[56:59], a[68:71], v[232:235]
  ds_read_b64_tr_b16 a[90:91], v15 offset:17408
  v_mfma_f32_16x16x32_bf16 v[236:239], a[60:63], a[68:71], v[236:239]
  ds_read_b64_tr_b16 a[92:93], v15 offset:24576
  buffer_load_dwordx4 v21, s[12:15], s65 offen offset:1024 lds
  v_mfma_f32_16x16x32_bf16 v[236:239], a[44:47], a[64:67], v[236:239]
  ds_read_b64_tr_b16 a[94:95], v15 offset:25600
  s_waitcnt lgkmcnt(8)
  v_mfma_f32_16x16x32_bf16 v[240:243], a[32:35], a[72:75], v[240:243]
  s_add_u32 s65, s69, 512
  v_mfma_f32_16x16x32_bf16 v[240:243], a[48:51], a[76:79], v[240:243]
  s_add_u32 m0, s84, 2048
  v_mfma_f32_16x16x32_bf16 v[244:247], a[52:55], a[76:79], v[244:247]
  buffer_load_dwordx4 v20, s[12:15], s65 offen offset:0 lds
  v_mfma_f32_16x16x32_bf16 v[244:247], a[36:39], a[72:75], v[244:247]
  v_mfma_f32_16x16x32_bf16 v[248:251], a[40:43], a[72:75], v[248:251]
  v_mfma_f32_16x16x32_bf16 v[248:251], a[56:59], a[76:79], v[248:251]
  v_mfma_f32_16x16x32_bf16 v[252:255], a[60:63], a[76:79], v[252:255]
  buffer_load_dwordx4 v21, s[12:15], s65 offen offset:1024 lds
  v_mfma_f32_16x16x32_bf16 v[252:255], a[44:47], a[72:75], v[252:255]
  s_waitcnt lgkmcnt(4)
  s_waitcnt vmcnt(22) lgkmcnt(0)
  s_barrier
  v_mfma_f32_16x16x32_bf16 a[128:131], a[32:35], a[80:83], a[128:131]
  ds_read_b64_tr_b16 a[64:65], v8 offset:32768
  s_add_u32 s65, s70, 512
  v_mfma_f32_16x16x32_bf16 a[128:131], a[48:51], a[84:87], a[128:131]
  ds_read_b64_tr_b16 a[66:67], v8 offset:33792
  s_add_u32 m0, s84, 4096
  v_mfma_f32_16x16x32_bf16 a[132:135], a[52:55], a[84:87], a[132:135]
  buffer_load_dwordx4 v20, s[12:15], s65 offen offset:0 lds
  v_mfma_f32_16x16x32_bf16 a[132:135], a[36:39], a[80:83], a[132:135]
  v_mfma_f32_16x16x32_bf16 a[136:139], a[40:43], a[80:83], a[136:139]
  ds_read_b64_tr_b16 a[68:69], v8 offset:40960
  v_mfma_f32_16x16x32_bf16 a[136:139], a[56:59], a[84:87], a[136:139]
  ds_read_b64_tr_b16 a[70:71], v8 offset:41984
  v_mfma_f32_16x16x32_bf16 a[140:143], a[60:63], a[84:87], a[140:143]
  buffer_load_dwordx4 v21, s[12:15], s65 offen offset:1024 lds
  v_mfma_f32_16x16x32_bf16 a[140:143], a[44:47], a[80:83], a[140:143]
  v_mfma_f32_16x16x32_bf16 a[144:147], a[32:35], a[88:91], a[144:147]
  ds_read_b64_tr_b16 a[72:73], v9 offset:32768
  s_add_u32 s65, s71, 512
  v_mfma_f32_16x16x32_bf16 a[144:147], a[48:51], a[92:95], a[144:147]
  ds_read_b64_tr_b16 a[74:75], v9 offset:33792
  s_add_u32 m0, s84, 6144
  v_mfma_f32_16x16x32_bf16 a[148:151], a[52:55], a[92:95], a[148:151]
  buffer_load_dwordx4 v20, s[12:15], s65 offen offset:0 lds
  v_mfma_f32_16x16x32_bf16 a[148:151], a[36:39], a[88:91], a[148:151]
  v_mfma_f32_16x16x32_bf16 a[152:155], a[40:43], a[88:91], a[152:155]
  ds_read_b64_tr_b16 a[76:77], v9 offset:40960
  v_mfma_f32_16x16x32_bf16 a[152:155], a[56:59], a[92:95], a[152:155]
  ds_read_b64_tr_b16 a[78:79], v9 offset:41984
  v_mfma_f32_16x16x32_bf16 a[156:159], a[60:63], a[92:95], a[156:159]
  buffer_load_dwordx4 v21, s[12:15], s65 offen offset:1024 lds
  v_mfma_f32_16x16x32_bf16 a[156:159], a[44:47], a[88:91], a[156:159]
  s_waitcnt lgkmcnt(4)
  s_waitcnt vmcnt(17)
  v_mfma_f32_16x16x32_bf16 v[32:35], a[64:67], a[0:3], v[32:35]
  ds_read_b64_tr_b16 a[80:81], v10 offset:32768
  v_mfma_f32_16x16x32_bf16 v[32:35], a[68:71], a[16:19], v[32:35]
  ds_read_b64_tr_b16 a[82:83], v10 offset:33792
  v_mfma_f32_16x16x32_bf16 v[36:39], a[68:71], a[20:23], v[36:39]
  v_mfma_f32_16x16x32_bf16 v[36:39], a[64:67], a[4:7], v[36:39]
  ds_read_b128 a[32:35], v28 offset:8192
  v_mfma_f32_16x16x32_bf16 v[40:43], a[64:67], a[8:11], v[40:43]
  ds_read_b64_tr_b16 a[84:85], v10 offset:40960
  v_mfma_f32_16x16x32_bf16 v[40:43], a[68:71], a[24:27], v[40:43]
  ds_read_b64_tr_b16 a[86:87], v10 offset:41984
  v_mfma_f32_16x16x32_bf16 v[44:47], a[68:71], a[28:31], v[44:47]
  v_mfma_f32_16x16x32_bf16 v[44:47], a[64:67], a[12:15], v[44:47]
  ds_read_b128 a[36:39], v28 offset:10240
  s_waitcnt lgkmcnt(6)
  v_mfma_f32_16x16x32_bf16 v[48:51], a[72:75], a[0:3], v[48:51]
  ds_read_b64_tr_b16 a[88:89], v11 offset:32768
  s_add_u32 s65, s76, 2097152
  v_mfma_f32_16x16x32_bf16 v[48:51], a[76:79], a[16:19], v[48:51]
  ds_read_b64_tr_b16 a[90:91], v11 offset:33792
  s_add_u32 m0, s78, 0
  v_mfma_f32_16x16x32_bf16 v[52:55], a[76:79], a[20:23], v[52:55]
  buffer_load_dwordx4 v2, s[20:23], s65 offen offset:0 lds
  v_mfma_f32_16x16x32_bf16 v[52:55], a[72:75], a[4:7], v[52:55]
  ds_read_b128 a[40:43], v28 offset:12288
  v_mfma_f32_16x16x32_bf16 v[56:59], a[72:75], a[8:11], v[56:59]
  ds_read_b64_tr_b16 a[92:93], v11 offset:40960
  v_mfma_f32_16x16x32_bf16 v[56:59], a[76:79], a[24:27], v[56:59]
  ds_read_b64_tr_b16 a[94:95], v11 offset:41984
  v_mfma_f32_16x16x32_bf16 v[60:63], a[76:79], a[28:31], v[60:63]
  buffer_load_dwordx4 v3, s[20:23], s65 offen offset:1024 lds
  v_mfma_f32_16x16x32_bf16 v[60:63], a[72:75], a[12:15], v[60:63]
  ds_read_b128 a[44:47], v28 offset:14336
  s_waitcnt lgkmcnt(7)
  v_mfma_f32_16x16x32_bf16 v[64:67], a[80:83], a[0:3], v[64:67]
  ds_read_b64_tr_b16 a[64:65], v12 offset:32768
  v_mfma_f32_16x16x32_bf16 v[64:67], a[84:87], a[16:19], v[64:67]
  ds_read_b64_tr_b16 a[66:67], v12 offset:33792
  v_mfma_f32_16x16x32_bf16 v[68:71], a[84:87], a[20:23], v[68:71]
  v_mfma_f32_16x16x32_bf16 v[68:71], a[80:83], a[4:7], v[68:71]
  ds_read_b128 a[48:51], v29 offset:8192
  v_mfma_f32_16x16x32_bf16 v[72:75], a[80:83], a[8:11], v[72:75]
  ds_read_b64_tr_b16 a[68:69], v12 offset:40960
  v_mfma_f32_16x16x32_bf16 v[72:75], a[84:87], a[24:27], v[72:75]
  ds_read_b64_tr_b16 a[70:71], v12 offset:41984
  v_mfma_f32_16x16x32_bf16 v[76:79], a[84:87], a[28:31], v[76:79]
  buffer_load_dwordx4 v4, s[20:23], s65 offen offset:2048 lds
  v_mfma_f32_16x16x32_bf16 v[76:79], a[80:83], a[12:15], v[76:79]
  ds_read_b128 a[52:55], v29 offset:10240
  s_waitcnt lgkmcnt(7)
  v_mfma_f32_16x16x32_bf16 v[80:83], a[88:91], a[0:3], v[80:83]
  ds_read_b64_tr_b16 a[72:73], v13 offset:32768
  v_mfma_f32_16x16x32_bf16 v[80:83], a[92:95], a[16:19], v[80:83]
  ds_read_b64_tr_b16 a[74:75], v13 offset:33792
  v_mfma_f32_16x16x32_bf16 v[84:87], a[92:95], a[20:23], v[84:87]
  v_mfma_f32_16x16x32_bf16 v[84:87], a[88:91], a[4:7], v[84:87]
  ds_read_b128 a[56:59], v29 offset:12288
  v_mfma_f32_16x16x32_bf16 v[88:91], a[88:91], a[8:11], v[88:91]
  ds_read_b64_tr_b16 a[76:77], v13 offset:40960
  v_mfma_f32_16x16x32_bf16 v[88:91], a[92:95], a[24:27], v[88:91]
  ds_read_b64_tr_b16 a[78:79], v13 offset:41984
  v_mfma_f32_16x16x32_bf16 v[92:95], a[92:95], a[28:31], v[92:95]
  buffer_load_dwordx4 v5, s[20:23], s65 offen offset:3072 lds
  v_mfma_f32_16x16x32_bf16 v[92:95], a[88:91], a[12:15], v[92:95]
  ds_read_b128 a[60:63], v29 offset:14336
  s_waitcnt lgkmcnt(7)
  v_mfma_f32_16x16x32_bf16 v[96:99], a[64:67], a[0:3], v[96:99]
  ds_read_b64_tr_b16 a[80:81], v14 offset:32768
  v_mfma_f32_16x16x32_bf16 v[96:99], a[68:71], a[16:19], v[96:99]
  ds_read_b64_tr_b16 a[82:83], v14 offset:33792
  s_add_u32 m0, s78, 16384
  v_mfma_f32_16x16x32_bf16 v[100:103], a[68:71], a[20:23], v[100:103]
  buffer_load_dwordx4 v2, s[24:27], s65 offen offset:0 lds
  s_cmp_eq_u32 s1, 2
  s_cselect_b32 s90, s92, 0
  v_mfma_f32_16x16x32_bf16 v[100:103], a[64:67], a[4:7], v[100:103]
  buffer_load_dword v26, v24, s[88:91], 0 offen
  v_mfma_f32_16x16x32_bf16 v[104:107], a[64:67], a[8:11], v[104:107]
  ds_read_b64_tr_b16 a[84:85], v14 offset:40960
  v_mfma_f32_16x16x32_bf16 v[104:107], a[68:71], a[24:27], v[104:107]
  ds_read_b64_tr_b16 a[86:87], v14 offset:41984
  v_mfma_f32_16x16x32_bf16 v[108:111], a[68:71], a[28:31], v[108:111]
  v_mfma_f32_16x16x32_bf16 v[108:111], a[64:67], a[12:15], v[108:111]
  s_waitcnt lgkmcnt(5)
  v_mfma_f32_16x16x32_bf16 v[112:115], a[72:75], a[0:3], v[112:115]
  ds_read_b64_tr_b16 a[88:89], v15 offset:32768
  v_mfma_f32_16x16x32_bf16 v[112:115], a[76:79], a[16:19], v[112:115]
  ds_read_b64_tr_b16 a[90:91], v15 offset:33792
  v_mfma_f32_16x16x32_bf16 v[116:119], a[76:79], a[20:23], v[116:119]
  buffer_load_dwordx4 v3, s[24:27], s65 offen offset:1024 lds
  v_mfma_f32_16x16x32_bf16 v[116:119], a[72:75], a[4:7], v[116:119]
  v_mfma_f32_16x16x32_bf16 v[120:123], a[72:75], a[8:11], v[120:123]
  ds_read_b64_tr_b16 a[92:93], v15 offset:40960
  v_mfma_f32_16x16x32_bf16 v[120:123], a[76:79], a[24:27], v[120:123]
  ds_read_b64_tr_b16 a[94:95], v15 offset:41984
  v_mfma_f32_16x16x32_bf16 v[124:127], a[76:79], a[28:31], v[124:127]
  v_mfma_f32_16x16x32_bf16 v[124:127], a[72:75], a[12:15], v[124:127]
  s_waitcnt lgkmcnt(4)
  v_mfma_f32_16x16x32_bf16 v[128:131], a[80:83], a[0:3], v[128:131]
  ds_read_b64_tr_b16 a[64:65], v8 offset:49152
  v_mfma_f32_16x16x32_bf16 v[128:131], a[84:87], a[16:19], v[128:131]
  ds_read_b64_tr_b16 a[66:67], v8 offset:50176
  v_mfma_f32_16x16x32_bf16 v[132:135], a[84:87], a[20:23], v[132:135]
  buffer_load_dwordx4 v4, s[24:27], s65 offen offset:2048 lds
  v_mfma_f32_16x16x32_bf16 v[132:135], a[80:83], a[4:7], v[132:135]
  v_mfma_f32_16x16x32_bf16 v[136:139], a[80:83], a[8:11], v[136:139]
  ds_read_b64_tr_b16 a[68:69], v8 offset:57344
  v_mfma_f32_16x16x32_bf16 v[136:139], a[84:87], a[24:27], v[136:139]
  ds_read_b64_tr_b16 a[70:71], v8 offset:58368
  v_mfma_f32_16x16x32_bf16 v[140:143], a[84:87], a[28:31], v[140:143]
  buffer_load_dwordx4 v5, s[24:27], s65 offen offset:3072 lds
  v_mfma_f32_16x16x32_bf16 v[140:143], a[80:83], a[12:15], v[140:143]
  s_waitcnt lgkmcnt(4)
  v_mfma_f32_16x16x32_bf16 v[144:147], a[88:91], a[0:3], v[144:147]
  ds_read_b64_tr_b16 a[72:73], v9 offset:49152
  v_mfma_f32_16x16x32_bf16 v[144:147], a[92:95], a[16:19], v[144:147]
  ds_read_b64_tr_b16 a[74:75], v9 offset:50176
  v_mfma_f32_16x16x32_bf16 v[148:151], a[92:95], a[20:23], v[148:151]
  v_mfma_f32_16x16x32_bf16 v[148:151], a[88:91], a[4:7], v[148:151]
  v_mfma_f32_16x16x32_bf16 v[152:155], a[88:91], a[8:11], v[152:155]
  ds_read_b64_tr_b16 a[76:77], v9 offset:57344
  v_mfma_f32_16x16x32_bf16 v[152:155], a[92:95], a[24:27], v[152:155]
  ds_read_b64_tr_b16 a[78:79], v9 offset:58368
  v_mfma_f32_16x16x32_bf16 v[156:159], a[92:95], a[28:31], v[156:159]
  s_or_b32 s63, s2, s60
  s_cbranch_scc1 Lnoinit2
  v_mov_b32 v22, 1
  s_mov_b64 exec, 1
  buffer_store_dword v22, off, s[48:51], 0 offset:128 sc1
  s_mov_b64 exec, -1
Lnoinit2:
  v_mfma_f32_16x16x32_bf16 v[156:159], a[88:91], a[12:15], v[156:159]
  s_waitcnt lgkmcnt(4)
  v_mfma_f32_16x16x32_bf16 v[160:163], a[0:3], a[64:67], v[160:163]
  ds_read_b64_tr_b16 a[80:81], v10 offset:49152
  v_mfma_f32_16x16x32_bf16 v[160:163], a[16:19], a[68:71], v[160:163]
  ds_read_b64_tr_b16 a[82:83], v10 offset:50176
  v_mfma_f32_16x16x32_bf16 v[164:167], a[20:23], a[68:71], v[164:167]
  v_mfma_f32_16x16x32_bf16 v[164:167], a[4:7], a[64:67], v[164:167]
  v_mfma_f32_16x16x32_bf16 v[168:171], a[8:11], a[64:67], v[168:171]
  ds_read_b64_tr_b16 a[84:85], v10 offset:57344
  s_add_u32 s65, s68, 640
  v_mfma_f32_16x16x32_bf16 v[168:171], a[24:27], a[68:71], v[168:171]
  ds_read_b64_tr_b16 a[86:87], v10 offset:58368
  s_add_u32 m0, s84, 8192
  v_mfma_f32_16x16x32_bf16 v[172:175], a[28:31], a[68:71], v[172:175]
  buffer_load_dwordx4 v20, s[12:15], s65 offen offset:0 lds
  v_mfma_f32_16x16x32_bf16 v[172:175], a[12:15], a[64:67], v[172:175]
  s_waitcnt lgkmcnt(4)
  v_mfma_f32_16x16x32_bf16 v[176:179], a[0:3], a[72:75], v[176:179]
  ds_read_b64_tr_b16 a[88:89], v11 offset:49152
  v_mfma_f32_16x16x32_bf16 v[176:179], a[16:19], a[76:79], v[176:179]
  ds_read_b64_tr_b16 a[90:91], v11 offset:50176
  v_mfma_f32_16x16x32_bf16 v[180:183], a[20:23], a[76:79], v[180:183]
  buffer_load_dwordx4 v21, s[12:15], s65 offen offset:1024 lds
  v_mfma_f32_16x16x32_bf16 v[180:183], a[4:7], a[72:75], v[180:183]
  v_mfma_f32_16x16x32_bf16 v[184:187], a[8:11], a[72:75], v[184:187]
  ds_read_b64_tr_b16 a[92:93], v11 offset:57344
  v_mfma_f32_16x16x32_bf16 v[184:187], a[24:27], a[76:79], v[184:187]
  ds_read_b64_tr_b16 a[94:95], v11 offset:58368
  v_mfma_f32_16x16x32_bf16 v[188:191], a[28:31], a[76:79], v[188:191]
  v_mfma_f32_16x16x32_bf16 v[188:191], a[12:15], a[72:75], v[188:191]
  s_waitcnt lgkmcnt(4)
  v_mfma_f32_16x16x32_bf16 v[192:195], a[0:3], a[80:83], v[192:195]
  ds_read_b64_tr_b16 a[64:65], v12 offset:49152
  s_add_u32 s65, s69, 640
  v_mfma_f32_16x16x32_bf16 v[192:195], a[16:19], a[84:87], v[192:195]
  ds_read_b64_tr_b16 a[66:67], v12 offset:50176
  s_add_u32 m0, s84, 10240
  v_mfma_f32_16x16x32_bf16 v[196:199], a[20:23], a[84:87], v[196:199]
  buffer_load_dwordx4 v20, s[12:15], s65 offen offset:0 lds
  v_mfma_f32_16x16x32_bf16 v[196:199], a[4:7], a[80:83], v[196:199]
  v_mfma_f32_16x16x32_bf16 v[200:203], a[8:11], a[80:83], v[200:203]
  ds_read_b64_tr_b16 a[68:69], v12 offset:57344
  v_mfma_f32_16x16x32_bf16 v[200:203], a[24:27], a[84:87], v[200:203]
  ds_read_b64_tr_b16 a[70:71], v12 offset:58368
  v_mfma_f32_16x16x32_bf16 v[204:207], a[28:31], a[84:87], v[204:207]
  v_mfma_f32_16x16x32_bf16 v[204:207], a[12:15], a[80:83], v[204:207]
  s_waitcnt lgkmcnt(4)
  v_mfma_f32_16x16x32_bf16 v[208:211], a[0:3], a[88:91], v[208:211]
  ds_read_b64_tr_b16 a[72:73], v13 offset:49152
  v_mfma_f32_16x16x32_bf16 v[208:211], a[16:19], a[92:95], v[208:211]
  ds_read_b64_tr_b16 a[74:75], v13 offset:50176
  v_mfma_f32_16x16x32_bf16 v[212:215], a[20:23], a[92:95], v[212:215]
  buffer_load_dwordx4 v21, s[12:15], s65 offen offset:1024 lds
  v_mfma_f32_16x16x32_bf16 v[212:215], a[4:7], a[88:91], v[212:215]
  v_mfma_f32_16x16x32_bf16 v[216:219], a[8:11], a[88:91], v[216:219]
  ds_read_b64_tr_b16 a[76:77], v13 offset:57344
  s_add_u32 s65, s70, 640
  v_mfma_f32_16x16x32_bf16 v[216:219], a[24:27], a[92:95], v[216:219]
  ds_read_b64_tr_b16 a[78:79], v13 offset:58368
  s_add_u32 m0, s84, 12288
  v_mfma_f32_16x16x32_bf16 v[220:223], a[28:31], a[92:95], v[220:223]
  buffer_load_dwordx4 v20, s[12:15], s65 offen offset:0 lds
  v_mfma_f32_16x16x32_bf16 v[220:223], a[12:15], a[88:91], v[220:223]
  s_waitcnt lgkmcnt(4)
  v_mfma_f32_16x16x32_bf16 v[224:227], a[0:3], a[64:67], v[224:227]
  ds_read_b64_tr_b16 a[80:81], v14 offset:49152
  v_mfma_f32_16x16x32_bf16 v[224:227], a[16:19], a[68:71], v[224:227]
  ds_read_b64_tr_b16 a[82:83], v14 offset:50176
  v_mfma_f32_16x16x32_bf16 v[228:231], a[20:23], a[68:71], v[228:231]
  ds_read_b64_tr_b16 a[84:85], v14 offset:57344
  s_cmp_eq_u32 s1, 3
  s_cselect_b32 s90, s92, 0
  v_mfma_f32_16x16x32_bf16 v[228:231], a[4:7], a[64:67], v[228:231]
  ds_read_b64_tr_b16 a[86:87], v14 offset:58368
  buffer_load_dword v26, v24, s[88:91], 0 offen
  v_mfma_f32_16x16x32_bf16 v[232:235], a[8:11], a[64:67], v[232:235]
  ds_read_b64_tr_b16 a[88:89], v15 offset:49152
  v_mfma_f32_16x16x32_bf16 v[232:235], a[24:27], a[68:71], v[232:235]
  ds_read_b64_tr_b16 a[90:91], v15 offset:50176
  v_mfma_f32_16x16x32_bf16 v[236:239], a[28:31], a[68:71], v[236:239]
  ds_read_b64_tr_b16 a[92:93], v15 offset:57344
  v_mfma_f32_16x16x32_bf16 v[236:239], a[12:15], a[64:67], v[236:239]
  ds_read_b64_tr_b16 a[94:95], v15 offset:58368
  s_waitcnt lgkmcnt(8)
  v_mfma_f32_16x16x32_bf16 v[240:243], a[0:3], a[72:75], v[240:243]
  v_mfma_f32_16x16x32_bf16 v[240:243], a[16:19], a[76:79], v[240:243]
  v_mfma_f32_16x16x32_bf16 v[244:247], a[20:23], a[76:79], v[244:247]
  buffer_load_dwordx4 v21, s[12:15], s65 offen offset:1024 lds
  v_mfma_f32_16x16x32_bf16 v[244:247], a[4:7], a[72:75], v[244:247]
  v_mfma_f32_16x16x32_bf16 v[248:251], a[8:11], a[72:75], v[248:251]
  s_add_u32 s65, s71, 640
  v_mfma_f32_16x16x32_bf16 v[248:251], a[24:27], a[76:79], v[248:251]
  s_add_u32 m0, s84, 14336
  v_mfma_f32_16x16x32_bf16 v[252:255], a[28:31], a[76:79], v[252:255]
  buffer_load_dwordx4 v20, s[12:15], s65 offen offset:0 lds
  v_mfma_f32_16x16x32_bf16 v[252:255], a[12:15], a[72:75], v[252:255]
  s_waitcnt lgkmcnt(4)
  v_add_u32 v8, 0x20000, v8
  s_waitcnt vmcnt(26) lgkmcnt(0)
  s_barrier
  v_mfma_f32_16x16x32_bf16 a[128:131], a[0:3], a[80:83], a[128:131]
  ds_read_b64_tr_b16 a[64:65], v8 offset:0
  v_mfma_f32_16x16x32_bf16 a[128:131], a[16:19], a[84:87], a[128:131]
  ds_read_b64_tr_b16 a[66:67], v8 offset:1024
  v_mfma_f32_16x16x32_bf16 a[132:135], a[20:23], a[84:87], a[132:135]
  v_mfma_f32_16x16x32_bf16 a[132:135], a[4:7], a[80:83], a[132:135]
  v_mfma_f32_16x16x32_bf16 a[136:139], a[8:11], a[80:83], a[136:139]
  ds_read_b64_tr_b16 a[68:69], v8 offset:8192
  v_mfma_f32_16x16x32_bf16 a[136:139], a[24:27], a[84:87], a[136:139]
  ds_read_b64_tr_b16 a[70:71], v8 offset:9216
  v_mfma_f32_16x16x32_bf16 a[140:143], a[28:31], a[84:87], a[140:143]
  buffer_load_dwordx4 v21, s[12:15], s65 offen offset:1024 lds
  v_mfma_f32_16x16x32_bf16 a[140:143], a[12:15], a[80:83], a[140:143]
  v_add_u32 v9, 0x20000, v9
  v_mfma_f32_16x16x32_bf16 a[144:147], a[0:3], a[88:91], a[144:147]
  ds_read_b64_tr_b16 a[72:73], v9 offset:0
  v_mfma_f32_16x16x32_bf16 a[144:147], a[16:19], a[92:95], a[144:147]
  ds_read_b64_tr_b16 a[74:75], v9 offset:1024
  v_mfma_f32_16x16x32_bf16 a[148:151], a[20:23], a[92:95], a[148:151]
  v_mfma_f32_16x16x32_bf16 a[148:151], a[4:7], a[88:91], a[148:151]
  v_mfma_f32_16x16x32_bf16 a[152:155], a[8:11], a[88:91], a[152:155]
  ds_read_b64_tr_b16 a[76:77], v9 offset:8192
  v_mfma_f32_16x16x32_bf16 a[152:155], a[24:27], a[92:95], a[152:155]
  ds_read_b64_tr_b16 a[78:79], v9 offset:9216
  v_mfma_f32_16x16x32_bf16 a[156:159], a[28:31], a[92:95], a[156:159]
  v_mfma_f32_16x16x32_bf16 a[156:159], a[12:15], a[88:91], a[156:159]
  s_waitcnt lgkmcnt(4)
  v_add_u32 v10, 0x20000, v10
  s_waitcnt vmcnt(18)
  v_mfma_f32_16x16x32_bf16 v[32:35], a[64:67], a[32:35], v[32:35]
  ds_read_b64_tr_b16 a[80:81], v10 offset:0
  s_add_u32 s65, s76, 2621440
  v_mfma_f32_16x16x32_bf16 v[32:35], a[68:71], a[48:51], v[32:35]
  ds_read_b64_tr_b16 a[82:83], v10 offset:1024
  s_add_u32 m0, s78, 32768
  v_mfma_f32_16x16x32_bf16 v[36:39], a[68:71], a[52:55], v[36:39]
  buffer_load_dwordx4 v2, s[20:23], s65 offen offset:0 lds
  v_mfma_f32_16x16x32_bf16 v[36:39], a[64:67], a[36:39], v[36:39]
  ds_read_b128 a[0:3], v28 offset:0
  v_mfma_f32_16x16x32_bf16 v[40:43], a[64:67], a[40:43], v[40:43]
  ds_read_b64_tr_b16 a[84:85], v10 offset:8192
  v_mfma_f32_16x16x32_bf16 v[40:43], a[68:71], a[56:59], v[40:43]
  ds_read_b64_tr_b16 a[86:87], v10 offset:9216
  v_mfma_f32_16x16x32_bf16 v[44:47], a[68:71], a[60:63], v[44:47]
  buffer_load_dwordx4 v3, s[20:23], s65 offen offset:1024 lds
  v_mfma_f32_16x16x32_bf16 v[44:47], a[64:67], a[44:47], v[44:47]
  ds_read_b128 a[4:7], v28 offset:2048
  s_waitcnt lgkmcnt(6)
  v_add_u32 v11, 0x20000, v11
  v_mfma_f32_16x16x32_bf16 v[48:51], a[72:75], a[32:35], v[48:51]
  ds_read_b64_tr_b16 a[88:89], v11 offset:0
  v_mfma_f32_16x16x32_bf16 v[48:51], a[76:79], a[48:51], v[48:51]
  ds_read_b64_tr_b16 a[90:91], v11 offset:1024
  v_mfma_f32_16x16x32_bf16 v[52:55], a[76:79], a[52:55], v[52:55]
  v_mfma_f32_16x16x32_bf16 v[52:55], a[72:75], a[36:39], v[52:55]
  ds_read_b128 a[8:11], v28 offset:4096
  v_mfma_f32_16x16x32_bf16 v[56:59], a[72:75], a[40:43], v[56:59]
  ds_read_b64_tr_b16 a[92:93], v11 offset:8192
  v_mfma_f32_16x16x32_bf16 v[56:59], a[76:79], a[56:59], v[56:59]
  ds_read_b64_tr_b16 a[94:95], v11 offset:9216
  v_mfma_f32_16x16x32_bf16 v[60:63], a[76:79], a[60:63], v[60:63]
  buffer_load_dwordx4 v4, s[20:23], s65 offen offset:2048 lds
  v_mfma_f32_16x16x32_bf16 v[60:63], a[72:75], a[44:47], v[60:63]
  ds_read_b128 a[12:15], v28 offset:6144
  s_waitcnt lgkmcnt(7)
  v_add_u32 v12, 0x20000, v12
  v_mfma_f32_16x16x32_bf16 v[64:67], a[80:83], a[32:35], v[64:67]
  ds_read_b64_tr_b16 a[64:65], v12 offset:0
  v_mfma_f32_16x16x32_bf16 v[64:67], a[84:87], a[48:51], v[64:67]
  ds_read_b64_tr_b16 a[66:67], v12 offset:1024
  v_mfma_f32_16x16x32_bf16 v[68:71], a[84:87], a[52:55], v[68:71]
  v_mfma_f32_16x16x32_bf16 v[68:71], a[80:83], a[36:39], v[68:71]
  ds_read_b128 a[16:19], v29 offset:0
  v_mfma_f32_16x16x32_bf16 v[72:75], a[80:83], a[40:43], v[72:75]
  ds_read_b64_tr_b16 a[68:69], v12 offset:8192
  v_mfma_f32_16x16x32_bf16 v[72:75], a[84:87], a[56:59], v[72:75]
  ds_read_b64_tr_b16 a[70:71], v12 offset:9216
  v_mfma_f32_16x16x32_bf16 v[76:79], a[84:87], a[60:63], v[76:79]
  buffer_load_dwordx4 v5, s[20:23], s65 offen offset:3072 lds
  v_mfma_f32_16x16x32_bf16 v[76:79], a[80:83], a[44:47], v[76:79]
  ds_read_b128 a[20:23], v29 offset:2048
  s_waitcnt lgkmcnt(7)
  v_add_u32 v13, 0x20000, v13
  v_mfma_f32_16x16x32_bf16 v[80:83], a[88:91], a[32:35], v[80:83]
  ds_read_b64_tr_b16 a[72:73], v13 offset:0
  v_mfma_f32_16x16x32_bf16 v[80:83], a[92:95], a[48:51], v[80:83]
  ds_read_b64_tr_b16 a[74:75], v13 offset:1024
  s_add_u32 m0, s78, 49152
  v_mfma_f32_16x16x32_bf16 v[84:87], a[92:95], a[52:55], v[84:87]
  buffer_load_dwordx4 v2, s[24:27], s65 offen offset:0 lds
  v_mfma_f32_16x16x32_bf16 v[84:87], a[88:91], a[36:39], v[84:87]
  ds_read_b128 a[24:27], v29 offset:4096
  v_mfma_f32_16x16x32_bf16 v[88:91], a[88:91], a[40:43], v[88:91]
  ds_read_b64_tr_b16 a[76:77], v13 offset:8192
  v_mfma_f32_16x16x32_bf16 v[88:91], a[92:95], a[56:59], v[88:91]
  ds_read_b64_tr_b16 a[78:79], v13 offset:9216
  v_mfma_f32_16x16x32_bf16 v[92:95], a[92:95], a[60:63], v[92:95]
  v_mfma_f32_16x16x32_bf16 v[92:95], a[88:91], a[44:47], v[92:95]
  ds_read_b128 a[28:31], v29 offset:6144
  s_waitcnt lgkmcnt(7)
  v_add_u32 v14, 0x20000, v14
  v_mfma_f32_16x16x32_bf16 v[96:99], a[64:67], a[32:35], v[96:99]
  ds_read_b64_tr_b16 a[80:81], v14 offset:0
  v_mfma_f32_16x16x32_bf16 v[96:99], a[68:71], a[48:51], v[96:99]
  ds_read_b64_tr_b16 a[82:83], v14 offset:1024
  v_mfma_f32_16x16x32_bf16 v[100:103], a[68:71], a[52:55], v[100:103]
  buffer_load_dwordx4 v3, s[24:27], s65 offen offset:1024 lds
  s_cmp_eq_u32 s1, 4
  s_cselect_b32 s90, s92, 0
  v_mfma_f32_16x16x32_bf16 v[100:103], a[64:67], a[36:39], v[100:103]
  buffer_load_dword v26, v24, s[88:91], 0 offen
  v_mfma_f32_16x16x32_bf16 v[104:107], a[64:67], a[40:43], v[104:107]
  ds_read_b64_tr_b16 a[84:85], v14 offset:8192
  v_mfma_f32_16x16x32_bf16 v[104:107], a[68:71], a[56:59], v[104:107]
  ds_read_b64_tr_b16 a[86:87], v14 offset:9216
  v_mfma_f32_16x16x32_bf16 v[108:111], a[68:71], a[60:63], v[108:111]
  v_mfma_f32_16x16x32_bf16 v[108:111], a[64:67], a[44:47], v[108:111]
  s_waitcnt lgkmcnt(5)
  v_add_u32 v15, 0x20000, v15
  v_mfma_f32_16x16x32_bf16 v[112:115], a[72:75], a[32:35], v[112:115]
  ds_read_b64_tr_b16 a[88:89], v15 offset:0
  v_mfma_f32_16x16x32_bf16 v[112:115], a[76:79], a[48:51], v[112:115]
  ds_read_b64_tr_b16 a[90:91], v15 offset:1024
  v_mfma_f32_16x16x32_bf16 v[116:119], a[76:79], a[52:55], v[116:119]
  buffer_load_dwordx4 v4, s[24:27], s65 offen offset:2048 lds
  v_mfma_f32_16x16x32_bf16 v[116:119], a[72:75], a[36:39], v[116:119]
  v_mfma_f32_16x16x32_bf16 v[120:123], a[72:75], a[40:43], v[120:123]
  ds_read_b64_tr_b16 a[92:93], v15 offset:8192
  v_mfma_f32_16x16x32_bf16 v[120:123], a[76:79], a[56:59], v[120:123]
  ds_read_b64_tr_b16 a[94:95], v15 offset:9216
  v_mfma_f32_16x16x32_bf16 v[124:127], a[76:79], a[60:63], v[124:127]
  buffer_load_dwordx4 v5, s[24:27], s65 offen offset:3072 lds
  v_mfma_f32_16x16x32_bf16 v[124:127], a[72:75], a[44:47], v[124:127]
  s_waitcnt lgkmcnt(4)
  v_mfma_f32_16x16x32_bf16 v[128:131], a[80:83], a[32:35], v[128:131]
  ds_read_b64_tr_b16 a[64:65], v8 offset:16384
  v_mfma_f32_16x16x32_bf16 v[128:131], a[84:87], a[48:51], v[128:131]
  ds_read_b64_tr_b16 a[66:67], v8 offset:17408
  v_mfma_f32_16x16x32_bf16 v[132:135], a[84:87], a[52:55], v[132:135]
  v_mfma_f32_16x16x32_bf16 v[132:135], a[80:83], a[36:39], v[132:135]
  v_mfma_f32_16x16x32_bf16 v[136:139], a[80:83], a[40:43], v[136:139]
  ds_read_b64_tr_b16 a[68:69], v8 offset:24576
  v_lshrrev_b32 v22, 5, v1
  v_mfma_f32_16x16x32_bf16 v[136:139], a[84:87], a[56:59], v[136:139]
  ds_read_b64_tr_b16 a[70:71], v8 offset:25600
  v_and_b32 v22, 24, v22
  s_lshl_b32 s64, s61, 7
  v_mfma_f32_16x16x32_bf16 v[140:143], a[84:87], a[60:63], v[140:143]
  buffer_load_dwordx2 a[96:97], v22, s[52:55], s64 offen offset:0
  v_mfma_f32_16x16x32_bf16 v[140:143], a[80:83], a[44:47], v[140:143]
  s_waitcnt lgkmcnt(4)
  v_mfma_f32_16x16x32_bf16 v[144:147], a[88:91], a[32:35], v[144:147]
  ds_read_b64_tr_b16 a[72:73], v9 offset:16384
  v_mfma_f32_16x16x32_bf16 v[144:147], a[92:95], a[48:51], v[144:147]
  ds_read_b64_tr_b16 a[74:75], v9 offset:17408
  v_mfma_f32_16x16x32_bf16 v[148:151], a[92:95], a[52:55], v[148:151]
  v_mfma_f32_16x16x32_bf16 v[148:151], a[88:91], a[36:39], v[148:151]
  v_mfma_f32_16x16x32_bf16 v[152:155], a[88:91], a[40:43], v[152:155]
  ds_read_b64_tr_b16 a[76:77], v9 offset:24576
  v_mfma_f32_16x16x32_bf16 v[152:155], a[92:95], a[56:59], v[152:155]
  ds_read_b64_tr_b16 a[78:79], v9 offset:25600
  v_mfma_f32_16x16x32_bf16 v[156:159], a[92:95], a[60:63], v[156:159]
  buffer_load_dwordx2 a[98:99], v22, s[52:55], s64 offen offset:32
  v_mfma_f32_16x16x32_bf16 v[156:159], a[88:91], a[44:47], v[156:159]
  s_waitcnt lgkmcnt(4)
  v_mfma_f32_16x16x32_bf16 v[160:163], a[32:35], a[64:67], v[160:163]
  ds_read_b64_tr_b16 a[80:81], v10 offset:16384
  v_mfma_f32_16x16x32_bf16 v[160:163], a[48:51], a[68:71], v[160:163]
  ds_read_b64_tr_b16 a[82:83], v10 offset:17408
  v_mfma_f32_16x16x32_bf16 v[164:167], a[52:55], a[68:71], v[164:167]
  buffer_load_dwordx2 a[100:101], v22, s[52:55], s64 offen offset:64
  v_mfma_f32_16x16x32_bf16 v[164:167], a[36:39], a[64:67], v[164:167]
  v_mfma_f32_16x16x32_bf16 v[168:171], a[40:43], a[64:67], v[168:171]
  ds_read_b64_tr_b16 a[84:85], v10 offset:24576
  v_mfma_f32_16x16x32_bf16 v[168:171], a[56:59], a[68:71], v[168:171]
  ds_read_b64_tr_b16 a[86:87], v10 offset:25600
  v_mfma_f32_16x16x32_bf16 v[172:175], a[60:63], a[68:71], v[172:175]
  v_mfma_f32_16x16x32_bf16 v[172:175], a[44:47], a[64:67], v[172:175]
  s_waitcnt lgkmcnt(4)
  v_mfma_f32_16x16x32_bf16 v[176:179], a[32:35], a[72:75], v[176:179]
  ds_read_b64_tr_b16 a[88:89], v11 offset:16384
  v_mfma_f32_16x16x32_bf16 v[176:179], a[48:51], a[76:79], v[176:179]
  ds_read_b64_tr_b16 a[90:91], v11 offset:17408
  v_mfma_f32_16x16x32_bf16 v[180:183], a[52:55], a[76:79], v[180:183]
  buffer_load_dwordx2 a[102:103], v22, s[52:55], s64 offen offset:96
  v_mfma_f32_16x16x32_bf16 v[180:183], a[36:39], a[72:75], v[180:183]
  v_mfma_f32_16x16x32_bf16 v[184:187], a[40:43], a[72:75], v[184:187]
  ds_read_b64_tr_b16 a[92:93], v11 offset:24576
  v_mfma_f32_16x16x32_bf16 v[184:187], a[56:59], a[76:79], v[184:187]
  ds_read_b64_tr_b16 a[94:95], v11 offset:25600
  v_mfma_f32_16x16x32_bf16 v[188:191], a[60:63], a[76:79], v[188:191]
  v_mfma_f32_16x16x32_bf16 v[188:191], a[44:47], a[72:75], v[188:191]
  s_waitcnt lgkmcnt(4)
  v_mfma_f32_16x16x32_bf16 v[192:195], a[32:35], a[80:83], v[192:195]
  ds_read_b64_tr_b16 a[64:65], v12 offset:16384
  s_add_u32 s65, s68, 768
  v_mfma_f32_16x16x32_bf16 v[192:195], a[48:51], a[84:87], v[192:195]
  ds_read_b64_tr_b16 a[66:67], v12 offset:17408
  s_add_u32 m0, s84, 0
  v_mfma_f32_16x16x32_bf16 v[196:199], a[52:55], a[84:87], v[196:199]
  buffer_load_dwordx4 v20, s[12:15], s65 offen offset:0 lds
  v_mfma_f32_16x16x32_bf16 v[196:199], a[36:39], a[80:83], v[196:199]
  v_mfma_f32_16x16x32_bf16 v[200:203], a[40:43], a[80:83], v[200:203]
  ds_read_b64_tr_b16 a[68:69], v12 offset:24576
  v_mfma_f32_16x16x32_bf16 v[200:203], a[56:59], a[84:87], v[200:203]
  ds_read_b64_tr_b16 a[70:71], v12 offset:25600
  v_mfma_f32_16x16x32_bf16 v[204:207], a[60:63], a[84:87], v[204:207]
  buffer_load_dwordx4 v21, s[12:15], s65 offen offset:1024 lds
  v_mfma_f32_16x16x32_bf16 v[204:207], a[44:47], a[80:83], v[204:207]
  s_waitcnt lgkmcnt(4)
  v_mfma_f32_16x16x32_bf16 v[208:211], a[32:35], a[88:91], v[208:211]
  ds_read_b64_tr_b16 a[72:73], v13 offset:16384
  v_mfma_f32_16x16x32_bf16 v[208:211], a[48:51], a[92:95], v[208:211]
  ds_read_b64_tr_b16 a[74:75], v13 offset:17408
  v_mfma_f32_16x16x32_bf16 v[212:215], a[52:55], a[92:95], v[212:215]
  v_mfma_f32_16x16x32_bf16 v[212:215], a[36:39], a[88:91], v[212:215]
  v_mfma_f32_16x16x32_bf16 v[216:219], a[40:43], a[88:91], v[216:219]
  ds_read_b64_tr_b16 a[76:77], v13 offset:24576
  s_add_u32 s65, s69, 768
  v_mfma_f32_16x16x32_bf16 v[216:219], a[56:59], a[92:95], v[216:219]
  ds_read_b64_tr_b16 a[78:79], v13 offset:25600
  s_add_u32 m0, s84, 2048
  v_mfma_f32_16x16x32_bf16 v[220:223], a[60:63], a[92:95], v[220:223]
  buffer_load_dwordx4 v20, s[12:15], s65 offen offset:0 lds
  v_mfma_f32_16x16x32_bf16 v[220:223], a[44:47], a[88:91], v[220:223]
  s_waitcnt lgkmcnt(4)
  v_mfma_f32_16x16x32_bf16 v[224:227], a[32:35], a[64:67], v[224:227]
  ds_read_b64_tr_b16 a[80:81], v14 offset:16384
  v_mfma_f32_16x16x32_bf16 v[224:227], a[48:51], a[68:71], v[224:227]
  ds_read_b64_tr_b16 a[82:83], v14 offset:17408
  v_mfma_f32_16x16x32_bf16 v[228:231], a[52:55], a[68:71], v[228:231]
  ds_read_b64_tr_b16 a[84:85], v14 offset:24576
  s_cmp_eq_u32 s1, 5
  s_cselect_b32 s90, s92, 0
  v_mfma_f32_16x16x32_bf16 v[228:231], a[36:39], a[64:67], v[228:231]
  ds_read_b64_tr_b16 a[86:87], v14 offset:25600
  buffer_load_dword v26, v24, s[88:91], 0 offen
  v_mfma_f32_16x16x32_bf16 v[232:235], a[40:43], a[64:67], v[232:235]
  ds_read_b64_tr_b16 a[88:89], v15 offset:16384
  v_mfma_f32_16x16x32_bf16 v[232:235], a[56:59], a[68:71], v[232:235]
  ds_read_b64_tr_b16 a[90:91], v15 offset:17408
  v_mfma_f32_16x16x32_bf16 v[236:239], a[60:63], a[68:71], v[236:239]
  ds_read_b64_tr_b16 a[92:93], v15 offset:24576
  v_mfma_f32_16x16x32_bf16 v[236:239], a[44:47], a[64:67], v[236:239]
  ds_read_b64_tr_b16 a[94:95], v15 offset:25600
  s_waitcnt lgkmcnt(8)
  v_mfma_f32_16x16x32_bf16 v[240:243], a[32:35], a[72:75], v[240:243]
  v_mfma_f32_16x16x32_bf16 v[240:243], a[48:51], a[76:79], v[240:243]
  v_mfma_f32_16x16x32_bf16 v[244:247], a[52:55], a[76:79], v[244:247]
  buffer_load_dwordx4 v21, s[12:15], s65 offen offset:1024 lds
  v_mfma_f32_16x16x32_bf16 v[244:247], a[36:39], a[72:75], v[244:247]
  v_mfma_f32_16x16x32_bf16 v[248:251], a[40:43], a[72:75], v[248:251]
  s_add_u32 s65, s70, 768
  v_mfma_f32_16x16x32_bf16 v[248:251], a[56:59], a[76:79], v[248:251]
  s_add_u32 m0, s84, 4096
  v_mfma_f32_16x16x32_bf16 v[252:255], a[60:63], a[76:79], v[252:255]
  buffer_load_dwordx4 v20, s[12:15], s65 offen offset:0 lds
  v_mfma_f32_16x16x32_bf16 v[252:255], a[44:47], a[72:75], v[252:255]
  s_waitcnt lgkmcnt(4)
  v_add_u32 v8, 0xfffe0000, v8
  s_waitcnt vmcnt(28) lgkmcnt(0)
  s_barrier
  v_mfma_f32_16x16x32_bf16 a[128:131], a[32:35], a[80:83], a[128:131]
  ds_read_b64_tr_b16 a[64:65], v8 offset:0
  v_mfma_f32_16x16x32_bf16 a[128:131], a[48:51], a[84:87], a[128:131]
  ds_read_b64_tr_b16 a[66:67], v8 offset:1024
  v_mfma_f32_16x16x32_bf16 a[132:135], a[52:55], a[84:87], a[132:135]
  buffer_load_dwordx4 v21, s[12:15], s65 offen offset:1024 lds
  v_mfma_f32_16x16x32_bf16 a[132:135], a[36:39], a[80:83], a[132:135]
  v_mfma_f32_16x16x32_bf16 a[136:139], a[40:43], a[80:83], a[136:139]
  ds_read_b64_tr_b16 a[68:69], v8 offset:8192
  s_add_u32 s65, s71, 768
  v_mfma_f32_16x16x32_bf16 a[136:139], a[56:59], a[84:87], a[136:139]
  ds_read_b64_tr_b16 a[70:71], v8 offset:9216
  s_add_u32 m0, s84, 6144
  v_mfma_f32_16x16x32_bf16 a[140:143], a[60:63], a[84:87], a[140:143]
  buffer_load_dwordx4 v20, s[12:15], s65 offen offset:0 lds
  v_mfma_f32_16x16x32_bf16 a[140:143], a[44:47], a[80:83], a[140:143]
  v_add_u32 v9, 0xfffe0000, v9
  v_mfma_f32_16x16x32_bf16 a[144:147], a[32:35], a[88:91], a[144:147]
  ds_read_b64_tr_b16 a[72:73], v9 offset:0
  v_mfma_f32_16x16x32_bf16 a[144:147], a[48:51], a[92:95], a[144:147]
  ds_read_b64_tr_b16 a[74:75], v9 offset:1024
  v_mfma_f32_16x16x32_bf16 a[148:151], a[52:55], a[92:95], a[148:151]
  buffer_load_dwordx4 v21, s[12:15], s65 offen offset:1024 lds
  v_mfma_f32_16x16x32_bf16 a[148:151], a[36:39], a[88:91], a[148:151]
  v_mfma_f32_16x16x32_bf16 a[152:155], a[40:43], a[88:91], a[152:155]
  ds_read_b64_tr_b16 a[76:77], v9 offset:8192
  v_mfma_f32_16x16x32_bf16 a[152:155], a[56:59], a[92:95], a[152:155]
  ds_read_b64_tr_b16 a[78:79], v9 offset:9216
  v_mfma_f32_16x16x32_bf16 a[156:159], a[60:63], a[92:95], a[156:159]
  v_mfma_f32_16x16x32_bf16 a[156:159], a[44:47], a[88:91], a[156:159]
  s_waitcnt lgkmcnt(4)
  v_add_u32 v10, 0xfffe0000, v10
  s_waitcnt vmcnt(22)
  v_mfma_f32_16x16x32_bf16 v[32:35], a[64:67], a[0:3], v[32:35]
  ds_read_b64_tr_b16 a[80:81], v10 offset:0
  v_mfma_f32_16x16x32_bf16 v[32:35], a[68:71], a[16:19], v[32:35]
  ds_read_b64_tr_b16 a[82:83], v10 offset:1024
  v_mfma_f32_16x16x32_bf16 v[36:39], a[68:71], a[20:23], v[36:39]
  v_mfma_f32_16x16x32_bf16 v[36:39], a[64:67], a[4:7], v[36:39]
  ds_read_b128 a[32:35], v28 offset:8192
  v_mfma_f32_16x16x32_bf16 v[40:43], a[64:67], a[8:11], v[40:43]
  ds_read_b64_tr_b16 a[84:85], v10 offset:8192
  v_mfma_f32_16x16x32_bf16 v[40:43], a[68:71], a[24:27], v[40:43]
  ds_read_b64_tr_b16 a[86:87], v10 offset:9216
  v_mfma_f32_16x16x32_bf16 v[44:47], a[68:71], a[28:31], v[44:47]
  v_mfma_f32_16x16x32_bf16 v[44:47], a[64:67], a[12:15], v[44:47]
  ds_read_b128 a[36:39], v28 offset:10240
  s_waitcnt lgkmcnt(6)
  v_add_u32 v11, 0xfffe0000, v11
  v_mfma_f32_16x16x32_bf16 v[48:51], a[72:75], a[0:3], v[48:51]
  ds_read_b64_tr_b16 a[88:89], v11 offset:0
  s_add_u32 s65, s76, 3145728
  v_mfma_f32_16x16x32_bf16 v[48:51], a[76:79], a[16:19], v[48:51]
  ds_read_b64_tr_b16 a[90:91], v11 offset:1024
  s_add_u32 m0, s78, 131072
  v_mfma_f32_16x16x32_bf16 v[52:55], a[76:79], a[20:23], v[52:55]
  buffer_load_dwordx4 v2, s[20:23], s65 offen offset:0 lds
  v_mfma_f32_16x16x32_bf16 v[52:55], a[72:75], a[4:7], v[52:55]
  ds_read_b128 a[40:43], v28 offset:12288
  v_mfma_f32_16x16x32_bf16 v[56:59], a[72:75], a[8:11], v[56:59]
  ds_read_b64_tr_b16 a[92:93], v11 offset:8192
  v_mfma_f32_16x16x32_bf16 v[56:59], a[76:79], a[24:27], v[56:59]
  ds_read_b64_tr_b16 a[94:95], v11 offset:9216
  v_mfma_f32_16x16x32_bf16 v[60:63], a[76:79], a[28:31], v[60:63]
  buffer_load_dwordx4 v3, s[20:23], s65 offen offset:1024 lds
  v_mfma_f32_16x16x32_bf16 v[60:63], a[72:75], a[12:15], v[60:63]
  ds_read_b128 a[44:47], v28 offset:14336
  s_waitcnt lgkmcnt(7)
  v_add_u32 v12, 0xfffe0000, v12
  v_mfma_f32_16x16x32_bf16 v[64:67], a[80:83], a[0:3], v[64:67]
  ds_read_b64_tr_b16 a[64:65], v12 offset:0
  v_mfma_f32_16x16x32_bf16 v[64:67], a[84:87], a[16:19], v[64:67]
  ds_read_b64_tr_b16 a[66:67], v12 offset:1024
  v_mfma_f32_16x16x32_bf16 v[68:71], a[84:87], a[20:23], v[68:71]
  v_mfma_f32_16x16x32_bf16 v[68:71], a[80:83], a[4:7], v[68:71]
  ds_read_b128 a[48:51], v29 offset:8192
  v_mfma_f32_16x16x32_bf16 v[72:75], a[80:83], a[8:11], v[72:75]
  ds_read_b64_tr_b16 a[68:69], v12 offset:8192
  v_mfma_f32_16x16x32_bf16 v[72:75], a[84:87], a[24:27], v[72:75]
  ds_read_b64_tr_b16 a[70:71], v12 offset:9216
  v_mfma_f32_16x16x32_bf16 v[76:79], a[84:87], a[28:31], v[76:79]
  buffer_load_dwordx4 v4, s[20:23], s65 offen offset:2048 lds
  v_mfma_f32_16x16x32_bf16 v[76:79], a[80:83], a[12:15], v[76:79]
  ds_read_b128 a[52:55], v29 offset:10240
  s_waitcnt lgkmcnt(7)
  v_add_u32 v13, 0xfffe0000, v13
  v_mfma_f32_16x16x32_bf16 v[80:83], a[88:91], a[0:3], v[80:83]
  ds_read_b64_tr_b16 a[72:73], v13 offset:0
  v_mfma_f32_16x16x32_bf16 v[80:83], a[92:95], a[16:19], v[80:83]
  ds_read_b64_tr_b16 a[74:75], v13 offset:1024
  v_mfma_f32_16x16x32_bf16 v[84:87], a[92:95], a[20:23], v[84:87]
  v_mfma_f32_16x16x32_bf16 v[84:87], a[88:91], a[4:7], v[84:87]
  ds_read_b128 a[56:59], v29 offset:12288
  v_mfma_f32_16x16x32_bf16 v[88:91], a[88:91], a[8:11], v[88:91]
  ds_read_b64_tr_b16 a[76:77], v13 offset:8192
  v_mfma_f32_16x16x32_bf16 v[88:91], a[92:95], a[24:27], v[88:91]
  ds_read_b64_tr_b16 a[78:79], v13 offset:9216
  v_mfma_f32_16x16x32_bf16 v[92:95], a[92:95], a[28:31], v[92:95]
  buffer_load_dwordx4 v5, s[20:23], s65 offen offset:3072 lds
  v_mfma_f32_16x16x32_bf16 v[92:95], a[88:91], a[12:15], v[92:95]
  ds_read_b128 a[60:63], v29 offset:14336
  s_waitcnt lgkmcnt(7)
  v_add_u32 v14, 0xfffe0000, v14
  v_mfma_f32_16x16x32_bf16 v[96:99], a[64:67], a[0:3], v[96:99]
  ds_read_b64_tr_b16 a[80:81], v14 offset:0
  v_mfma_f32_16x16x32_bf16 v[96:99], a[68:71], a[16:19], v[96:99]
  ds_read_b64_tr_b16 a[82:83], v14 offset:1024
  s_add_u32 m0, s78, 147456
  v_mfma_f32_16x16x32_bf16 v[100:103], a[68:71], a[20:23], v[100:103]
  buffer_load_dwordx4 v2, s[24:27], s65 offen offset:0 lds
  s_cmp_eq_u32 s1, 6
  s_cselect_b32 s90, s92, 0
  v_mfma_f32_16x16x32_bf16 v[100:103], a[64:67], a[4:7], v[100:103]
  buffer_load_dword v26, v24, s[88:91], 0 offen
  v_mfma_f32_16x16x32_bf16 v[104:107], a[64:67], a[8:11], v[104:107]
  ds_read_b64_tr_b16 a[84:85], v14 offset:8192
  v_mfma_f32_16x16x32_bf16 v[104:107], a[68:71], a[24:27], v[104:107]
  ds_read_b64_tr_b16 a[86:87], v14 offset:9216
  v_mfma_f32_16x16x32_bf16 v[108:111], a[68:71], a[28:31], v[108:111]
  v_mfma_f32_16x16x32_bf16 v[108:111], a[64:67], a[12:15], v[108:111]
  s_waitcnt lgkmcnt(5)
  v_add_u32 v15, 0xfffe0000, v15
  v_mfma_f32_16x16x32_bf16 v[112:115], a[72:75], a[0:3], v[112:115]
  ds_read_b64_tr_b16 a[88:89], v15 offset:0
  v_mfma_f32_16x16x32_bf16 v[112:115], a[76:79], a[16:19], v[112:115]
  ds_read_b64_tr_b16 a[90:91], v15 offset:1024
  v_mfma_f32_16x16x32_bf16 v[116:119], a[76:79], a[20:23], v[116:119]
  buffer_load_dwordx4 v3, s[24:27], s65 offen offset:1024 lds
  v_mfma_f32_16x16x32_bf16 v[116:119], a[72:75], a[4:7], v[116:119]
  v_mfma_f32_16x16x32_bf16 v[120:123], a[72:75], a[8:11], v[120:123]
  ds_read_b64_tr_b16 a[92:93], v15 offset:8192
  v_mfma_f32_16x16x32_bf16 v[120:123], a[76:79], a[24:27], v[120:123]
  ds_read_b64_tr_b16 a[94:95], v15 offset:9216
  v_mfma_f32_16x16x32_bf16 v[124:127], a[76:79], a[28:31], v[124:127]
  v_mfma_f32_16x16x32_bf16 v[124:127], a[72:75], a[12:15], v[124:127]
  s_waitcnt lgkmcnt(4)
  v_mfma_f32_16x16x32_bf16 v[128:131], a[80:83], a[0:3], v[128:131]
  ds_read_b64_tr_b16 a[64:65], v8 offset:16384
  v_mfma_f32_16x16x32_bf16 v[128:131], a[84:87], a[16:19], v[128:131]
  ds_read_b64_tr_b16 a[66:67], v8 offset:17408
  v_mfma_f32_16x16x32_bf16 v[132:135], a[84:87], a[20:23], v[132:135]
  buffer_load_dwordx4 v4, s[24:27], s65 offen offset:2048 lds
  v_mfma_f32_16x16x32_bf16 v[132:135], a[80:83], a[4:7], v[132:135]
  v_mfma_f32_16x16x32_bf16 v[136:139], a[80:83], a[8:11], v[136:139]
  ds_read_b64_tr_b16 a[68:69], v8 offset:24576
  v_mfma_f32_16x16x32_bf16 v[136:139], a[84:87], a[24:27], v[136:139]
  ds_read_b64_tr_b16 a[70:71], v8 offset:25600
  v_mfma_f32_16x16x32_bf16 v[140:143], a[84:87], a[28:31], v[140:143]
  buffer_load_dwordx4 v5, s[24:27], s65 offen offset:3072 lds
  v_mfma_f32_16x16x32_bf16 v[140:143], a[80:83], a[12:15], v[140:143]
  s_waitcnt lgkmcnt(4)
  v_mfma_f32_16x16x32_bf16 v[144:147], a[88:91], a[0:3], v[144:147]
  ds_read_b64_tr_b16 a[72:73], v9 offset:16384
  v_mfma_f32_16x16x32_bf16 v[144:147], a[92:95], a[16:19], v[144:147]
  ds_read_b64_tr_b16 a[74:75], v9 offset:17408
  v_mfma_f32_16x16x32_bf16 v[148:151], a[92:95], a[20:23], v[148:151]
  v_mfma_f32_16x16x32_bf16 v[148:151], a[88:91], a[4:7], v[148:151]
  v_mfma_f32_16x16x32_bf16 v[152:155], a[88:91], a[8:11], v[152:155]
  ds_read_b64_tr_b16 a[76:77], v9 offset:24576
  s_lshl_b32 s63, s61, 2
  s_add_u32 s63, s63, s60
  s_and_b32 s63, s63, 63
  s_lshl_b32 s63, s63, 11
  v_mfma_f32_16x16x32_bf16 v[152:155], a[92:95], a[24:27], v[152:155]
  ds_read_b64_tr_b16 a[78:79], v9 offset:25600
  s_sub_u32 s64, 15, s62
  s_cmp_ge_u32 s61, 16
  s_cselect_b32 s64, s64, s62
  s_lshl_b32 s64, s64, 17
  s_add_u32 s7, s63, s64
  v_mfma_f32_16x16x32_bf16 v[156:159], a[92:95], a[28:31], v[156:159]
  buffer_load_dwordx4 a[104:107], v1, s[56:59], 0 offen
  v_mfma_f32_16x16x32_bf16 v[156:159], a[88:91], a[12:15], v[156:159]
  s_waitcnt lgkmcnt(4)
  v_mfma_f32_16x16x32_bf16 v[160:163], a[0:3], a[64:67], v[160:163]
  ds_read_b64_tr_b16 a[80:81], v10 offset:16384
  v_mfma_f32_16x16x32_bf16 v[160:163], a[16:19], a[68:71], v[160:163]
  ds_read_b64_tr_b16 a[82:83], v10 offset:17408
  v_mfma_f32_16x16x32_bf16 v[164:167], a[20:23], a[68:71], v[164:167]
  v_mfma_f32_16x16x32_bf16 v[164:167], a[4:7], a[64:67], v[164:167]
  v_mfma_f32_16x16x32_bf16 v[168:171], a[8:11], a[64:67], v[168:171]
  ds_read_b64_tr_b16 a[84:85], v10 offset:24576
  v_mfma_f32_16x16x32_bf16 v[168:171], a[24:27], a[68:71], v[168:171]
  ds_read_b64_tr_b16 a[86:87], v10 offset:25600
  v_mfma_f32_16x16x32_bf16 v[172:175], a[28:31], a[68:71], v[172:175]
  buffer_load_dwordx4 a[108:111], v1, s[8:11], s7 offen
  v_mfma_f32_16x16x32_bf16 v[172:175], a[12:15], a[64:67], v[172:175]
  s_waitcnt lgkmcnt(4)
  v_mfma_f32_16x16x32_bf16 v[176:179], a[0:3], a[72:75], v[176:179]
  ds_read_b64_tr_b16 a[88:89], v11 offset:16384
  v_mfma_f32_16x16x32_bf16 v[176:179], a[16:19], a[76:79], v[176:179]
  ds_read_b64_tr_b16 a[90:91], v11 offset:17408
  v_mfma_f32_16x16x32_bf16 v[180:183], a[20:23], a[76:79], v[180:183]
  buffer_load_dwordx4 a[112:115], v1, s[8:11], s7 offen offset:1024
  v_mfma_f32_16x16x32_bf16 v[180:183], a[4:7], a[72:75], v[180:183]
  v_mfma_f32_16x16x32_bf16 v[184:187], a[8:11], a[72:75], v[184:187]
  ds_read_b64_tr_b16 a[92:93], v11 offset:24576
  v_mfma_f32_16x16x32_bf16 v[184:187], a[24:27], a[76:79], v[184:187]
  ds_read_b64_tr_b16 a[94:95], v11 offset:25600
  v_mfma_f32_16x16x32_bf16 v[188:191], a[28:31], a[76:79], v[188:191]
  v_mfma_f32_16x16x32_bf16 v[188:191], a[12:15], a[72:75], v[188:191]
  s_waitcnt lgkmcnt(4)
  v_mfma_f32_16x16x32_bf16 v[192:195], a[0:3], a[80:83], v[192:195]
  ds_read_b64_tr_b16 a[64:65], v12 offset:16384
  s_add_u32 s65, s68, 896
  v_mfma_f32_16x16x32_bf16 v[192:195], a[16:19], a[84:87], v[192:195]
  ds_read_b64_tr_b16 a[66:67], v12 offset:17408
  s_add_u32 m0, s84, 8192
  v_mfma_f32_16x16x32_bf16 v[196:199], a[20:23], a[84:87], v[196:199]
  buffer_load_dwordx4 v20, s[12:15], s65 offen offset:0 lds
  v_mfma_f32_16x16x32_bf16 v[196:199], a[4:7], a[80:83], v[196:199]
  v_mfma_f32_16x16x32_bf16 v[200:203], a[8:11], a[80:83], v[200:203]
  ds_read_b64_tr_b16 a[68:69], v12 offset:24576
  v_mfma_f32_16x16x32_bf16 v[200:203], a[24:27], a[84:87], v[200:203]
  ds_read_b64_tr_b16 a[70:71], v12 offset:25600
  v_mfma_f32_16x16x32_bf16 v[204:207], a[28:31], a[84:87], v[204:207]
  v_mfma_f32_16x16x32_bf16 v[204:207], a[12:15], a[80:83], v[204:207]
  s_waitcnt lgkmcnt(4)
  v_mfma_f32_16x16x32_bf16 v[208:211], a[0:3], a[88:91], v[208:211]
  ds_read_b64_tr_b16 a[72:73], v13 offset:16384
  v_mfma_f32_16x16x32_bf16 v[208:211], a[16:19], a[92:95], v[208:211]
  ds_read_b64_tr_b16 a[74:75], v13 offset:17408
  v_mfma_f32_16x16x32_bf16 v[212:215], a[20:23], a[92:95], v[212:215]
  buffer_load_dwordx4 v21, s[12:15], s65 offen offset:1024 lds
  v_mfma_f32_16x16x32_bf16 v[212:215], a[4:7], a[88:91], v[212:215]
  v_mfma_f32_16x16x32_bf16 v[216:219], a[8:11], a[88:91], v[216:219]
  ds_read_b64_tr_b16 a[76:77], v13 offset:24576
  s_add_u32 s65, s69, 896
  v_mfma_f32_16x16x32_bf16 v[216:219], a[24:27], a[92:95], v[216:219]
  ds_read_b64_tr_b16 a[78:79], v13 offset:25600
  s_add_u32 m0, s84, 10240
  v_mfma_f32_16x16x32_bf16 v[220:223], a[28:31], a[92:95], v[220:223]
  buffer_load_dwordx4 v20, s[12:15], s65 offen offset:0 lds
  v_mfma_f32_16x16x32_bf16 v[220:223], a[12:15], a[88:91], v[220:223]
  s_waitcnt lgkmcnt(4)
  v_mfma_f32_16x16x32_bf16 v[224:227], a[0:3], a[64:67], v[224:227]
  ds_read_b64_tr_b16 a[80:81], v14 offset:16384
  v_mfma_f32_16x16x32_bf16 v[224:227], a[16:19], a[68:71], v[224:227]
  ds_read_b64_tr_b16 a[82:83], v14 offset:17408
  v_mfma_f32_16x16x32_bf16 v[228:231], a[20:23], a[68:71], v[228:231]
  ds_read_b64_tr_b16 a[84:85], v14 offset:24576
  s_cmp_eq_u32 s1, 7
  s_cselect_b32 s90, s92, 0
  v_mfma_f32_16x16x32_bf16 v[228:231], a[4:7], a[64:67], v[228:231]
  ds_read_b64_tr_b16 a[86:87], v14 offset:25600
  buffer_load_dword v26, v24, s[88:91], 0 offen
  v_mfma_f32_16x16x32_bf16 v[232:235], a[8:11], a[64:67], v[232:235]
  ds_read_b64_tr_b16 a[88:89], v15 offset:16384
  v_mfma_f32_16x16x32_bf16 v[232:235], a[24:27], a[68:71], v[232:235]
  ds_read_b64_tr_b16 a[90:91], v15 offset:17408
  v_mfma_f32_16x16x32_bf16 v[236:239], a[28:31], a[68:71], v[236:239]
  ds_read_b64_tr_b16 a[92:93], v15 offset:24576
  v_mfma_f32_16x16x32_bf16 v[236:239], a[12:15], a[64:67], v[236:239]
  ds_read_b64_tr_b16 a[94:95], v15 offset:25600
  s_waitcnt lgkmcnt(8)
  v_mfma_f32_16x16x32_bf16 v[240:243], a[0:3], a[72:75], v[240:243]
  v_mfma_f32_16x16x32_bf16 v[240:243], a[16:19], a[76:79], v[240:243]
  v_mfma_f32_16x16x32_bf16 v[244:247], a[20:23], a[76:79], v[244:247]
  buffer_load_dwordx4 v21, s[12:15], s65 offen offset:1024 lds
  v_mfma_f32_16x16x32_bf16 v[244:247], a[4:7], a[72:75], v[244:247]
  v_mfma_f32_16x16x32_bf16 v[248:251], a[8:11], a[72:75], v[248:251]
  s_add_u32 s65, s70, 896
  v_mfma_f32_16x16x32_bf16 v[248:251], a[24:27], a[76:79], v[248:251]
  s_add_u32 m0, s84, 12288
  v_mfma_f32_16x16x32_bf16 v[252:255], a[28:31], a[76:79], v[252:255]
  buffer_load_dwordx4 v20, s[12:15], s65 offen offset:0 lds
  v_mfma_f32_16x16x32_bf16 v[252:255], a[12:15], a[72:75], v[252:255]
  s_waitcnt lgkmcnt(4)
  s_waitcnt vmcnt(31) lgkmcnt(0)
  s_barrier
  v_mfma_f32_16x16x32_bf16 a[128:131], a[0:3], a[80:83], a[128:131]
  ds_read_b64_tr_b16 a[64:65], v8 offset:32768
  v_mfma_f32_16x16x32_bf16 a[128:131], a[16:19], a[84:87], a[128:131]
  ds_read_b64_tr_b16 a[66:67], v8 offset:33792
  v_mfma_f32_16x16x32_bf16 a[132:135], a[20:23], a[84:87], a[132:135]
  buffer_load_dwordx4 v21, s[12:15], s65 offen offset:1024 lds
  v_mfma_f32_16x16x32_bf16 a[132:135], a[4:7], a[80:83], a[132:135]
  v_mfma_f32_16x16x32_bf16 a[136:139], a[8:11], a[80:83], a[136:139]
  ds_read_b64_tr_b16 a[68:69], v8 offset:40960
  s_add_u32 s65, s71, 896
  v_mfma_f32_16x16x32_bf16 a[136:139], a[24:27], a[84:87], a[136:139]
  ds_read_b64_tr_b16 a[70:71], v8 offset:41984
  s_add_u32 m0, s84, 14336
  v_mfma_f32_16x16x32_bf16 a[140:143], a[28:31], a[84:87], a[140:143]
  buffer_load_dwordx4 v20, s[12:15], s65 offen offset:0 lds
  v_mfma_f32_16x16x32_bf16 a[140:143], a[12:15], a[80:83], a[140:143]
  v_mfma_f32_16x16x32_bf16 a[144:147], a[0:3], a[88:91], a[144:147]
  ds_read_b64_tr_b16 a[72:73], v9 offset:32768
  v_mfma_f32_16x16x32_bf16 a[144:147], a[16:19], a[92:95], a[144:147]
  ds_read_b64_tr_b16 a[74:75], v9 offset:33792
  v_mfma_f32_16x16x32_bf16 a[148:151], a[20:23], a[92:95], a[148:151]
  buffer_load_dwordx4 v21, s[12:15], s65 offen offset:1024 lds
  v_mfma_f32_16x16x32_bf16 a[148:151], a[4:7], a[88:91], a[148:151]
  v_mfma_f32_16x16x32_bf16 a[152:155], a[8:11], a[88:91], a[152:155]
  ds_read_b64_tr_b16 a[76:77], v9 offset:40960
  v_mfma_f32_16x16x32_bf16 a[152:155], a[24:27], a[92:95], a[152:155]
  ds_read_b64_tr_b16 a[78:79], v9 offset:41984
  v_mfma_f32_16x16x32_bf16 a[156:159], a[28:31], a[92:95], a[156:159]
  v_mfma_f32_16x16x32_bf16 a[156:159], a[12:15], a[88:91], a[156:159]
  s_waitcnt lgkmcnt(4)
  s_waitcnt vmcnt(21)
  v_mfma_f32_16x16x32_bf16 v[32:35], a[64:67], a[32:35], v[32:35]
  ds_read_b64_tr_b16 a[80:81], v10 offset:32768
  v_mfma_f32_16x16x32_bf16 v[32:35], a[68:71], a[48:51], v[32:35]
  ds_read_b64_tr_b16 a[82:83], v10 offset:33792
  v_mfma_f32_16x16x32_bf16 v[36:39], a[68:71], a[52:55], v[36:39]
  v_mfma_f32_16x16x32_bf16 v[36:39], a[64:67], a[36:39], v[36:39]
  ds_read_b128 a[0:3], v28 offset:0
  v_mfma_f32_16x16x32_bf16 v[40:43], a[64:67], a[40:43], v[40:43]
  ds_read_b64_tr_b16 a[84:85], v10 offset:40960
  v_mfma_f32_16x16x32_bf16 v[40:43], a[68:71], a[56:59], v[40:43]
  ds_read_b64_tr_b16 a[86:87], v10 offset:41984
  v_mfma_f32_16x16x32_bf16 v[44:47], a[68:71], a[60:63], v[44:47]
  v_mfma_f32_16x16x32_bf16 v[44:47], a[64:67], a[44:47], v[44:47]
  ds_read_b128 a[4:7], v28 offset:2048
  s_waitcnt lgkmcnt(6)
  v_mfma_f32_16x16x32_bf16 v[48:51], a[72:75], a[32:35], v[48:51]
  ds_read_b64_tr_b16 a[88:89], v11 offset:32768
  s_add_u32 s65, s76, 3670016
  v_mfma_f32_16x16x32_bf16 v[48:51], a[76:79], a[48:51], v[48:51]
  ds_read_b64_tr_b16 a[90:91], v11 offset:33792
  s_add_u32 m0, s78, 0
  v_mfma_f32_16x16x32_bf16 v[52:55], a[76:79], a[52:55], v[52:55]
  buffer_load_dwordx4 v2, s[20:23], s65 offen offset:0 lds
  v_mfma_f32_16x16x32_bf16 v[52:55], a[72:75], a[36:39], v[52:55]
  ds_read_b128 a[8:11], v28 offset:4096
  v_mfma_f32_16x16x32_bf16 v[56:59], a[72:75], a[40:43], v[56:59]
  ds_read_b64_tr_b16 a[92:93], v11 offset:40960
  v_mfma_f32_16x16x32_bf16 v[56:59], a[76:79], a[56:59], v[56:59]
  ds_read_b64_tr_b16 a[94:95], v11 offset:41984
  v_mfma_f32_16x16x32_bf16 v[60:63], a[76:79], a[60:63], v[60:63]
  buffer_load_dwordx4 v3, s[20:23], s65 offen offset:1024 lds
  v_mfma_f32_16x16x32_bf16 v[60:63], a[72:75], a[44:47], v[60:63]
  ds_read_b128 a[12:15], v28 offset:6144
  s_waitcnt lgkmcnt(7)
  v_mfma_f32_16x16x32_bf16 v[64:67], a[80:83], a[32:35], v[64:67]
  ds_read_b64_tr_b16 a[64:65], v12 offset:32768
  v_mfma_f32_16x16x32_bf16 v[64:67], a[84:87], a[48:51], v[64:67]
  ds_read_b64_tr_b16 a[66:67], v12 offset:33792
  v_mfma_f32_16x16x32_bf16 v[68:71], a[84:87], a[52:55], v[68:71]
  v_mfma_f32_16x16x32_bf16 v[68:71], a[80:83], a[36:39], v[68:71]
  ds_read_b128 a[16:19], v29 offset:0
  v_mfma_f32_16x16x32_bf16 v[72:75], a[80:83], a[40:43], v[72:75]
  ds_read_b64_tr_b16 a[68:69], v12 offset:40960
  v_mfma_f32_16x16x32_bf16 v[72:75], a[84:87], a[56:59], v[72:75]
  ds_read_b64_tr_b16 a[70:71], v12 offset:41984
  v_mfma_f32_16x16x32_bf16 v[76:79], a[84:87], a[60:63], v[76:79]
  buffer_load_dwordx4 v4, s[20:23], s65 offen offset:2048 lds
  v_mfma_f32_16x16x32_bf16 v[76:79], a[80:83], a[44:47], v[76:79]
  ds_read_b128 a[20:23], v29 offset:2048
  s_waitcnt lgkmcnt(7)
  v_mfma_f32_16x16x32_bf16 v[80:83], a[88:91], a[32:35], v[80:83]
  ds_read_b64_tr_b16 a[72:73], v13 offset:32768
  v_mfma_f32_16x16x32_bf16 v[80:83], a[92:95], a[48:51], v[80:83]
  ds_read_b64_tr_b16 a[74:75], v13 offset:33792
  v_mfma_f32_16x16x32_bf16 v[84:87], a[92:95], a[52:55], v[84:87]
  v_mfma_f32_16x16x32_bf16 v[84:87], a[88:91], a[36:39], v[84:87]
  ds_read_b128 a[24:27], v29 offset:4096
  v_mfma_f32_16x16x32_bf16 v[88:91], a[88:91], a[40:43], v[88:91]
  ds_read_b64_tr_b16 a[76:77], v13 offset:40960
  v_mfma_f32_16x16x32_bf16 v[88:91], a[92:95], a[56:59], v[88:91]
  ds_read_b64_tr_b16 a[78:79], v13 offset:41984
  v_mfma_f32_16x16x32_bf16 v[92:95], a[92:95], a[60:63], v[92:95]
  buffer_load_dwordx4 v5, s[20:23], s65 offen offset:3072 lds
  v_mfma_f32_16x16x32_bf16 v[92:95], a[88:91], a[44:47], v[92:95]
  ds_read_b128 a[28:31], v29 offset:6144
  s_waitcnt lgkmcnt(7)
  v_mfma_f32_16x16x32_bf16 v[96:99], a[64:67], a[32:35], v[96:99]
  ds_read_b64_tr_b16 a[80:81], v14 offset:32768
  v_mfma_f32_16x16x32_bf16 v[96:99], a[68:71], a[48:51], v[96:99]
  ds_read_b64_tr_b16 a[82:83], v14 offset:33792
  s_add_u32 m0, s78, 16384
  v_mfma_f32_16x16x32_bf16 v[100:103], a[68:71], a[52:55], v[100:103]
  buffer_load_dwordx4 v2, s[24:27], s65 offen offset:0 lds
  v_mfma_f32_16x16x32_bf16 v[100:103], a[64:67], a[36:39], v[100:103]
  v_mfma_f32_16x16x32_bf16 v[104:107], a[64:67], a[40:43], v[104:107]
  ds_read_b64_tr_b16 a[84:85], v14 offset:40960
  v_mfma_f32_16x16x32_bf16 v[104:107], a[68:71], a[56:59], v[104:107]
  ds_read_b64_tr_b16 a[86:87], v14 offset:41984
  v_mfma_f32_16x16x32_bf16 v[108:111], a[68:71], a[60:63], v[108:111]
  v_mfma_f32_16x16x32_bf16 v[108:111], a[64:67], a[44:47], v[108:111]
  s_waitcnt lgkmcnt(5)
  v_mfma_f32_16x16x32_bf16 v[112:115], a[72:75], a[32:35], v[112:115]
  ds_read_b64_tr_b16 a[88:89], v15 offset:32768
  v_mfma_f32_16x16x32_bf16 v[112:115], a[76:79], a[48:51], v[112:115]
  ds_read_b64_tr_b16 a[90:91], v15 offset:33792
  v_mfma_f32_16x16x32_bf16 v[116:119], a[76:79], a[52:55], v[116:119]
  buffer_load_dwordx4 v3, s[24:27], s65 offen offset:1024 lds
  v_mfma_f32_16x16x32_bf16 v[116:119], a[72:75], a[36:39], v[116:119]
  v_mfma_f32_16x16x32_bf16 v[120:123], a[72:75], a[40:43], v[120:123]
  ds_read_b64_tr_b16 a[92:93], v15 offset:40960
  v_mfma_f32_16x16x32_bf16 v[120:123], a[76:79], a[56:59], v[120:123]
  ds_read_b64_tr_b16 a[94:95], v15 offset:41984
  v_mfma_f32_16x16x32_bf16 v[124:127], a[76:79], a[60:63], v[124:127]
  v_mfma_f32_16x16x32_bf16 v[124:127], a[72:75], a[44:47], v[124:127]
  s_waitcnt lgkmcnt(4)
  v_mfma_f32_16x16x32_bf16 v[128:131], a[80:83], a[32:35], v[128:131]
  ds_read_b64_tr_b16 a[64:65], v8 offset:49152
  v_mfma_f32_16x16x32_bf16 v[128:131], a[84:87], a[48:51], v[128:131]
  ds_read_b64_tr_b16 a[66:67], v8 offset:50176
  v_mfma_f32_16x16x32_bf16 v[132:135], a[84:87], a[52:55], v[132:135]
  buffer_load_dwordx4 v4, s[24:27], s65 offen offset:2048 lds
  v_mfma_f32_16x16x32_bf16 v[132:135], a[80:83], a[36:39], v[132:135]
  v_mfma_f32_16x16x32_bf16 v[136:139], a[80:83], a[40:43], v[136:139]
  ds_read_b64_tr_b16 a[68:69], v8 offset:57344
  v_mfma_f32_16x16x32_bf16 v[136:139], a[84:87], a[56:59], v[136:139]
  ds_read_b64_tr_b16 a[70:71], v8 offset:58368
  v_mfma_f32_16x16x32_bf16 v[140:143], a[84:87], a[60:63], v[140:143]
  buffer_load_dwordx4 v5, s[24:27], s65 offen offset:3072 lds
  v_mfma_f32_16x16x32_bf16 v[140:143], a[80:83], a[44:47], v[140:143]
  s_waitcnt lgkmcnt(4)
  v_mfma_f32_16x16x32_bf16 v[144:147], a[88:91], a[32:35], v[144:147]
  ds_read_b64_tr_b16 a[72:73], v9 offset:49152
  v_mfma_f32_16x16x32_bf16 v[144:147], a[92:95], a[48:51], v[144:147]
  ds_read_b64_tr_b16 a[74:75], v9 offset:50176
  v_mfma_f32_16x16x32_bf16 v[148:151], a[92:95], a[52:55], v[148:151]
  v_mfma_f32_16x16x32_bf16 v[148:151], a[88:91], a[36:39], v[148:151]
  v_mfma_f32_16x16x32_bf16 v[152:155], a[88:91], a[40:43], v[152:155]
  ds_read_b64_tr_b16 a[76:77], v9 offset:57344
  s_mov_b64 s[56:57], s[32:33]
  v_mfma_f32_16x16x32_bf16 v[152:155], a[92:95], a[56:59], v[152:155]
  ds_read_b64_tr_b16 a[78:79], v9 offset:58368
  s_cmp_ge_u32 s61, 28
  s_cselect_b32 s58, 0, s34
  v_mfma_f32_16x16x32_bf16 v[156:159], a[92:95], a[60:63], v[156:159]
  buffer_load_dword v25, off, s[48:51], 0 offset:128 sc1
  v_mfma_f32_16x16x32_bf16 v[156:159], a[88:91], a[44:47], v[156:159]
  s_waitcnt lgkmcnt(4)
  v_mfma_f32_16x16x32_bf16 v[160:163], a[32:35], a[64:67], v[160:163]
  ds_read_b64_tr_b16 a[80:81], v10 offset:49152
  v_mfma_f32_16x16x32_bf16 v[160:163], a[48:51], a[68:71], v[160:163]
  ds_read_b64_tr_b16 a[82:83], v10 offset:50176
  v_mfma_f32_16x16x32_bf16 v[164:167], a[52:55], a[68:71], v[164:167]
  v_mfma_f32_16x16x32_bf16 v[164:167], a[36:39], a[64:67], v[164:167]
  v_mfma_f32_16x16x32_bf16 v[168:171], a[40:43], a[64:67], v[168:171]
  ds_read_b64_tr_b16 a[84:85], v10 offset:57344
  s_add_u32 s65, s72, 0
  v_mfma_f32_16x16x32_bf16 v[168:171], a[56:59], a[68:71], v[168:171]
  ds_read_b64_tr_b16 a[86:87], v10 offset:58368
  s_add_u32 m0, s84, 0
  v_mfma_f32_16x16x32_bf16 v[172:175], a[60:63], a[68:71], v[172:175]
  buffer_load_dwordx4 v20, s[8:11], s65 offen offset:0 lds
  v_mfma_f32_16x16x32_bf16 v[172:175], a[44:47], a[64:67], v[172:175]
  s_waitcnt lgkmcnt(4)
  v_mfma_f32_16x16x32_bf16 v[176:179], a[32:35], a[72:75], v[176:179]
  ds_read_b64_tr_b16 a[88:89], v11 offset:49152
  v_mfma_f32_16x16x32_bf16 v[176:179], a[48:51], a[76:79], v[176:179]
  ds_read_b64_tr_b16 a[90:91], v11 offset:50176
  v_mfma_f32_16x16x32_bf16 v[180:183], a[52:55], a[76:79], v[180:183]
  buffer_load_dwordx4 v21, s[8:11], s65 offen offset:1024 lds
  v_mfma_f32_16x16x32_bf16 v[180:183], a[36:39], a[72:75], v[180:183]
  v_mfma_f32_16x16x32_bf16 v[184:187], a[40:43], a[72:75], v[184:187]
  ds_read_b64_tr_b16 a[92:93], v11 offset:57344
  v_mfma_f32_16x16x32_bf16 v[184:187], a[56:59], a[76:79], v[184:187]
  ds_read_b64_tr_b16 a[94:95], v11 offset:58368
  v_mfma_f32_16x16x32_bf16 v[188:191], a[60:63], a[76:79], v[188:191]
  v_mfma_f32_16x16x32_bf16 v[188:191], a[44:47], a[72:75], v[188:191]
  s_waitcnt lgkmcnt(4)
  v_mfma_f32_16x16x32_bf16 v[192:195], a[32:35], a[80:83], v[192:195]
  ds_read_b64_tr_b16 a[64:65], v12 offset:49152
  s_add_u32 s65, s73, 0
  v_mfma_f32_16x16x32_bf16 v[192:195], a[48:51], a[84:87], v[192:195]
  ds_read_b64_tr_b16 a[66:67], v12 offset:50176
  s_add_u32 m0, s84, 2048
  v_mfma_f32_16x16x32_bf16 v[196:199], a[52:55], a[84:87], v[196:199]
  buffer_load_dwordx4 v20, s[8:11], s65 offen offset:0 lds
  v_mfma_f32_16x16x32_bf16 v[196:199], a[36:39], a[80:83], v[196:199]
  v_mfma_f32_16x16x32_bf16 v[200:203], a[40:43], a[80:83], v[200:203]
  ds_read_b64_tr_b16 a[68:69], v12 offset:57344
  v_mfma_f32_16x16x32_bf16 v[200:203], a[56:59], a[84:87], v[200:203]
  ds_read_b64_tr_b16 a[70:71], v12 offset:58368
  v_mfma_f32_16x16x32_bf16 v[204:207], a[60:63], a[84:87], v[204:207]
  v_mfma_f32_16x16x32_bf16 v[204:207], a[44:47], a[80:83], v[204:207]
  s_waitcnt lgkmcnt(4)
  v_mfma_f32_16x16x32_bf16 v[208:211], a[32:35], a[88:91], v[208:211]
  ds_read_b64_tr_b16 a[72:73], v13 offset:49152
  v_mfma_f32_16x16x32_bf16 v[208:211], a[48:51], a[92:95], v[208:211]
  ds_read_b64_tr_b16 a[74:75], v13 offset:50176
  v_mfma_f32_16x16x32_bf16 v[212:215], a[52:55], a[92:95], v[212:215]
  buffer_load_dwordx4 v21, s[8:11], s65 offen offset:1024 lds
  v_mfma_f32_16x16x32_bf16 v[212:215], a[36:39], a[88:91], v[212:215]
  v_mfma_f32_16x16x32_bf16 v[216:219], a[40:43], a[88:91], v[216:219]
  ds_read_b64_tr_b16 a[76:77], v13 offset:57344
  s_add_u32 s65, s74, 0
  v_mfma_f32_16x16x32_bf16 v[216:219], a[56:59], a[92:95], v[216:219]
  ds_read_b64_tr_b16 a[78:79], v13 offset:58368
  s_add_u32 m0, s84, 4096
  v_mfma_f32_16x16x32_bf16 v[220:223], a[60:63], a[92:95], v[220:223]
  buffer_load_dwordx4 v20, s[8:11], s65 offen offset:0 lds
  v_mfma_f32_16x16x32_bf16 v[220:223], a[44:47], a[88:91], v[220:223]
  s_waitcnt lgkmcnt(4)
  v_mfma_f32_16x16x32_bf16 v[224:227], a[32:35], a[64:67], v[224:227]
  ds_read_b64_tr_b16 a[80:81], v14 offset:49152
  v_mfma_f32_16x16x32_bf16 v[224:227], a[48:51], a[68:71], v[224:227]
  ds_read_b64_tr_b16 a[82:83], v14 offset:50176
  v_mfma_f32_16x16x32_bf16 v[228:231], a[52:55], a[68:71], v[228:231]
  ds_read_b64_tr_b16 a[84:85], v14 offset:57344
  v_mfma_f32_16x16x32_bf16 v[228:231], a[36:39], a[64:67], v[228:231]
  ds_read_b64_tr_b16 a[86:87], v14 offset:58368
  v_mfma_f32_16x16x32_bf16 v[232:235], a[40:43], a[64:67], v[232:235]
  ds_read_b64_tr_b16 a[88:89], v15 offset:49152
  v_mfma_f32_16x16x32_bf16 v[232:235], a[56:59], a[68:71], v[232:235]
  ds_read_b64_tr_b16 a[90:91], v15 offset:50176
  v_mfma_f32_16x16x32_bf16 v[236:239], a[60:63], a[68:71], v[236:239]
  ds_read_b64_tr_b16 a[92:93], v15 offset:57344
  v_mfma_f32_16x16x32_bf16 v[236:239], a[44:47], a[64:67], v[236:239]
  ds_read_b64_tr_b16 a[94:95], v15 offset:58368
  s_waitcnt lgkmcnt(8)
  v_mfma_f32_16x16x32_bf16 v[240:243], a[32:35], a[72:75], v[240:243]
  v_mfma_f32_16x16x32_bf16 v[240:243], a[48:51], a[76:79], v[240:243]
  v_mfma_f32_16x16x32_bf16 v[244:247], a[52:55], a[76:79], v[244:247]
  buffer_load_dwordx4 v21, s[8:11], s65 offen offset:1024 lds
  v_mfma_f32_16x16x32_bf16 v[244:247], a[36:39], a[72:75], v[244:247]
  v_mfma_f32_16x16x32_bf16 v[248:251], a[40:43], a[72:75], v[248:251]
  s_add_u32 s65, s75, 0
  v_mfma_f32_16x16x32_bf16 v[248:251], a[56:59], a[76:79], v[248:251]
  s_add_u32 m0, s84, 6144
  v_mfma_f32_16x16x32_bf16 v[252:255], a[60:63], a[76:79], v[252:255]
  buffer_load_dwordx4 v20, s[8:11], s65 offen offset:0 lds
  v_mfma_f32_16x16x32_bf16 v[252:255], a[44:47], a[72:75], v[252:255]
  s_waitcnt lgkmcnt(4)
  v_add_u32 v8, 0x20000, v8
  s_waitcnt vmcnt(28) lgkmcnt(0)
  s_barrier
  v_mfma_f32_16x16x32_bf16 a[128:131], a[32:35], a[80:83], a[128:131]
  ds_read_b64_tr_b16 a[64:65], v8 offset:0
  v_mfma_f32_16x16x32_bf16 a[128:131], a[48:51], a[84:87], a[128:131]
  ds_read_b64_tr_b16 a[66:67], v8 offset:1024
  v_mfma_f32_16x16x32_bf16 a[132:135], a[52:55], a[84:87], a[132:135]
  v_mfma_f32_16x16x32_bf16 a[132:135], a[36:39], a[80:83], a[132:135]
  v_mfma_f32_16x16x32_bf16 a[136:139], a[40:43], a[80:83], a[136:139]
  ds_read_b64_tr_b16 a[68:69], v8 offset:8192
  v_mfma_f32_16x16x32_bf16 a[136:139], a[56:59], a[84:87], a[136:139]
  ds_read_b64_tr_b16 a[70:71], v8 offset:9216
  v_mfma_f32_16x16x32_bf16 a[140:143], a[60:63], a[84:87], a[140:143]
  buffer_load_dwordx4 v21, s[8:11], s65 offen offset:1024 lds
  v_mfma_f32_16x16x32_bf16 a[140:143], a[44:47], a[80:83], a[140:143]
  v_add_u32 v9, 0x20000, v9
  v_mfma_f32_16x16x32_bf16 a[144:147], a[32:35], a[88:91], a[144:147]
  ds_read_b64_tr_b16 a[72:73], v9 offset:0
  v_mfma_f32_16x16x32_bf16 a[144:147], a[48:51], a[92:95], a[144:147]
  ds_read_b64_tr_b16 a[74:75], v9 offset:1024
  v_mfma_f32_16x16x32_bf16 a[148:151], a[52:55], a[92:95], a[148:151]
  v_mfma_f32_16x16x32_bf16 a[148:151], a[36:39], a[88:91], a[148:151]
  v_mfma_f32_16x16x32_bf16 a[152:155], a[40:43], a[88:91], a[152:155]
  ds_read_b64_tr_b16 a[76:77], v9 offset:8192
  v_mfma_f32_16x16x32_bf16 a[152:155], a[56:59], a[92:95], a[152:155]
  ds_read_b64_tr_b16 a[78:79], v9 offset:9216
  v_mfma_f32_16x16x32_bf16 a[156:159], a[60:63], a[92:95], a[156:159]
  v_mfma_f32_16x16x32_bf16 a[156:159], a[44:47], a[88:91], a[156:159]
  s_waitcnt lgkmcnt(4)
  v_add_u32 v10, 0x20000, v10
  s_waitcnt vmcnt(17)
  v_mfma_f32_16x16x32_bf16 v[32:35], a[64:67], a[0:3], v[32:35]
  ds_read_b64_tr_b16 a[80:81], v10 offset:0
  s_add_u32 s65, s76, 0
  v_mfma_f32_16x16x32_bf16 v[32:35], a[68:71], a[16:19], v[32:35]
  ds_read_b64_tr_b16 a[82:83], v10 offset:1024
  s_add_u32 m0, s78, 32768
  v_mfma_f32_16x16x32_bf16 v[36:39], a[68:71], a[20:23], v[36:39]
  buffer_load_dwordx4 v2, s[16:19], s65 offen offset:0 lds
  v_mfma_f32_16x16x32_bf16 v[36:39], a[64:67], a[4:7], v[36:39]
  ds_read_b128 a[32:35], v28 offset:8192
  v_mfma_f32_16x16x32_bf16 v[40:43], a[64:67], a[8:11], v[40:43]
  ds_read_b64_tr_b16 a[84:85], v10 offset:8192
  v_mfma_f32_16x16x32_bf16 v[40:43], a[68:71], a[24:27], v[40:43]
  ds_read_b64_tr_b16 a[86:87], v10 offset:9216
  v_mfma_f32_16x16x32_bf16 v[44:47], a[68:71], a[28:31], v[44:47]
  buffer_load_dwordx4 v3, s[16:19], s65 offen offset:1024 lds
  v_mfma_f32_16x16x32_bf16 v[44:47], a[64:67], a[12:15], v[44:47]
  ds_read_b128 a[36:39], v28 offset:10240
  s_waitcnt lgkmcnt(6)
  v_add_u32 v11, 0x20000, v11
  v_mfma_f32_16x16x32_bf16 v[48:51], a[72:75], a[0:3], v[48:51]
  ds_read_b64_tr_b16 a[88:89], v11 offset:0
  v_mfma_f32_16x16x32_bf16 v[48:51], a[76:79], a[16:19], v[48:51]
  ds_read_b64_tr_b16 a[90:91], v11 offset:1024
  v_mfma_f32_16x16x32_bf16 v[52:55], a[76:79], a[20:23], v[52:55]
  v_mfma_f32_16x16x32_bf16 v[52:55], a[72:75], a[4:7], v[52:55]
  ds_read_b128 a[40:43], v28 offset:12288
  v_mfma_f32_16x16x32_bf16 v[56:59], a[72:75], a[8:11], v[56:59]
  ds_read_b64_tr_b16 a[92:93], v11 offset:8192
  v_mfma_f32_16x16x32_bf16 v[56:59], a[76:79], a[24:27], v[56:59]
  ds_read_b64_tr_b16 a[94:95], v11 offset:9216
  v_mfma_f32_16x16x32_bf16 v[60:63], a[76:79], a[28:31], v[60:63]
  buffer_load_dwordx4 v4, s[16:19], s65 offen offset:2048 lds
  v_mfma_f32_16x16x32_bf16 v[60:63], a[72:75], a[12:15], v[60:63]
  ds_read_b128 a[44:47], v28 offset:14336
  s_waitcnt lgkmcnt(7)
  v_add_u32 v12, 0x20000, v12
  v_mfma_f32_16x16x32_bf16 v[64:67], a[80:83], a[0:3], v[64:67]
  ds_read_b64_tr_b16 a[64:65], v12 offset:0
  v_mfma_f32_16x16x32_bf16 v[64:67], a[84:87], a[16:19], v[64:67]
  ds_read_b64_tr_b16 a[66:67], v12 offset:1024
  v_mfma_f32_16x16x32_bf16 v[68:71], a[84:87], a[20:23], v[68:71]
  v_mfma_f32_16x16x32_bf16 v[68:71], a[80:83], a[4:7], v[68:71]
  ds_read_b128 a[48:51], v29 offset:8192
  v_mfma_f32_16x16x32_bf16 v[72:75], a[80:83], a[8:11], v[72:75]
  ds_read_b64_tr_b16 a[68:69], v12 offset:8192
  v_mfma_f32_16x16x32_bf16 v[72:75], a[84:87], a[24:27], v[72:75]
  ds_read_b64_tr_b16 a[70:71], v12 offset:9216
  v_mfma_f32_16x16x32_bf16 v[76:79], a[84:87], a[28:31], v[76:79]
  buffer_load_dwordx4 v5, s[16:19], s65 offen offset:3072 lds
  v_mfma_f32_16x16x32_bf16 v[76:79], a[80:83], a[12:15], v[76:79]
  ds_read_b128 a[52:55], v29 offset:10240
  s_waitcnt lgkmcnt(7)
  v_add_u32 v13, 0x20000, v13
  v_mfma_f32_16x16x32_bf16 v[80:83], a[88:91], a[0:3], v[80:83]
  ds_read_b64_tr_b16 a[72:73], v13 offset:0
  s_add_u32 s65, s77, 0
  v_mfma_f32_16x16x32_bf16 v[80:83], a[92:95], a[16:19], v[80:83]
  ds_read_b64_tr_b16 a[74:75], v13 offset:1024
  s_add_u32 m0, s79, 49152
  v_mfma_f32_16x16x32_bf16 v[84:87], a[92:95], a[20:23], v[84:87]
  buffer_load_dwordx4 v6, s[56:59], s65 offen offset:0 lds
  v_mfma_f32_16x16x32_bf16 v[84:87], a[88:91], a[4:7], v[84:87]
  ds_read_b128 a[56:59], v29 offset:12288
  v_mfma_f32_16x16x32_bf16 v[88:91], a[88:91], a[8:11], v[88:91]
  ds_read_b64_tr_b16 a[76:77], v13 offset:8192
  v_mfma_f32_16x16x32_bf16 v[88:91], a[92:95], a[24:27], v[88:91]
  ds_read_b64_tr_b16 a[78:79], v13 offset:9216
  v_mfma_f32_16x16x32_bf16 v[92:95], a[92:95], a[28:31], v[92:95]
  v_mfma_f32_16x16x32_bf16 v[92:95], a[88:91], a[12:15], v[92:95]
  ds_read_b128 a[60:63], v29 offset:14336
  s_waitcnt lgkmcnt(7)
  v_add_u32 v14, 0x20000, v14
  v_mfma_f32_16x16x32_bf16 v[96:99], a[64:67], a[0:3], v[96:99]
  ds_read_b64_tr_b16 a[80:81], v14 offset:0
  v_mfma_f32_16x16x32_bf16 v[96:99], a[68:71], a[16:19], v[96:99]
  ds_read_b64_tr_b16 a[82:83], v14 offset:1024
  v_mfma_f32_16x16x32_bf16 v[100:103], a[68:71], a[20:23], v[100:103]
  buffer_load_dwordx4 v7, s[56:59], s65 offen offset:1024 lds
  v_mfma_f32_16x16x32_bf16 v[100:103], a[64:67], a[4:7], v[100:103]
  v_mfma_f32_16x16x32_bf16 v[104:107], a[64:67], a[8:11], v[104:107]
  ds_read_b64_tr_b16 a[84:85], v14 offset:8192
  v_mfma_f32_16x16x32_bf16 v[104:107], a[68:71], a[24:27], v[104:107]
  ds_read_b64_tr_b16 a[86:87], v14 offset:9216
  v_mfma_f32_16x16x32_bf16 v[108:111], a[68:71], a[28:31], v[108:111]
  v_mfma_f32_16x16x32_bf16 v[108:111], a[64:67], a[12:15], v[108:111]
  s_waitcnt lgkmcnt(5)
  v_add_u32 v15, 0x20000, v15
  v_mfma_f32_16x16x32_bf16 v[112:115], a[72:75], a[0:3], v[112:115]
  ds_read_b64_tr_b16 a[88:89], v15 offset:0
  s_lshr_b32 s54, s2, 3
  s_lshl_b32 s54, s54, 2
  s_add_u32 s54, s54, s60
  s_lshl_b32 s54, s54, 8
  v_mfma_f32_16x16x32_bf16 v[112:115], a[76:79], a[16:19], v[112:115]
  ds_read_b64_tr_b16 a[90:91], v15 offset:1024
  s_add_u32 s54, s54, Lp1epi-Lcw1
  v_add_u32 v22, s54, v0
  v_min_u32 v22, Lcodeend-Lcw1-4, v22
  s_getpc_b64 s[54:55]
Lcw1:
  v_mfma_f32_16x16x32_bf16 v[116:119], a[76:79], a[20:23], v[116:119]
  global_load_dword v26, v22, s[54:55]
  v_mfma_f32_16x16x32_bf16 v[116:119], a[72:75], a[4:7], v[116:119]
  v_mfma_f32_16x16x32_bf16 v[120:123], a[72:75], a[8:11], v[120:123]
  ds_read_b64_tr_b16 a[92:93], v15 offset:8192
  v_mfma_f32_16x16x32_bf16 v[120:123], a[76:79], a[24:27], v[120:123]
  ds_read_b64_tr_b16 a[94:95], v15 offset:9216
  v_mfma_f32_16x16x32_bf16 v[124:127], a[76:79], a[28:31], v[124:127]
  v_mfma_f32_16x16x32_bf16 v[124:127], a[72:75], a[12:15], v[124:127]
  s_waitcnt lgkmcnt(4)
  v_mfma_f32_16x16x32_bf16 v[128:131], a[80:83], a[0:3], v[128:131]
  ds_read_b64_tr_b16 a[64:65], v8 offset:16384
  s_add_u32 s65, s72, 128
  v_mfma_f32_16x16x32_bf16 v[128:131], a[84:87], a[16:19], v[128:131]
  ds_read_b64_tr_b16 a[66:67], v8 offset:17408
  s_add_u32 m0, s84, 8192
  v_mfma_f32_16x16x32_bf16 v[132:135], a[84:87], a[20:23], v[132:135]
  buffer_load_dwordx4 v20, s[8:11], s65 offen offset:0 lds
  v_mfma_f32_16x16x32_bf16 v[132:135], a[80:83], a[4:7], v[132:135]
  v_mfma_f32_16x16x32_bf16 v[136:139], a[80:83], a[8:11], v[136:139]
  ds_read_b64_tr_b16 a[68:69], v8 offset:24576
  v_mfma_f32_16x16x32_bf16 v[136:139], a[84:87], a[24:27], v[136:139]
  ds_read_b64_tr_b16 a[70:71], v8 offset:25600
  v_mfma_f32_16x16x32_bf16 v[140:143], a[84:87], a[28:31], v[140:143]
  buffer_load_dwordx4 v21, s[8:11], s65 offen offset:1024 lds
  v_mfma_f32_16x16x32_bf16 v[140:143], a[80:83], a[12:15], v[140:143]
  s_waitcnt lgkmcnt(4)
  v_mfma_f32_16x16x32_bf16 v[144:147], a[88:91], a[0:3], v[144:147]
  ds_read_b64_tr_b16 a[72:73], v9 offset:16384
  v_mfma_f32_16x16x32_bf16 v[144:147], a[92:95], a[16:19], v[144:147]
  ds_read_b64_tr_b16 a[74:75], v9 offset:17408
  v_mfma_f32_16x16x32_bf16 v[148:151], a[92:95], a[20:23], v[148:151]
  v_mfma_f32_16x16x32_bf16 v[148:151], a[88:91], a[4:7], v[148:151]
  v_mfma_f32_16x16x32_bf16 v[152:155], a[88:91], a[8:11], v[152:155]
  ds_read_b64_tr_b16 a[76:77], v9 offset:24576
  s_add_u32 s65, s73, 128
  v_mfma_f32_16x16x32_bf16 v[152:155], a[92:95], a[24:27], v[152:155]
  ds_read_b64_tr_b16 a[78:79], v9 offset:25600
  s_add_u32 m0, s84, 10240
  v_mfma_f32_16x16x32_bf16 v[156:159], a[92:95], a[28:31], v[156:159]
  buffer_load_dwordx4 v20, s[8:11], s65 offen offset:0 lds
  v_mfma_f32_16x16x32_bf16 v[156:159], a[88:91], a[12:15], v[156:159]
  s_waitcnt lgkmcnt(4)
  v_mfma_f32_16x16x32_bf16 v[160:163], a[0:3], a[64:67], v[160:163]
  ds_read_b64_tr_b16 a[80:81], v10 offset:16384
  v_mfma_f32_16x16x32_bf16 v[160:163], a[16:19], a[68:71], v[160:163]
  ds_read_b64_tr_b16 a[82:83], v10 offset:17408
  v_mfma_f32_16x16x32_bf16 v[164:167], a[20:23], a[68:71], v[164:167]
  v_mfma_f32_16x16x32_bf16 v[164:167], a[4:7], a[64:67], v[164:167]
  v_mfma_f32_16x16x32_bf16 v[168:171], a[8:11], a[64:67], v[168:171]
  ds_read_b64_tr_b16 a[84:85], v10 offset:24576
  v_mfma_f32_16x16x32_bf16 v[168:171], a[24:27], a[68:71], v[168:171]
  ds_read_b64_tr_b16 a[86:87], v10 offset:25600
  v_mfma_f32_16x16x32_bf16 v[172:175], a[28:31], a[68:71], v[172:175]
  buffer_load_dwordx4 v21, s[8:11], s65 offen offset:1024 lds
  v_mfma_f32_16x16x32_bf16 v[172:175], a[12:15], a[64:67], v[172:175]
  s_waitcnt lgkmcnt(4)
  v_mfma_f32_16x16x32_bf16 v[176:179], a[0:3], a[72:75], v[176:179]
  ds_read_b64_tr_b16 a[88:89], v11 offset:16384
  s_add_u32 s65, s74, 128
  v_mfma_f32_16x16x32_bf16 v[176:179], a[16:19], a[76:79], v[176:179]
  ds_read_b64_tr_b16 a[90:91], v11 offset:17408
  s_add_u32 m0, s84, 12288
  v_mfma_f32_16x16x32_bf16 v[180:183], a[20:23], a[76:79], v[180:183]
  buffer_load_dwordx4 v20, s[8:11], s65 offen offset:0 lds
  v_mfma_f32_16x16x32_bf16 v[180:183], a[4:7], a[72:75], v[180:183]
  v_mfma_f32_16x16x32_bf16 v[184:187], a[8:11], a[72:75], v[184:187]
  ds_read_b64_tr_b16 a[92:93], v11 offset:24576
  v_mfma_f32_16x16x32_bf16 v[184:187], a[24:27], a[76:79], v[184:187]
  ds_read_b64_tr_b16 a[94:95], v11 offset:25600
  v_mfma_f32_16x16x32_bf16 v[188:191], a[28:31], a[76:79], v[188:191]
  v_mfma_f32_16x16x32_bf16 v[188:191], a[12:15], a[72:75], v[188:191]
  s_waitcnt lgkmcnt(4)
  v_mfma_f32_16x16x32_bf16 v[192:195], a[0:3], a[80:83], v[192:195]
  ds_read_b64_tr_b16 a[64:65], v12 offset:16384
  v_mfma_f32_16x16x32_bf16 v[192:195], a[16:19], a[84:87], v[192:195]
  ds_read_b64_tr_b16 a[66:67], v12 offset:17408
  v_mfma_f32_16x16x32_bf16 v[196:199], a[20:23], a[84:87], v[196:199]
  buffer_load_dwordx4 v21, s[8:11], s65 offen offset:1024 lds
  v_mfma_f32_16x16x32_bf16 v[196:199], a[4:7], a[80:83], v[196:199]
  v_mfma_f32_16x16x32_bf16 v[200:203], a[8:11], a[80:83], v[200:203]
  ds_read_b64_tr_b16 a[68:69], v12 offset:24576
  v_mfma_f32_16x16x32_bf16 v[200:203], a[24:27], a[84:87], v[200:203]
  ds_read_b64_tr_b16 a[70:71], v12 offset:25600
  v_mfma_f32_16x16x32_bf16 v[204:207], a[28:31], a[84:87], v[204:207]
  v_mfma_f32_16x16x32_bf16 v[204:207], a[12:15], a[80:83], v[204:207]
  s_waitcnt lgkmcnt(4)
  v_mfma_f32_16x16x32_bf16 v[208:211], a[0:3], a[88:91], v[208:211]
  ds_read_b64_tr_b16 a[72:73], v13 offset:16384
  s_add_u32 s65, s75, 128
  v_mfma_f32_16x16x32_bf16 v[208:211], a[16:19], a[92:95], v[208:211]
  ds_read_b64_tr_b16 a[74:75], v13 offset:17408
  s_add_u32 m0, s84, 14336
  v_mfma_f32_16x16x32_bf16 v[212:215], a[20:23], a[92:95], v[212:215]
  buffer_load_dwordx4 v20, s[8:11], s65 offen offset:0 lds
  v_mfma_f32_16x16x32_bf16 v[212:215], a[4:7], a[88:91], v[212:215]
  v_mfma_f32_16x16x32_bf16 v[216:219], a[8:11], a[88:91], v[216:219]
  ds_read_b64_tr_b16 a[76:77], v13 offset:24576
  v_mfma_f32_16x16x32_bf16 v[216:219], a[24:27], a[92:95], v[216:219]
  ds_read_b64_tr_b16 a[78:79], v13 offset:25600
  v_mfma_f32_16x16x32_bf16 v[220:223], a[28:31], a[92:95], v[220:223]
  buffer_load_dwordx4 v21, s[8:11], s65 offen offset:1024 lds
  v_mfma_f32_16x16x32_bf16 v[220:223], a[12:15], a[88:91], v[220:223]
  s_waitcnt lgkmcnt(4)
  v_mfma_f32_16x16x32_bf16 v[224:227], a[0:3], a[64:67], v[224:227]
  ds_read_b64_tr_b16 a[80:81], v14 offset:16384
  v_mfma_f32_16x16x32_bf16 v[224:227], a[16:19], a[68:71], v[224:227]
  ds_read_b64_tr_b16 a[82:83], v14 offset:17408
  v_mfma_f32_16x16x32_bf16 v[228:231], a[20:23], a[68:71], v[228:231]
  ds_read_b64_tr_b16 a[84:85], v14 offset:24576
  v_mfma_f32_16x16x32_bf16 v[228:231], a[4:7], a[64:67], v[228:231]
  ds_read_b64_tr_b16 a[86:87], v14 offset:25600
  v_mfma_f32_16x16x32_bf16 v[232:235], a[8:11], a[64:67], v[232:235]
  ds_read_b64_tr_b16 a[88:89], v15 offset:16384
  v_mfma_f32_16x16x32_bf16 v[232:235], a[24:27], a[68:71], v[232:235]
  ds_read_b64_tr_b16 a[90:91], v15 offset:17408
  v_mfma_f32_16x16x32_bf16 v[236:239], a[28:31], a[68:71], v[236:239]
  ds_read_b64_tr_b16 a[92:93], v15 offset:24576
  v_mfma_f32_16x16x32_bf16 v[236:239], a[12:15], a[64:67], v[236:239]
  ds_read_b64_tr_b16 a[94:95], v15 offset:25600
  s_waitcnt lgkmcnt(8)
  v_mfma_f32_16x16x32_bf16 v[240:243], a[0:3], a[72:75], v[240:243]
  v_mfma_f32_16x16x32_bf16 v[240:243], a[16:19], a[76:79], v[240:243]
  v_mfma_f32_16x16x32_bf16 v[244:247], a[20:23], a[76:79], v[244:247]
  v_mfma_f32_16x16x32_bf16 v[244:247], a[4:7], a[72:75], v[244:247]
  v_mfma_f32_16x16x32_bf16 v[248:251], a[8:11], a[72:75], v[248:251]
  v_mfma_f32_16x16x32_bf16 v[248:251], a[24:27], a[76:79], v[248:251]
  v_mfma_f32_16x16x32_bf16 v[252:255], a[28:31], a[76:79], v[252:255]
  v_mfma_f32_16x16x32_bf16 v[252:255], a[12:15], a[72:75], v[252:255]
  s_waitcnt lgkmcnt(4)
  v_add_u32 v8, 0xfffe0000, v8
  s_waitcnt vmcnt(24) lgkmcnt(0)
  s_barrier
  v_mfma_f32_16x16x32_bf16 a[128:131], a[0:3], a[80:83], a[128:131]
  ds_read_b64_tr_b16 a[64:65], v8 offset:0
  v_mfma_f32_16x16x32_bf16 a[128:131], a[16:19], a[84:87], a[128:131]
  ds_read_b64_tr_b16 a[66:67], v8 offset:1024
  v_mfma_f32_16x16x32_bf16 a[132:135], a[20:23], a[84:87], a[132:135]
  v_mfma_f32_16x16x32_bf16 a[132:135], a[4:7], a[80:83], a[132:135]
  v_mfma_f32_16x16x32_bf16 a[136:139], a[8:11], a[80:83], a[136:139]
  ds_read_b64_tr_b16 a[68:69], v8 offset:8192
  v_mfma_f32_16x16x32_bf16 a[136:139], a[24:27], a[84:87], a[136:139]
  ds_read_b64_tr_b16 a[70:71], v8 offset:9216
  v_mfma_f32_16x16x32_bf16 a[140:143], a[28:31], a[84:87], a[140:143]
  v_mfma_f32_16x16x32_bf16 a[140:143], a[12:15], a[80:83], a[140:143]
  v_add_u32 v9, 0xfffe0000, v9
  v_mfma_f32_16x16x32_bf16 a[144:147], a[0:3], a[88:91], a[144:147]
  ds_read_b64_tr_b16 a[72:73], v9 offset:0
  v_mfma_f32_16x16x32_bf16 a[144:147], a[16:19], a[92:95], a[144:147]
  ds_read_b64_tr_b16 a[74:75], v9 offset:1024
  v_mfma_f32_16x16x32_bf16 a[148:151], a[20:23], a[92:95], a[148:151]
  v_mfma_f32_16x16x32_bf16 a[148:151], a[4:7], a[88:91], a[148:151]
  v_mfma_f32_16x16x32_bf16 a[152:155], a[8:11], a[88:91], a[152:155]
  ds_read_b64_tr_b16 a[76:77], v9 offset:8192
  v_mfma_f32_16x16x32_bf16 a[152:155], a[24:27], a[92:95], a[152:155]
  ds_read_b64_tr_b16 a[78:79], v9 offset:9216
  v_mfma_f32_16x16x32_bf16 a[156:159], a[28:31], a[92:95], a[156:159]
  v_mfma_f32_16x16x32_bf16 a[156:159], a[12:15], a[88:91], a[156:159]
  s_waitcnt lgkmcnt(4)
  v_add_u32 v10, 0xfffe0000, v10
  s_waitcnt vmcnt(15)
  v_mfma_f32_16x16x32_bf16 v[32:35], a[64:67], a[32:35], v[32:35]
  ds_read_b64_tr_b16 a[80:81], v10 offset:0
  s_add_u32 s65, s76, 524288
  v_mfma_f32_16x16x32_bf16 v[32:35], a[68:71], a[48:51], v[32:35]
  ds_read_b64_tr_b16 a[82:83], v10 offset:1024
  s_add_u32 m0, s78, 131072
  v_mfma_f32_16x16x32_bf16 v[36:39], a[68:71], a[52:55], v[36:39]
  buffer_load_dwordx4 v2, s[16:19], s65 offen offset:0 lds
  v_mfma_f32_16x16x32_bf16 v[36:39], a[64:67], a[36:39], v[36:39]
  ds_read_b128 a[0:3], v28 offset:0
  v_mfma_f32_16x16x32_bf16 v[40:43], a[64:67], a[40:43], v[40:43]
  ds_read_b64_tr_b16 a[84:85], v10 offset:8192
  v_mfma_f32_16x16x32_bf16 v[40:43], a[68:71], a[56:59], v[40:43]
  ds_read_b64_tr_b16 a[86:87], v10 offset:9216
  v_mfma_f32_16x16x32_bf16 v[44:47], a[68:71], a[60:63], v[44:47]
  buffer_load_dwordx4 v3, s[16:19], s65 offen offset:1024 lds
  v_mfma_f32_16x16x32_bf16 v[44:47], a[64:67], a[44:47], v[44:47]
  ds_read_b128 a[4:7], v28 offset:2048
  s_waitcnt lgkmcnt(6)
  v_add_u32 v11, 0xfffe0000, v11
  v_mfma_f32_16x16x32_bf16 v[48:51], a[72:75], a[32:35], v[48:51]
  ds_read_b64_tr_b16 a[88:89], v11 offset:0
  v_mfma_f32_16x16x32_bf16 v[48:51], a[76:79], a[48:51], v[48:51]
  ds_read_b64_tr_b16 a[90:91], v11 offset:1024
  v_mfma_f32_16x16x32_bf16 v[52:55], a[76:79], a[52:55], v[52:55]
  buffer_load_dwordx4 v4, s[16:19], s65 offen offset:2048 lds
  v_mfma_f32_16x16x32_bf16 v[52:55], a[72:75], a[36:39], v[52:55]
  ds_read_b128 a[8:11], v28 offset:4096
  v_mfma_f32_16x16x32_bf16 v[56:59], a[72:75], a[40:43], v[56:59]
  ds_read_b64_tr_b16 a[92:93], v11 offset:8192
  v_mfma_f32_16x16x32_bf16 v[56:59], a[76:79], a[56:59], v[56:59]
  ds_read_b64_tr_b16 a[94:95], v11 offset:9216
  v_mfma_f32_16x16x32_bf16 v[60:63], a[76:79], a[60:63], v[60:63]
  v_mfma_f32_16x16x32_bf16 v[60:63], a[72:75], a[44:47], v[60:63]
  ds_read_b128 a[12:15], v28 offset:6144
  s_waitcnt lgkmcnt(7)
  v_add_u32 v12, 0xfffe0000, v12
  v_mfma_f32_16x16x32_bf16 v[64:67], a[80:83], a[32:35], v[64:67]
  ds_read_b64_tr_b16 a[64:65], v12 offset:0
  v_mfma_f32_16x16x32_bf16 v[64:67], a[84:87], a[48:51], v[64:67]
  ds_read_b64_tr_b16 a[66:67], v12 offset:1024
  v_mfma_f32_16x16x32_bf16 v[68:71], a[84:87], a[52:55], v[68:71]
  buffer_load_dwordx4 v5, s[16:19], s65 offen offset:3072 lds
  v_mfma_f32_16x16x32_bf16 v[68:71], a[80:83], a[36:39], v[68:71]
  ds_read_b128 a[16:19], v29 offset:0
  v_mfma_f32_16x16x32_bf16 v[72:75], a[80:83], a[40:43], v[72:75]
  ds_read_b64_tr_b16 a[68:69], v12 offset:8192
  s_add_u32 s65, s77, 229376
  v_cvt_pk_bf16_f32 v32, v32, v33
  v_mfma_f32_16x16x32_bf16 v[72:75], a[84:87], a[56:59], v[72:75]
  ds_read_b64_tr_b16 a[70:71], v12 offset:9216
  s_add_u32 m0, s79, 147456
  v_cvt_pk_bf16_f32 v33, v34, v35
  v_mfma_f32_16x16x32_bf16 v[76:79], a[84:87], a[60:63], v[76:79]
  buffer_load_dwordx4 v6, s[56:59], s65 offen offset:0 lds
  v_mfma_f32_16x16x32_bf16 v[76:79], a[80:83], a[44:47], v[76:79]
  ds_read_b128 a[20:23], v29 offset:2048
  s_waitcnt lgkmcnt(7)
  v_add_u32 v13, 0xfffe0000, v13
  v_mfma_f32_16x16x32_bf16 v[80:83], a[88:91], a[32:35], v[80:83]
  ds_read_b64_tr_b16 a[72:73], v13 offset:0
  v_cvt_pk_bf16_f32 v34, v48, v49
  v_mfma_f32_16x16x32_bf16 v[80:83], a[92:95], a[48:51], v[80:83]
  ds_read_b64_tr_b16 a[74:75], v13 offset:1024
  v_cvt_pk_bf16_f32 v35, v50, v51
  v_mfma_f32_16x16x32_bf16 v[84:87], a[92:95], a[52:55], v[84:87]
  buffer_load_dwordx4 v7, s[56:59], s65 offen offset:1024 lds
  v_mfma_f32_16x16x32_bf16 v[84:87], a[88:91], a[36:39], v[84:87]
  ds_read_b128 a[24:27], v29 offset:4096
  v_cvt_pk_bf16_f32 v36, v36, v37
  v_mfma_f32_16x16x32_bf16 v[88:91], a[88:91], a[40:43], v[88:91]
  ds_read_b64_tr_b16 a[76:77], v13 offset:8192
  v_cvt_pk_bf16_f32 v37, v38, v39
  v_mfma_f32_16x16x32_bf16 v[88:91], a[92:95], a[56:59], v[88:91]
  ds_read_b64_tr_b16 a[78:79], v13 offset:9216
  s_add_u32 s81, s85, 0
  v_cvt_pk_bf16_f32 v38, v52, v53
  v_mfma_f32_16x16x32_bf16 v[92:95], a[92:95], a[60:63], v[92:95]
  buffer_store_dwordx4 v[32:35], v1, s[40:43], s81 offen sc1
  v_mfma_f32_16x16x32_bf16 v[92:95], a[88:91], a[44:47], v[92:95]
  ds_read_b128 a[28:31], v29 offset:6144
  s_waitcnt lgkmcnt(7)
  v_add_u32 v14, 0xfffe0000, v14
  v_mfma_f32_16x16x32_bf16 v[96:99], a[64:67], a[32:35], v[96:99]
  ds_read_b64_tr_b16 a[80:81], v14 offset:0
  v_cvt_pk_bf16_f32 v39, v54, v55
  v_mfma_f32_16x16x32_bf16 v[96:99], a[68:71], a[48:51], v[96:99]
  ds_read_b64_tr_b16 a[82:83], v14 offset:1024
  v_cvt_pk_bf16_f32 v40, v40, v41
  v_mfma_f32_16x16x32_bf16 v[100:103], a[68:71], a[52:55], v[100:103]
  v_cvt_pk_bf16_f32 v41, v42, v43
  v_cvt_pk_bf16_f32 v42, v56, v57
  v_mfma_f32_16x16x32_bf16 v[100:103], a[64:67], a[36:39], v[100:103]
  v_cvt_pk_bf16_f32 v43, v58, v59
  v_cvt_pk_bf16_f32 v44, v44, v45
  v_mfma_f32_16x16x32_bf16 v[104:107], a[64:67], a[40:43], v[104:107]
  ds_read_b64_tr_b16 a[84:85], v14 offset:8192
  v_cvt_pk_bf16_f32 v45, v46, v47
  v_mfma_f32_16x16x32_bf16 v[104:107], a[68:71], a[56:59], v[104:107]
  ds_read_b64_tr_b16 a[86:87], v14 offset:9216
  v_cvt_pk_bf16_f32 v46, v60, v61
  v_mfma_f32_16x16x32_bf16 v[108:111], a[68:71], a[60:63], v[108:111]
  s_waitcnt vmcnt(30)
  v_cmp_eq_u32 vcc, 0, v25
  s_and_b32 s63, vcc_lo, 1
  s_cbranch_scc1 Lspin2
Lpok2:
  v_mfma_f32_16x16x32_bf16 v[108:111], a[64:67], a[44:47], v[108:111]
  s_waitcnt lgkmcnt(5)
  v_add_u32 v15, 0xfffe0000, v15
  v_cvt_pk_bf16_f32 v47, v62, v63
  v_mfma_f32_16x16x32_bf16 v[112:115], a[72:75], a[32:35], v[112:115]
  ds_read_b64_tr_b16 a[88:89], v15 offset:0
  v_cvt_pk_bf16_f32 v64, v64, v65
  v_mfma_f32_16x16x32_bf16 v[112:115], a[76:79], a[48:51], v[112:115]
  ds_read_b64_tr_b16 a[90:91], v15 offset:1024
  v_cvt_pk_bf16_f32 v65, v66, v67
  v_mfma_f32_16x16x32_bf16 v[116:119], a[76:79], a[52:55], v[116:119]
  v_cvt_pk_bf16_f32 v66, v80, v81
  v_cvt_pk_bf16_f32 v67, v82, v83
  v_mfma_f32_16x16x32_bf16 v[116:119], a[72:75], a[36:39], v[116:119]
  v_cvt_pk_bf16_f32 v68, v68, v69
  v_cvt_pk_bf16_f32 v69, v70, v71
  v_mfma_f32_16x16x32_bf16 v[120:123], a[72:75], a[40:43], v[120:123]
  ds_read_b64_tr_b16 a[92:93], v15 offset:8192
  v_cvt_pk_bf16_f32 v70, v84, v85
  v_mfma_f32_16x16x32_bf16 v[120:123], a[76:79], a[56:59], v[120:123]
  ds_read_b64_tr_b16 a[94:95], v15 offset:9216
  s_add_u32 s81, s85, 1024
  v_cvt_pk_bf16_f32 v71, v86, v87
  v_mfma_f32_16x16x32_bf16 v[124:127], a[76:79], a[60:63], v[124:127]
  buffer_store_dwordx4 v[36:39], v1, s[40:43], s81 offen sc1
  v_mfma_f32_16x16x32_bf16 v[124:127], a[72:75], a[44:47], v[124:127]
  s_waitcnt lgkmcnt(4)
  v_cvt_pk_bf16_f32 v72, v72, v73
  v_cvt_pk_bf16_f32 v73, v74, v75
  v_mfma_f32_16x16x32_bf16 v[128:131], a[80:83], a[32:35], v[128:131]
  ds_read_b64_tr_b16 a[64:65], v14 offset:16384
  s_add_u32 s65, s72, 256
  v_cvt_pk_bf16_f32 v74, v88, v89
  v_mfma_f32_16x16x32_bf16 v[128:131], a[84:87], a[48:51], v[128:131]
  ds_read_b64_tr_b16 a[66:67], v14 offset:17408
  s_add_u32 m0, s84, 0
  v_cvt_pk_bf16_f32 v75, v90, v91
  v_mfma_f32_16x16x32_bf16 v[132:135], a[84:87], a[52:55], v[132:135]
  buffer_load_dwordx4 v20, s[8:11], s65 offen offset:0 lds
  v_mfma_f32_16x16x32_bf16 v[132:135], a[80:83], a[36:39], v[132:135]
  v_cvt_pk_bf16_f32 v76, v76, v77
  v_cvt_pk_bf16_f32 v77, v78, v79
  v_mfma_f32_16x16x32_bf16 v[136:139], a[80:83], a[40:43], v[136:139]
  ds_read_b64_tr_b16 a[68:69], v14 offset:24576
  v_cvt_pk_bf16_f32 v78, v92, v93
  v_mfma_f32_16x16x32_bf16 v[136:139], a[84:87], a[56:59], v[136:139]
  ds_read_b64_tr_b16 a[70:71], v14 offset:25600
  v_cvt_pk_bf16_f32 v79, v94, v95
  v_mfma_f32_16x16x32_bf16 v[140:143], a[84:87], a[60:63], v[140:143]
  buffer_load_dwordx4 v21, s[8:11], s65 offen offset:1024 lds
  v_mfma_f32_16x16x32_bf16 v[140:143], a[80:83], a[44:47], v[140:143]
  s_waitcnt lgkmcnt(4)
  v_cvt_pk_bf16_f32 v96, v96, v97
  v_cvt_pk_bf16_f32 v97, v98, v99
  v_mfma_f32_16x16x32_bf16 v[144:147], a[88:91], a[32:35], v[144:147]
  ds_read_b64_tr_b16 a[72:73], v15 offset:16384
  v_cvt_pk_bf16_f32 v98, v112, v113
  v_mfma_f32_16x16x32_bf16 v[144:147], a[92:95], a[48:51], v[144:147]
  ds_read_b64_tr_b16 a[74:75], v15 offset:17408
  v_cvt_pk_bf16_f32 v99, v114, v115
  v_mfma_f32_16x16x32_bf16 v[148:151], a[92:95], a[52:55], v[148:151]
  v_cvt_pk_bf16_f32 v100, v100, v101
  v_cvt_pk_bf16_f32 v101, v102, v103
  v_mfma_f32_16x16x32_bf16 v[148:151], a[88:91], a[36:39], v[148:151]
  v_cvt_pk_bf16_f32 v102, v116, v117
  v_cvt_pk_bf16_f32 v103, v118, v119
  v_mfma_f32_16x16x32_bf16 v[152:155], a[88:91], a[40:43], v[152:155]
  ds_read_b64_tr_b16 a[76:77], v15 offset:24576
  s_add_u32 s65, s73, 256
  v_cvt_pk_bf16_f32 v104, v104, v105
  v_mfma_f32_16x16x32_bf16 v[152:155], a[92:95], a[56:59], v[152:155]
  ds_read_b64_tr_b16 a[78:79], v15 offset:25600
  s_add_u32 m0, s84, 2048
  v_cvt_pk_bf16_f32 v105, v106, v107
  v_mfma_f32_16x16x32_bf16 v[156:159], a[92:95], a[60:63], v[156:159]
  buffer_load_dwordx4 v20, s[8:11], s65 offen offset:0 lds
  v_mfma_f32_16x16x32_bf16 v[156:159], a[88:91], a[44:47], v[156:159]
  s_waitcnt lgkmcnt(4)
  v_cvt_pk_bf16_f32 v106, v120, v121
  v_cvt_pk_bf16_f32 v107, v122, v123
  v_mfma_f32_16x16x32_bf16 a[128:131], a[32:35], a[64:67], a[128:131]
  ds_read_b64_tr_b16 a[80:81], v8 offset:16384
  v_cvt_pk_bf16_f32 v108, v108, v109
  v_mfma_f32_16x16x32_bf16 a[128:131], a[48:51], a[68:71], a[128:131]
  ds_read_b64_tr_b16 a[82:83], v8 offset:17408
  v_cvt_pk_bf16_f32 v109, v110, v111
  v_mfma_f32_16x16x32_bf16 a[132:135], a[52:55], a[68:71], a[132:135]
  buffer_load_dwordx4 v21, s[8:11], s65 offen offset:1024 lds
  v_mfma_f32_16x16x32_bf16 a[132:135], a[36:39], a[64:67], a[132:135]
  v_cvt_pk_bf16_f32 v110, v124, v125
  v_cvt_pk_bf16_f32 v111, v126, v127
  v_mfma_f32_16x16x32_bf16 a[136:139], a[40:43], a[64:67], a[136:139]
  ds_read_b64_tr_b16 a[84:85], v8 offset:24576
  s_add_u32 s65, s74, 256
  v_cvt_pk_bf16_f32 v128, v128, v129
  v_mfma_f32_16x16x32_bf16 a[136:139], a[56:59], a[68:71], a[136:139]
  ds_read_b64_tr_b16 a[86:87], v8 offset:25600
  s_add_u32 m0, s84, 4096
  v_cvt_pk_bf16_f32 v129, v130, v131
  v_mfma_f32_16x16x32_bf16 a[140:143], a[60:63], a[68:71], a[140:143]
  buffer_load_dwordx4 v20, s[8:11], s65 offen offset:0 lds
  v_mfma_f32_16x16x32_bf16 a[140:143], a[44:47], a[64:67], a[140:143]
  s_waitcnt lgkmcnt(4)
  v_cvt_pk_bf16_f32 v130, v144, v145
  v_cvt_pk_bf16_f32 v131, v146, v147
  v_mfma_f32_16x16x32_bf16 a[144:147], a[32:35], a[72:75], a[144:147]
  ds_read_b64_tr_b16 a[88:89], v9 offset:16384
  v_cvt_pk_bf16_f32 v132, v132, v133
  v_mfma_f32_16x16x32_bf16 a[144:147], a[48:51], a[76:79], a[144:147]
  ds_read_b64_tr_b16 a[90:91], v9 offset:17408
  s_add_u32 s81, s85, 2048
  v_cvt_pk_bf16_f32 v133, v134, v135
  v_mfma_f32_16x16x32_bf16 a[148:151], a[52:55], a[76:79], a[148:151]
  buffer_store_dwordx4 v[64:67], v1, s[40:43], s81 offen sc1
  v_mfma_f32_16x16x32_bf16 a[148:151], a[36:39], a[72:75], a[148:151]
  v_cvt_pk_bf16_f32 v134, v148, v149
  v_cvt_pk_bf16_f32 v135, v150, v151
  v_mfma_f32_16x16x32_bf16 a[152:155], a[40:43], a[72:75], a[152:155]
  ds_read_b64_tr_b16 a[92:93], v9 offset:24576
  v_cvt_pk_bf16_f32 v136, v136, v137
  v_mfma_f32_16x16x32_bf16 a[152:155], a[56:59], a[76:79], a[152:155]
  ds_read_b64_tr_b16 a[94:95], v9 offset:25600
  v_cvt_pk_bf16_f32 v137, v138, v139
  v_mfma_f32_16x16x32_bf16 a[156:159], a[60:63], a[76:79], a[156:159]
  v_cvt_pk_bf16_f32 v138, v152, v153
  v_cvt_pk_bf16_f32 v139, v154, v155
  v_mfma_f32_16x16x32_bf16 a[156:159], a[44:47], a[72:75], a[156:159]
  s_waitcnt lgkmcnt(4)
  v_cvt_pk_bf16_f32 v140, v140, v141
  v_cvt_pk_bf16_f32 v141, v142, v143
  v_mfma_f32_16x16x32_bf16 v[160:163], a[32:35], a[80:83], v[160:163]
  ds_read_b64_tr_b16 a[64:65], v10 offset:16384
  v_cvt_pk_bf16_f32 v142, v156, v157
  v_mfma_f32_16x16x32_bf16 v[160:163], a[48:51], a[84:87], v[160:163]
  ds_read_b64_tr_b16 a[66:67], v10 offset:17408
  v_cvt_pk_bf16_f32 v143, v158, v159
  v_mfma_f32_16x16x32_bf16 v[164:167], a[52:55], a[84:87], v[164:167]
  buffer_load_dwordx4 v21, s[8:11], s65 offen offset:1024 lds
  v_mfma_f32_16x16x32_bf16 v[164:167], a[36:39], a[80:83], v[164:167]
  v_mfma_f32_16x16x32_bf16 v[168:171], a[40:43], a[80:83], v[168:171]
  ds_read_b64_tr_b16 a[68:69], v10 offset:24576
  s_add_u32 s65, s75, 256
  v_accvgpr_read_b32 v48, a128
  v_mfma_f32_16x16x32_bf16 v[168:171], a[56:59], a[84:87], v[168:171]
  ds_read_b64_tr_b16 a[70:71], v10 offset:25600
  s_add_u32 m0, s84, 6144
  v_accvgpr_read_b32 v49, a129
  v_mfma_f32_16x16x32_bf16 v[172:175], a[60:63], a[84:87], v[172:175]
  buffer_load_dwordx4 v20, s[8:11], s65 offen offset:0 lds
  v_mfma_f32_16x16x32_bf16 v[172:175], a[44:47], a[80:83], v[172:175]
  s_waitcnt lgkmcnt(4)
  v_mfma_f32_16x16x32_bf16 v[176:179], a[32:35], a[88:91], v[176:179]
  ds_read_b64_tr_b16 a[72:73], v11 offset:16384
  v_accvgpr_read_b32 v50, a130
  v_mfma_f32_16x16x32_bf16 v[176:179], a[48:51], a[92:95], v[176:179]
  ds_read_b64_tr_b16 a[74:75], v11 offset:17408
  v_accvgpr_read_b32 v51, a131
  v_mfma_f32_16x16x32_bf16 v[180:183], a[52:55], a[92:95], v[180:183]
  buffer_load_dwordx4 v21, s[8:11], s65 offen offset:1024 lds
  v_mfma_f32_16x16x32_bf16 v[180:183], a[36:39], a[88:91], v[180:183]
  v_mfma_f32_16x16x32_bf16 v[184:187], a[40:43], a[88:91], v[184:187]
  ds_read_b64_tr_b16 a[76:77], v11 offset:24576
  v_accvgpr_read_b32 v52, a132
  v_mfma_f32_16x16x32_bf16 v[184:187], a[56:59], a[92:95], v[184:187]
  ds_read_b64_tr_b16 a[78:79], v11 offset:25600
  v_accvgpr_read_b32 v53, a133
  v_mfma_f32_16x16x32_bf16 v[188:191], a[60:63], a[92:95], v[188:191]
  v_accvgpr_read_b32 v54, a134
  v_accvgpr_read_b32 v55, a135
  v_mfma_f32_16x16x32_bf16 v[188:191], a[44:47], a[88:91], v[188:191]
  s_waitcnt lgkmcnt(4)
  v_mfma_f32_16x16x32_bf16 v[192:195], a[32:35], a[64:67], v[192:195]
  ds_read_b64_tr_b16 a[80:81], v12 offset:16384
  v_accvgpr_read_b32 v56, a144
  v_mfma_f32_16x16x32_bf16 v[192:195], a[48:51], a[68:71], v[192:195]
  ds_read_b64_tr_b16 a[82:83], v12 offset:17408
  v_accvgpr_read_b32 v57, a145
  v_mfma_f32_16x16x32_bf16 v[196:199], a[52:55], a[68:71], v[196:199]
  ds_read_b64_tr_b16 a[84:85], v12 offset:24576
  v_accvgpr_read_b32 v58, a146
  v_mfma_f32_16x16x32_bf16 v[196:199], a[36:39], a[64:67], v[196:199]
  ds_read_b64_tr_b16 a[86:87], v12 offset:25600
  v_mfma_f32_16x16x32_bf16 v[200:203], a[40:43], a[64:67], v[200:203]
  ds_read_b64_tr_b16 a[88:89], v13 offset:16384
  v_accvgpr_read_b32 v59, a147
  v_mfma_f32_16x16x32_bf16 v[200:203], a[56:59], a[68:71], v[200:203]
  ds_read_b64_tr_b16 a[90:91], v13 offset:17408
  v_accvgpr_read_b32 v60, a148
  v_mfma_f32_16x16x32_bf16 v[204:207], a[60:63], a[68:71], v[204:207]
  ds_read_b64_tr_b16 a[92:93], v13 offset:24576
  v_accvgpr_read_b32 v61, a149
  v_mfma_f32_16x16x32_bf16 v[204:207], a[44:47], a[64:67], v[204:207]
  ds_read_b64_tr_b16 a[94:95], v13 offset:25600
  s_waitcnt lgkmcnt(8)
  v_mfma_f32_16x16x32_bf16 v[208:211], a[32:35], a[72:75], v[208:211]
  v_accvgpr_read_b32 v62, a150
  v_accvgpr_read_b32 v63, a151
  v_mfma_f32_16x16x32_bf16 v[208:211], a[48:51], a[76:79], v[208:211]
  s_add_u32 s81, s85, 3072
  v_accvgpr_read_b32 v80, a136
  v_accvgpr_read_b32 v81, a137
  v_mfma_f32_16x16x32_bf16 v[212:215], a[52:55], a[76:79], v[212:215]
  buffer_store_dwordx4 v[68:71], v1, s[40:43], s81 offen sc1
  v_mfma_f32_16x16x32_bf16 v[212:215], a[36:39], a[72:75], v[212:215]
  v_mfma_f32_16x16x32_bf16 v[216:219], a[40:43], a[72:75], v[216:219]
  v_accvgpr_read_b32 v82, a138
  v_accvgpr_read_b32 v83, a139
  v_mfma_f32_16x16x32_bf16 v[216:219], a[56:59], a[76:79], v[216:219]
  v_accvgpr_read_b32 v84, a140
  v_accvgpr_read_b32 v85, a141
  v_mfma_f32_16x16x32_bf16 v[220:223], a[60:63], a[76:79], v[220:223]
  v_accvgpr_read_b32 v86, a142
  v_accvgpr_read_b32 v87, a143
  v_mfma_f32_16x16x32_bf16 v[220:223], a[44:47], a[72:75], v[220:223]
  s_waitcnt lgkmcnt(4)
  s_waitcnt vmcnt(27) lgkmcnt(0)
  s_barrier
  v_mfma_f32_16x16x32_bf16 v[224:227], a[32:35], a[80:83], v[224:227]
  ds_read_b64_tr_b16 a[64:65], v10 offset:32768
  v_accvgpr_read_b32 v88, a152
  v_mfma_f32_16x16x32_bf16 v[224:227], a[48:51], a[84:87], v[224:227]
  ds_read_b64_tr_b16 a[66:67], v10 offset:33792
  v_accvgpr_read_b32 v89, a153
  v_mfma_f32_16x16x32_bf16 v[228:231], a[52:55], a[84:87], v[228:231]
  v_accvgpr_read_b32 v90, a154
  v_accvgpr_read_b32 v91, a155
  v_mfma_f32_16x16x32_bf16 v[228:231], a[36:39], a[80:83], v[228:231]
  v_mfma_f32_16x16x32_bf16 v[232:235], a[40:43], a[80:83], v[232:235]
  ds_read_b64_tr_b16 a[68:69], v10 offset:40960
  v_accvgpr_read_b32 v92, a156
  v_mfma_f32_16x16x32_bf16 v[232:235], a[56:59], a[84:87], v[232:235]
  ds_read_b64_tr_b16 a[70:71], v10 offset:41984
  v_accvgpr_read_b32 v93, a157
  v_mfma_f32_16x16x32_bf16 v[236:239], a[60:63], a[84:87], v[236:239]
  v_accvgpr_read_b32 v94, a158
  v_accvgpr_read_b32 v95, a159
  v_mfma_f32_16x16x32_bf16 v[236:239], a[44:47], a[80:83], v[236:239]
  v_mfma_f32_16x16x32_bf16 v[240:243], a[32:35], a[88:91], v[240:243]
  ds_read_b64_tr_b16 a[72:73], v11 offset:32768
  v_cvt_pk_bf16_f32 v160, v160, v161
  v_mfma_f32_16x16x32_bf16 v[240:243], a[48:51], a[92:95], v[240:243]
  ds_read_b64_tr_b16 a[74:75], v11 offset:33792
  v_cvt_pk_bf16_f32 v161, v162, v163
  v_mfma_f32_16x16x32_bf16 v[244:247], a[52:55], a[92:95], v[244:247]
  v_cvt_pk_bf16_f32 v162, v164, v165
  v_cvt_pk_bf16_f32 v163, v166, v167
  v_mfma_f32_16x16x32_bf16 v[244:247], a[36:39], a[88:91], v[244:247]
  v_mfma_f32_16x16x32_bf16 v[248:251], a[40:43], a[88:91], v[248:251]
  ds_read_b64_tr_b16 a[76:77], v11 offset:40960
  v_cvt_pk_bf16_f32 v168, v168, v169
  v_mfma_f32_16x16x32_bf16 v[248:251], a[56:59], a[92:95], v[248:251]
  ds_read_b64_tr_b16 a[78:79], v11 offset:41984
  v_cvt_pk_bf16_f32 v169, v170, v171
  v_mfma_f32_16x16x32_bf16 v[252:255], a[60:63], a[92:95], v[252:255]
  v_cvt_pk_bf16_f32 v170, v172, v173
  v_cvt_pk_bf16_f32 v171, v174, v175
  v_mfma_f32_16x16x32_bf16 v[252:255], a[44:47], a[88:91], v[252:255]
  s_waitcnt lgkmcnt(4)
Lp1epi:
  s_waitcnt vmcnt(18)
  v_mfma_f32_16x16x32_bf16 a[160:163], a[64:67], a[0:3], 0
  ds_read_b64_tr_b16 a[80:81], v12 offset:32768
  v_cvt_pk_bf16_f32 v176, v176, v177
  v_mfma_f32_16x16x32_bf16 a[160:163], a[68:71], a[16:19], a[160:163]
  ds_read_b64_tr_b16 a[82:83], v12 offset:33792
  s_add_u32 s81, s85, 4096
  v_cvt_pk_bf16_f32 v177, v178, v179
  v_mfma_f32_16x16x32_bf16 a[164:167], a[68:71], a[20:23], 0
  buffer_store_dwordx4 v[96:99], v1, s[40:43], s81 offen sc1
  v_mfma_f32_16x16x32_bf16 a[164:167], a[64:67], a[4:7], a[164:167]
  ds_read_b128 a[32:35], v28 offset:8192
  v_mfma_f32_16x16x32_bf16 a[168:171], a[64:67], a[8:11], 0
  ds_read_b64_tr_b16 a[84:85], v12 offset:40960
  s_add_u32 s65, s76, 1048576
  v_cvt_pk_bf16_f32 v178, v180, v181
  v_mfma_f32_16x16x32_bf16 a[168:171], a[68:71], a[24:27], a[168:171]
  ds_read_b64_tr_b16 a[86:87], v12 offset:41984
  s_add_u32 m0, s78, 0
  v_cvt_pk_bf16_f32 v179, v182, v183
  v_mfma_f32_16x16x32_bf16 a[172:175], a[68:71], a[28:31], 0
  buffer_load_dwordx4 v2, s[16:19], s65 offen offset:0 lds
  v_mfma_f32_16x16x32_bf16 a[172:175], a[64:67], a[12:15], a[172:175]
  ds_read_b128 a[36:39], v28 offset:10240
  s_waitcnt lgkmcnt(6)
  v_mfma_f32_16x16x32_bf16 a[176:179], a[72:75], a[0:3], 0
  ds_read_b64_tr_b16 a[88:89], v13 offset:32768
  v_cvt_pk_bf16_f32 v184, v184, v185
  v_mfma_f32_16x16x32_bf16 a[176:179], a[76:79], a[16:19], a[176:179]
  ds_read_b64_tr_b16 a[90:91], v13 offset:33792
  v_cvt_pk_bf16_f32 v185, v186, v187
  v_mfma_f32_16x16x32_bf16 a[180:183], a[76:79], a[20:23], 0
  buffer_load_dwordx4 v3, s[16:19], s65 offen offset:1024 lds
  v_mfma_f32_16x16x32_bf16 a[180:183], a[72:75], a[4:7], a[180:183]
  ds_read_b128 a[40:43], v28 offset:12288
  v_mfma_f32_16x16x32_bf16 a[184:187], a[72:75], a[8:11], 0
  ds_read_b64_tr_b16 a[92:93], v13 offset:40960
  v_cvt_pk_bf16_f32 v186, v188, v189
  v_mfma_f32_16x16x32_bf16 a[184:187], a[76:79], a[24:27], a[184:187]
  ds_read_b64_tr_b16 a[94:95], v13 offset:41984
  v_cvt_pk_bf16_f32 v187, v190, v191
  v_mfma_f32_16x16x32_bf16 a[188:191], a[76:79], a[28:31], 0
  v_cvt_pk_bf16_f32 v192, v192, v193
  v_cvt_pk_bf16_f32 v193, v194, v195
  v_mfma_f32_16x16x32_bf16 a[188:191], a[72:75], a[12:15], a[188:191]
  ds_read_b128 a[44:47], v28 offset:14336
  s_waitcnt lgkmcnt(7)
  v_mfma_f32_16x16x32_bf16 a[192:195], a[80:83], a[0:3], 0
  ds_read_b64_tr_b16 a[64:65], v14 offset:32768
  v_cvt_pk_bf16_f32 v194, v196, v197
  v_mfma_f32_16x16x32_bf16 a[192:195], a[84:87], a[16:19], a[192:195]
  ds_read_b64_tr_b16 a[66:67], v14 offset:33792
  v_cvt_pk_bf16_f32 v195, v198, v199
  v_mfma_f32_16x16x32_bf16 a[196:199], a[84:87], a[20:23], 0
  buffer_load_dwordx4 v4, s[16:19], s65 offen offset:2048 lds
  v_mfma_f32_16x16x32_bf16 a[196:199], a[80:83], a[4:7], a[196:199]
  ds_read_b128 a[48:51], v29 offset:8192
  v_mfma_f32_16x16x32_bf16 a[200:203], a[80:83], a[8:11], 0
  ds_read_b64_tr_b16 a[68:69], v14 offset:40960
  v_cvt_pk_bf16_f32 v200, v200, v201
  v_mfma_f32_16x16x32_bf16 a[200:203], a[84:87], a[24:27], a[200:203]
  ds_read_b64_tr_b16 a[70:71], v14 offset:41984
  v_cvt_pk_bf16_f32 v201, v202, v203
  v_mfma_f32_16x16x32_bf16 a[204:207], a[84:87], a[28:31], 0
  buffer_load_dwordx4 v5, s[16:19], s65 offen offset:3072 lds
  v_mfma_f32_16x16x32_bf16 a[204:207], a[80:83], a[12:15], a[204:207]
  ds_read_b128 a[52:55], v29 offset:10240
  s_waitcnt lgkmcnt(7)
  v_mfma_f32_16x16x32_bf16 a[208:211], a[88:91], a[0:3], 0
  ds_read_b64_tr_b16 a[72:73], v15 offset:32768
  s_add_u32 s65, s77, 458752
  v_cvt_pk_bf16_f32 v202, v204, v205
  v_mfma_f32_16x16x32_bf16 a[208:211], a[92:95], a[16:19], a[208:211]
  ds_read_b64_tr_b16 a[74:75], v15 offset:33792
  s_add_u32 m0, s79, 16384
  v_cvt_pk_bf16_f32 v203, v206, v207
  v_mfma_f32_16x16x32_bf16 a[212:215], a[92:95], a[20:23], 0
  buffer_load_dwordx4 v6, s[56:59], s65 offen offset:0 lds
  v_mfma_f32_16x16x32_bf16 a[212:215], a[88:91], a[4:7], a[212:215]
  ds_read_b128 a[56:59], v29 offset:12288
  v_mfma_f32_16x16x32_bf16 a[216:219], a[88:91], a[8:11], 0
  ds_read_b64_tr_b16 a[76:77], v15 offset:40960
  v_cvt_pk_bf16_f32 v208, v208, v209
  v_mfma_f32_16x16x32_bf16 a[216:219], a[92:95], a[24:27], a[216:219]
  ds_read_b64_tr_b16 a[78:79], v15 offset:41984
  s_add_u32 s81, s85, 5120
  v_cvt_pk_bf16_f32 v209, v210, v211
  v_mfma_f32_16x16x32_bf16 a[220:223], a[92:95], a[28:31], 0
  buffer_store_dwordx4 v[100:103], v1, s[40:43], s81 offen sc1
  v_mfma_f32_16x16x32_bf16 a[220:223], a[88:91], a[12:15], a[220:223]
  ds_read_b128 a[60:63], v29 offset:14336
  s_waitcnt lgkmcnt(7)
  v_mfma_f32_16x16x32_bf16 a[224:227], a[64:67], a[0:3], 0
  ds_read_b64_tr_b16 a[80:81], v8 offset:32768
  v_cvt_pk_bf16_f32 v210, v212, v213
  v_mfma_f32_16x16x32_bf16 a[224:227], a[68:71], a[16:19], a[224:227]
  ds_read_b64_tr_b16 a[82:83], v8 offset:33792
  v_cvt_pk_bf16_f32 v211, v214, v215
  v_mfma_f32_16x16x32_bf16 a[228:231], a[68:71], a[20:23], 0
  v_cvt_pk_bf16_f32 v216, v216, v217
  v_cvt_pk_bf16_f32 v217, v218, v219
  v_mfma_f32_16x16x32_bf16 a[228:231], a[64:67], a[4:7], a[228:231]
  v_mfma_f32_16x16x32_bf16 a[232:235], a[64:67], a[8:11], 0
  ds_read_b64_tr_b16 a[84:85], v8 offset:40960
  v_cvt_pk_bf16_f32 v218, v220, v221
  v_mfma_f32_16x16x32_bf16 a[232:235], a[68:71], a[24:27], a[232:235]
  ds_read_b64_tr_b16 a[86:87], v8 offset:41984
  v_cvt_pk_bf16_f32 v219, v222, v223
  v_mfma_f32_16x16x32_bf16 a[236:239], a[68:71], a[28:31], 0
  buffer_load_dwordx4 v7, s[56:59], s65 offen offset:1024 lds
  v_mfma_f32_16x16x32_bf16 a[236:239], a[64:67], a[12:15], a[236:239]
  s_waitcnt lgkmcnt(5)
  v_mfma_f32_16x16x32_bf16 a[240:243], a[72:75], a[0:3], 0
  ds_read_b64_tr_b16 a[88:89], v9 offset:32768
  v_cvt_pk_bf16_f32 v196, v48, v49
  v_mfma_f32_16x16x32_bf16 a[240:243], a[76:79], a[16:19], a[240:243]
  ds_read_b64_tr_b16 a[90:91], v9 offset:33792
  v_cvt_pk_bf16_f32 v197, v50, v51
  v_mfma_f32_16x16x32_bf16 a[244:247], a[76:79], a[20:23], 0
  v_cvt_pk_bf16_f32 v198, v52, v53
  v_cvt_pk_bf16_f32 v199, v54, v55
  v_mfma_f32_16x16x32_bf16 a[244:247], a[72:75], a[4:7], a[244:247]
  v_mfma_f32_16x16x32_bf16 a[248:251], a[72:75], a[8:11], 0
  ds_read_b64_tr_b16 a[92:93], v9 offset:40960
  v_cvt_pk_bf16_f32 v204, v56, v57
  v_mfma_f32_16x16x32_bf16 a[248:251], a[76:79], a[24:27], a[248:251]
  ds_read_b64_tr_b16 a[94:95], v9 offset:41984
  v_cvt_pk_bf16_f32 v205, v58, v59
  v_mfma_f32_16x16x32_bf16 a[252:255], a[76:79], a[28:31], 0
  v_cvt_pk_bf16_f32 v206, v60, v61
  v_cvt_pk_bf16_f32 v207, v62, v63
  v_mfma_f32_16x16x32_bf16 a[252:255], a[72:75], a[12:15], a[252:255]
  s_waitcnt lgkmcnt(4)
  v_mfma_f32_16x16x32_bf16 a[128:131], a[80:83], a[0:3], 0
  ds_read_b64_tr_b16 a[64:65], v16 offset:49152
  s_add_u32 s65, s72, 384
  v_cvt_pk_bf16_f32 v212, v80, v81
  v_mfma_f32_16x16x32_bf16 a[128:131], a[84:87], a[16:19], a[128:131]
  ds_read_b64_tr_b16 a[66:67], v16 offset:49664
  s_add_u32 m0, s84, 8192
  v_cvt_pk_bf16_f32 v213, v82, v83
  v_mfma_f32_16x16x32_bf16 a[132:135], a[84:87], a[20:23], 0
  buffer_load_dwordx4 v20, s[8:11], s65 offen offset:0 lds
  v_mfma_f32_16x16x32_bf16 a[132:135], a[80:83], a[4:7], a[132:135]
  v_mfma_f32_16x16x32_bf16 a[136:139], a[80:83], a[8:11], 0
  ds_read_b64_tr_b16 a[68:69], v16 offset:53248
  v_cvt_pk_bf16_f32 v214, v84, v85
  v_mfma_f32_16x16x32_bf16 a[136:139], a[84:87], a[24:27], a[136:139]
  ds_read_b64_tr_b16 a[70:71], v16 offset:53760
  v_cvt_pk_bf16_f32 v215, v86, v87
  v_mfma_f32_16x16x32_bf16 a[140:143], a[84:87], a[28:31], 0
  buffer_load_dwordx4 v21, s[8:11], s65 offen offset:1024 lds
  v_mfma_f32_16x16x32_bf16 a[140:143], a[80:83], a[12:15], a[140:143]
  s_waitcnt lgkmcnt(4)
  v_mfma_f32_16x16x32_bf16 a[144:147], a[88:91], a[0:3], 0
  ds_read_b64_tr_b16 a[72:73], v17 offset:49152
  v_cvt_pk_bf16_f32 v220, v88, v89
  v_mfma_f32_16x16x32_bf16 a[144:147], a[92:95], a[16:19], a[144:147]
  ds_read_b64_tr_b16 a[74:75], v17 offset:49664
  s_add_u32 s81, s85, 6144
  v_cvt_pk_bf16_f32 v221, v90, v91
  v_mfma_f32_16x16x32_bf16 a[148:151], a[92:95], a[20:23], 0
  buffer_store_dwordx4 v[128:131], v1, s[40:43], s81 offen sc1
  v_mfma_f32_16x16x32_bf16 a[148:151], a[88:91], a[4:7], a[148:151]
  v_mfma_f32_16x16x32_bf16 a[152:155], a[88:91], a[8:11], 0
  ds_read_b64_tr_b16 a[76:77], v17 offset:53248
  v_cvt_pk_bf16_f32 v222, v92, v93
  v_mfma_f32_16x16x32_bf16 a[152:155], a[92:95], a[24:27], a[152:155]
  ds_read_b64_tr_b16 a[78:79], v17 offset:53760
  v_cvt_pk_bf16_f32 v223, v94, v95
  v_mfma_f32_16x16x32_bf16 a[156:159], a[92:95], a[28:31], 0
  v_accvgpr_read_b32 v165, a96
  v_accvgpr_read_b32 v167, a97
  v_mfma_f32_16x16x32_bf16 a[156:159], a[88:91], a[12:15], a[156:159]
  s_waitcnt lgkmcnt(4)
  v_lshlrev_b32 v164, 16, v165
  v_lshlrev_b32 v166, 16, v167
  v_and_b32 v165, 0xffff0000, v165
  v_and_b32 v167, 0xffff0000, v167
  v_accvgpr_read_b32 v173, a98
  v_accvgpr_read_b32 v175, a99
  v_lshlrev_b32 v172, 16, v173
  v_lshlrev_b32 v174, 16, v175
  v_and_b32 v173, 0xffff0000, v173
  v_and_b32 v175, 0xffff0000, v175
  v_accvgpr_read_b32 v181, a100
  v_accvgpr_read_b32 v183, a101
  v_lshlrev_b32 v180, 16, v181
  v_lshlrev_b32 v182, 16, v183
  v_and_b32 v181, 0xffff0000, v181
  v_and_b32 v183, 0xffff0000, v183
  v_accvgpr_read_b32 v189, a102
  v_accvgpr_read_b32 v191, a103
  v_lshlrev_b32 v188, 16, v189
  v_lshlrev_b32 v190, 16, v191
  v_and_b32 v189, 0xffff0000, v189
  v_and_b32 v191, 0xffff0000, v191
  s_nop 1
  v_mfma_f32_16x16x32_bf16 v[48:51], a[64:67], a[0:3], v[164:167]
  ds_read_b64_tr_b16 a[80:81], v18 offset:49152
  v_cvt_pk_bf16_f32 v224, v224, v225
  v_mfma_f32_16x16x32_bf16 v[48:51], a[68:71], a[16:19], v[48:51]
  ds_read_b64_tr_b16 a[82:83], v18 offset:49664
  v_cvt_pk_bf16_f32 v225, v226, v227
  v_mfma_f32_16x16x32_bf16 v[52:55], a[68:71], a[20:23], v[164:167]
  ds_read_b64_tr_b16 a[84:85], v18 offset:53248
  v_cvt_pk_bf16_f32 v226, v228, v229
  v_mfma_f32_16x16x32_bf16 v[52:55], a[64:67], a[4:7], v[52:55]
  ds_read_b64_tr_b16 a[86:87], v18 offset:53760
  v_cvt_pk_bf16_f32 v227, v230, v231
  v_mfma_f32_16x16x32_bf16 v[56:59], a[64:67], a[8:11], v[164:167]
  ds_read_b64_tr_b16 a[88:89], v19 offset:49152
  s_add_u32 s65, s73, 384
  v_cvt_pk_bf16_f32 v232, v232, v233
  v_mfma_f32_16x16x32_bf16 v[56:59], a[68:71], a[24:27], v[56:59]
  ds_read_b64_tr_b16 a[90:91], v19 offset:49664
  s_add_u32 m0, s84, 10240
  v_cvt_pk_bf16_f32 v233, v234, v235
  v_mfma_f32_16x16x32_bf16 v[60:63], a[68:71], a[28:31], v[164:167]
  ds_read_b64_tr_b16 a[92:93], v19 offset:53248
  buffer_load_dwordx4 v20, s[8:11], s65 offen offset:0 lds
  v_mfma_f32_16x16x32_bf16 v[60:63], a[64:67], a[12:15], v[60:63]
  ds_read_b64_tr_b16 a[94:95], v19 offset:53760
  s_waitcnt lgkmcnt(8)
  v_cvt_pk_bf16_f32 v234, v236, v237
  v_mfma_f32_16x16x32_bf16 v[80:83], a[72:75], a[0:3], v[172:175]
  v_cvt_pk_bf16_f32 v235, v238, v239
  v_cvt_pk_bf16_f32 v240, v240, v241
  v_mfma_f32_16x16x32_bf16 v[80:83], a[76:79], a[16:19], v[80:83]
  v_cvt_pk_bf16_f32 v241, v242, v243
  v_cvt_pk_bf16_f32 v242, v244, v245
  v_mfma_f32_16x16x32_bf16 v[84:87], a[76:79], a[20:23], v[172:175]
  buffer_load_dwordx4 v21, s[8:11], s65 offen offset:1024 lds
  v_mfma_f32_16x16x32_bf16 v[84:87], a[72:75], a[4:7], v[84:87]
  v_cvt_pk_bf16_f32 v243, v246, v247
  v_cvt_pk_bf16_f32 v248, v248, v249
  v_mfma_f32_16x16x32_bf16 v[88:91], a[72:75], a[8:11], v[172:175]
  s_add_u32 s65, s74, 384
  v_cvt_pk_bf16_f32 v249, v250, v251
  v_cvt_pk_bf16_f32 v250, v252, v253
  v_mfma_f32_16x16x32_bf16 v[88:91], a[76:79], a[24:27], v[88:91]
  s_add_u32 m0, s84, 12288
  v_cvt_pk_bf16_f32 v251, v254, v255
  v_accvgpr_read_b32 v228, a104
  v_mfma_f32_16x16x32_bf16 v[92:95], a[76:79], a[28:31], v[172:175]
  buffer_load_dwordx4 v20, s[8:11], s65 offen offset:0 lds
  v_mfma_f32_16x16x32_bf16 v[92:95], a[72:75], a[12:15], v[92:95]
  s_waitcnt lgkmcnt(4)
  v_add_u32 v8, 0x20000, v8
  v_accvgpr_read_b32 v229, a105
  s_waitcnt vmcnt(26) lgkmcnt(0)
  s_barrier
  v_mfma_f32_16x16x32_bf16 v[112:115], a[80:83], a[0:3], v[180:183]
  ds_read_b64_tr_b16 a[64:65], v8 offset:0
  v_accvgpr_read_b32 v230, a106
  v_mfma_f32_16x16x32_bf16 v[112:115], a[84:87], a[16:19], v[112:115]
  ds_read_b64_tr_b16 a[66:67], v8 offset:1024
  v_accvgpr_read_b32 v231, a107
  v_mfma_f32_16x16x32_bf16 v[116:119], a[84:87], a[20:23], v[180:183]
  buffer_load_dwordx4 v21, s[8:11], s65 offen offset:1024 lds
  v_mfma_f32_16x16x32_bf16 v[116:119], a[80:83], a[4:7], v[116:119]
  v_accvgpr_read_b32 v236, a108
  v_accvgpr_read_b32 v237, a109
  v_mfma_f32_16x16x32_bf16 v[120:123], a[80:83], a[8:11], v[180:183]
  ds_read_b64_tr_b16 a[68:69], v8 offset:8192
  s_add_u32 s65, s75, 384
  v_accvgpr_read_b32 v238, a110
  v_mfma_f32_16x16x32_bf16 v[120:123], a[84:87], a[24:27], v[120:123]
  ds_read_b64_tr_b16 a[70:71], v8 offset:9216
  s_add_u32 m0, s84, 14336
  v_accvgpr_read_b32 v239, a111
  v_mfma_f32_16x16x32_bf16 v[124:127], a[84:87], a[28:31], v[180:183]
  buffer_load_dwordx4 v20, s[8:11], s65 offen offset:0 lds
  v_mfma_f32_16x16x32_bf16 v[124:127], a[80:83], a[12:15], v[124:127]
  v_add_u32 v9, 0x20000, v9
  v_accvgpr_read_b32 v244, a112
  v_mfma_f32_16x16x32_bf16 v[144:147], a[88:91], a[0:3], v[188:191]
  ds_read_b64_tr_b16 a[72:73], v9 offset:0
  v_accvgpr_read_b32 v245, a113
  v_mfma_f32_16x16x32_bf16 v[144:147], a[92:95], a[16:19], v[144:147]
  ds_read_b64_tr_b16 a[74:75], v9 offset:1024
  v_accvgpr_read_b32 v246, a114
  v_mfma_f32_16x16x32_bf16 v[148:151], a[92:95], a[20:23], v[188:191]
  buffer_load_dwordx4 v21, s[8:11], s65 offen offset:1024 lds
  v_mfma_f32_16x16x32_bf16 v[148:151], a[88:91], a[4:7], v[148:151]
  v_accvgpr_read_b32 v247, a115
  v_mfma_f32_16x16x32_bf16 v[152:155], a[88:91], a[8:11], v[188:191]
  ds_read_b64_tr_b16 a[76:77], v9 offset:8192
  v_mfma_f32_16x16x32_bf16 v[152:155], a[92:95], a[24:27], v[152:155]
  ds_read_b64_tr_b16 a[78:79], v9 offset:9216
  s_add_u32 s81, s85, 7168
  v_mfma_f32_16x16x32_bf16 v[156:159], a[92:95], a[28:31], v[188:191]
  buffer_store_dwordx4 v[132:135], v1, s[40:43], s81 offen sc1
  v_mfma_f32_16x16x32_bf16 v[156:159], a[88:91], a[12:15], v[156:159]
  s_waitcnt lgkmcnt(4)
  v_add_u32 v10, 0x20000, v10
  s_waitcnt vmcnt(19)
  v_mfma_f32_16x16x32_bf16 a[128:131], a[64:67], a[32:35], a[128:131]
  ds_read_b64_tr_b16 a[80:81], v10 offset:0
  v_mfma_f32_16x16x32_bf16 a[128:131], a[68:71], a[48:51], a[128:131]
  ds_read_b64_tr_b16 a[82:83], v10 offset:1024
  v_mfma_f32_16x16x32_bf16 a[132:135], a[68:71], a[52:55], a[132:135]
  v_dot2_f32_bf16 v252, v228, v236, 0
  v_mfma_f32_16x16x32_bf16 a[132:135], a[64:67], a[36:39], a[132:135]
  ds_read_b128 a[0:3], v28 offset:0
  v_mfma_f32_16x16x32_bf16 a[136:139], a[64:67], a[40:43], a[136:139]
  ds_read_b64_tr_b16 a[84:85], v10 offset:8192
  v_mfma_f32_16x16x32_bf16 a[136:139], a[68:71], a[56:59], a[136:139]
  ds_read_b64_tr_b16 a[86:87], v10 offset:9216
  v_mfma_f32_16x16x32_bf16 a[140:143], a[68:71], a[60:63], a[140:143]
  v_dot2_f32_bf16 v253, v228, v244, 0
  v_mfma_f32_16x16x32_bf16 a[140:143], a[64:67], a[44:47], a[140:143]
  ds_read_b128 a[4:7], v28 offset:2048
  s_waitcnt lgkmcnt(6)
  v_add_u32 v11, 0x20000, v11
  v_mfma_f32_16x16x32_bf16 a[144:147], a[72:75], a[32:35], a[144:147]
  ds_read_b64_tr_b16 a[88:89], v11 offset:0
  s_add_u32 s65, s76, 1572864
  v_mfma_f32_16x16x32_bf16 a[144:147], a[76:79], a[48:51], a[144:147]
  ds_read_b64_tr_b16 a[90:91], v11 offset:1024
  s_add_u32 m0, s78, 32768
  v_mfma_f32_16x16x32_bf16 a[148:151], a[76:79], a[52:55], a[148:151]
  buffer_load_dwordx4 v2, s[16:19], s65 offen offset:0 lds
  v_mfma_f32_16x16x32_bf16 a[148:151], a[72:75], a[36:39], a[148:151]
  ds_read_b128 a[8:11], v28 offset:4096
  v_mfma_f32_16x16x32_bf16 a[152:155], a[72:75], a[40:43], a[152:155]
  ds_read_b64_tr_b16 a[92:93], v11 offset:8192
  v_mfma_f32_16x16x32_bf16 a[152:155], a[76:79], a[56:59], a[152:155]
  ds_read_b64_tr_b16 a[94:95], v11 offset:9216
  v_mfma_f32_16x16x32_bf16 a[156:159], a[76:79], a[60:63], a[156:159]
  buffer_load_dwordx4 v3, s[16:19], s65 offen offset:1024 lds
  v_mfma_f32_16x16x32_bf16 a[156:159], a[72:75], a[44:47], a[156:159]
  ds_read_b128 a[12:15], v28 offset:6144
  s_waitcnt lgkmcnt(7)
  v_add_u32 v12, 0x20000, v12
  v_mfma_f32_16x16x32_bf16 a[160:163], a[80:83], a[32:35], a[160:163]
  ds_read_b64_tr_b16 a[64:65], v12 offset:0
  v_mfma_f32_16x16x32_bf16 a[160:163], a[84:87], a[48:51], a[160:163]
  ds_read_b64_tr_b16 a[66:67], v12 offset:1024
  s_add_u32 s81, s85, 16777216
  v_mfma_f32_16x16x32_bf16 a[164:167], a[84:87], a[52:55], a[164:167]
  buffer_store_dwordx4 v[160:163], v1, s[40:43], s81 offen sc1
  v_mfma_f32_16x16x32_bf16 a[164:167], a[80:83], a[36:39], a[164:167]
  ds_read_b128 a[16:19], v29 offset:0
  v_mfma_f32_16x16x32_bf16 a[168:171], a[80:83], a[40:43], a[168:171]
  ds_read_b64_tr_b16 a[68:69], v12 offset:8192
  v_mfma_f32_16x16x32_bf16 a[168:171], a[84:87], a[56:59], a[168:171]
  ds_read_b64_tr_b16 a[70:71], v12 offset:9216
  v_mfma_f32_16x16x32_bf16 a[172:175], a[84:87], a[60:63], a[172:175]
  v_dot2_f32_bf16 v252, v229, v237, v252
  v_mfma_f32_16x16x32_bf16 a[172:175], a[80:83], a[44:47], a[172:175]
  ds_read_b128 a[20:23], v29 offset:2048
  s_waitcnt lgkmcnt(7)
  v_add_u32 v13, 0x20000, v13
  v_mfma_f32_16x16x32_bf16 a[176:179], a[88:91], a[32:35], a[176:179]
  ds_read_b64_tr_b16 a[72:73], v13 offset:0
  v_mfma_f32_16x16x32_bf16 a[176:179], a[92:95], a[48:51], a[176:179]
  ds_read_b64_tr_b16 a[74:75], v13 offset:1024
  v_mfma_f32_16x16x32_bf16 a[180:183], a[92:95], a[52:55], a[180:183]
  buffer_load_dwordx4 v4, s[16:19], s65 offen offset:2048 lds
  v_mfma_f32_16x16x32_bf16 a[180:183], a[88:91], a[36:39], a[180:183]
  ds_read_b128 a[24:27], v29 offset:4096
  v_mfma_f32_16x16x32_bf16 a[184:187], a[88:91], a[40:43], a[184:187]
  ds_read_b64_tr_b16 a[76:77], v13 offset:8192
  v_mfma_f32_16x16x32_bf16 a[184:187], a[92:95], a[56:59], a[184:187]
  ds_read_b64_tr_b16 a[78:79], v13 offset:9216
  v_mfma_f32_16x16x32_bf16 a[188:191], a[92:95], a[60:63], a[188:191]
  buffer_load_dwordx4 v5, s[16:19], s65 offen offset:3072 lds
  v_mfma_f32_16x16x32_bf16 a[188:191], a[88:91], a[44:47], a[188:191]
  ds_read_b128 a[28:31], v29 offset:6144
  s_waitcnt lgkmcnt(7)
  v_add_u32 v14, 0x20000, v14
  v_mfma_f32_16x16x32_bf16 a[192:195], a[64:67], a[32:35], a[192:195]
  ds_read_b64_tr_b16 a[80:81], v14 offset:0
  s_add_u32 s65, s77, 688128
  v_mfma_f32_16x16x32_bf16 a[192:195], a[68:71], a[48:51], a[192:195]
  ds_read_b64_tr_b16 a[82:83], v14 offset:1024
  s_add_u32 m0, s79, 49152
  v_mfma_f32_16x16x32_bf16 a[196:199], a[68:71], a[52:55], a[196:199]
  buffer_load_dwordx4 v6, s[56:59], s65 offen offset:0 lds
  v_mfma_f32_16x16x32_bf16 a[196:199], a[64:67], a[36:39], a[196:199]
  v_dot2_f32_bf16 v253, v229, v245, v253
  v_mfma_f32_16x16x32_bf16 a[200:203], a[64:67], a[40:43], a[200:203]
  ds_read_b64_tr_b16 a[84:85], v14 offset:8192
  v_mfma_f32_16x16x32_bf16 a[200:203], a[68:71], a[56:59], a[200:203]
  ds_read_b64_tr_b16 a[86:87], v14 offset:9216
  v_mfma_f32_16x16x32_bf16 a[204:207], a[68:71], a[60:63], a[204:207]
  v_dot2_f32_bf16 v252, v230, v238, v252
  v_mfma_f32_16x16x32_bf16 a[204:207], a[64:67], a[44:47], a[204:207]
  s_waitcnt lgkmcnt(5)
  v_add_u32 v15, 0x20000, v15
  v_mfma_f32_16x16x32_bf16 a[208:211], a[72:75], a[32:35], a[208:211]
  ds_read_b64_tr_b16 a[88:89], v15 offset:0
  v_mfma_f32_16x16x32_bf16 a[208:211], a[76:79], a[48:51], a[208:211]
  ds_read_b64_tr_b16 a[90:91], v15 offset:1024
  v_mfma_f32_16x16x32_bf16 a[212:215], a[76:79], a[52:55], a[212:215]
  buffer_load_dwordx4 v7, s[56:59], s65 offen offset:1024 lds
  v_mfma_f32_16x16x32_bf16 a[212:215], a[72:75], a[36:39], a[212:215]
  v_dot2_f32_bf16 v253, v230, v246, v253
  v_mfma_f32_16x16x32_bf16 a[216:219], a[72:75], a[40:43], a[216:219]
  ds_read_b64_tr_b16 a[92:93], v15 offset:8192
  v_mfma_f32_16x16x32_bf16 a[216:219], a[76:79], a[56:59], a[216:219]
  ds_read_b64_tr_b16 a[94:95], v15 offset:9216
  s_add_u32 s81, s85, 16778240
  v_mfma_f32_16x16x32_bf16 a[220:223], a[76:79], a[60:63], a[220:223]
  buffer_store_dwordx4 v[176:179], v1, s[40:43], s81 offen sc1
  v_mfma_f32_16x16x32_bf16 a[220:223], a[72:75], a[44:47], a[220:223]
  s_waitcnt lgkmcnt(4)
  v_add_u32 v16, 0x20000, v16
  v_mfma_f32_16x16x32_bf16 a[224:227], a[80:83], a[32:35], a[224:227]
  ds_read_b64_tr_b16 a[64:65], v16 offset:16384
  s_add_u32 s65, s72, 512
  v_mfma_f32_16x16x32_bf16 a[224:227], a[84:87], a[48:51], a[224:227]
  ds_read_b64_tr_b16 a[66:67], v16 offset:16896
  s_add_u32 m0, s84, 0
  v_mfma_f32_16x16x32_bf16 a[228:231], a[84:87], a[52:55], a[228:231]
  buffer_load_dwordx4 v20, s[8:11], s65 offen offset:0 lds
  v_mfma_f32_16x16x32_bf16 a[228:231], a[80:83], a[36:39], a[228:231]
  v_dot2_f32_bf16 v252, v231, v239, v252
  v_mfma_f32_16x16x32_bf16 a[232:235], a[80:83], a[40:43], a[232:235]
  ds_read_b64_tr_b16 a[68:69], v16 offset:20480
  v_mfma_f32_16x16x32_bf16 a[232:235], a[84:87], a[56:59], a[232:235]
  ds_read_b64_tr_b16 a[70:71], v16 offset:20992
  v_mfma_f32_16x16x32_bf16 a[236:239], a[84:87], a[60:63], a[236:239]
  v_dot2_f32_bf16 v253, v231, v247, v253
  v_mfma_f32_16x16x32_bf16 a[236:239], a[80:83], a[44:47], a[236:239]
  s_waitcnt lgkmcnt(4)
  v_add_u32 v17, 0x20000, v17
  s_nop 2
  v_mfma_f32_16x16x32_bf16 a[240:243], a[88:91], a[32:35], a[240:243]
  ds_read_b64_tr_b16 a[72:73], v17 offset:16384
  v_add_f32_dpp v252, v252, v252 quad_perm:[1,0,3,2] row_mask:0xf bank_mask:0xf
  v_mfma_f32_16x16x32_bf16 a[240:243], a[92:95], a[48:51], a[240:243]
  ds_read_b64_tr_b16 a[74:75], v17 offset:16896
  v_add_f32_dpp v253, v253, v253 quad_perm:[1,0,3,2] row_mask:0xf bank_mask:0xf
  v_mfma_f32_16x16x32_bf16 a[244:247], a[92:95], a[52:55], a[244:247]
  buffer_load_dwordx4 v21, s[8:11], s65 offen offset:1024 lds
  s_nop 0
  v_mfma_f32_16x16x32_bf16 a[244:247], a[88:91], a[36:39], a[244:247]
  v_add_f32_dpp v252, v252, v252 quad_perm:[2,3,0,1] row_mask:0xf bank_mask:0xf
  v_add_f32_dpp v253, v253, v253 quad_perm:[2,3,0,1] row_mask:0xf bank_mask:0xf
  v_mfma_f32_16x16x32_bf16 a[248:251], a[88:91], a[40:43], a[248:251]
  ds_read_b64_tr_b16 a[76:77], v17 offset:20480
  s_add_u32 s65, s73, 512
  s_nop 0
  v_mfma_f32_16x16x32_bf16 a[248:251], a[92:95], a[56:59], a[248:251]
  ds_read_b64_tr_b16 a[78:79], v17 offset:20992
  s_add_u32 m0, s84, 2048
  v_add_f32_dpp v252, v252, v252 row_half_mirror row_mask:0xf bank_mask:0xf
  v_mfma_f32_16x16x32_bf16 a[252:255], a[92:95], a[60:63], a[252:255]
  buffer_load_dwordx4 v20, s[8:11], s65 offen offset:0 lds
  v_mfma_f32_16x16x32_bf16 a[252:255], a[88:91], a[44:47], a[252:255]
  s_waitcnt lgkmcnt(4)
  v_add_u32 v18, 0x20000, v18
  v_add_f32_dpp v253, v253, v253 row_half_mirror row_mask:0xf bank_mask:0xf
  v_mfma_f32_16x16x32_bf16 v[48:51], a[64:67], a[32:35], v[48:51]
  ds_read_b64_tr_b16 a[80:81], v18 offset:16384
  s_nop 0
  v_add_f32_dpp v252, v252, v252 row_mirror row_mask:0xf bank_mask:0xf
  v_mfma_f32_16x16x32_bf16 v[48:51], a[68:71], a[48:51], v[48:51]
  ds_read_b64_tr_b16 a[82:83], v18 offset:16896
  v_add_f32_dpp v253, v253, v253 row_mirror row_mask:0xf bank_mask:0xf
  v_mfma_f32_16x16x32_bf16 v[52:55], a[68:71], a[52:55], v[52:55]
  ds_read_b64_tr_b16 a[84:85], v18 offset:20480
  s_nop 0
  v_mov_b32 v254, v252
  v_mfma_f32_16x16x32_bf16 v[52:55], a[64:67], a[36:39], v[52:55]
  ds_read_b64_tr_b16 a[86:87], v18 offset:20992
  v_add_u32 v19, 0x20000, v19
  v_mfma_f32_16x16x32_bf16 v[56:59], a[64:67], a[40:43], v[56:59]
  ds_read_b64_tr_b16 a[88:89], v19 offset:16384
  v_mov_b32 v255, v253
  v_mfma_f32_16x16x32_bf16 v[56:59], a[68:71], a[56:59], v[56:59]
  ds_read_b64_tr_b16 a[90:91], v19 offset:16896
  s_nop 1
  v_permlane16_swap_b32 v252, v254
  v_mfma_f32_16x16x32_bf16 v[60:63], a[68:71], a[60:63], v[60:63]
  ds_read_b64_tr_b16 a[92:93], v19 offset:20480
  v_permlane16_swap_b32 v253, v255
  v_mfma_f32_16x16x32_bf16 v[60:63], a[64:67], a[44:47], v[60:63]
  ds_read_b64_tr_b16 a[94:95], v19 offset:20992
  s_waitcnt lgkmcnt(8)
  v_add_f32 v252, v252, v254
  v_mfma_f32_16x16x32_bf16 v[80:83], a[72:75], a[32:35], v[80:83]
  v_add_f32 v253, v253, v255
  v_mov_b32 v254, v252
  v_mfma_f32_16x16x32_bf16 v[80:83], a[76:79], a[48:51], v[80:83]
  v_mov_b32 v255, v253
  s_nop 1
  v_mfma_f32_16x16x32_bf16 v[84:87], a[76:79], a[52:55], v[84:87]
  buffer_load_dwordx4 v21, s[8:11], s65 offen offset:1024 lds
  v_mfma_f32_16x16x32_bf16 v[84:87], a[72:75], a[36:39], v[84:87]
  v_permlane32_swap_b32 v252, v254
  v_permlane32_swap_b32 v253, v255
  v_mfma_f32_16x16x32_bf16 v[88:91], a[72:75], a[40:43], v[88:91]
  s_add_u32 s65, s74, 512
  v_add_f32 v252, v252, v254
  v_add_f32 v253, v253, v255
  v_mfma_f32_16x16x32_bf16 v[88:91], a[76:79], a[56:59], v[88:91]
  s_add_u32 m0, s84, 4096
  v_mul_f32 v252, 0xbfb8aa3b, v252
  v_mul_f32 v253, 0xbfb8aa3b, v253
  v_mfma_f32_16x16x32_bf16 v[92:95], a[76:79], a[60:63], v[92:95]
  buffer_load_dwordx4 v20, s[8:11], s65 offen offset:0 lds
  v_mfma_f32_16x16x32_bf16 v[92:95], a[72:75], a[44:47], v[92:95]
  s_waitcnt lgkmcnt(4)
  v_add_u32 v8, 0xfffe0000, v8
  s_waitcnt vmcnt(23) lgkmcnt(0)
  s_barrier
  v_mfma_f32_16x16x32_bf16 v[112:115], a[80:83], a[32:35], v[112:115]
  ds_read_b64_tr_b16 a[64:65], v8 offset:0
  v_mfma_f32_16x16x32_bf16 v[112:115], a[84:87], a[48:51], v[112:115]
  ds_read_b64_tr_b16 a[66:67], v8 offset:1024
  v_mfma_f32_16x16x32_bf16 v[116:119], a[84:87], a[52:55], v[116:119]
  buffer_load_dwordx4 v21, s[8:11], s65 offen offset:1024 lds
  v_mfma_f32_16x16x32_bf16 v[116:119], a[80:83], a[36:39], v[116:119]
  v_exp_f32 v252, v252
  v_mfma_f32_16x16x32_bf16 v[120:123], a[80:83], a[40:43], v[120:123]
  ds_read_b64_tr_b16 a[68:69], v8 offset:8192
  s_add_u32 s65, s75, 512
  v_mfma_f32_16x16x32_bf16 v[120:123], a[84:87], a[56:59], v[120:123]
  ds_read_b64_tr_b16 a[70:71], v8 offset:9216
  s_add_u32 m0, s84, 6144
  v_mfma_f32_16x16x32_bf16 v[124:127], a[84:87], a[60:63], v[124:127]
  buffer_load_dwordx4 v20, s[8:11], s65 offen offset:0 lds
  v_mfma_f32_16x16x32_bf16 v[124:127], a[80:83], a[44:47], v[124:127]
  v_add_u32 v9, 0xfffe0000, v9
  v_mfma_f32_16x16x32_bf16 v[144:147], a[88:91], a[32:35], v[144:147]
  ds_read_b64_tr_b16 a[72:73], v9 offset:0
  v_mfma_f32_16x16x32_bf16 v[144:147], a[92:95], a[48:51], v[144:147]
  ds_read_b64_tr_b16 a[74:75], v9 offset:1024
  v_mfma_f32_16x16x32_bf16 v[148:151], a[92:95], a[52:55], v[148:151]
  buffer_load_dwordx4 v21, s[8:11], s65 offen offset:1024 lds
  v_mfma_f32_16x16x32_bf16 v[148:151], a[88:91], a[36:39], v[148:151]
  v_exp_f32 v253, v253
  v_mfma_f32_16x16x32_bf16 v[152:155], a[88:91], a[40:43], v[152:155]
  ds_read_b64_tr_b16 a[76:77], v9 offset:8192
  s_lshr_b32 s7, s7, 8
  v_add_f32 v252, 1.0, v252
  v_mfma_f32_16x16x32_bf16 v[152:155], a[92:95], a[56:59], v[152:155]
  ds_read_b64_tr_b16 a[78:79], v9 offset:9216
  s_add_u32 s81, s85, 16779264
  v_add_f32 v253, 1.0, v253
  v_mfma_f32_16x16x32_bf16 v[156:159], a[92:95], a[60:63], v[156:159]
  buffer_store_dwordx4 v[192:195], v1, s[40:43], s81 offen sc1
  v_mfma_f32_16x16x32_bf16 v[156:159], a[88:91], a[44:47], v[156:159]
  s_waitcnt lgkmcnt(4)
  v_add_u32 v10, 0xfffe0000, v10
  s_waitcnt vmcnt(18)
  v_mfma_f32_16x16x32_bf16 a[128:131], a[64:67], a[0:3], a[128:131]
  ds_read_b64_tr_b16 a[80:81], v10 offset:0
  v_mfma_f32_16x16x32_bf16 a[128:131], a[68:71], a[16:19], a[128:131]
  ds_read_b64_tr_b16 a[82:83], v10 offset:1024
  v_mfma_f32_16x16x32_bf16 a[132:135], a[68:71], a[20:23], a[132:135]
  v_rcp_f32 v252, v252
  v_mfma_f32_16x16x32_bf16 a[132:135], a[64:67], a[4:7], a[132:135]
  ds_read_b128 a[32:35], v28 offset:8192
  v_mfma_f32_16x16x32_bf16 a[136:139], a[64:67], a[8:11], a[136:139]
  ds_read_b64_tr_b16 a[84:85], v10 offset:8192
  s_add_u32 s65, s76, 2097152
  v_mfma_f32_16x16x32_bf16 a[136:139], a[68:71], a[24:27], a[136:139]
  ds_read_b64_tr_b16 a[86:87], v10 offset:9216
  s_add_u32 m0, s78, 131072
  v_mfma_f32_16x16x32_bf16 a[140:143], a[68:71], a[28:31], a[140:143]
  buffer_load_dwordx4 v2, s[16:19], s65 offen offset:0 lds
  v_mfma_f32_16x16x32_bf16 a[140:143], a[64:67], a[12:15], a[140:143]
  ds_read_b128 a[36:39], v28 offset:10240
  s_waitcnt lgkmcnt(6)
  v_add_u32 v11, 0xfffe0000, v11
  v_mfma_f32_16x16x32_bf16 a[144:147], a[72:75], a[0:3], a[144:147]
  ds_read_b64_tr_b16 a[88:89], v11 offset:0
  v_mfma_f32_16x16x32_bf16 a[144:147], a[76:79], a[16:19], a[144:147]
  ds_read_b64_tr_b16 a[90:91], v11 offset:1024
  v_mfma_f32_16x16x32_bf16 a[148:151], a[76:79], a[20:23], a[148:151]
  v_rcp_f32 v253, v253
  s_add_u32 s7, s7, 58720256
  s_mov_b64 exec, 1
  buffer_store_dwordx2 v[252:253], off, s[40:43], s7 sc1
  s_mov_b64 exec, -1
  v_mfma_f32_16x16x32_bf16 a[148:151], a[72:75], a[4:7], a[148:151]
  ds_read_b128 a[40:43], v28 offset:12288
  v_mfma_f32_16x16x32_bf16 a[152:155], a[72:75], a[8:11], a[152:155]
  ds_read_b64_tr_b16 a[92:93], v11 offset:8192
  v_mfma_f32_16x16x32_bf16 a[152:155], a[76:79], a[24:27], a[152:155]
  ds_read_b64_tr_b16 a[94:95], v11 offset:9216
  s_add_u32 s81, s85, 16780288
  v_mfma_f32_16x16x32_bf16 a[156:159], a[76:79], a[28:31], a[156:159]
  buffer_store_dwordx4 v[208:211], v1, s[40:43], s81 offen sc1
  v_mfma_f32_16x16x32_bf16 a[156:159], a[72:75], a[12:15], a[156:159]
  ds_read_b128 a[44:47], v28 offset:14336
  s_waitcnt lgkmcnt(7)
  v_add_u32 v12, 0xfffe0000, v12
  v_mfma_f32_16x16x32_bf16 a[160:163], a[80:83], a[0:3], a[160:163]
  ds_read_b64_tr_b16 a[64:65], v12 offset:0
  v_mfma_f32_16x16x32_bf16 a[160:163], a[84:87], a[16:19], a[160:163]
  ds_read_b64_tr_b16 a[66:67], v12 offset:1024
  v_mfma_f32_16x16x32_bf16 a[164:167], a[84:87], a[20:23], a[164:167]
  buffer_load_dwordx4 v3, s[16:19], s65 offen offset:1024 lds
  v_mfma_f32_16x16x32_bf16 a[164:167], a[80:83], a[4:7], a[164:167]
  ds_read_b128 a[48:51], v29 offset:8192
  v_mfma_f32_16x16x32_bf16 a[168:171], a[80:83], a[8:11], a[168:171]
  ds_read_b64_tr_b16 a[68:69], v12 offset:8192
  v_mfma_f32_16x16x32_bf16 a[168:171], a[84:87], a[24:27], a[168:171]
  ds_read_b64_tr_b16 a[70:71], v12 offset:9216
  v_mfma_f32_16x16x32_bf16 a[172:175], a[84:87], a[28:31], a[172:175]
  buffer_load_dwordx4 v4, s[16:19], s65 offen offset:2048 lds
  v_mfma_f32_16x16x32_bf16 a[172:175], a[80:83], a[12:15], a[172:175]
  ds_read_b128 a[52:55], v29 offset:10240
  s_waitcnt lgkmcnt(7)
  v_add_u32 v13, 0xfffe0000, v13
  v_mfma_f32_16x16x32_bf16 a[176:179], a[88:91], a[0:3], a[176:179]
  ds_read_b64_tr_b16 a[72:73], v13 offset:0
  v_mfma_f32_16x16x32_bf16 a[176:179], a[92:95], a[16:19], a[176:179]
  ds_read_b64_tr_b16 a[74:75], v13 offset:1024
  v_mfma_f32_16x16x32_bf16 a[180:183], a[92:95], a[20:23], a[180:183]
  v_mfma_f32_16x16x32_bf16 a[180:183], a[88:91], a[4:7], a[180:183]
  ds_read_b128 a[56:59], v29 offset:12288
  v_mfma_f32_16x16x32_bf16 a[184:187], a[88:91], a[8:11], a[184:187]
  ds_read_b64_tr_b16 a[76:77], v13 offset:8192
  v_mfma_f32_16x16x32_bf16 a[184:187], a[92:95], a[24:27], a[184:187]
  ds_read_b64_tr_b16 a[78:79], v13 offset:9216
  v_mfma_f32_16x16x32_bf16 a[188:191], a[92:95], a[28:31], a[188:191]
  buffer_load_dwordx4 v5, s[16:19], s65 offen offset:3072 lds
  v_mfma_f32_16x16x32_bf16 a[188:191], a[88:91], a[12:15], a[188:191]
  ds_read_b128 a[60:63], v29 offset:14336
  s_waitcnt lgkmcnt(7)
  v_add_u32 v14, 0xfffe0000, v14
  v_mfma_f32_16x16x32_bf16 a[192:195], a[64:67], a[0:3], a[192:195]
  ds_read_b64_tr_b16 a[80:81], v14 offset:0
  s_add_u32 s65, s77, 917504
  v_mfma_f32_16x16x32_bf16 a[192:195], a[68:71], a[16:19], a[192:195]
  ds_read_b64_tr_b16 a[82:83], v14 offset:1024
  s_add_u32 m0, s79, 147456
  v_mfma_f32_16x16x32_bf16 a[196:199], a[68:71], a[20:23], a[196:199]
  buffer_load_dwordx4 v6, s[56:59], s65 offen offset:0 lds
  v_mfma_f32_16x16x32_bf16 a[196:199], a[64:67], a[4:7], a[196:199]
  v_mfma_f32_16x16x32_bf16 a[200:203], a[64:67], a[8:11], a[200:203]
  ds_read_b64_tr_b16 a[84:85], v14 offset:8192
  v_mfma_f32_16x16x32_bf16 a[200:203], a[68:71], a[24:27], a[200:203]
  ds_read_b64_tr_b16 a[86:87], v14 offset:9216
  v_mfma_f32_16x16x32_bf16 a[204:207], a[68:71], a[28:31], a[204:207]
  buffer_load_dwordx4 v7, s[56:59], s65 offen offset:1024 lds
  v_mfma_f32_16x16x32_bf16 a[204:207], a[64:67], a[12:15], a[204:207]
  s_waitcnt lgkmcnt(5)
  v_add_u32 v15, 0xfffe0000, v15
  v_mfma_f32_16x16x32_bf16 a[208:211], a[72:75], a[0:3], a[208:211]
  ds_read_b64_tr_b16 a[88:89], v15 offset:0
  v_mfma_f32_16x16x32_bf16 a[208:211], a[76:79], a[16:19], a[208:211]
  ds_read_b64_tr_b16 a[90:91], v15 offset:1024
  s_add_u32 s81, s85, 16781312
  v_mfma_f32_16x16x32_bf16 a[212:215], a[76:79], a[20:23], a[212:215]
  buffer_store_dwordx4 v[224:227], v1, s[40:43], s81 offen sc1
  v_mfma_f32_16x16x32_bf16 a[212:215], a[72:75], a[4:7], a[212:215]
  v_mfma_f32_16x16x32_bf16 a[216:219], a[72:75], a[8:11], a[216:219]
  ds_read_b64_tr_b16 a[92:93], v15 offset:8192
  v_mfma_f32_16x16x32_bf16 a[216:219], a[76:79], a[24:27], a[216:219]
  ds_read_b64_tr_b16 a[94:95], v15 offset:9216
  v_mfma_f32_16x16x32_bf16 a[220:223], a[76:79], a[28:31], a[220:223]
  v_mfma_f32_16x16x32_bf16 a[220:223], a[72:75], a[12:15], a[220:223]
  s_waitcnt lgkmcnt(4)
  v_add_u32 v16, 0xfffe0000, v16
  v_mfma_f32_16x16x32_bf16 a[224:227], a[80:83], a[0:3], a[224:227]
  ds_read_b64_tr_b16 a[64:65], v16 offset:16384
  s_add_u32 s65, s72, 640
  v_mfma_f32_16x16x32_bf16 a[224:227], a[84:87], a[16:19], a[224:227]
  ds_read_b64_tr_b16 a[66:67], v16 offset:16896
  s_add_u32 m0, s84, 8192
  v_mfma_f32_16x16x32_bf16 a[228:231], a[84:87], a[20:23], a[228:231]
  buffer_load_dwordx4 v20, s[8:11], s65 offen offset:0 lds
  v_mfma_f32_16x16x32_bf16 a[228:231], a[80:83], a[4:7], a[228:231]
  v_mfma_f32_16x16x32_bf16 a[232:235], a[80:83], a[8:11], a[232:235]
  ds_read_b64_tr_b16 a[68:69], v16 offset:20480
  v_mfma_f32_16x16x32_bf16 a[232:235], a[84:87], a[24:27], a[232:235]
  ds_read_b64_tr_b16 a[70:71], v16 offset:20992
  v_mfma_f32_16x16x32_bf16 a[236:239], a[84:87], a[28:31], a[236:239]
  buffer_load_dwordx4 v21, s[8:11], s65 offen offset:1024 lds
  v_mfma_f32_16x16x32_bf16 a[236:239], a[80:83], a[12:15], a[236:239]
  s_waitcnt lgkmcnt(4)
  v_add_u32 v17, 0xfffe0000, v17
  v_mfma_f32_16x16x32_bf16 a[240:243], a[88:91], a[0:3], a[240:243]
  ds_read_b64_tr_b16 a[72:73], v17 offset:16384
  s_add_u32 s65, s73, 640
  v_mfma_f32_16x16x32_bf16 a[240:243], a[92:95], a[16:19], a[240:243]
  ds_read_b64_tr_b16 a[74:75], v17 offset:16896
  s_add_u32 m0, s84, 10240
  v_mfma_f32_16x16x32_bf16 a[244:247], a[92:95], a[20:23], a[244:247]
  buffer_load_dwordx4 v20, s[8:11], s65 offen offset:0 lds
  v_mfma_f32_16x16x32_bf16 a[244:247], a[88:91], a[4:7], a[244:247]
  v_mfma_f32_16x16x32_bf16 a[248:251], a[88:91], a[8:11], a[248:251]
  ds_read_b64_tr_b16 a[76:77], v17 offset:20480
  v_mfma_f32_16x16x32_bf16 a[248:251], a[92:95], a[24:27], a[248:251]
  ds_read_b64_tr_b16 a[78:79], v17 offset:20992
  v_mfma_f32_16x16x32_bf16 a[252:255], a[92:95], a[28:31], a[252:255]
  v_mfma_f32_16x16x32_bf16 a[252:255], a[88:91], a[12:15], a[252:255]
  s_waitcnt lgkmcnt(4)
  v_add_u32 v18, 0xfffe0000, v18
  v_mfma_f32_16x16x32_bf16 v[48:51], a[64:67], a[0:3], v[48:51]
  ds_read_b64_tr_b16 a[80:81], v18 offset:16384
  v_mfma_f32_16x16x32_bf16 v[48:51], a[68:71], a[16:19], v[48:51]
  ds_read_b64_tr_b16 a[82:83], v18 offset:16896
  v_mfma_f32_16x16x32_bf16 v[52:55], a[68:71], a[20:23], v[52:55]
  ds_read_b64_tr_b16 a[84:85], v18 offset:20480
  v_mfma_f32_16x16x32_bf16 v[52:55], a[64:67], a[4:7], v[52:55]
  ds_read_b64_tr_b16 a[86:87], v18 offset:20992
  v_add_u32 v19, 0xfffe0000, v19
  v_mfma_f32_16x16x32_bf16 v[56:59], a[64:67], a[8:11], v[56:59]
  ds_read_b64_tr_b16 a[88:89], v19 offset:16384
  v_mfma_f32_16x16x32_bf16 v[56:59], a[68:71], a[24:27], v[56:59]
  ds_read_b64_tr_b16 a[90:91], v19 offset:16896
  v_mfma_f32_16x16x32_bf16 v[60:63], a[68:71], a[28:31], v[60:63]
  ds_read_b64_tr_b16 a[92:93], v19 offset:20480
  v_mfma_f32_16x16x32_bf16 v[60:63], a[64:67], a[12:15], v[60:63]
  ds_read_b64_tr_b16 a[94:95], v19 offset:20992
  s_waitcnt lgkmcnt(8)
  v_mfma_f32_16x16x32_bf16 v[80:83], a[72:75], a[0:3], v[80:83]
  v_mfma_f32_16x16x32_bf16 v[80:83], a[76:79], a[16:19], v[80:83]
  v_mfma_f32_16x16x32_bf16 v[84:87], a[76:79], a[20:23], v[84:87]
  buffer_load_dwordx4 v21, s[8:11], s65 offen offset:1024 lds
  v_mfma_f32_16x16x32_bf16 v[84:87], a[72:75], a[4:7], v[84:87]
  v_mfma_f32_16x16x32_bf16 v[88:91], a[72:75], a[8:11], v[88:91]
  s_add_u32 s65, s74, 640
  v_mfma_f32_16x16x32_bf16 v[88:91], a[76:79], a[24:27], v[88:91]
  s_add_u32 m0, s84, 12288
  v_mfma_f32_16x16x32_bf16 v[92:95], a[76:79], a[28:31], v[92:95]
  buffer_load_dwordx4 v20, s[8:11], s65 offen offset:0 lds
  v_mfma_f32_16x16x32_bf16 v[92:95], a[72:75], a[12:15], v[92:95]
  s_waitcnt lgkmcnt(4)
  s_waitcnt vmcnt(24) lgkmcnt(0)
  s_barrier
  v_mfma_f32_16x16x32_bf16 v[112:115], a[80:83], a[0:3], v[112:115]
  ds_read_b64_tr_b16 a[64:65], v8 offset:32768
  v_mfma_f32_16x16x32_bf16 v[112:115], a[84:87], a[16:19], v[112:115]
  ds_read_b64_tr_b16 a[66:67], v8 offset:33792
  v_mfma_f32_16x16x32_bf16 v[116:119], a[84:87], a[20:23], v[116:119]
  buffer_load_dwordx4 v21, s[8:11], s65 offen offset:1024 lds
  v_mfma_f32_16x16x32_bf16 v[116:119], a[80:83], a[4:7], v[116:119]
  v_mfma_f32_16x16x32_bf16 v[120:123], a[80:83], a[8:11], v[120:123]
  ds_read_b64_tr_b16 a[68:69], v8 offset:40960
  s_add_u32 s65, s75, 640
  v_mfma_f32_16x16x32_bf16 v[120:123], a[84:87], a[24:27], v[120:123]
  ds_read_b64_tr_b16 a[70:71], v8 offset:41984
  s_add_u32 m0, s84, 14336
  v_mfma_f32_16x16x32_bf16 v[124:127], a[84:87], a[28:31], v[124:127]
  buffer_load_dwordx4 v20, s[8:11], s65 offen offset:0 lds
  v_mfma_f32_16x16x32_bf16 v[124:127], a[80:83], a[12:15], v[124:127]
  v_mfma_f32_16x16x32_bf16 v[144:147], a[88:91], a[0:3], v[144:147]
  ds_read_b64_tr_b16 a[72:73], v9 offset:32768
  v_mfma_f32_16x16x32_bf16 v[144:147], a[92:95], a[16:19], v[144:147]
  ds_read_b64_tr_b16 a[74:75], v9 offset:33792
  v_mfma_f32_16x16x32_bf16 v[148:151], a[92:95], a[20:23], v[148:151]
  buffer_load_dwordx4 v21, s[8:11], s65 offen offset:1024 lds
  v_mfma_f32_16x16x32_bf16 v[148:151], a[88:91], a[4:7], v[148:151]
  v_mfma_f32_16x16x32_bf16 v[152:155], a[88:91], a[8:11], v[152:155]
  ds_read_b64_tr_b16 a[76:77], v9 offset:40960
  v_mfma_f32_16x16x32_bf16 v[152:155], a[92:95], a[24:27], v[152:155]
  ds_read_b64_tr_b16 a[78:79], v9 offset:41984
  s_add_u32 s81, s85, 16782336
  v_mfma_f32_16x16x32_bf16 v[156:159], a[92:95], a[28:31], v[156:159]
  buffer_store_dwordx4 v[240:243], v1, s[40:43], s81 offen sc1
  v_mfma_f32_16x16x32_bf16 v[156:159], a[88:91], a[12:15], v[156:159]
  s_waitcnt lgkmcnt(4)
  s_waitcnt vmcnt(19)
  v_mfma_f32_16x16x32_bf16 a[128:131], a[64:67], a[32:35], a[128:131]
  ds_read_b64_tr_b16 a[80:81], v10 offset:32768
  v_mfma_f32_16x16x32_bf16 a[128:131], a[68:71], a[48:51], a[128:131]
  ds_read_b64_tr_b16 a[82:83], v10 offset:33792
  v_mfma_f32_16x16x32_bf16 a[132:135], a[68:71], a[52:55], a[132:135]
  v_mfma_f32_16x16x32_bf16 a[132:135], a[64:67], a[36:39], a[132:135]
  ds_read_b128 a[0:3], v28 offset:0
  v_mfma_f32_16x16x32_bf16 a[136:139], a[64:67], a[40:43], a[136:139]
  ds_read_b64_tr_b16 a[84:85], v10 offset:40960
  s_add_u32 s65, s76, 2621440
  v_mfma_f32_16x16x32_bf16 a[136:139], a[68:71], a[56:59], a[136:139]
  ds_read_b64_tr_b16 a[86:87], v10 offset:41984
  s_add_u32 m0, s78, 0
  v_mfma_f32_16x16x32_bf16 a[140:143], a[68:71], a[60:63], a[140:143]
  buffer_load_dwordx4 v2, s[16:19], s65 offen offset:0 lds
  v_mfma_f32_16x16x32_bf16 a[140:143], a[64:67], a[44:47], a[140:143]
  ds_read_b128 a[4:7], v28 offset:2048
  s_waitcnt lgkmcnt(6)
  v_mfma_f32_16x16x32_bf16 a[144:147], a[72:75], a[32:35], a[144:147]
  ds_read_b64_tr_b16 a[88:89], v11 offset:32768
  v_mfma_f32_16x16x32_bf16 a[144:147], a[76:79], a[48:51], a[144:147]
  ds_read_b64_tr_b16 a[90:91], v11 offset:33792
  v_mfma_f32_16x16x32_bf16 a[148:151], a[76:79], a[52:55], a[148:151]
  v_mfma_f32_16x16x32_bf16 a[148:151], a[72:75], a[36:39], a[148:151]
  ds_read_b128 a[8:11], v28 offset:4096
  v_mfma_f32_16x16x32_bf16 a[152:155], a[72:75], a[40:43], a[152:155]
  ds_read_b64_tr_b16 a[92:93], v11 offset:40960
  v_accvgpr_read_b32 v32, a128
  v_mfma_f32_16x16x32_bf16 a[152:155], a[76:79], a[56:59], a[152:155]
  ds_read_b64_tr_b16 a[94:95], v11 offset:41984
  s_add_u32 s81, s85, 16783360
  v_accvgpr_read_b32 v33, a129
  v_mfma_f32_16x16x32_bf16 a[156:159], a[76:79], a[60:63], a[156:159]
  buffer_store_dwordx4 v[196:199], v1, s[40:43], s81 offen sc1
  v_mfma_f32_16x16x32_bf16 a[156:159], a[72:75], a[44:47], a[156:159]
  ds_read_b128 a[12:15], v28 offset:6144
  s_waitcnt lgkmcnt(7)
  v_accvgpr_read_b32 v34, a130
  v_mfma_f32_16x16x32_bf16 a[160:163], a[80:83], a[32:35], a[160:163]
  ds_read_b64_tr_b16 a[64:65], v12 offset:32768
  v_accvgpr_read_b32 v35, a131
  v_mfma_f32_16x16x32_bf16 a[160:163], a[84:87], a[48:51], a[160:163]
  ds_read_b64_tr_b16 a[66:67], v12 offset:33792
  v_accvgpr_read_b32 v36, a132
  v_mfma_f32_16x16x32_bf16 a[164:167], a[84:87], a[52:55], a[164:167]
  buffer_load_dwordx4 v3, s[16:19], s65 offen offset:1024 lds
  v_mfma_f32_16x16x32_bf16 a[164:167], a[80:83], a[36:39], a[164:167]
  ds_read_b128 a[16:19], v29 offset:0
  v_accvgpr_read_b32 v37, a133
  v_mfma_f32_16x16x32_bf16 a[168:171], a[80:83], a[40:43], a[168:171]
  ds_read_b64_tr_b16 a[68:69], v12 offset:40960
  v_accvgpr_read_b32 v38, a134
  v_mfma_f32_16x16x32_bf16 a[168:171], a[84:87], a[56:59], a[168:171]
  ds_read_b64_tr_b16 a[70:71], v12 offset:41984
  v_accvgpr_read_b32 v39, a135
  v_mfma_f32_16x16x32_bf16 a[172:175], a[84:87], a[60:63], a[172:175]
  buffer_load_dwordx4 v4, s[16:19], s65 offen offset:2048 lds
  v_mfma_f32_16x16x32_bf16 a[172:175], a[80:83], a[44:47], a[172:175]
  ds_read_b128 a[20:23], v29 offset:2048
  s_waitcnt lgkmcnt(7)
  v_accvgpr_read_b32 v64, a136
  v_mfma_f32_16x16x32_bf16 a[176:179], a[88:91], a[32:35], a[176:179]
  ds_read_b64_tr_b16 a[72:73], v13 offset:32768
  v_accvgpr_read_b32 v65, a137
  v_mfma_f32_16x16x32_bf16 a[176:179], a[92:95], a[48:51], a[176:179]
  ds_read_b64_tr_b16 a[74:75], v13 offset:33792
  v_accvgpr_read_b32 v66, a138
  v_mfma_f32_16x16x32_bf16 a[180:183], a[92:95], a[52:55], a[180:183]
  v_accvgpr_read_b32 v67, a139
  v_accvgpr_read_b32 v68, a140
  v_mfma_f32_16x16x32_bf16 a[180:183], a[88:91], a[36:39], a[180:183]
  ds_read_b128 a[24:27], v29 offset:4096
  v_accvgpr_read_b32 v69, a141
  v_mfma_f32_16x16x32_bf16 a[184:187], a[88:91], a[40:43], a[184:187]
  ds_read_b64_tr_b16 a[76:77], v13 offset:40960
  v_accvgpr_read_b32 v70, a142
  v_mfma_f32_16x16x32_bf16 a[184:187], a[92:95], a[56:59], a[184:187]
  ds_read_b64_tr_b16 a[78:79], v13 offset:41984
  v_accvgpr_read_b32 v71, a143
  v_mfma_f32_16x16x32_bf16 a[188:191], a[92:95], a[60:63], a[188:191]
  buffer_load_dwordx4 v5, s[16:19], s65 offen offset:3072 lds
  v_mfma_f32_16x16x32_bf16 a[188:191], a[88:91], a[44:47], a[188:191]
  ds_read_b128 a[28:31], v29 offset:6144
  s_waitcnt lgkmcnt(7)
  v_accvgpr_read_b32 v96, a144
  v_mfma_f32_16x16x32_bf16 a[192:195], a[64:67], a[32:35], a[192:195]
  ds_read_b64_tr_b16 a[80:81], v14 offset:32768
  s_add_u32 s65, s77, 1146880
  v_accvgpr_read_b32 v97, a145
  v_mfma_f32_16x16x32_bf16 a[192:195], a[68:71], a[48:51], a[192:195]
  ds_read_b64_tr_b16 a[82:83], v14 offset:33792
  s_add_u32 m0, s79, 16384
  v_accvgpr_read_b32 v98, a146
  v_mfma_f32_16x16x32_bf16 a[196:199], a[68:71], a[52:55], a[196:199]
  buffer_load_dwordx4 v6, s[56:59], s65 offen offset:0 lds
  v_mfma_f32_16x16x32_bf16 a[196:199], a[64:67], a[36:39], a[196:199]
  v_accvgpr_read_b32 v99, a147
  v_accvgpr_read_b32 v100, a148
  v_mfma_f32_16x16x32_bf16 a[200:203], a[64:67], a[40:43], a[200:203]
  ds_read_b64_tr_b16 a[84:85], v14 offset:40960
  v_accvgpr_read_b32 v101, a149
  v_mfma_f32_16x16x32_bf16 a[200:203], a[68:71], a[56:59], a[200:203]
  ds_read_b64_tr_b16 a[86:87], v14 offset:41984
  v_accvgpr_read_b32 v102, a150
  v_mfma_f32_16x16x32_bf16 a[204:207], a[68:71], a[60:63], a[204:207]
  buffer_load_dwordx4 v7, s[56:59], s65 offen offset:1024 lds
  v_mfma_f32_16x16x32_bf16 a[204:207], a[64:67], a[44:47], a[204:207]
  s_waitcnt lgkmcnt(5)
  v_accvgpr_read_b32 v103, a151
  v_accvgpr_read_b32 v128, a152
  v_mfma_f32_16x16x32_bf16 a[208:211], a[72:75], a[32:35], a[208:211]
  ds_read_b64_tr_b16 a[88:89], v15 offset:32768
  v_accvgpr_read_b32 v129, a153
  v_mfma_f32_16x16x32_bf16 a[208:211], a[76:79], a[48:51], a[208:211]
  ds_read_b64_tr_b16 a[90:91], v15 offset:33792
  s_add_u32 s81, s85, 16784384
  v_accvgpr_read_b32 v130, a154
  v_mfma_f32_16x16x32_bf16 a[212:215], a[76:79], a[52:55], a[212:215]
  buffer_store_dwordx4 v[204:207], v1, s[40:43], s81 offen sc1
  v_mfma_f32_16x16x32_bf16 a[212:215], a[72:75], a[36:39], a[212:215]
  v_accvgpr_read_b32 v131, a155
  v_accvgpr_read_b32 v132, a156
  v_mfma_f32_16x16x32_bf16 a[216:219], a[72:75], a[40:43], a[216:219]
  ds_read_b64_tr_b16 a[92:93], v15 offset:40960
  v_accvgpr_read_b32 v133, a157
  v_mfma_f32_16x16x32_bf16 a[216:219], a[76:79], a[56:59], a[216:219]
  ds_read_b64_tr_b16 a[94:95], v15 offset:41984
  v_accvgpr_read_b32 v134, a158
  v_mfma_f32_16x16x32_bf16 a[220:223], a[76:79], a[60:63], a[220:223]
  v_accvgpr_read_b32 v135, a159
  v_accvgpr_read_b32 v164, a176
  v_mfma_f32_16x16x32_bf16 a[220:223], a[72:75], a[44:47], a[220:223]
  s_waitcnt lgkmcnt(4)
  v_accvgpr_read_b32 v165, a177
  v_accvgpr_read_b32 v166, a178
  v_mfma_f32_16x16x32_bf16 a[224:227], a[80:83], a[32:35], a[224:227]
  ds_read_b64_tr_b16 a[64:65], v16 offset:49152
  s_add_u32 s65, s72, 768
  v_accvgpr_read_b32 v167, a179
  v_mfma_f32_16x16x32_bf16 a[224:227], a[84:87], a[48:51], a[224:227]
  ds_read_b64_tr_b16 a[66:67], v16 offset:49664
  s_add_u32 m0, s84, 0
  v_accvgpr_read_b32 v172, a180
  v_mfma_f32_16x16x32_bf16 a[228:231], a[84:87], a[52:55], a[228:231]
  buffer_load_dwordx4 v20, s[8:11], s65 offen offset:0 lds
  v_mfma_f32_16x16x32_bf16 a[228:231], a[80:83], a[36:39], a[228:231]
  v_accvgpr_read_b32 v173, a181
  v_accvgpr_read_b32 v174, a182
  v_mfma_f32_16x16x32_bf16 a[232:235], a[80:83], a[40:43], a[232:235]
  ds_read_b64_tr_b16 a[68:69], v16 offset:53248
  v_accvgpr_read_b32 v175, a183
  v_mfma_f32_16x16x32_bf16 a[232:235], a[84:87], a[56:59], a[232:235]
  ds_read_b64_tr_b16 a[70:71], v16 offset:53760
  v_accvgpr_read_b32 v180, a184
  v_mfma_f32_16x16x32_bf16 a[236:239], a[84:87], a[60:63], a[236:239]
  buffer_load_dwordx4 v21, s[8:11], s65 offen offset:1024 lds
  v_mfma_f32_16x16x32_bf16 a[236:239], a[80:83], a[44:47], a[236:239]
  s_waitcnt lgkmcnt(4)
  v_accvgpr_read_b32 v181, a185
  v_accvgpr_read_b32 v182, a186
  v_mfma_f32_16x16x32_bf16 a[240:243], a[88:91], a[32:35], a[240:243]
  ds_read_b64_tr_b16 a[72:73], v17 offset:49152
  s_add_u32 s65, s73, 768
  v_accvgpr_read_b32 v183, a187
  v_mfma_f32_16x16x32_bf16 a[240:243], a[92:95], a[48:51], a[240:243]
  ds_read_b64_tr_b16 a[74:75], v17 offset:49664
  s_add_u32 m0, s84, 2048
  v_accvgpr_read_b32 v188, a188
  v_mfma_f32_16x16x32_bf16 a[244:247], a[92:95], a[52:55], a[244:247]
  buffer_load_dwordx4 v20, s[8:11], s65 offen offset:0 lds
  v_mfma_f32_16x16x32_bf16 a[244:247], a[88:91], a[36:39], a[244:247]
  v_accvgpr_read_b32 v189, a189
  v_accvgpr_read_b32 v190, a190
  v_mfma_f32_16x16x32_bf16 a[248:251], a[88:91], a[40:43], a[248:251]
  ds_read_b64_tr_b16 a[76:77], v17 offset:53248
  v_accvgpr_read_b32 v191, a191
  v_mfma_f32_16x16x32_bf16 a[248:251], a[92:95], a[56:59], a[248:251]
  ds_read_b64_tr_b16 a[78:79], v17 offset:53760
  v_accvgpr_read_b32 v160, a208
  v_mfma_f32_16x16x32_bf16 a[252:255], a[92:95], a[60:63], a[252:255]
  v_accvgpr_read_b32 v161, a209
  v_accvgpr_read_b32 v162, a210
  v_mfma_f32_16x16x32_bf16 a[252:255], a[88:91], a[44:47], a[252:255]
  s_waitcnt lgkmcnt(4)
  v_accvgpr_read_b32 v163, a211
  v_accvgpr_read_b32 v176, a212
  v_mfma_f32_16x16x32_bf16 v[48:51], a[64:67], a[32:35], v[48:51]
  ds_read_b64_tr_b16 a[80:81], v18 offset:49152
  v_accvgpr_read_b32 v177, a213
  v_mfma_f32_16x16x32_bf16 v[48:51], a[68:71], a[48:51], v[48:51]
  ds_read_b64_tr_b16 a[82:83], v18 offset:49664
  v_accvgpr_read_b32 v178, a214
  v_mfma_f32_16x16x32_bf16 v[52:55], a[68:71], a[52:55], v[52:55]
  ds_read_b64_tr_b16 a[84:85], v18 offset:53248
  v_accvgpr_read_b32 v179, a215
  v_mfma_f32_16x16x32_bf16 v[52:55], a[64:67], a[36:39], v[52:55]
  ds_read_b64_tr_b16 a[86:87], v18 offset:53760
  v_accvgpr_read_b32 v192, a216
  v_mfma_f32_16x16x32_bf16 v[56:59], a[64:67], a[40:43], v[56:59]
  ds_read_b64_tr_b16 a[88:89], v19 offset:49152
  v_accvgpr_read_b32 v193, a217
  v_mfma_f32_16x16x32_bf16 v[56:59], a[68:71], a[56:59], v[56:59]
  ds_read_b64_tr_b16 a[90:91], v19 offset:49664
  v_accvgpr_read_b32 v194, a218
  v_mfma_f32_16x16x32_bf16 v[60:63], a[68:71], a[60:63], v[60:63]
  ds_read_b64_tr_b16 a[92:93], v19 offset:53248
  v_accvgpr_read_b32 v195, a219
  v_mfma_f32_16x16x32_bf16 v[60:63], a[64:67], a[44:47], v[60:63]
  ds_read_b64_tr_b16 a[94:95], v19 offset:53760
  s_waitcnt lgkmcnt(8)
  v_accvgpr_read_b32 v228, a220
  v_mfma_f32_16x16x32_bf16 v[80:83], a[72:75], a[32:35], v[80:83]
  v_accvgpr_read_b32 v229, a221
  v_accvgpr_read_b32 v230, a222
  v_mfma_f32_16x16x32_bf16 v[80:83], a[76:79], a[48:51], v[80:83]
  v_accvgpr_read_b32 v231, a223
  v_accvgpr_read_b32 v236, a240
  v_mfma_f32_16x16x32_bf16 v[84:87], a[76:79], a[52:55], v[84:87]
  buffer_load_dwordx4 v21, s[8:11], s65 offen offset:1024 lds
  v_mfma_f32_16x16x32_bf16 v[84:87], a[72:75], a[36:39], v[84:87]
  v_accvgpr_read_b32 v237, a241
  v_accvgpr_read_b32 v238, a242
  v_mfma_f32_16x16x32_bf16 v[88:91], a[72:75], a[40:43], v[88:91]
  s_add_u32 s65, s74, 768
  v_accvgpr_read_b32 v239, a243
  v_accvgpr_read_b32 v244, a244
  v_mfma_f32_16x16x32_bf16 v[88:91], a[76:79], a[56:59], v[88:91]
  s_add_u32 m0, s84, 4096
  v_accvgpr_read_b32 v245, a245
  v_accvgpr_read_b32 v246, a246
  v_mfma_f32_16x16x32_bf16 v[92:95], a[76:79], a[60:63], v[92:95]
  buffer_load_dwordx4 v20, s[8:11], s65 offen offset:0 lds
  v_mfma_f32_16x16x32_bf16 v[92:95], a[72:75], a[44:47], v[92:95]
  s_waitcnt lgkmcnt(4)
  v_add_u32 v8, 0x20000, v8
  v_accvgpr_read_b32 v247, a247
  s_waitcnt vmcnt(23) lgkmcnt(0)
  s_barrier
  v_mfma_f32_16x16x32_bf16 v[112:115], a[80:83], a[32:35], v[112:115]
  ds_read_b64_tr_b16 a[64:65], v8 offset:0
  v_accvgpr_read_b32 v252, a248
  v_mfma_f32_16x16x32_bf16 v[112:115], a[84:87], a[48:51], v[112:115]
  ds_read_b64_tr_b16 a[66:67], v8 offset:1024
  v_accvgpr_read_b32 v253, a249
  v_mfma_f32_16x16x32_bf16 v[116:119], a[84:87], a[52:55], v[116:119]
  buffer_load_dwordx4 v21, s[8:11], s65 offen offset:1024 lds
  v_mfma_f32_16x16x32_bf16 v[116:119], a[80:83], a[36:39], v[116:119]
  v_accvgpr_read_b32 v254, a250
  v_accvgpr_read_b32 v255, a251
  v_mfma_f32_16x16x32_bf16 v[120:123], a[80:83], a[40:43], v[120:123]
  ds_read_b64_tr_b16 a[68:69], v8 offset:8192
  s_add_u32 s65, s75, 768
  v_accvgpr_read_b32 v208, a252
  v_mfma_f32_16x16x32_bf16 v[120:123], a[84:87], a[56:59], v[120:123]
  ds_read_b64_tr_b16 a[70:71], v8 offset:9216
  s_add_u32 m0, s84, 6144
  v_accvgpr_read_b32 v209, a253
  v_mfma_f32_16x16x32_bf16 v[124:127], a[84:87], a[60:63], v[124:127]
  buffer_load_dwordx4 v20, s[8:11], s65 offen offset:0 lds
  v_mfma_f32_16x16x32_bf16 v[124:127], a[80:83], a[44:47], v[124:127]
  v_add_u32 v9, 0x20000, v9
  v_accvgpr_read_b32 v210, a254
  v_mfma_f32_16x16x32_bf16 v[144:147], a[88:91], a[32:35], v[144:147]
  ds_read_b64_tr_b16 a[72:73], v9 offset:0
  v_accvgpr_read_b32 v211, a255
  v_mfma_f32_16x16x32_bf16 v[144:147], a[92:95], a[48:51], v[144:147]
  ds_read_b64_tr_b16 a[74:75], v9 offset:1024
  v_mfma_f32_16x16x32_bf16 v[148:151], a[92:95], a[52:55], v[148:151]
  buffer_load_dwordx4 v21, s[8:11], s65 offen offset:1024 lds
  v_mfma_f32_16x16x32_bf16 v[148:151], a[88:91], a[36:39], v[148:151]
  v_mfma_f32_16x16x32_bf16 v[152:155], a[88:91], a[40:43], v[152:155]
  ds_read_b64_tr_b16 a[76:77], v9 offset:8192
  v_mfma_f32_16x16x32_bf16 v[152:155], a[92:95], a[56:59], v[152:155]
  ds_read_b64_tr_b16 a[78:79], v9 offset:9216
  s_add_u32 s81, s85, 262144
  v_mfma_f32_16x16x32_bf16 v[156:159], a[92:95], a[60:63], v[156:159]
  buffer_store_dwordx4 v[40:43], v1, s[40:43], s81 offen sc1
  v_mfma_f32_16x16x32_bf16 v[156:159], a[88:91], a[44:47], v[156:159]
  s_waitcnt lgkmcnt(4)
  v_add_u32 v10, 0x20000, v10
  s_waitcnt vmcnt(18)
  v_mfma_f32_16x16x32_bf16 v[32:35], a[64:67], a[0:3], v[32:35]
  ds_read_b64_tr_b16 a[80:81], v10 offset:0
  v_mfma_f32_16x16x32_bf16 v[32:35], a[68:71], a[16:19], v[32:35]
  ds_read_b64_tr_b16 a[82:83], v10 offset:1024
  v_mfma_f32_16x16x32_bf16 v[36:39], a[68:71], a[20:23], v[36:39]
  v_mfma_f32_16x16x32_bf16 v[36:39], a[64:67], a[4:7], v[36:39]
  ds_read_b128 a[32:35], v28 offset:8192
  v_mfma_f32_16x16x32_bf16 v[64:67], a[64:67], a[8:11], v[64:67]
  ds_read_b64_tr_b16 a[84:85], v10 offset:8192
  s_add_u32 s65, s76, 3145728
  v_mfma_f32_16x16x32_bf16 v[64:67], a[68:71], a[24:27], v[64:67]
  ds_read_b64_tr_b16 a[86:87], v10 offset:9216
  s_add_u32 m0, s78, 32768
  v_mfma_f32_16x16x32_bf16 v[68:71], a[68:71], a[28:31], v[68:71]
  buffer_load_dwordx4 v2, s[16:19], s65 offen offset:0 lds
  v_mfma_f32_16x16x32_bf16 v[68:71], a[64:67], a[12:15], v[68:71]
  ds_read_b128 a[36:39], v28 offset:10240
  s_waitcnt lgkmcnt(6)
  v_add_u32 v11, 0x20000, v11
  v_mfma_f32_16x16x32_bf16 v[96:99], a[72:75], a[0:3], v[96:99]
  ds_read_b64_tr_b16 a[88:89], v11 offset:0
  v_mfma_f32_16x16x32_bf16 v[96:99], a[76:79], a[16:19], v[96:99]
  ds_read_b64_tr_b16 a[90:91], v11 offset:1024
  v_mfma_f32_16x16x32_bf16 v[100:103], a[76:79], a[20:23], v[100:103]
  v_mfma_f32_16x16x32_bf16 v[100:103], a[72:75], a[4:7], v[100:103]
  ds_read_b128 a[40:43], v28 offset:12288
  v_mfma_f32_16x16x32_bf16 v[128:131], a[72:75], a[8:11], v[128:131]
  ds_read_b64_tr_b16 a[92:93], v11 offset:8192
  v_mfma_f32_16x16x32_bf16 v[128:131], a[76:79], a[24:27], v[128:131]
  ds_read_b64_tr_b16 a[94:95], v11 offset:9216
  s_add_u32 s81, s85, 263168
  v_mfma_f32_16x16x32_bf16 v[132:135], a[76:79], a[28:31], v[132:135]
  buffer_store_dwordx4 v[44:47], v1, s[40:43], s81 offen sc1
  v_mfma_f32_16x16x32_bf16 v[132:135], a[72:75], a[12:15], v[132:135]
  ds_read_b128 a[44:47], v28 offset:14336
  s_waitcnt lgkmcnt(7)
  v_add_u32 v12, 0x20000, v12
  v_mfma_f32_16x16x32_bf16 a[160:163], a[80:83], a[0:3], a[160:163]
  ds_read_b64_tr_b16 a[64:65], v12 offset:0
  v_mfma_f32_16x16x32_bf16 a[160:163], a[84:87], a[16:19], a[160:163]
  ds_read_b64_tr_b16 a[66:67], v12 offset:1024
  v_mfma_f32_16x16x32_bf16 a[164:167], a[84:87], a[20:23], a[164:167]
  buffer_load_dwordx4 v3, s[16:19], s65 offen offset:1024 lds
  v_mfma_f32_16x16x32_bf16 a[164:167], a[80:83], a[4:7], a[164:167]
  ds_read_b128 a[48:51], v29 offset:8192
  v_mfma_f32_16x16x32_bf16 a[168:171], a[80:83], a[8:11], a[168:171]
  ds_read_b64_tr_b16 a[68:69], v12 offset:8192
  v_mfma_f32_16x16x32_bf16 a[168:171], a[84:87], a[24:27], a[168:171]
  ds_read_b64_tr_b16 a[70:71], v12 offset:9216
  v_mfma_f32_16x16x32_bf16 a[172:175], a[84:87], a[28:31], a[172:175]
  buffer_load_dwordx4 v4, s[16:19], s65 offen offset:2048 lds
  v_mfma_f32_16x16x32_bf16 a[172:175], a[80:83], a[12:15], a[172:175]
  ds_read_b128 a[52:55], v29 offset:10240
  s_waitcnt lgkmcnt(7)
  v_add_u32 v13, 0x20000, v13
  v_mfma_f32_16x16x32_bf16 v[164:167], a[88:91], a[0:3], v[164:167]
  ds_read_b64_tr_b16 a[72:73], v13 offset:0
  v_mfma_f32_16x16x32_bf16 v[164:167], a[92:95], a[16:19], v[164:167]
  ds_read_b64_tr_b16 a[74:75], v13 offset:1024
  v_mfma_f32_16x16x32_bf16 v[172:175], a[92:95], a[20:23], v[172:175]
  v_mfma_f32_16x16x32_bf16 v[172:175], a[88:91], a[4:7], v[172:175]
  ds_read_b128 a[56:59], v29 offset:12288
  v_mfma_f32_16x16x32_bf16 v[180:183], a[88:91], a[8:11], v[180:183]
  ds_read_b64_tr_b16 a[76:77], v13 offset:8192
  v_accvgpr_read_b32 v224, a160
  v_mfma_f32_16x16x32_bf16 v[180:183], a[92:95], a[24:27], v[180:183]
  ds_read_b64_tr_b16 a[78:79], v13 offset:9216
  v_accvgpr_read_b32 v225, a161
  v_mfma_f32_16x16x32_bf16 v[188:191], a[92:95], a[28:31], v[188:191]
  buffer_load_dwordx4 v5, s[16:19], s65 offen offset:3072 lds
  v_mfma_f32_16x16x32_bf16 v[188:191], a[88:91], a[12:15], v[188:191]
  ds_read_b128 a[60:63], v29 offset:14336
  s_waitcnt lgkmcnt(7)
  v_add_u32 v14, 0x20000, v14
  v_mfma_f32_16x16x32_bf16 a[192:195], a[64:67], a[0:3], a[192:195]
  ds_read_b64_tr_b16 a[80:81], v14 offset:0
  s_add_u32 s65, s77, 1376256
  v_accvgpr_read_b32 v226, a162
  v_mfma_f32_16x16x32_bf16 a[192:195], a[68:71], a[16:19], a[192:195]
  ds_read_b64_tr_b16 a[82:83], v14 offset:1024
  s_add_u32 m0, s79, 49152
  v_accvgpr_read_b32 v227, a163
  v_mfma_f32_16x16x32_bf16 a[196:199], a[68:71], a[20:23], a[196:199]
  buffer_load_dwordx4 v6, s[56:59], s65 offen offset:0 lds
  v_mfma_f32_16x16x32_bf16 a[196:199], a[64:67], a[4:7], a[196:199]
  v_accvgpr_read_b32 v240, a164
  v_accvgpr_read_b32 v241, a165
  v_mfma_f32_16x16x32_bf16 a[200:203], a[64:67], a[8:11], a[200:203]
  ds_read_b64_tr_b16 a[84:85], v14 offset:8192
  v_accvgpr_read_b32 v242, a166
  v_mfma_f32_16x16x32_bf16 a[200:203], a[68:71], a[24:27], a[200:203]
  ds_read_b64_tr_b16 a[86:87], v14 offset:9216
  v_accvgpr_read_b32 v243, a167
  v_mfma_f32_16x16x32_bf16 a[204:207], a[68:71], a[28:31], a[204:207]
  buffer_load_dwordx4 v7, s[56:59], s65 offen offset:1024 lds
  v_mfma_f32_16x16x32_bf16 a[204:207], a[64:67], a[12:15], a[204:207]
  s_waitcnt lgkmcnt(5)
  v_add_u32 v15, 0x20000, v15
  v_accvgpr_read_b32 v196, a168
  v_mfma_f32_16x16x32_bf16 v[160:163], a[72:75], a[0:3], v[160:163]
  ds_read_b64_tr_b16 a[88:89], v15 offset:0
  v_accvgpr_read_b32 v197, a169
  v_mfma_f32_16x16x32_bf16 v[160:163], a[76:79], a[16:19], v[160:163]
  ds_read_b64_tr_b16 a[90:91], v15 offset:1024
  s_add_u32 s81, s85, 264192
  v_accvgpr_read_b32 v198, a170
  v_mfma_f32_16x16x32_bf16 v[176:179], a[76:79], a[20:23], v[176:179]
  buffer_store_dwordx4 v[72:75], v1, s[40:43], s81 offen sc1
  v_mfma_f32_16x16x32_bf16 v[176:179], a[72:75], a[4:7], v[176:179]
  v_accvgpr_read_b32 v199, a171
  v_accvgpr_read_b32 v204, a172
  v_mfma_f32_16x16x32_bf16 v[192:195], a[72:75], a[8:11], v[192:195]
  ds_read_b64_tr_b16 a[92:93], v15 offset:8192
  v_accvgpr_read_b32 v205, a173
  v_mfma_f32_16x16x32_bf16 v[192:195], a[76:79], a[24:27], v[192:195]
  ds_read_b64_tr_b16 a[94:95], v15 offset:9216
  v_accvgpr_read_b32 v206, a174
  v_mfma_f32_16x16x32_bf16 v[228:231], a[76:79], a[28:31], v[228:231]
  v_accvgpr_read_b32 v207, a175
  v_mfma_f32_16x16x32_bf16 v[228:231], a[72:75], a[12:15], v[228:231]
  s_waitcnt lgkmcnt(4)
  v_add_u32 v16, 0x20000, v16
  v_mfma_f32_16x16x32_bf16 a[224:227], a[80:83], a[0:3], a[224:227]
  ds_read_b64_tr_b16 a[64:65], v16 offset:16384
  s_lshr_b32 s54, s2, 3
  s_lshl_b32 s54, s54, 2
  s_add_u32 s54, s54, s60
  s_lshl_b32 s54, s54, 8
  v_mfma_f32_16x16x32_bf16 a[224:227], a[84:87], a[16:19], a[224:227]
  ds_read_b64_tr_b16 a[66:67], v16 offset:16896
  s_add_u32 s54, s54, Lp2epi-Lcw3
  v_add_u32 v22, s54, v0
  v_min_u32 v22, Lcodeend-Lcw3-4, v22
  s_getpc_b64 s[54:55]
Lcw3:
  v_mfma_f32_16x16x32_bf16 a[228:231], a[84:87], a[20:23], a[228:231]
  global_load_dword v26, v22, s[54:55]
  v_mfma_f32_16x16x32_bf16 a[228:231], a[80:83], a[4:7], a[228:231]
  v_mfma_f32_16x16x32_bf16 a[232:235], a[80:83], a[8:11], a[232:235]
  ds_read_b64_tr_b16 a[68:69], v16 offset:20480
  s_add_u32 s65, s72, 896
  v_mfma_f32_16x16x32_bf16 a[232:235], a[84:87], a[24:27], a[232:235]
  ds_read_b64_tr_b16 a[70:71], v16 offset:20992
  s_add_u32 m0, s84, 8192
  v_mfma_f32_16x16x32_bf16 a[236:239], a[84:87], a[28:31], a[236:239]
  buffer_load_dwordx4 v20, s[8:11], s65 offen offset:0 lds
  v_mfma_f32_16x16x32_bf16 a[236:239], a[80:83], a[12:15], a[236:239]
  s_waitcnt lgkmcnt(4)
  v_add_u32 v17, 0x20000, v17
  v_mfma_f32_16x16x32_bf16 v[236:239], a[88:91], a[0:3], v[236:239]
  ds_read_b64_tr_b16 a[72:73], v17 offset:16384
  v_mfma_f32_16x16x32_bf16 v[236:239], a[92:95], a[16:19], v[236:239]
  ds_read_b64_tr_b16 a[74:75], v17 offset:16896
  v_mfma_f32_16x16x32_bf16 v[244:247], a[92:95], a[20:23], v[244:247]
  buffer_load_dwordx4 v21, s[8:11], s65 offen offset:1024 lds
  v_mfma_f32_16x16x32_bf16 v[244:247], a[88:91], a[4:7], v[244:247]
  v_mfma_f32_16x16x32_bf16 v[252:255], a[88:91], a[8:11], v[252:255]
  ds_read_b64_tr_b16 a[76:77], v17 offset:20480
  v_mfma_f32_16x16x32_bf16 v[252:255], a[92:95], a[24:27], v[252:255]
  ds_read_b64_tr_b16 a[78:79], v17 offset:20992
  v_mfma_f32_16x16x32_bf16 v[208:211], a[92:95], a[28:31], v[208:211]
  v_mfma_f32_16x16x32_bf16 v[208:211], a[88:91], a[12:15], v[208:211]
  s_waitcnt lgkmcnt(4)
  v_add_u32 v18, 0x20000, v18
  v_mfma_f32_16x16x32_bf16 v[48:51], a[64:67], a[0:3], v[48:51]
  ds_read_b64_tr_b16 a[80:81], v18 offset:16384
  v_mfma_f32_16x16x32_bf16 v[48:51], a[68:71], a[16:19], v[48:51]
  ds_read_b64_tr_b16 a[82:83], v18 offset:16896
  v_mfma_f32_16x16x32_bf16 v[52:55], a[68:71], a[20:23], v[52:55]
  ds_read_b64_tr_b16 a[84:85], v18 offset:20480
  v_mfma_f32_16x16x32_bf16 v[52:55], a[64:67], a[4:7], v[52:55]
  ds_read_b64_tr_b16 a[86:87], v18 offset:20992
  v_add_u32 v19, 0x20000, v19
  v_mfma_f32_16x16x32_bf16 v[56:59], a[64:67], a[8:11], v[56:59]
  ds_read_b64_tr_b16 a[88:89], v19 offset:16384
  s_add_u32 s65, s73, 896
  v_mfma_f32_16x16x32_bf16 v[56:59], a[68:71], a[24:27], v[56:59]
  ds_read_b64_tr_b16 a[90:91], v19 offset:16896
  s_add_u32 m0, s84, 10240
  v_mfma_f32_16x16x32_bf16 v[60:63], a[68:71], a[28:31], v[60:63]
  ds_read_b64_tr_b16 a[92:93], v19 offset:20480
  buffer_load_dwordx4 v20, s[8:11], s65 offen offset:0 lds
  v_mfma_f32_16x16x32_bf16 v[60:63], a[64:67], a[12:15], v[60:63]
  ds_read_b64_tr_b16 a[94:95], v19 offset:20992
  s_waitcnt lgkmcnt(8)
  v_mfma_f32_16x16x32_bf16 v[80:83], a[72:75], a[0:3], v[80:83]
  v_mfma_f32_16x16x32_bf16 v[80:83], a[76:79], a[16:19], v[80:83]
  v_mfma_f32_16x16x32_bf16 v[84:87], a[76:79], a[20:23], v[84:87]
  buffer_load_dwordx4 v21, s[8:11], s65 offen offset:1024 lds
  v_mfma_f32_16x16x32_bf16 v[84:87], a[72:75], a[4:7], v[84:87]
  v_mfma_f32_16x16x32_bf16 v[88:91], a[72:75], a[8:11], v[88:91]
  s_add_u32 s65, s74, 896
  v_mfma_f32_16x16x32_bf16 v[88:91], a[76:79], a[24:27], v[88:91]
  s_add_u32 m0, s84, 12288
  v_mfma_f32_16x16x32_bf16 v[92:95], a[76:79], a[28:31], v[92:95]
  buffer_load_dwordx4 v20, s[8:11], s65 offen offset:0 lds
  v_mfma_f32_16x16x32_bf16 v[92:95], a[72:75], a[12:15], v[92:95]
  s_waitcnt lgkmcnt(4)
  v_add_u32 v8, 0xfffe0000, v8
  s_waitcnt vmcnt(24) lgkmcnt(0)
  s_barrier
  v_mfma_f32_16x16x32_bf16 v[112:115], a[80:83], a[0:3], v[112:115]
  ds_read_b64_tr_b16 a[64:65], v8 offset:0
  v_mfma_f32_16x16x32_bf16 v[112:115], a[84:87], a[16:19], v[112:115]
  ds_read_b64_tr_b16 a[66:67], v8 offset:1024
  v_mfma_f32_16x16x32_bf16 v[116:119], a[84:87], a[20:23], v[116:119]
  buffer_load_dwordx4 v21, s[8:11], s65 offen offset:1024 lds
  v_mfma_f32_16x16x32_bf16 v[116:119], a[80:83], a[4:7], v[116:119]
  v_mfma_f32_16x16x32_bf16 v[120:123], a[80:83], a[8:11], v[120:123]
  ds_read_b64_tr_b16 a[68:69], v8 offset:8192
  s_add_u32 s65, s75, 896
  v_mfma_f32_16x16x32_bf16 v[120:123], a[84:87], a[24:27], v[120:123]
  ds_read_b64_tr_b16 a[70:71], v8 offset:9216
  s_add_u32 m0, s84, 14336
  v_mfma_f32_16x16x32_bf16 v[124:127], a[84:87], a[28:31], v[124:127]
  buffer_load_dwordx4 v20, s[8:11], s65 offen offset:0 lds
  v_mfma_f32_16x16x32_bf16 v[124:127], a[80:83], a[12:15], v[124:127]
  v_add_u32 v9, 0xfffe0000, v9
  v_mfma_f32_16x16x32_bf16 v[144:147], a[88:91], a[0:3], v[144:147]
  ds_read_b64_tr_b16 a[72:73], v9 offset:0
  v_mfma_f32_16x16x32_bf16 v[144:147], a[92:95], a[16:19], v[144:147]
  ds_read_b64_tr_b16 a[74:75], v9 offset:1024
  v_mfma_f32_16x16x32_bf16 v[148:151], a[92:95], a[20:23], v[148:151]
  buffer_load_dwordx4 v21, s[8:11], s65 offen offset:1024 lds
  v_mfma_f32_16x16x32_bf16 v[148:151], a[88:91], a[4:7], v[148:151]
  v_mfma_f32_16x16x32_bf16 v[152:155], a[88:91], a[8:11], v[152:155]
  ds_read_b64_tr_b16 a[76:77], v9 offset:8192
  v_mfma_f32_16x16x32_bf16 v[152:155], a[92:95], a[24:27], v[152:155]
  ds_read_b64_tr_b16 a[78:79], v9 offset:9216
  s_add_u32 s81, s85, 265216
  v_mfma_f32_16x16x32_bf16 v[156:159], a[92:95], a[28:31], v[156:159]
  buffer_store_dwordx4 v[76:79], v1, s[40:43], s81 offen sc1
  v_mfma_f32_16x16x32_bf16 v[156:159], a[88:91], a[12:15], v[156:159]
  s_waitcnt lgkmcnt(4)
  v_add_u32 v10, 0xfffe0000, v10
  s_waitcnt vmcnt(19)
  v_mfma_f32_16x16x32_bf16 v[32:35], a[64:67], a[32:35], v[32:35]
  ds_read_b64_tr_b16 a[80:81], v10 offset:0
  v_mfma_f32_16x16x32_bf16 v[32:35], a[68:71], a[48:51], v[32:35]
  ds_read_b64_tr_b16 a[82:83], v10 offset:1024
  v_mfma_f32_16x16x32_bf16 v[36:39], a[68:71], a[52:55], v[36:39]
  v_mfma_f32_16x16x32_bf16 v[36:39], a[64:67], a[36:39], v[36:39]
  ds_read_b128 a[0:3], v28 offset:0
  v_mfma_f32_16x16x32_bf16 v[64:67], a[64:67], a[40:43], v[64:67]
  ds_read_b64_tr_b16 a[84:85], v10 offset:8192
  v_mfma_f32_16x16x32_bf16 v[64:67], a[68:71], a[56:59], v[64:67]
  ds_read_b64_tr_b16 a[86:87], v10 offset:9216
  v_mfma_f32_16x16x32_bf16 v[68:71], a[68:71], a[60:63], v[68:71]
  v_mfma_f32_16x16x32_bf16 v[68:71], a[64:67], a[44:47], v[68:71]
  ds_read_b128 a[4:7], v28 offset:2048
  s_waitcnt lgkmcnt(6)
  v_add_u32 v11, 0xfffe0000, v11
  v_mfma_f32_16x16x32_bf16 v[96:99], a[72:75], a[32:35], v[96:99]
  ds_read_b64_tr_b16 a[88:89], v11 offset:0
  s_add_u32 s65, s76, 3670016
  v_mfma_f32_16x16x32_bf16 v[96:99], a[76:79], a[48:51], v[96:99]
  ds_read_b64_tr_b16 a[90:91], v11 offset:1024
  s_add_u32 m0, s78, 131072
  v_mfma_f32_16x16x32_bf16 v[100:103], a[76:79], a[52:55], v[100:103]
  buffer_load_dwordx4 v2, s[16:19], s65 offen offset:0 lds
  v_mfma_f32_16x16x32_bf16 v[100:103], a[72:75], a[36:39], v[100:103]
  ds_read_b128 a[8:11], v28 offset:4096
  v_mfma_f32_16x16x32_bf16 v[128:131], a[72:75], a[40:43], v[128:131]
  ds_read_b64_tr_b16 a[92:93], v11 offset:8192
  v_mfma_f32_16x16x32_bf16 v[128:131], a[76:79], a[56:59], v[128:131]
  ds_read_b64_tr_b16 a[94:95], v11 offset:9216
  s_add_u32 s81, s85, 266240
  v_mfma_f32_16x16x32_bf16 v[132:135], a[76:79], a[60:63], v[132:135]
  buffer_store_dwordx4 v[104:107], v1, s[40:43], s81 offen sc1
  v_mfma_f32_16x16x32_bf16 v[132:135], a[72:75], a[44:47], v[132:135]
  ds_read_b128 a[12:15], v28 offset:6144
  s_waitcnt lgkmcnt(7)
  v_add_u32 v12, 0xfffe0000, v12
  v_mfma_f32_16x16x32_bf16 v[224:227], a[80:83], a[32:35], v[224:227]
  ds_read_b64_tr_b16 a[64:65], v12 offset:0
  v_mfma_f32_16x16x32_bf16 v[224:227], a[84:87], a[48:51], v[224:227]
  ds_read_b64_tr_b16 a[66:67], v12 offset:1024
  v_mfma_f32_16x16x32_bf16 v[240:243], a[84:87], a[52:55], v[240:243]
  buffer_load_dwordx4 v3, s[16:19], s65 offen offset:1024 lds
  v_mfma_f32_16x16x32_bf16 v[240:243], a[80:83], a[36:39], v[240:243]
  ds_read_b128 a[16:19], v29 offset:0
  v_mfma_f32_16x16x32_bf16 v[196:199], a[80:83], a[40:43], v[196:199]
  ds_read_b64_tr_b16 a[68:69], v12 offset:8192
  v_mfma_f32_16x16x32_bf16 v[196:199], a[84:87], a[56:59], v[196:199]
  ds_read_b64_tr_b16 a[70:71], v12 offset:9216
  v_mfma_f32_16x16x32_bf16 v[204:207], a[84:87], a[60:63], v[204:207]
  v_mfma_f32_16x16x32_bf16 v[204:207], a[80:83], a[44:47], v[204:207]
  ds_read_b128 a[20:23], v29 offset:2048
  s_waitcnt lgkmcnt(7)
  v_add_u32 v13, 0xfffe0000, v13
  v_mfma_f32_16x16x32_bf16 v[164:167], a[88:91], a[32:35], v[164:167]
  ds_read_b64_tr_b16 a[72:73], v13 offset:0
  v_mfma_f32_16x16x32_bf16 v[164:167], a[92:95], a[48:51], v[164:167]
  ds_read_b64_tr_b16 a[74:75], v13 offset:1024
  v_mfma_f32_16x16x32_bf16 v[172:175], a[92:95], a[52:55], v[172:175]
  buffer_load_dwordx4 v4, s[16:19], s65 offen offset:2048 lds
  v_mfma_f32_16x16x32_bf16 v[172:175], a[88:91], a[36:39], v[172:175]
  ds_read_b128 a[24:27], v29 offset:4096
  v_mfma_f32_16x16x32_bf16 v[180:183], a[88:91], a[40:43], v[180:183]
  ds_read_b64_tr_b16 a[76:77], v13 offset:8192
  v_mfma_f32_16x16x32_bf16 v[180:183], a[92:95], a[56:59], v[180:183]
  ds_read_b64_tr_b16 a[78:79], v13 offset:9216
  v_mfma_f32_16x16x32_bf16 v[188:191], a[92:95], a[60:63], v[188:191]
  buffer_load_dwordx4 v5, s[16:19], s65 offen offset:3072 lds
  v_mfma_f32_16x16x32_bf16 v[188:191], a[88:91], a[44:47], v[188:191]
  ds_read_b128 a[28:31], v29 offset:6144
  s_waitcnt lgkmcnt(7)
  v_add_u32 v14, 0xfffe0000, v14
  v_mfma_f32_16x16x32_bf16 a[192:195], a[64:67], a[32:35], a[192:195]
  ds_read_b64_tr_b16 a[80:81], v14 offset:0
  s_add_u32 s65, s77, 1605632
  v_mfma_f32_16x16x32_bf16 a[192:195], a[68:71], a[48:51], a[192:195]
  ds_read_b64_tr_b16 a[82:83], v14 offset:1024
  s_add_u32 m0, s79, 147456
  v_mfma_f32_16x16x32_bf16 a[196:199], a[68:71], a[52:55], a[196:199]
  buffer_load_dwordx4 v6, s[56:59], s65 offen offset:0 lds
  v_mfma_f32_16x16x32_bf16 a[196:199], a[64:67], a[36:39], a[196:199]
  v_mfma_f32_16x16x32_bf16 a[200:203], a[64:67], a[40:43], a[200:203]
  ds_read_b64_tr_b16 a[84:85], v14 offset:8192
  v_mfma_f32_16x16x32_bf16 a[200:203], a[68:71], a[56:59], a[200:203]
  ds_read_b64_tr_b16 a[86:87], v14 offset:9216
  v_mfma_f32_16x16x32_bf16 a[204:207], a[68:71], a[60:63], a[204:207]
  v_mfma_f32_16x16x32_bf16 a[204:207], a[64:67], a[44:47], a[204:207]
  s_waitcnt lgkmcnt(5)
  v_add_u32 v15, 0xfffe0000, v15
  v_mfma_f32_16x16x32_bf16 v[160:163], a[72:75], a[32:35], v[160:163]
  ds_read_b64_tr_b16 a[88:89], v15 offset:0
  v_mfma_f32_16x16x32_bf16 v[160:163], a[76:79], a[48:51], v[160:163]
  ds_read_b64_tr_b16 a[90:91], v15 offset:1024
  s_add_u32 s81, s85, 267264
  v_mfma_f32_16x16x32_bf16 v[176:179], a[76:79], a[52:55], v[176:179]
  buffer_store_dwordx4 v[108:111], v1, s[40:43], s81 offen sc1
  v_mfma_f32_16x16x32_bf16 v[176:179], a[72:75], a[36:39], v[176:179]
  v_mfma_f32_16x16x32_bf16 v[192:195], a[72:75], a[40:43], v[192:195]
  ds_read_b64_tr_b16 a[92:93], v15 offset:8192
  v_accvgpr_read_b32 v40, a192
  v_mfma_f32_16x16x32_bf16 v[192:195], a[76:79], a[56:59], v[192:195]
  ds_read_b64_tr_b16 a[94:95], v15 offset:9216
  v_accvgpr_read_b32 v41, a193
  v_mfma_f32_16x16x32_bf16 v[228:231], a[76:79], a[60:63], v[228:231]
  buffer_load_dwordx4 v7, s[56:59], s65 offen offset:1024 lds
  v_mfma_f32_16x16x32_bf16 v[228:231], a[72:75], a[44:47], v[228:231]
  s_waitcnt lgkmcnt(4)
  v_add_u32 v16, 0xfffe0000, v16
  v_accvgpr_read_b32 v42, a194
  v_mfma_f32_16x16x32_bf16 a[224:227], a[80:83], a[32:35], a[224:227]
  ds_read_b64_tr_b16 a[64:65], v16 offset:16384
  s_mov_b32 s68, 0x3e0293ee
  v_accvgpr_read_b32 v43, a195
  v_mfma_f32_16x16x32_bf16 a[224:227], a[84:87], a[48:51], a[224:227]
  ds_read_b64_tr_b16 a[66:67], v16 offset:16896
  s_mov_b32 s69, 0x3e0293ee
  v_accvgpr_read_b32 v44, a196
  v_mfma_f32_16x16x32_bf16 a[228:231], a[84:87], a[52:55], a[228:231]
  v_accvgpr_read_b32 v45, a197
  v_accvgpr_read_b32 v46, a198
  v_mfma_f32_16x16x32_bf16 a[228:231], a[80:83], a[36:39], a[228:231]
  v_accvgpr_read_b32 v47, a199
  v_accvgpr_read_b32 v72, a200
  v_mfma_f32_16x16x32_bf16 a[232:235], a[80:83], a[40:43], a[232:235]
  ds_read_b64_tr_b16 a[68:69], v16 offset:20480
  v_accvgpr_read_b32 v73, a201
  v_mfma_f32_16x16x32_bf16 a[232:235], a[84:87], a[56:59], a[232:235]
  ds_read_b64_tr_b16 a[70:71], v16 offset:20992
  v_accvgpr_read_b32 v74, a202
  v_mfma_f32_16x16x32_bf16 a[236:239], a[84:87], a[60:63], a[236:239]
  v_accvgpr_read_b32 v75, a203
  v_accvgpr_read_b32 v76, a204
  v_mfma_f32_16x16x32_bf16 a[236:239], a[80:83], a[44:47], a[236:239]
  s_waitcnt lgkmcnt(4)
  v_add_u32 v17, 0xfffe0000, v17
  v_accvgpr_read_b32 v77, a205
  v_mfma_f32_16x16x32_bf16 v[236:239], a[88:91], a[32:35], v[236:239]
  ds_read_b64_tr_b16 a[72:73], v17 offset:16384
  v_accvgpr_read_b32 v78, a206
  v_mfma_f32_16x16x32_bf16 v[236:239], a[92:95], a[48:51], v[236:239]
  ds_read_b64_tr_b16 a[74:75], v17 offset:16896
  v_accvgpr_read_b32 v79, a207
  v_mfma_f32_16x16x32_bf16 v[244:247], a[92:95], a[52:55], v[244:247]
  v_mfma_f32_16x16x32_bf16 v[244:247], a[88:91], a[36:39], v[244:247]
  v_mfma_f32_16x16x32_bf16 v[252:255], a[88:91], a[40:43], v[252:255]
  ds_read_b64_tr_b16 a[76:77], v17 offset:20480
  v_mfma_f32_16x16x32_bf16 v[252:255], a[92:95], a[56:59], v[252:255]
  ds_read_b64_tr_b16 a[78:79], v17 offset:20992
  v_mfma_f32_16x16x32_bf16 v[208:211], a[92:95], a[60:63], v[208:211]
  v_mfma_f32_16x16x32_bf16 v[208:211], a[88:91], a[44:47], v[208:211]
  s_waitcnt lgkmcnt(4)
  v_add_u32 v18, 0xfffe0000, v18
  v_mfma_f32_16x16x32_bf16 v[48:51], a[64:67], a[32:35], v[48:51]
  ds_read_b64_tr_b16 a[80:81], v18 offset:16384
  v_mfma_f32_16x16x32_bf16 v[48:51], a[68:71], a[48:51], v[48:51]
  ds_read_b64_tr_b16 a[82:83], v18 offset:16896
  v_mfma_f32_16x16x32_bf16 v[52:55], a[68:71], a[52:55], v[52:55]
  ds_read_b64_tr_b16 a[84:85], v18 offset:20480
  v_mfma_f32_16x16x32_bf16 v[52:55], a[64:67], a[36:39], v[52:55]
  ds_read_b64_tr_b16 a[86:87], v18 offset:20992
  v_add_u32 v19, 0xfffe0000, v19
  v_mfma_f32_16x16x32_bf16 v[56:59], a[64:67], a[40:43], v[56:59]
  ds_read_b64_tr_b16 a[88:89], v19 offset:16384
  v_mfma_f32_16x16x32_bf16 v[56:59], a[68:71], a[56:59], v[56:59]
  ds_read_b64_tr_b16 a[90:91], v19 offset:16896
  v_mfma_f32_16x16x32_bf16 v[60:63], a[68:71], a[60:63], v[60:63]
  ds_read_b64_tr_b16 a[92:93], v19 offset:20480
  v_mfma_f32_16x16x32_bf16 v[60:63], a[64:67], a[44:47], v[60:63]
  ds_read_b64_tr_b16 a[94:95], v19 offset:20992
  s_waitcnt lgkmcnt(8)
  v_mfma_f32_16x16x32_bf16 v[80:83], a[72:75], a[32:35], v[80:83]
  v_mfma_f32_16x16x32_bf16 v[80:83], a[76:79], a[48:51], v[80:83]
  s_add_u32 s81, s85, 268288
  v_mfma_f32_16x16x32_bf16 v[84:87], a[76:79], a[52:55], v[84:87]
  buffer_store_dwordx4 v[136:139], v1, s[40:43], s81 offen sc1
  v_mfma_f32_16x16x32_bf16 v[84:87], a[72:75], a[36:39], v[84:87]
  v_mfma_f32_16x16x32_bf16 v[88:91], a[72:75], a[40:43], v[88:91]
  v_mfma_f32_16x16x32_bf16 v[88:91], a[76:79], a[56:59], v[88:91]
  v_mfma_f32_16x16x32_bf16 v[92:95], a[76:79], a[60:63], v[92:95]
  v_mfma_f32_16x16x32_bf16 v[92:95], a[72:75], a[44:47], v[92:95]
  s_waitcnt lgkmcnt(4)
  s_waitcnt vmcnt(20) lgkmcnt(0)
  s_barrier
  s_add_u32 s63, s62, 0
  s_lshl_b64 exec, s[94:95], s63
  buffer_store_dword v27, v0, s[40:43], s66 offen sc1
  s_mov_b64 exec, -1
  v_mfma_f32_16x16x32_bf16 v[112:115], a[80:83], a[32:35], v[112:115]
  ds_read_b64_tr_b16 a[64:65], v8 offset:32768
  v_mfma_f32_16x16x32_bf16 v[112:115], a[84:87], a[48:51], v[112:115]
  ds_read_b64_tr_b16 a[66:67], v8 offset:33792
  v_mfma_f32_16x16x32_bf16 v[116:119], a[84:87], a[52:55], v[116:119]
  v_mfma_f32_16x16x32_bf16 v[116:119], a[80:83], a[36:39], v[116:119]
  v_mfma_f32_16x16x32_bf16 v[120:123], a[80:83], a[40:43], v[120:123]
  ds_read_b64_tr_b16 a[68:69], v8 offset:40960
  v_mfma_f32_16x16x32_bf16 v[120:123], a[84:87], a[56:59], v[120:123]
  ds_read_b64_tr_b16 a[70:71], v8 offset:41984
  v_mfma_f32_16x16x32_bf16 v[124:127], a[84:87], a[60:63], v[124:127]
  v_mfma_f32_16x16x32_bf16 v[124:127], a[80:83], a[44:47], v[124:127]
  v_mfma_f32_16x16x32_bf16 v[144:147], a[88:91], a[32:35], v[144:147]
  ds_read_b64_tr_b16 a[72:73], v9 offset:32768
  v_mfma_f32_16x16x32_bf16 v[144:147], a[92:95], a[48:51], v[144:147]
  ds_read_b64_tr_b16 a[74:75], v9 offset:33792
  v_mfma_f32_16x16x32_bf16 v[148:151], a[92:95], a[52:55], v[148:151]
  v_mfma_f32_16x16x32_bf16 v[148:151], a[88:91], a[36:39], v[148:151]
  v_mfma_f32_16x16x32_bf16 v[152:155], a[88:91], a[40:43], v[152:155]
  ds_read_b64_tr_b16 a[76:77], v9 offset:40960
  v_mfma_f32_16x16x32_bf16 v[152:155], a[92:95], a[56:59], v[152:155]
  ds_read_b64_tr_b16 a[78:79], v9 offset:41984
  v_mfma_f32_16x16x32_bf16 v[156:159], a[92:95], a[60:63], v[156:159]
  v_mfma_f32_16x16x32_bf16 v[156:159], a[88:91], a[44:47], v[156:159]
  s_waitcnt lgkmcnt(4)
  s_waitcnt vmcnt(10)
  v_mfma_f32_16x16x32_bf16 v[32:35], a[64:67], a[0:3], v[32:35]
  ds_read_b64_tr_b16 a[80:81], v10 offset:32768
  s_lshl_b32 s63, s61, 19
  v_mfma_f32_16x16x32_bf16 v[32:35], a[68:71], a[16:19], v[32:35]
  ds_read_b64_tr_b16 a[82:83], v10 offset:33792
  s_add_u32 s81, s85, 269312
  v_mfma_f32_16x16x32_bf16 v[36:39], a[68:71], a[20:23], v[36:39]
  buffer_store_dwordx4 v[140:143], v1, s[40:43], s81 offen sc1
  v_mfma_f32_16x16x32_bf16 v[36:39], a[64:67], a[4:7], v[36:39]
  ds_read_b128 a[32:35], v28 offset:8192
  s_add_u32 s20, s40, s63
  s_addc_u32 s21, s41, 0
  v_mfma_f32_16x16x32_bf16 v[64:67], a[64:67], a[8:11], v[64:67]
  ds_read_b64_tr_b16 a[84:85], v10 offset:40960
  s_add_u32 s24, s20, 16777216
  s_addc_u32 s25, s21, 0
  v_mfma_f32_16x16x32_bf16 v[64:67], a[68:71], a[24:27], v[64:67]
  ds_read_b64_tr_b16 a[86:87], v10 offset:41984
  s_sub_u32 s63, 16, s62
  v_mfma_f32_16x16x32_bf16 v[68:71], a[68:71], a[28:31], v[68:71]
  s_lshl_b32 s22, s63, 15
  v_mfma_f32_16x16x32_bf16 v[68:71], a[64:67], a[12:15], v[68:71]
  ds_read_b128 a[36:39], v28 offset:10240
  s_waitcnt lgkmcnt(6)
  v_mfma_f32_16x16x32_bf16 v[96:99], a[72:75], a[0:3], v[96:99]
  ds_read_b64_tr_b16 a[88:89], v11 offset:32768
  s_mov_b32 s26, s22
  v_mfma_f32_16x16x32_bf16 v[96:99], a[76:79], a[16:19], v[96:99]
  ds_read_b64_tr_b16 a[90:91], v11 offset:33792
  s_lshl_b32 s87, s62, 2
  v_mfma_f32_16x16x32_bf16 v[100:103], a[76:79], a[20:23], v[100:103]
  s_add_u32 s67, s87, s60
  v_mfma_f32_16x16x32_bf16 v[100:103], a[72:75], a[4:7], v[100:103]
  ds_read_b128 a[40:43], v28 offset:12288
  s_sub_u32 s87, s87, 2
  v_mfma_f32_16x16x32_bf16 v[128:131], a[72:75], a[8:11], v[128:131]
  ds_read_b64_tr_b16 a[92:93], v11 offset:40960
  s_mov_b32 s5, 0
  v_mfma_f32_16x16x32_bf16 v[128:131], a[76:79], a[24:27], v[128:131]
  ds_read_b64_tr_b16 a[94:95], v11 offset:41984
  s_mov_b32 s90, 0x7f7fffff
  v_mfma_f32_16x16x32_bf16 v[132:135], a[76:79], a[28:31], v[132:135]
  s_mov_b32 s91, 0xf149f2ca
  v_mfma_f32_16x16x32_bf16 v[132:135], a[72:75], a[12:15], v[132:135]
  ds_read_b128 a[44:47], v28 offset:14336
  s_waitcnt lgkmcnt(7)
  v_mfma_f32_16x16x32_bf16 v[224:227], a[80:83], a[0:3], v[224:227]
  ds_read_b64_tr_b16 a[64:65], v12 offset:32768
  s_and_b32 s4, s60, 1
  v_mfma_f32_16x16x32_bf16 v[224:227], a[84:87], a[16:19], v[224:227]
  ds_read_b64_tr_b16 a[66:67], v12 offset:33792
  s_lshl_b32 s4, s4, 13
  v_mfma_f32_16x16x32_bf16 v[240:243], a[84:87], a[20:23], v[240:243]
  s_add_u32 s63, s4, 8192
  v_mfma_f32_16x16x32_bf16 v[240:243], a[80:83], a[4:7], v[240:243]
  ds_read_b128 a[48:51], v29 offset:8192
  s_cmp_eq_u32 s62, 7
  s_cselect_b32 s53, s63, 16384
  s_cselect_b32 s52, 1, 2
  v_mfma_f32_16x16x32_bf16 v[196:199], a[80:83], a[8:11], v[196:199]
  ds_read_b64_tr_b16 a[68:69], v12 offset:40960
  s_lshl_b32 s52, s52, 13
  v_mfma_f32_16x16x32_bf16 v[196:199], a[84:87], a[24:27], v[196:199]
  ds_read_b64_tr_b16 a[70:71], v12 offset:41984
  s_lshl_b32 s71, s61, 11
  v_mfma_f32_16x16x32_bf16 v[204:207], a[84:87], a[28:31], v[204:207]
  s_add_u32 s71, s71, 33685504
  v_mfma_f32_16x16x32_bf16 v[204:207], a[80:83], a[12:15], v[204:207]
  ds_read_b128 a[52:55], v29 offset:10240
  s_waitcnt lgkmcnt(7)
  v_mfma_f32_16x16x32_bf16 v[164:167], a[88:91], a[0:3], v[164:167]
  ds_read_b64_tr_b16 a[72:73], v13 offset:32768
  s_mov_b64 s[8:9], s[40:41]
  v_mfma_f32_16x16x32_bf16 v[164:167], a[92:95], a[16:19], v[164:167]
  ds_read_b64_tr_b16 a[74:75], v13 offset:33792
  s_cmp_ge_u32 s61, 28
  s_cselect_b32 s10, 0, s42
  v_mfma_f32_16x16x32_bf16 v[172:175], a[92:95], a[20:23], v[172:175]
  s_bfe_u32 s84, s2, 0x30003
  v_mfma_f32_16x16x32_bf16 v[172:175], a[88:91], a[4:7], v[172:175]
  ds_read_b128 a[56:59], v29 offset:12288
  s_and_b32 s63, s2, 4
  v_mfma_f32_16x16x32_bf16 v[180:183], a[88:91], a[8:11], v[180:183]
  ds_read_b64_tr_b16 a[76:77], v13 offset:40960
  s_lshl_b32 s63, s63, 1
  v_mfma_f32_16x16x32_bf16 v[180:183], a[92:95], a[24:27], v[180:183]
  ds_read_b64_tr_b16 a[78:79], v13 offset:41984
  s_add_u32 s81, s85, 17039360
  v_mfma_f32_16x16x32_bf16 v[188:191], a[92:95], a[28:31], v[188:191]
  buffer_store_dwordx4 v[168:171], v1, s[40:43], s81 offen sc1
  v_mfma_f32_16x16x32_bf16 v[188:191], a[88:91], a[12:15], v[188:191]
  ds_read_b128 a[60:63], v29 offset:14336
  s_waitcnt lgkmcnt(7)
  v_mfma_f32_16x16x32_bf16 v[40:43], a[64:67], a[0:3], v[40:43]
  ds_read_b64_tr_b16 a[80:81], v14 offset:32768
  s_add_u32 s84, s84, s63
  v_mfma_f32_16x16x32_bf16 v[40:43], a[68:71], a[16:19], v[40:43]
  ds_read_b64_tr_b16 a[82:83], v14 offset:33792
  s_lshr_b32 s1, s2, 6
  v_mfma_f32_16x16x32_bf16 v[44:47], a[68:71], a[20:23], v[44:47]
  ds_read_b64_tr_b16 a[84:85], v14 offset:40960
  s_mul_i32 s17, s84, 0
  v_mfma_f32_16x16x32_bf16 v[44:47], a[64:67], a[4:7], v[44:47]
  ds_read_b64_tr_b16 a[86:87], v14 offset:41984
  s_and_b32 s18, s17, 7
  v_mfma_f32_16x16x32_bf16 v[72:75], a[64:67], a[8:11], v[72:75]
  ds_read_b64_tr_b16 a[88:89], v15 offset:32768
  s_min_u32 s18, s18, 6
  v_mfma_f32_16x16x32_bf16 v[72:75], a[68:71], a[24:27], v[72:75]
  ds_read_b64_tr_b16 a[90:91], v15 offset:33792
  s_lshl_b32 s63, s84, 2
  v_mfma_f32_16x16x32_bf16 v[76:79], a[68:71], a[28:31], v[76:79]
  ds_read_b64_tr_b16 a[92:93], v15 offset:40960
  s_add_u32 s63, s63, s1
  v_mfma_f32_16x16x32_bf16 v[76:79], a[64:67], a[12:15], v[76:79]
  ds_read_b64_tr_b16 a[94:95], v15 offset:41984
  s_waitcnt lgkmcnt(9)
  v_mfma_f32_16x16x32_bf16 v[160:163], a[72:75], a[0:3], v[160:163]
  s_lshl_b32 s12, s63, 6
  v_mfma_f32_16x16x32_bf16 v[160:163], a[76:79], a[16:19], v[160:163]
  s_add_u32 s12, s12, 58791936
  v_mfma_f32_16x16x32_bf16 v[176:179], a[76:79], a[20:23], v[176:179]
  s_lshl_b32 s13, s63, 17
  v_mfma_f32_16x16x32_bf16 v[176:179], a[72:75], a[4:7], v[176:179]
  s_add_u32 s13, s13, 62914560
  v_mfma_f32_16x16x32_bf16 v[192:195], a[72:75], a[8:11], v[192:195]
  s_lshl_b32 s63, s0, 15
  v_mfma_f32_16x16x32_bf16 v[192:195], a[76:79], a[24:27], v[192:195]
  s_add_u32 s63, s13, s63
  v_mfma_f32_16x16x32_bf16 v[228:231], a[76:79], a[28:31], v[228:231]
  s_lshl_b32 s64, s60, 11
  v_mfma_f32_16x16x32_bf16 v[228:231], a[72:75], a[12:15], v[228:231]
  s_waitcnt lgkmcnt(4)
  v_add_u32 v8, 0x20000, v8
  s_waitcnt vmcnt(3) lgkmcnt(0)
  s_barrier
  v_mfma_f32_16x16x32_bf16 a[224:227], a[80:83], a[0:3], a[224:227]
  ds_read_b64_tr_b16 a[64:65], v8 offset:0
  s_add_u32 s64, s64, s63
  v_mfma_f32_16x16x32_bf16 a[224:227], a[84:87], a[16:19], a[224:227]
  ds_read_b64_tr_b16 a[66:67], v8 offset:1024
  s_add_u32 s63, s0, 1
  v_mfma_f32_16x16x32_bf16 a[228:231], a[84:87], a[20:23], a[228:231]
  s_and_b32 s63, s63, 3
  v_mfma_f32_16x16x32_bf16 a[228:231], a[80:83], a[4:7], a[228:231]
  s_lshl_b32 s63, s63, 13
  v_mfma_f32_16x16x32_bf16 a[232:235], a[80:83], a[8:11], a[232:235]
  ds_read_b64_tr_b16 a[68:69], v8 offset:8192
  s_add_u32 s14, s63, s64
  v_mfma_f32_16x16x32_bf16 a[232:235], a[84:87], a[24:27], a[232:235]
  ds_read_b64_tr_b16 a[70:71], v8 offset:9216
  s_add_u32 s63, s0, 2
  v_mfma_f32_16x16x32_bf16 a[236:239], a[84:87], a[28:31], a[236:239]
  s_and_b32 s63, s63, 3
  v_mfma_f32_16x16x32_bf16 a[236:239], a[80:83], a[12:15], a[236:239]
  v_add_u32 v9, 0x20000, v9
  v_mfma_f32_16x16x32_bf16 v[236:239], a[88:91], a[0:3], v[236:239]
  ds_read_b64_tr_b16 a[72:73], v9 offset:0
  s_lshl_b32 s63, s63, 13
  v_mfma_f32_16x16x32_bf16 v[236:239], a[92:95], a[16:19], v[236:239]
  ds_read_b64_tr_b16 a[74:75], v9 offset:1024
  s_add_u32 s81, s85, 17040384
  v_mfma_f32_16x16x32_bf16 v[244:247], a[92:95], a[20:23], v[244:247]
  buffer_store_dwordx4 v[184:187], v1, s[40:43], s81 offen sc1
  v_mfma_f32_16x16x32_bf16 v[244:247], a[88:91], a[4:7], v[244:247]
  s_add_u32 s15, s63, s64
  v_mfma_f32_16x16x32_bf16 v[252:255], a[88:91], a[8:11], v[252:255]
  ds_read_b64_tr_b16 a[76:77], v9 offset:8192
  s_add_u32 s63, s0, 3
  v_accvgpr_read_b32 v104, a224
  v_mfma_f32_16x16x32_bf16 v[252:255], a[92:95], a[24:27], v[252:255]
  ds_read_b64_tr_b16 a[78:79], v9 offset:9216
  s_and_b32 s63, s63, 3
  v_accvgpr_read_b32 v105, a225
  v_mfma_f32_16x16x32_bf16 v[208:211], a[92:95], a[28:31], v[208:211]
  s_lshl_b32 s63, s63, 13
  v_accvgpr_read_b32 v106, a226
  v_accvgpr_read_b32 v107, a227
  v_mfma_f32_16x16x32_bf16 v[208:211], a[88:91], a[12:15], v[208:211]
  s_waitcnt lgkmcnt(4)
  v_add_u32 v10, 0x20000, v10
  v_accvgpr_read_b32 v108, a228
  v_mfma_f32_16x16x32_bf16 v[32:35], a[64:67], a[32:35], v[32:35]
  ds_read_b64_tr_b16 a[80:81], v10 offset:0
  v_accvgpr_write_b32 a128, -1
  v_accvgpr_write_b32 a129, -1
  v_mfma_f32_16x16x32_bf16 v[32:35], a[68:71], a[48:51], v[32:35]
  ds_read_b64_tr_b16 a[82:83], v10 offset:1024
  v_accvgpr_write_b32 a130, -1
  v_accvgpr_write_b32 a131, -1
  v_mfma_f32_16x16x32_bf16 v[36:39], a[68:71], a[52:55], v[36:39]
  s_add_u32 s16, s63, s64
  v_accvgpr_read_b32 v109, a229
  v_accvgpr_read_b32 v110, a230
  v_mfma_f32_16x16x32_bf16 v[36:39], a[64:67], a[36:39], v[36:39]
  v_accvgpr_read_b32 v111, a231
  v_accvgpr_read_b32 v136, a232
  v_mfma_f32_16x16x32_bf16 v[64:67], a[64:67], a[40:43], v[64:67]
  ds_read_b64_tr_b16 a[84:85], v10 offset:8192
  v_accvgpr_read_b32 v137, a233
  v_mfma_f32_16x16x32_bf16 v[64:67], a[68:71], a[56:59], v[64:67]
  ds_read_b64_tr_b16 a[86:87], v10 offset:9216
  v_accvgpr_read_b32 v138, a234
  v_mfma_f32_16x16x32_bf16 v[68:71], a[68:71], a[60:63], v[68:71]
  v_accvgpr_read_b32 v139, a235
  v_accvgpr_read_b32 v140, a236
  v_mfma_f32_16x16x32_bf16 v[68:71], a[64:67], a[44:47], v[68:71]
  s_waitcnt lgkmcnt(4)
  v_add_u32 v11, 0x20000, v11
  v_accvgpr_read_b32 v141, a237
  v_mfma_f32_16x16x32_bf16 v[96:99], a[72:75], a[32:35], v[96:99]
  ds_read_b64_tr_b16 a[88:89], v11 offset:0
  v_accvgpr_read_b32 v142, a238
  v_mfma_f32_16x16x32_bf16 v[96:99], a[76:79], a[48:51], v[96:99]
  ds_read_b64_tr_b16 a[90:91], v11 offset:1024
  v_accvgpr_read_b32 v143, a239
  v_mfma_f32_16x16x32_bf16 v[100:103], a[76:79], a[52:55], v[100:103]
  v_mfma_f32_16x16x32_bf16 v[100:103], a[72:75], a[36:39], v[100:103]
  v_mfma_f32_16x16x32_bf16 v[128:131], a[72:75], a[40:43], v[128:131]
  ds_read_b64_tr_b16 a[92:93], v11 offset:8192
  v_mfma_f32_16x16x32_bf16 v[128:131], a[76:79], a[56:59], v[128:131]
  ds_read_b64_tr_b16 a[94:95], v11 offset:9216
  v_mfma_f32_16x16x32_bf16 v[132:135], a[76:79], a[60:63], v[132:135]
  v_mfma_f32_16x16x32_bf16 v[132:135], a[72:75], a[44:47], v[132:135]
  s_waitcnt lgkmcnt(4)
  v_add_u32 v12, 0x20000, v12
  v_mfma_f32_16x16x32_bf16 v[224:227], a[80:83], a[32:35], v[224:227]
  ds_read_b64_tr_b16 a[64:65], v12 offset:0
  v_mfma_f32_16x16x32_bf16 v[224:227], a[84:87], a[48:51], v[224:227]
  ds_read_b64_tr_b16 a[66:67], v12 offset:1024
  v_mfma_f32_16x16x32_bf16 v[240:243], a[84:87], a[52:55], v[240:243]
  v_mfma_f32_16x16x32_bf16 v[240:243], a[80:83], a[36:39], v[240:243]
  v_mfma_f32_16x16x32_bf16 v[196:199], a[80:83], a[40:43], v[196:199]
  ds_read_b64_tr_b16 a[68:69], v12 offset:8192
  v_mul_f32 v64, s68, v64
  v_mfma_f32_16x16x32_bf16 v[196:199], a[84:87], a[56:59], v[196:199]
  ds_read_b64_tr_b16 a[70:71], v12 offset:9216
  s_add_u32 s81, s85, 17041408
  v_mul_f32 v65, s68, v65
  v_mfma_f32_16x16x32_bf16 v[204:207], a[84:87], a[60:63], v[204:207]
  buffer_store_dwordx4 v[200:203], v1, s[40:43], s81 offen sc1
  v_mfma_f32_16x16x32_bf16 v[204:207], a[80:83], a[44:47], v[204:207]
  s_waitcnt lgkmcnt(4)
  v_add_u32 v13, 0x20000, v13
  v_mul_f32 v66, s68, v66
  v_mfma_f32_16x16x32_bf16 v[164:167], a[88:91], a[32:35], v[164:167]
  ds_read_b64_tr_b16 a[72:73], v13 offset:0
  v_mul_f32 v67, s68, v67
  v_mfma_f32_16x16x32_bf16 v[164:167], a[92:95], a[48:51], v[164:167]
  ds_read_b64_tr_b16 a[74:75], v13 offset:1024
  v_mul_f32 v128, s68, v128
  v_mfma_f32_16x16x32_bf16 v[172:175], a[92:95], a[52:55], v[172:175]
  v_mul_f32 v129, s68, v129
  v_mul_f32 v130, s68, v130
  v_mfma_f32_16x16x32_bf16 v[172:175], a[88:91], a[36:39], v[172:175]
  v_mul_f32 v131, s68, v131
  v_cvt_pk_bf16_f32 v64, v64, v65
  v_mfma_f32_16x16x32_bf16 v[180:183], a[88:91], a[40:43], v[180:183]
  ds_read_b64_tr_b16 a[76:77], v13 offset:8192
  v_cvt_pk_bf16_f32 v65, v66, v67
  v_mfma_f32_16x16x32_bf16 v[180:183], a[92:95], a[56:59], v[180:183]
  ds_read_b64_tr_b16 a[78:79], v13 offset:9216
  v_cvt_pk_bf16_f32 v66, v128, v129
  v_mfma_f32_16x16x32_bf16 v[188:191], a[92:95], a[60:63], v[188:191]
  v_cvt_pk_bf16_f32 v67, v130, v131
  v_accvgpr_write_b32 a96, v64
  v_mfma_f32_16x16x32_bf16 v[188:191], a[88:91], a[44:47], v[188:191]
  s_waitcnt lgkmcnt(4)
  v_add_u32 v14, 0x20000, v14
  v_accvgpr_write_b32 a97, v65
  v_mfma_f32_16x16x32_bf16 v[40:43], a[64:67], a[32:35], v[40:43]
  ds_read_b64_tr_b16 a[80:81], v14 offset:0
  v_accvgpr_write_b32 a98, v66
  v_mfma_f32_16x16x32_bf16 v[40:43], a[68:71], a[48:51], v[40:43]
  ds_read_b64_tr_b16 a[82:83], v14 offset:1024
  v_accvgpr_write_b32 a99, v67
  v_mfma_f32_16x16x32_bf16 v[44:47], a[68:71], a[52:55], v[44:47]
  v_mul_f32 v68, s68, v68
  v_mul_f32 v69, s68, v69
  v_mfma_f32_16x16x32_bf16 v[44:47], a[64:67], a[36:39], v[44:47]
  v_mul_f32 v70, s68, v70
  v_mul_f32 v71, s68, v71
  v_mfma_f32_16x16x32_bf16 v[72:75], a[64:67], a[40:43], v[72:75]
  ds_read_b64_tr_b16 a[84:85], v14 offset:8192
  v_mul_f32 v132, s68, v132
  v_mfma_f32_16x16x32_bf16 v[72:75], a[68:71], a[56:59], v[72:75]
  ds_read_b64_tr_b16 a[86:87], v14 offset:9216
  v_mul_f32 v133, s68, v133
  v_mfma_f32_16x16x32_bf16 v[76:79], a[68:71], a[60:63], v[76:79]
  v_mul_f32 v134, s68, v134
  v_mul_f32 v135, s68, v135
  v_mfma_f32_16x16x32_bf16 v[76:79], a[64:67], a[44:47], v[76:79]
  s_waitcnt lgkmcnt(4)
  v_add_u32 v15, 0x20000, v15
  v_cvt_pk_bf16_f32 v68, v68, v69
  v_mfma_f32_16x16x32_bf16 v[160:163], a[72:75], a[32:35], v[160:163]
  ds_read_b64_tr_b16 a[88:89], v15 offset:0
  v_cvt_pk_bf16_f32 v69, v70, v71
  v_mfma_f32_16x16x32_bf16 v[160:163], a[76:79], a[48:51], v[160:163]
  ds_read_b64_tr_b16 a[90:91], v15 offset:1024
  v_cvt_pk_bf16_f32 v70, v132, v133
  v_mfma_f32_16x16x32_bf16 v[176:179], a[76:79], a[52:55], v[176:179]
  v_cvt_pk_bf16_f32 v71, v134, v135
  v_accvgpr_write_b32 a100, v68
  v_mfma_f32_16x16x32_bf16 v[176:179], a[72:75], a[36:39], v[176:179]
  v_accvgpr_write_b32 a101, v69
  v_accvgpr_write_b32 a102, v70
  v_mfma_f32_16x16x32_bf16 v[192:195], a[72:75], a[40:43], v[192:195]
  ds_read_b64_tr_b16 a[92:93], v15 offset:8192
  v_accvgpr_write_b32 a103, v71
  v_mfma_f32_16x16x32_bf16 v[192:195], a[76:79], a[56:59], v[192:195]
  ds_read_b64_tr_b16 a[94:95], v15 offset:9216
  v_mul_f32 v196, s68, v196
  v_mfma_f32_16x16x32_bf16 v[228:231], a[76:79], a[60:63], v[228:231]
  v_mul_f32 v197, s68, v197
  v_mul_f32 v198, s68, v198
  v_mfma_f32_16x16x32_bf16 v[228:231], a[72:75], a[44:47], v[228:231]
  s_waitcnt lgkmcnt(4)
  v_add_u32 v16, 0x20000, v16
  v_mul_f32 v199, s68, v199
  v_mfma_f32_16x16x32_bf16 v[104:107], a[80:83], a[32:35], v[104:107]
  ds_read_b64_tr_b16 a[64:65], v16 offset:16384
  v_mul_f32 v180, s68, v180
  v_mfma_f32_16x16x32_bf16 v[104:107], a[84:87], a[48:51], v[104:107]
  ds_read_b64_tr_b16 a[66:67], v16 offset:16896
  s_add_u32 s81, s85, 17042432
  v_mul_f32 v181, s68, v181
  v_mfma_f32_16x16x32_bf16 v[108:111], a[84:87], a[52:55], v[108:111]
  buffer_store_dwordx4 v[216:219], v1, s[40:43], s81 offen sc1
  v_mfma_f32_16x16x32_bf16 v[108:111], a[80:83], a[36:39], v[108:111]
  v_mul_f32 v182, s68, v182
  v_mul_f32 v183, s68, v183
  v_mfma_f32_16x16x32_bf16 v[136:139], a[80:83], a[40:43], v[136:139]
  ds_read_b64_tr_b16 a[68:69], v16 offset:20480
  v_cvt_pk_bf16_f32 v196, v196, v197
  v_mfma_f32_16x16x32_bf16 v[136:139], a[84:87], a[56:59], v[136:139]
  ds_read_b64_tr_b16 a[70:71], v16 offset:20992
  v_cvt_pk_bf16_f32 v197, v198, v199
  v_mfma_f32_16x16x32_bf16 v[140:143], a[84:87], a[60:63], v[140:143]
  v_cvt_pk_bf16_f32 v198, v180, v181
  v_cvt_pk_bf16_f32 v199, v182, v183
  v_mfma_f32_16x16x32_bf16 v[140:143], a[80:83], a[44:47], v[140:143]
  s_waitcnt lgkmcnt(4)
  v_add_u32 v17, 0x20000, v17
  v_accvgpr_write_b32 a104, v196
  v_mfma_f32_16x16x32_bf16 v[236:239], a[88:91], a[32:35], v[236:239]
  ds_read_b64_tr_b16 a[72:73], v17 offset:16384
  v_accvgpr_write_b32 a105, v197
  v_mfma_f32_16x16x32_bf16 v[236:239], a[92:95], a[48:51], v[236:239]
  ds_read_b64_tr_b16 a[74:75], v17 offset:16896
  v_accvgpr_write_b32 a106, v198
  v_mfma_f32_16x16x32_bf16 v[244:247], a[92:95], a[52:55], v[244:247]
  v_accvgpr_write_b32 a107, v199
  v_mul_f32 v204, s68, v204
  v_mfma_f32_16x16x32_bf16 v[244:247], a[88:91], a[36:39], v[244:247]
  v_mul_f32 v205, s68, v205
  v_mul_f32 v206, s68, v206
  v_mfma_f32_16x16x32_bf16 v[252:255], a[88:91], a[40:43], v[252:255]
  ds_read_b64_tr_b16 a[76:77], v17 offset:20480
  v_mul_f32 v207, s68, v207
  v_mfma_f32_16x16x32_bf16 v[252:255], a[92:95], a[56:59], v[252:255]
  ds_read_b64_tr_b16 a[78:79], v17 offset:20992
  v_mul_f32 v188, s68, v188
  v_mfma_f32_16x16x32_bf16 v[208:211], a[92:95], a[60:63], v[208:211]
  v_mul_f32 v189, s68, v189
  v_mul_f32 v190, s68, v190
  v_mfma_f32_16x16x32_bf16 v[208:211], a[88:91], a[44:47], v[208:211]
  s_waitcnt lgkmcnt(4)
  v_add_u32 v18, 0x20000, v18
  v_mul_f32 v191, s68, v191
  v_mfma_f32_16x16x32_bf16 v[48:51], a[64:67], a[32:35], v[48:51]
  ds_read_b64_tr_b16 a[80:81], v18 offset:16384
  v_cvt_pk_bf16_f32 v204, v204, v205
  v_mfma_f32_16x16x32_bf16 v[48:51], a[68:71], a[48:51], v[48:51]
  ds_read_b64_tr_b16 a[82:83], v18 offset:16896
  v_cvt_pk_bf16_f32 v205, v206, v207
  v_mfma_f32_16x16x32_bf16 v[52:55], a[68:71], a[52:55], v[52:55]
  v_cvt_pk_bf16_f32 v206, v188, v189
  v_cvt_pk_bf16_f32 v207, v190, v191
  v_mfma_f32_16x16x32_bf16 v[52:55], a[64:67], a[36:39], v[52:55]
  v_accvgpr_write_b32 a108, v204
  v_accvgpr_write_b32 a109, v205
  v_mfma_f32_16x16x32_bf16 v[56:59], a[64:67], a[40:43], v[56:59]
  ds_read_b64_tr_b16 a[84:85], v18 offset:20480
  v_accvgpr_write_b32 a110, v206
  v_mfma_f32_16x16x32_bf16 v[56:59], a[68:71], a[56:59], v[56:59]
  ds_read_b64_tr_b16 a[86:87], v18 offset:20992
  v_accvgpr_write_b32 a111, v207
  v_mfma_f32_16x16x32_bf16 v[60:63], a[68:71], a[60:63], v[60:63]
  v_mul_f32 v72, s68, v72
  v_mul_f32 v73, s68, v73
  v_mfma_f32_16x16x32_bf16 v[60:63], a[64:67], a[44:47], v[60:63]
  s_waitcnt lgkmcnt(4)
  v_add_u32 v19, 0x20000, v19
  v_mul_f32 v74, s68, v74
  v_mfma_f32_16x16x32_bf16 v[80:83], a[72:75], a[32:35], v[80:83]
  ds_read_b64_tr_b16 a[88:89], v19 offset:16384
  v_mul_f32 v75, s68, v75
  v_mfma_f32_16x16x32_bf16 v[80:83], a[76:79], a[48:51], v[80:83]
  ds_read_b64_tr_b16 a[90:91], v19 offset:16896
  v_mul_f32 v192, s68, v192
  v_mfma_f32_16x16x32_bf16 v[84:87], a[76:79], a[52:55], v[84:87]
  v_mul_f32 v193, s68, v193
  v_mul_f32 v194, s68, v194
  v_mfma_f32_16x16x32_bf16 v[84:87], a[72:75], a[36:39], v[84:87]
  v_mul_f32 v195, s68, v195
  v_cvt_pk_bf16_f32 v72, v72, v73
  v_mfma_f32_16x16x32_bf16 v[88:91], a[72:75], a[40:43], v[88:91]
  ds_read_b64_tr_b16 a[92:93], v19 offset:20480
  v_cvt_pk_bf16_f32 v73, v74, v75
  v_mfma_f32_16x16x32_bf16 v[88:91], a[76:79], a[56:59], v[88:91]
  ds_read_b64_tr_b16 a[94:95], v19 offset:20992
  s_add_u32 s81, s85, 17043456
  v_cvt_pk_bf16_f32 v74, v192, v193
  v_mfma_f32_16x16x32_bf16 v[92:95], a[76:79], a[60:63], v[92:95]
  buffer_store_dwordx4 v[232:235], v1, s[40:43], s81 offen sc1
  v_mfma_f32_16x16x32_bf16 v[92:95], a[72:75], a[44:47], v[92:95]
  s_waitcnt lgkmcnt(4)
  v_add_u32 v16, 0xfffe0000, v16
  v_cvt_pk_bf16_f32 v75, v194, v195
  v_mfma_f32_16x16x32_bf16 v[112:115], a[80:83], a[32:35], v[112:115]
  ds_read_b64_tr_b16 a[64:65], v16 offset:49152
  v_accvgpr_write_b32 a112, v72
  v_mfma_f32_16x16x32_bf16 v[112:115], a[84:87], a[48:51], v[112:115]
  ds_read_b64_tr_b16 a[66:67], v16 offset:49664
  v_accvgpr_write_b32 a113, v73
  v_mfma_f32_16x16x32_bf16 v[116:119], a[84:87], a[52:55], v[116:119]
  v_accvgpr_write_b32 a114, v74
  v_accvgpr_write_b32 a115, v75
  v_mfma_f32_16x16x32_bf16 v[116:119], a[80:83], a[36:39], v[116:119]
  v_mul_f32 v76, s68, v76
  v_mul_f32 v77, s68, v77
  v_mfma_f32_16x16x32_bf16 v[120:123], a[80:83], a[40:43], v[120:123]
  ds_read_b64_tr_b16 a[68:69], v16 offset:53248
  v_mul_f32 v78, s68, v78
  v_mfma_f32_16x16x32_bf16 v[120:123], a[84:87], a[56:59], v[120:123]
  ds_read_b64_tr_b16 a[70:71], v16 offset:53760
  v_mul_f32 v79, s68, v79
  v_mfma_f32_16x16x32_bf16 v[124:127], a[84:87], a[60:63], v[124:127]
  v_mul_f32 v228, s68, v228
  v_mul_f32 v229, s68, v229
  v_mfma_f32_16x16x32_bf16 v[124:127], a[80:83], a[44:47], v[124:127]
  s_waitcnt lgkmcnt(4)
  v_add_u32 v17, 0xfffe0000, v17
  v_mul_f32 v230, s68, v230
  v_mfma_f32_16x16x32_bf16 v[144:147], a[88:91], a[32:35], v[144:147]
  ds_read_b64_tr_b16 a[72:73], v17 offset:49152
  v_mul_f32 v231, s68, v231
  v_mfma_f32_16x16x32_bf16 v[144:147], a[92:95], a[48:51], v[144:147]
  ds_read_b64_tr_b16 a[74:75], v17 offset:49664
  v_cvt_pk_bf16_f32 v76, v76, v77
  v_mfma_f32_16x16x32_bf16 v[148:151], a[92:95], a[52:55], v[148:151]
  v_cvt_pk_bf16_f32 v77, v78, v79
  v_cvt_pk_bf16_f32 v78, v228, v229
  v_mfma_f32_16x16x32_bf16 v[148:151], a[88:91], a[36:39], v[148:151]
  v_cvt_pk_bf16_f32 v79, v230, v231
  v_accvgpr_write_b32 a116, v76
  v_mfma_f32_16x16x32_bf16 v[152:155], a[88:91], a[40:43], v[152:155]
  ds_read_b64_tr_b16 a[76:77], v17 offset:53248
  v_accvgpr_write_b32 a117, v77
  v_mfma_f32_16x16x32_bf16 v[152:155], a[92:95], a[56:59], v[152:155]
  ds_read_b64_tr_b16 a[78:79], v17 offset:53760
  v_accvgpr_write_b32 a118, v78
  v_mfma_f32_16x16x32_bf16 v[156:159], a[92:95], a[60:63], v[156:159]
  v_accvgpr_write_b32 a119, v79
  v_mul_f32 v136, s68, v136
  v_mfma_f32_16x16x32_bf16 v[156:159], a[88:91], a[44:47], v[156:159]
  s_waitcnt lgkmcnt(4)
  v_add_u32 v18, 0xfffe0000, v18
  v_mul_f32 v137, s68, v137
  v_mfma_f32_16x16x32_bf16 v[48:51], a[64:67], a[0:3], v[48:51]
  ds_read_b64_tr_b16 a[80:81], v18 offset:49152
  v_mul_f32 v138, s68, v138
  v_mfma_f32_16x16x32_bf16 v[48:51], a[68:71], a[16:19], v[48:51]
  ds_read_b64_tr_b16 a[82:83], v18 offset:49664
  v_mul_f32 v139, s68, v139
  v_mfma_f32_16x16x32_bf16 v[52:55], a[68:71], a[20:23], v[52:55]
  v_mul_f32 v252, s68, v252
  v_mul_f32 v253, s68, v253
  v_mfma_f32_16x16x32_bf16 v[52:55], a[64:67], a[4:7], v[52:55]
  v_mul_f32 v254, s68, v254
  v_mul_f32 v255, s68, v255
  v_mfma_f32_16x16x32_bf16 v[56:59], a[64:67], a[8:11], v[56:59]
  ds_read_b64_tr_b16 a[84:85], v18 offset:53248
  v_cvt_pk_bf16_f32 v136, v136, v137
  v_mfma_f32_16x16x32_bf16 v[56:59], a[68:71], a[24:27], v[56:59]
  ds_read_b64_tr_b16 a[86:87], v18 offset:53760
  v_cvt_pk_bf16_f32 v137, v138, v139
  v_mfma_f32_16x16x32_bf16 v[60:63], a[68:71], a[28:31], v[60:63]
  v_cvt_pk_bf16_f32 v138, v252, v253
  v_cvt_pk_bf16_f32 v139, v254, v255
  v_mfma_f32_16x16x32_bf16 v[60:63], a[64:67], a[12:15], v[60:63]
  s_waitcnt lgkmcnt(4)
  v_add_u32 v19, 0xfffe0000, v19
  v_accvgpr_write_b32 a120, v136
  v_mfma_f32_16x16x32_bf16 v[80:83], a[72:75], a[0:3], v[80:83]
  ds_read_b64_tr_b16 a[88:89], v19 offset:49152
  v_accvgpr_write_b32 a121, v137
  v_mfma_f32_16x16x32_bf16 v[80:83], a[76:79], a[16:19], v[80:83]
  ds_read_b64_tr_b16 a[90:91], v19 offset:49664
  s_add_u32 s81, s85, 17044480
  v_accvgpr_write_b32 a122, v138
  v_mfma_f32_16x16x32_bf16 v[84:87], a[76:79], a[20:23], v[84:87]
  buffer_store_dwordx4 v[248:251], v1, s[40:43], s81 offen sc1
  v_mfma_f32_16x16x32_bf16 v[84:87], a[72:75], a[4:7], v[84:87]
  v_accvgpr_write_b32 a123, v139
  v_mul_f32 v140, s68, v140
  v_mfma_f32_16x16x32_bf16 v[88:91], a[72:75], a[8:11], v[88:91]
  ds_read_b64_tr_b16 a[92:93], v19 offset:53248
  v_mul_f32 v141, s68, v141
  v_mfma_f32_16x16x32_bf16 v[88:91], a[76:79], a[24:27], v[88:91]
  ds_read_b64_tr_b16 a[94:95], v19 offset:53760
  v_mul_f32 v142, s68, v142
  v_mfma_f32_16x16x32_bf16 v[92:95], a[76:79], a[28:31], v[92:95]
  v_mul_f32 v143, s68, v143
  v_mul_f32 v208, s68, v208
  v_mfma_f32_16x16x32_bf16 v[92:95], a[72:75], a[12:15], v[92:95]
  s_waitcnt lgkmcnt(4)
  v_mul_f32 v209, s68, v209
  v_mul_f32 v210, s68, v210
  v_mfma_f32_16x16x32_bf16 v[112:115], a[80:83], a[0:3], v[112:115]
  v_mul_f32 v211, s68, v211
  v_cvt_pk_bf16_f32 v140, v140, v141
  v_mfma_f32_16x16x32_bf16 v[112:115], a[84:87], a[16:19], v[112:115]
  v_cvt_pk_bf16_f32 v141, v142, v143
  v_cvt_pk_bf16_f32 v142, v208, v209
  v_mfma_f32_16x16x32_bf16 v[116:119], a[84:87], a[20:23], v[116:119]
  v_cvt_pk_bf16_f32 v143, v210, v211
  v_accvgpr_write_b32 a124, v140
  v_mfma_f32_16x16x32_bf16 v[116:119], a[80:83], a[4:7], v[116:119]
  v_accvgpr_write_b32 a125, v141
  v_accvgpr_write_b32 a126, v142
  v_mfma_f32_16x16x32_bf16 v[120:123], a[80:83], a[8:11], v[120:123]
  v_accvgpr_write_b32 a127, v143
  v_mul_f32 v32, s68, v32
  v_mfma_f32_16x16x32_bf16 v[120:123], a[84:87], a[24:27], v[120:123]
  v_mul_f32 v33, s68, v33
  v_mul_f32 v34, s68, v34
  v_mfma_f32_16x16x32_bf16 v[124:127], a[84:87], a[28:31], v[124:127]
  v_mul_f32 v35, s68, v35
  v_mul_f32 v96, s68, v96
  v_mfma_f32_16x16x32_bf16 v[124:127], a[80:83], a[12:15], v[124:127]
  s_waitcnt lgkmcnt(0)
  v_mul_f32 v97, s68, v97
  v_mul_f32 v98, s68, v98
  v_mfma_f32_16x16x32_bf16 v[144:147], a[88:91], a[0:3], v[144:147]
  v_mul_f32 v99, s68, v99
  v_cvt_pk_bf16_f32 v32, v32, v33
  v_mfma_f32_16x16x32_bf16 v[144:147], a[92:95], a[16:19], v[144:147]
  v_cvt_pk_bf16_f32 v33, v34, v35
  v_cvt_pk_bf16_f32 v34, v96, v97
  v_mfma_f32_16x16x32_bf16 v[148:151], a[92:95], a[20:23], v[148:151]
  v_cvt_pk_bf16_f32 v35, v98, v99
  v_mul_f32 v36, s68, v36
  v_mfma_f32_16x16x32_bf16 v[148:151], a[88:91], a[4:7], v[148:151]
  v_mul_f32 v37, s68, v37
  v_mul_f32 v38, s68, v38
  v_mfma_f32_16x16x32_bf16 v[152:155], a[88:91], a[8:11], v[152:155]
  v_mul_f32 v39, s68, v39
  v_mul_f32 v100, s68, v100
  v_mfma_f32_16x16x32_bf16 v[152:155], a[92:95], a[24:27], v[152:155]
  v_mul_f32 v101, s68, v101
  v_mul_f32 v102, s68, v102
  v_mfma_f32_16x16x32_bf16 v[156:159], a[92:95], a[28:31], v[156:159]
  v_mul_f32 v103, s68, v103
  v_cvt_pk_bf16_f32 v36, v36, v37
  v_mfma_f32_16x16x32_bf16 v[156:159], a[88:91], a[12:15], v[156:159]
  v_cvt_pk_bf16_f32 v37, v38, v39
  v_cvt_pk_bf16_f32 v38, v100, v101
  v_cvt_pk_bf16_f32 v39, v102, v103
  s_nop 1
  s_add_u32 s81, s85, 17045504
  buffer_store_dwordx4 v[212:215], v1, s[40:43], s81 offen sc1
  s_add_u32 s81, s85, 17046528
  buffer_store_dwordx4 v[220:223], v1, s[40:43], s81 offen sc1
Lp2epi:
  s_nop 3
  s_lshl_b32 s63, s60, 13
  s_add_u32 s63, s63, 131072
  v_add_u32 v5, s63, v1
  buffer_load_dword v25, v0, s[40:43], s66 offen sc1
  s_barrier
.p2align 3
  ds_write_b128 v5, v[32:35] offset:0
  v_pk_mul_f32 v[224:225], v[224:225], s[68:69]
  v_pk_mul_f32 v[226:227], v[226:227], s[68:69]
  v_pk_mul_f32 v[164:165], v[164:165], s[68:69]
  v_pk_mul_f32 v[166:167], v[166:167], s[68:69]
  v_cvt_pk_bf16_f32 v224, v224, v225
  v_cvt_pk_bf16_f32 v225, v226, v227
  v_cvt_pk_bf16_f32 v226, v164, v165
  v_cvt_pk_bf16_f32 v227, v166, v167
  ds_write_b128 v5, v[36:39] offset:1024
  v_pk_mul_f32 v[240:241], v[240:241], s[68:69]
  v_pk_mul_f32 v[242:243], v[242:243], s[68:69]
  v_pk_mul_f32 v[172:173], v[172:173], s[68:69]
  v_pk_mul_f32 v[174:175], v[174:175], s[68:69]
  v_cvt_pk_bf16_f32 v240, v240, v241
  v_cvt_pk_bf16_f32 v241, v242, v243
  v_cvt_pk_bf16_f32 v242, v172, v173
  v_cvt_pk_bf16_f32 v243, v174, v175
  ds_write_b128 v5, v[224:227] offset:2048
  v_pk_mul_f32 v[40:41], v[40:41], s[68:69]
  v_pk_mul_f32 v[42:43], v[42:43], s[68:69]
  v_pk_mul_f32 v[160:161], v[160:161], s[68:69]
  v_pk_mul_f32 v[162:163], v[162:163], s[68:69]
  v_cvt_pk_bf16_f32 v40, v40, v41
  v_cvt_pk_bf16_f32 v41, v42, v43
  v_cvt_pk_bf16_f32 v42, v160, v161
  v_cvt_pk_bf16_f32 v43, v162, v163
  ds_write_b128 v5, v[240:243] offset:3072
  v_pk_mul_f32 v[44:45], v[44:45], s[68:69]
  v_pk_mul_f32 v[46:47], v[46:47], s[68:69]
  v_pk_mul_f32 v[176:177], v[176:177], s[68:69]
  v_pk_mul_f32 v[178:179], v[178:179], s[68:69]
  v_cvt_pk_bf16_f32 v44, v44, v45
  v_cvt_pk_bf16_f32 v45, v46, v47
  v_cvt_pk_bf16_f32 v46, v176, v177
  v_cvt_pk_bf16_f32 v47, v178, v179
  ds_write_b128 v5, v[40:43] offset:4096
  v_pk_mul_f32 v[104:105], v[104:105], s[68:69]
  v_pk_mul_f32 v[106:107], v[106:107], s[68:69]
  v_pk_mul_f32 v[236:237], v[236:237], s[68:69]
  v_pk_mul_f32 v[238:239], v[238:239], s[68:69]
  v_cvt_pk_bf16_f32 v104, v104, v105
  v_cvt_pk_bf16_f32 v105, v106, v107
  v_cvt_pk_bf16_f32 v106, v236, v237
  v_cvt_pk_bf16_f32 v107, v238, v239
  ds_write_b128 v5, v[44:47] offset:5120
  v_pk_mul_f32 v[108:109], v[108:109], s[68:69]
  v_pk_mul_f32 v[110:111], v[110:111], s[68:69]
  v_pk_mul_f32 v[244:245], v[244:245], s[68:69]
  v_pk_mul_f32 v[246:247], v[246:247], s[68:69]
  v_cvt_pk_bf16_f32 v108, v108, v109
  v_cvt_pk_bf16_f32 v109, v110, v111
  v_cvt_pk_bf16_f32 v110, v244, v245
  v_cvt_pk_bf16_f32 v111, v246, v247
  ds_write_b128 v5, v[104:107] offset:6144
  ds_write_b128 v5, v[108:111] offset:7168
  ds_read_b128 a[64:67], v5 offset:0
  ds_read_b128 a[68:71], v5 offset:1024
  ds_read_b128 a[72:75], v5 offset:2048
  ds_read_b128 a[76:79], v5 offset:3072
  ds_read_b128 a[80:83], v5 offset:4096
  ds_read_b128 a[84:87], v5 offset:5120
  ds_read_b128 a[88:91], v5 offset:6144
  ds_read_b128 a[92:95], v5 offset:7168
  s_cmp_ge_u32 s61, 28
  s_cbranch_scc1 Lnomish
  s_mov_b32 s80, 0x3fb8aa3b
  s_mov_b32 s81, s80
.p2align 3
  v_pk_mul_f32 v[224:225], v[48:49], s[80:81]
  v_pk_mul_f32 v[226:227], v[50:51], s[80:81]
  v_pk_mul_f32 v[228:229], v[80:81], s[80:81]
  v_pk_mul_f32 v[230:231], v[82:83], s[80:81]
  v_pk_mul_f32 v[232:233], v[112:113], s[80:81]
  v_pk_mul_f32 v[234:235], v[114:115], s[80:81]
  v_pk_mul_f32 v[236:237], v[144:145], s[80:81]
  v_pk_mul_f32 v[238:239], v[146:147], s[80:81]
  v_exp_f32 v224, v224
  v_exp_f32 v225, v225
  v_exp_f32 v226, v226
  v_exp_f32 v227, v227
  v_exp_f32 v228, v228
  v_exp_f32 v229, v229
  v_exp_f32 v230, v230
  v_exp_f32 v231, v231
  v_exp_f32 v232, v232
  v_exp_f32 v233, v233
  v_exp_f32 v234, v234
  v_exp_f32 v235, v235
  v_exp_f32 v236, v236
  v_exp_f32 v237, v237
  v_exp_f32 v238, v238
  v_exp_f32 v239, v239
.p2align 3
  v_pk_fma_f32 v[240:241], v[224:225], 0.5, 1.0 op_sel_hi:[1,0,0]
  v_pk_fma_f32 v[242:243], v[226:227], 0.5, 1.0 op_sel_hi:[1,0,0]
  v_pk_fma_f32 v[244:245], v[228:229], 0.5, 1.0 op_sel_hi:[1,0,0]
  v_pk_fma_f32 v[246:247], v[230:231], 0.5, 1.0 op_sel_hi:[1,0,0]
  v_pk_fma_f32 v[248:249], v[232:233], 0.5, 1.0 op_sel_hi:[1,0,0]
  v_pk_fma_f32 v[250:251], v[234:235], 0.5, 1.0 op_sel_hi:[1,0,0]
  v_pk_fma_f32 v[252:253], v[236:237], 0.5, 1.0 op_sel_hi:[1,0,0]
  v_pk_fma_f32 v[254:255], v[238:239], 0.5, 1.0 op_sel_hi:[1,0,0]
  v_pk_fma_f32 v[224:225], v[224:225], v[240:241], 1.0 op_sel_hi:[1,1,0]
  v_pk_fma_f32 v[226:227], v[226:227], v[242:243], 1.0 op_sel_hi:[1,1,0]
  v_pk_fma_f32 v[228:229], v[228:229], v[244:245], 1.0 op_sel_hi:[1,1,0]
  v_pk_fma_f32 v[230:231], v[230:231], v[246:247], 1.0 op_sel_hi:[1,1,0]
  v_pk_fma_f32 v[232:233], v[232:233], v[248:249], 1.0 op_sel_hi:[1,1,0]
  v_pk_fma_f32 v[234:235], v[234:235], v[250:251], 1.0 op_sel_hi:[1,1,0]
  v_pk_fma_f32 v[236:237], v[236:237], v[252:253], 1.0 op_sel_hi:[1,1,0]
  v_pk_fma_f32 v[238:239], v[238:239], v[254:255], 1.0 op_sel_hi:[1,1,0]
  v_rcp_f32 v224, v224
  v_rcp_f32 v225, v225
  v_rcp_f32 v226, v226
  v_rcp_f32 v227, v227
  v_rcp_f32 v228, v228
  v_rcp_f32 v229, v229
  v_rcp_f32 v230, v230
  v_rcp_f32 v231, v231
  v_rcp_f32 v232, v232
  v_rcp_f32 v233, v233
  v_rcp_f32 v234, v234
  v_rcp_f32 v235, v235
  v_rcp_f32 v236, v236
  v_rcp_f32 v237, v237
  v_rcp_f32 v238, v238
  v_rcp_f32 v239, v239
.p2align 3
  v_pk_fma_f32 v[224:225], v[224:225], v[48:49], v[48:49] neg_lo:[1,0,0] neg_hi:[1,0,0]
  v_pk_fma_f32 v[226:227], v[226:227], v[50:51], v[50:51] neg_lo:[1,0,0] neg_hi:[1,0,0]
  v_pk_fma_f32 v[228:229], v[228:229], v[80:81], v[80:81] neg_lo:[1,0,0] neg_hi:[1,0,0]
  v_pk_fma_f32 v[230:231], v[230:231], v[82:83], v[82:83] neg_lo:[1,0,0] neg_hi:[1,0,0]
  v_pk_fma_f32 v[232:233], v[232:233], v[112:113], v[112:113] neg_lo:[1,0,0] neg_hi:[1,0,0]
  v_pk_fma_f32 v[234:235], v[234:235], v[114:115], v[114:115] neg_lo:[1,0,0] neg_hi:[1,0,0]
  v_pk_fma_f32 v[236:237], v[236:237], v[144:145], v[144:145] neg_lo:[1,0,0] neg_hi:[1,0,0]
  v_pk_fma_f32 v[238:239], v[238:239], v[146:147], v[146:147] neg_lo:[1,0,0] neg_hi:[1,0,0]
  v_cvt_pk_bf16_f32 v160, v224, v225
  v_cvt_pk_bf16_f32 v161, v226, v227
  v_cvt_pk_bf16_f32 v162, v228, v229
  v_cvt_pk_bf16_f32 v163, v230, v231
  v_cvt_pk_bf16_f32 v164, v232, v233
  v_cvt_pk_bf16_f32 v165, v234, v235
  v_cvt_pk_bf16_f32 v166, v236, v237
  v_cvt_pk_bf16_f32 v167, v238, v239
  v_pk_mul_f32 v[224:225], v[52:53], s[80:81]
  v_pk_mul_f32 v[226:227], v[54:55], s[80:81]
  v_pk_mul_f32 v[228:229], v[84:85], s[80:81]
  v_pk_mul_f32 v[230:231], v[86:87], s[80:81]
  v_pk_mul_f32 v[232:233], v[116:117], s[80:81]
  v_pk_mul_f32 v[234:235], v[118:119], s[80:81]
  v_pk_mul_f32 v[236:237], v[148:149], s[80:81]
  v_pk_mul_f32 v[238:239], v[150:151], s[80:81]
  v_exp_f32 v224, v224
  v_exp_f32 v225, v225
  v_exp_f32 v226, v226
  v_exp_f32 v227, v227
  v_exp_f32 v228, v228
  v_exp_f32 v229, v229
  v_exp_f32 v230, v230
  v_exp_f32 v231, v231
  v_exp_f32 v232, v232
  v_exp_f32 v233, v233
  v_exp_f32 v234, v234
  v_exp_f32 v235, v235
  v_exp_f32 v236, v236
  v_exp_f32 v237, v237
  v_exp_f32 v238, v238
  v_exp_f32 v239, v239
  v_pk_fma_f32 v[240:241], v[224:225], 0.5, 1.0 op_sel_hi:[1,0,0]
  v_pk_fma_f32 v[242:243], v[226:227], 0.5, 1.0 op_sel_hi:[1,0,0]
  v_pk_fma_f32 v[244:245], v[228:229], 0.5, 1.0 op_sel_hi:[1,0,0]
  v_pk_fma_f32 v[246:247], v[230:231], 0.5, 1.0 op_sel_hi:[1,0,0]
  s_waitcnt vmcnt(0)
  v_cmp_eq_u32 vcc, 0, v25
  s_and_b32 s63, vcc_lo, 0xff
  s_cbranch_scc1 Lspin4
Lpok4:
.p2align 3
  v_pk_fma_f32 v[248:249], v[232:233], 0.5, 1.0 op_sel_hi:[1,0,0]
  v_pk_fma_f32 v[250:251], v[234:235], 0.5, 1.0 op_sel_hi:[1,0,0]
  v_pk_fma_f32 v[252:253], v[236:237], 0.5, 1.0 op_sel_hi:[1,0,0]
  v_pk_fma_f32 v[254:255], v[238:239], 0.5, 1.0 op_sel_hi:[1,0,0]
  v_pk_fma_f32 v[224:225], v[224:225], v[240:241], 1.0 op_sel_hi:[1,1,0]
  v_pk_fma_f32 v[226:227], v[226:227], v[242:243], 1.0 op_sel_hi:[1,1,0]
  v_pk_fma_f32 v[228:229], v[228:229], v[244:245], 1.0 op_sel_hi:[1,1,0]
  v_pk_fma_f32 v[230:231], v[230:231], v[246:247], 1.0 op_sel_hi:[1,1,0]
  v_pk_fma_f32 v[232:233], v[232:233], v[248:249], 1.0 op_sel_hi:[1,1,0]
  s_mov_b32 s92, s78
  s_mov_b32 s93, s78
  s_and_b32 m0, s92, 0xffff
  v_pk_fma_f32 v[234:235], v[234:235], v[250:251], 1.0 op_sel_hi:[1,1,0]
  buffer_load_dwordx4 v1, s[20:23], s92 offen offset:0 sc1 lds
  v_pk_fma_f32 v[236:237], v[236:237], v[252:253], 1.0 op_sel_hi:[1,1,0]
  v_pk_fma_f32 v[238:239], v[238:239], v[254:255], 1.0 op_sel_hi:[1,1,0]
  v_rcp_f32 v224, v224
  v_rcp_f32 v225, v225
  v_rcp_f32 v226, v226
  v_rcp_f32 v227, v227
  v_rcp_f32 v228, v228
  v_rcp_f32 v229, v229
  v_rcp_f32 v230, v230
  v_rcp_f32 v231, v231
  buffer_load_dwordx4 v1, s[20:23], s92 offen offset:1024 sc1 lds
  v_rcp_f32 v232, v232
  v_rcp_f32 v233, v233
  v_rcp_f32 v234, v234
  v_rcp_f32 v235, v235
  v_rcp_f32 v236, v236
  v_rcp_f32 v237, v237
  v_rcp_f32 v238, v238
  v_rcp_f32 v239, v239
.p2align 3
  v_pk_fma_f32 v[224:225], v[224:225], v[52:53], v[52:53] neg_lo:[1,0,0] neg_hi:[1,0,0]
  v_pk_fma_f32 v[226:227], v[226:227], v[54:55], v[54:55] neg_lo:[1,0,0] neg_hi:[1,0,0]
  buffer_load_dwordx4 v1, s[20:23], s92 offen offset:2048 sc1 lds
  v_pk_fma_f32 v[228:229], v[228:229], v[84:85], v[84:85] neg_lo:[1,0,0] neg_hi:[1,0,0]
  v_pk_fma_f32 v[230:231], v[230:231], v[86:87], v[86:87] neg_lo:[1,0,0] neg_hi:[1,0,0]
  v_pk_fma_f32 v[232:233], v[232:233], v[116:117], v[116:117] neg_lo:[1,0,0] neg_hi:[1,0,0]
  v_pk_fma_f32 v[234:235], v[234:235], v[118:119], v[118:119] neg_lo:[1,0,0] neg_hi:[1,0,0]
  v_pk_fma_f32 v[236:237], v[236:237], v[148:149], v[148:149] neg_lo:[1,0,0] neg_hi:[1,0,0]
  v_pk_fma_f32 v[238:239], v[238:239], v[150:151], v[150:151] neg_lo:[1,0,0] neg_hi:[1,0,0]
  v_cvt_pk_bf16_f32 v168, v224, v225
  v_cvt_pk_bf16_f32 v169, v226, v227
  v_cvt_pk_bf16_f32 v170, v228, v229
  v_cvt_pk_bf16_f32 v171, v230, v231
  buffer_load_dwordx4 v1, s[20:23], s92 offen offset:3072 sc1 lds
  v_cvt_pk_bf16_f32 v172, v232, v233
  v_cvt_pk_bf16_f32 v173, v234, v235
  v_cvt_pk_bf16_f32 v174, v236, v237
  v_cvt_pk_bf16_f32 v175, v238, v239
  v_pk_mul_f32 v[224:225], v[56:57], s[80:81]
  v_pk_mul_f32 v[226:227], v[58:59], s[80:81]
  v_pk_mul_f32 v[228:229], v[88:89], s[80:81]
  v_pk_mul_f32 v[230:231], v[90:91], s[80:81]
  v_pk_mul_f32 v[232:233], v[120:121], s[80:81]
  s_add_u32 s92, s92, 16384
  s_and_b32 s65, s93, 0xffff
  s_add_u32 m0, s65, 65536
  v_pk_mul_f32 v[234:235], v[122:123], s[80:81]
  buffer_load_dwordx4 v1, s[24:27], s93 offen offset:0 sc1 lds
  v_pk_mul_f32 v[236:237], v[152:153], s[80:81]
  v_pk_mul_f32 v[238:239], v[154:155], s[80:81]
  v_exp_f32 v224, v224
  v_exp_f32 v225, v225
  v_exp_f32 v226, v226
  v_exp_f32 v227, v227
  v_exp_f32 v228, v228
  v_exp_f32 v229, v229
  v_exp_f32 v230, v230
  v_exp_f32 v231, v231
  buffer_load_dwordx4 v1, s[24:27], s93 offen offset:1024 sc1 lds
  v_exp_f32 v232, v232
  v_exp_f32 v233, v233
  v_exp_f32 v234, v234
  v_exp_f32 v235, v235
  v_exp_f32 v236, v236
  v_exp_f32 v237, v237
  v_exp_f32 v238, v238
  v_exp_f32 v239, v239
.p2align 3
  v_pk_fma_f32 v[240:241], v[224:225], 0.5, 1.0 op_sel_hi:[1,0,0]
  v_pk_fma_f32 v[242:243], v[226:227], 0.5, 1.0 op_sel_hi:[1,0,0]
  buffer_load_dwordx4 v1, s[24:27], s93 offen offset:2048 sc1 lds
  v_pk_fma_f32 v[244:245], v[228:229], 0.5, 1.0 op_sel_hi:[1,0,0]
  v_pk_fma_f32 v[246:247], v[230:231], 0.5, 1.0 op_sel_hi:[1,0,0]
  v_pk_fma_f32 v[248:249], v[232:233], 0.5, 1.0 op_sel_hi:[1,0,0]
  v_pk_fma_f32 v[250:251], v[234:235], 0.5, 1.0 op_sel_hi:[1,0,0]
  v_pk_fma_f32 v[252:253], v[236:237], 0.5, 1.0 op_sel_hi:[1,0,0]
  v_pk_fma_f32 v[254:255], v[238:239], 0.5, 1.0 op_sel_hi:[1,0,0]
  v_pk_fma_f32 v[224:225], v[224:225], v[240:241], 1.0 op_sel_hi:[1,1,0]
  v_pk_fma_f32 v[226:227], v[226:227], v[242:243], 1.0 op_sel_hi:[1,1,0]
  v_pk_fma_f32 v[228:229], v[228:229], v[244:245], 1.0 op_sel_hi:[1,1,0]
  v_pk_fma_f32 v[230:231], v[230:231], v[246:247], 1.0 op_sel_hi:[1,1,0]
  buffer_load_dwordx4 v1, s[24:27], s93 offen offset:3072 sc1 lds
  v_pk_fma_f32 v[232:233], v[232:233], v[248:249], 1.0 op_sel_hi:[1,1,0]
  v_pk_fma_f32 v[234:235], v[234:235], v[250:251], 1.0 op_sel_hi:[1,1,0]
  v_pk_fma_f32 v[236:237], v[236:237], v[252:253], 1.0 op_sel_hi:[1,1,0]
  v_pk_fma_f32 v[238:239], v[238:239], v[254:255], 1.0 op_sel_hi:[1,1,0]
  v_rcp_f32 v224, v224
  v_rcp_f32 v225, v225
  v_rcp_f32 v226, v226
  v_rcp_f32 v227, v227
  v_rcp_f32 v228, v228
  s_add_u32 s93, s93, 16384
  s_and_b32 m0, s92, 0xffff
  v_rcp_f32 v229, v229
  buffer_load_dwordx4 v1, s[20:23], s92 offen offset:0 sc1 lds
  v_rcp_f32 v230, v230
  v_rcp_f32 v231, v231
  v_rcp_f32 v232, v232
  v_rcp_f32 v233, v233
  v_rcp_f32 v234, v234
  v_rcp_f32 v235, v235
  v_rcp_f32 v236, v236
  v_rcp_f32 v237, v237
  v_rcp_f32 v238, v238
  v_rcp_f32 v239, v239
.p2align 3
  buffer_load_dwordx4 v1, s[20:23], s92 offen offset:1024 sc1 lds
  v_pk_fma_f32 v[224:225], v[224:225], v[56:57], v[56:57] neg_lo:[1,0,0] neg_hi:[1,0,0]
  v_pk_fma_f32 v[226:227], v[226:227], v[58:59], v[58:59] neg_lo:[1,0,0] neg_hi:[1,0,0]
  v_pk_fma_f32 v[228:229], v[228:229], v[88:89], v[88:89] neg_lo:[1,0,0] neg_hi:[1,0,0]
  v_pk_fma_f32 v[230:231], v[230:231], v[90:91], v[90:91] neg_lo:[1,0,0] neg_hi:[1,0,0]
  v_pk_fma_f32 v[232:233], v[232:233], v[120:121], v[120:121] neg_lo:[1,0,0] neg_hi:[1,0,0]
  v_pk_fma_f32 v[234:235], v[234:235], v[122:123], v[122:123] neg_lo:[1,0,0] neg_hi:[1,0,0]
  v_pk_fma_f32 v[236:237], v[236:237], v[152:153], v[152:153] neg_lo:[1,0,0] neg_hi:[1,0,0]
  v_pk_fma_f32 v[238:239], v[238:239], v[154:155], v[154:155] neg_lo:[1,0,0] neg_hi:[1,0,0]
  v_cvt_pk_bf16_f32 v176, v224, v225
  v_cvt_pk_bf16_f32 v177, v226, v227
  buffer_load_dwordx4 v1, s[20:23], s92 offen offset:2048 sc1 lds
  v_cvt_pk_bf16_f32 v178, v228, v229
  v_cvt_pk_bf16_f32 v179, v230, v231
  v_cvt_pk_bf16_f32 v180, v232, v233
  v_cvt_pk_bf16_f32 v181, v234, v235
  v_cvt_pk_bf16_f32 v182, v236, v237
  v_cvt_pk_bf16_f32 v183, v238, v239
  v_pk_mul_f32 v[224:225], v[60:61], s[80:81]
  v_pk_mul_f32 v[226:227], v[62:63], s[80:81]
  v_pk_mul_f32 v[228:229], v[92:93], s[80:81]
  v_pk_mul_f32 v[230:231], v[94:95], s[80:81]
  buffer_load_dwordx4 v1, s[20:23], s92 offen offset:3072 sc1 lds
  v_pk_mul_f32 v[232:233], v[124:125], s[80:81]
  v_pk_mul_f32 v[234:235], v[126:127], s[80:81]
  v_pk_mul_f32 v[236:237], v[156:157], s[80:81]
  v_pk_mul_f32 v[238:239], v[158:159], s[80:81]
  v_exp_f32 v224, v224
  v_exp_f32 v225, v225
  v_exp_f32 v226, v226
  v_exp_f32 v227, v227
  v_exp_f32 v228, v228
  s_add_u32 s92, s92, 16384
  s_and_b32 s65, s93, 0xffff
  s_add_u32 m0, s65, 65536
  v_exp_f32 v229, v229
  buffer_load_dwordx4 v1, s[24:27], s93 offen offset:0 sc1 lds
  v_exp_f32 v230, v230
  v_exp_f32 v231, v231
  v_exp_f32 v232, v232
  v_exp_f32 v233, v233
  v_exp_f32 v234, v234
  v_exp_f32 v235, v235
  v_exp_f32 v236, v236
  v_exp_f32 v237, v237
  v_exp_f32 v238, v238
  v_exp_f32 v239, v239
.p2align 3
  buffer_load_dwordx4 v1, s[24:27], s93 offen offset:1024 sc1 lds
  v_pk_fma_f32 v[240:241], v[224:225], 0.5, 1.0 op_sel_hi:[1,0,0]
  v_pk_fma_f32 v[242:243], v[226:227], 0.5, 1.0 op_sel_hi:[1,0,0]
  v_pk_fma_f32 v[244:245], v[228:229], 0.5, 1.0 op_sel_hi:[1,0,0]
  v_pk_fma_f32 v[246:247], v[230:231], 0.5, 1.0 op_sel_hi:[1,0,0]
  v_pk_fma_f32 v[248:249], v[232:233], 0.5, 1.0 op_sel_hi:[1,0,0]
  v_pk_fma_f32 v[250:251], v[234:235], 0.5, 1.0 op_sel_hi:[1,0,0]
  v_pk_fma_f32 v[252:253], v[236:237], 0.5, 1.0 op_sel_hi:[1,0,0]
  v_pk_fma_f32 v[254:255], v[238:239], 0.5, 1.0 op_sel_hi:[1,0,0]
  v_pk_fma_f32 v[224:225], v[224:225], v[240:241], 1.0 op_sel_hi:[1,1,0]
  v_pk_fma_f32 v[226:227], v[226:227], v[242:243], 1.0 op_sel_hi:[1,1,0]
  buffer_load_dwordx4 v1, s[24:27], s93 offen offset:2048 sc1 lds
  v_pk_fma_f32 v[228:229], v[228:229], v[244:245], 1.0 op_sel_hi:[1,1,0]
  v_pk_fma_f32 v[230:231], v[230:231], v[246:247], 1.0 op_sel_hi:[1,1,0]
  v_pk_fma_f32 v[232:233], v[232:233], v[248:249], 1.0 op_sel_hi:[1,1,0]
  v_pk_fma_f32 v[234:235], v[234:235], v[250:251], 1.0 op_sel_hi:[1,1,0]
  v_pk_fma_f32 v[236:237], v[236:237], v[252:253], 1.0 op_sel_hi:[1,1,0]
  v_pk_fma_f32 v[238:239], v[238:239], v[254:255], 1.0 op_sel_hi:[1,1,0]
  v_rcp_f32 v224, v224
  v_rcp_f32 v225, v225
  v_rcp_f32 v226, v226
  v_rcp_f32 v227, v227
  buffer_load_dwordx4 v1, s[24:27], s93 offen offset:3072 sc1 lds
  v_rcp_f32 v228, v228
  v_rcp_f32 v229, v229
  v_rcp_f32 v230, v230
  v_rcp_f32 v231, v231
  v_rcp_f32 v232, v232
  v_rcp_f32 v233, v233
  v_rcp_f32 v234, v234
  v_rcp_f32 v235, v235
  v_rcp_f32 v236, v236
  s_add_u32 s93, s93, 16384
  v_rcp_f32 v237, v237
  v_rcp_f32 v238, v238
  v_rcp_f32 v239, v239
.p2align 3
  v_pk_fma_f32 v[224:225], v[224:225], v[60:61], v[60:61] neg_lo:[1,0,0] neg_hi:[1,0,0]
  v_pk_fma_f32 v[226:227], v[226:227], v[62:63], v[62:63] neg_lo:[1,0,0] neg_hi:[1,0,0]
  v_pk_fma_f32 v[228:229], v[228:229], v[92:93], v[92:93] neg_lo:[1,0,0] neg_hi:[1,0,0]
  v_pk_fma_f32 v[230:231], v[230:231], v[94:95], v[94:95] neg_lo:[1,0,0] neg_hi:[1,0,0]
  v_pk_fma_f32 v[232:233], v[232:233], v[124:125], v[124:125] neg_lo:[1,0,0] neg_hi:[1,0,0]
  v_pk_fma_f32 v[234:235], v[234:235], v[126:127], v[126:127] neg_lo:[1,0,0] neg_hi:[1,0,0]
  v_pk_fma_f32 v[236:237], v[236:237], v[156:157], v[156:157] neg_lo:[1,0,0] neg_hi:[1,0,0]
  v_pk_fma_f32 v[238:239], v[238:239], v[158:159], v[158:159] neg_lo:[1,0,0] neg_hi:[1,0,0]
  v_cvt_pk_bf16_f32 v184, v224, v225
  v_cvt_pk_bf16_f32 v185, v226, v227
  v_cvt_pk_bf16_f32 v186, v228, v229
  v_cvt_pk_bf16_f32 v187, v230, v231
  v_cvt_pk_bf16_f32 v188, v232, v233
  v_cvt_pk_bf16_f32 v189, v234, v235
  v_cvt_pk_bf16_f32 v190, v236, v237
  v_cvt_pk_bf16_f32 v191, v238, v239
Lp2done:
Lp3start:
  s_waitcnt vmcnt(4) lgkmcnt(0)
  s_barrier
  ds_read_b128 a[160:163], v1 offset:0
  ds_read_b128 a[164:167], v1 offset:1024
  ds_read_b128 a[168:171], v1 offset:2048
  ds_read_b128 a[172:175], v1 offset:3072
  ds_read_b128 a[176:179], v1 offset:4096
  ds_read_b128 a[180:183], v1 offset:5120
  ds_read_b128 a[184:187], v1 offset:6144
  ds_read_b128 a[188:191], v1 offset:7168
  s_add_u32 s63, s62, 8
  s_lshl_b64 exec, s[94:95], s63
  buffer_store_dword v27, v0, s[40:43], s66 offen sc1
  s_mov_b64 exec, -1
  s_mov_b64 s[68:69], 0
  s_mov_b32 s86, 2
  s_mov_b32 s6, 24
  s_mov_b32 s88, 24576
  s_mov_b32 s89, 0x10000
  v_xor_b32 v28, 0x2000, v5
  s_waitcnt lgkmcnt(7)
  v_mfma_f32_16x16x32_bf16 v[32:35], a[160:163], a[64:67], 0
  ds_read_b128 a[192:195], v1 offset:8192
  v_bfe_u32 v149, v1, 4, 4
  v_mfma_f32_16x16x32_bf16 v[40:43], a[160:163], a[68:71], 0
  ds_read_b128 a[196:199], v1 offset:9216
  v_lshrrev_b32 v148, 8, v1
  v_mfma_f32_16x16x32_bf16 v[48:51], a[160:163], a[96:99], 0
  ds_read_b128 a[200:203], v1 offset:10240
  v_lshlrev_b32 v148, 2, v148
  v_mfma_f32_16x16x32_bf16 v[56:59], a[160:163], a[100:103], 0
  ds_read_b128 a[204:207], v1 offset:11264
  s_waitcnt lgkmcnt(10)
  v_sub_u32 v148, v149, v148
  v_mfma_f32_16x16x32_bf16 v[36:39], a[164:167], a[64:67], 0
  ds_read_b128 a[208:211], v1 offset:12288
  v_mov_b32 v150, s91
  v_mfma_f32_16x16x32_bf16 v[44:47], a[164:167], a[68:71], 0
  ds_read_b128 a[212:215], v1 offset:13312
  v_mov_b32 v151, s90
  v_mfma_f32_16x16x32_bf16 v[52:55], a[164:167], a[96:99], 0
  ds_read_b128 a[216:219], v1 offset:14336
  v_mov_b32 v152, 0x3f803f80
  v_mfma_f32_16x16x32_bf16 v[60:63], a[164:167], a[100:103], 0
  ds_read_b128 a[220:223], v1 offset:15360
  s_waitcnt lgkmcnt(13)
  v_and_b32 v149, 3, v149
  v_mfma_f32_16x16x32_bf16 v[32:35], a[168:171], a[72:75], v[32:35]
  ds_read_b128 a[128:131], v28 offset:0
  v_add_u32 v3, s89, v1
  v_mfma_f32_16x16x32_bf16 v[40:43], a[168:171], a[76:79], v[40:43]
  ds_read_b128 a[132:135], v28 offset:1024
  v_sub_u32 v156, v28, v1
  v_mfma_f32_16x16x32_bf16 v[48:51], a[168:171], a[104:107], v[48:51]
  ds_read_b128 a[136:139], v28 offset:2048
  v_add_u32 v156, v156, v0
  v_mfma_f32_16x16x32_bf16 v[56:59], a[168:171], a[108:111], v[56:59]
  ds_read_b128 a[140:143], v28 offset:3072
  s_waitcnt lgkmcnt(14)
  v_cmp_eq_u32 vcc, 0, v149
  s_nop 1
  v_mfma_f32_16x16x32_bf16 v[36:39], a[172:175], a[72:75], v[36:39]
  ds_read_b128 a[144:147], v28 offset:4096
  v_cndmask_b32 v152, 0, v152, vcc
  v_mfma_f32_16x16x32_bf16 v[44:47], a[172:175], a[76:79], v[44:47]
  ds_read_b128 a[148:151], v28 offset:5120
  v_cmp_le_i32 vcc, 0, v148
  v_mfma_f32_16x16x32_bf16 v[52:55], a[172:175], a[104:107], v[52:55]
  ds_read_b128 a[152:155], v28 offset:6144
  s_and_b32 m0, s92, 0xffff
  v_accvgpr_write_b32 a240, v152
  s_nop 0
  v_mfma_f32_16x16x32_bf16 v[60:63], a[172:175], a[108:111], v[60:63]
  ds_read_b128 a[156:159], v28 offset:7168
  s_waitcnt lgkmcnt(14)
  v_cndmask_b32 v140, v150, v151, vcc
  v_mfma_f32_16x16x32_bf16 v[32:35], a[176:179], a[80:83], v[32:35]
  buffer_load_dwordx4 v1, s[20:23], s92 offen offset:0 sc1 lds
  v_mfma_f32_16x16x32_bf16 v[40:43], a[176:179], a[84:87], v[40:43]
  v_cmp_le_i32 vcc, 1, v148
  v_accvgpr_write_b32 a241, v152
  s_nop 0
  v_mfma_f32_16x16x32_bf16 v[48:51], a[176:179], a[112:115], v[48:51]
  v_cndmask_b32 v141, v150, v151, vcc
  v_cmp_le_i32 vcc, 2, v148
  v_mfma_f32_16x16x32_bf16 v[56:59], a[176:179], a[116:119], v[56:59]
  s_waitcnt lgkmcnt(14)
  v_accvgpr_write_b32 a242, v152
  s_nop 0
  v_cndmask_b32 v142, v150, v151, vcc
  v_mfma_f32_16x16x32_bf16 v[36:39], a[180:183], a[80:83], v[36:39]
  buffer_load_dwordx4 v1, s[20:23], s92 offen offset:1024 sc1 lds
  v_mfma_f32_16x16x32_bf16 v[44:47], a[180:183], a[84:87], v[44:47]
  v_cmp_le_i32 vcc, 3, v148
  v_accvgpr_write_b32 a243, v152
  s_nop 0
  v_mfma_f32_16x16x32_bf16 v[52:55], a[180:183], a[112:115], v[52:55]
  v_cndmask_b32 v143, v150, v151, vcc
  s_cmp_lg_u32 s67, 0
  s_cselect_b32 s100, s90, s91
  v_max_f32 v144, s100, v140
  v_mfma_f32_16x16x32_bf16 v[60:63], a[180:183], a[116:119], v[60:63]
  s_waitcnt lgkmcnt(14)
  v_max_f32 v145, s100, v141
  v_max_f32 v146, s100, v142
  v_mfma_f32_16x16x32_bf16 v[32:35], a[184:187], a[88:91], v[32:35]
  buffer_load_dwordx4 v1, s[20:23], s92 offen offset:2048 sc1 lds
  v_mfma_f32_16x16x32_bf16 v[40:43], a[184:187], a[92:95], v[40:43]
  v_max_f32 v147, s100, v143
  v_mfma_f32_16x16x32_bf16 v[48:51], a[184:187], a[120:123], v[48:51]
  v_mfma_f32_16x16x32_bf16 v[56:59], a[184:187], a[124:127], v[56:59]
  s_waitcnt lgkmcnt(14)
  v_mfma_f32_16x16x32_bf16 v[36:39], a[188:191], a[88:91], v[36:39]
  buffer_load_dwordx4 v1, s[20:23], s92 offen offset:3072 sc1 lds
  v_mfma_f32_16x16x32_bf16 v[44:47], a[188:191], a[92:95], v[44:47]
  s_add_u32 s92, s92, 16384
  s_lshr_b32 s63, s72, 14
  s_mul_i32 s63, s63, 188416
  s_add_u32 s63, s63, s71
  v_mfma_f32_16x16x32_bf16 v[52:55], a[188:191], a[120:123], v[52:55]
  v_mfma_f32_16x16x32_bf16 v[60:63], a[188:191], a[124:127], v[60:63]
  buffer_store_dwordx4 v[160:163], v1, s[8:11], s63 offen offset:0 sc1
  s_cmp_lg_u32 s5, 0
  s_nop 1
  v_min_f32 v48, v144, v48
  v_min_f32 v49, v145, v49
  v_min_f32 v50, v146, v50
  v_min_f32 v51, v147, v51
  v_min_f32 v52, s100, v52
  v_min_f32 v53, s100, v53
  v_min_f32 v54, s100, v54
  v_min_f32 v55, s100, v55
  v_min_f32 v60, v144, v60
  v_min_f32 v61, v145, v61
  v_min_f32 v62, v146, v62
  v_min_f32 v63, v147, v63
  s_cbranch_scc1 Lhavem
.p2align 3
  v_max3_f32 v136, v32, v33, v34
  v_max3_f32 v137, v40, v41, v42
  v_max3_f32 v138, v48, v49, v50
  v_max3_f32 v139, v56, v57, v58
  v_max3_f32 v136, v35, v36, v136
  v_max3_f32 v137, v43, v44, v137
  v_max3_f32 v138, v51, v52, v138
  v_max3_f32 v139, v59, v60, v139
  v_max3_f32 v136, v37, v38, v136
  v_max3_f32 v137, v45, v46, v137
  v_max3_f32 v138, v53, v54, v138
  v_max3_f32 v139, v61, v62, v139
  v_max_f32 v136, v39, v136
  v_max_f32 v137, v47, v137
  v_max_f32 v138, v55, v138
  v_max_f32 v139, v63, v139
  v_mov_b32 v148, v136
  v_mov_b32 v149, v137
  v_mov_b32 v150, v138
  v_mov_b32 v151, v139
  s_nop 0
  v_permlane16_swap_b32 v136, v148
  v_permlane16_swap_b32 v137, v149
  v_permlane16_swap_b32 v138, v150
  v_permlane16_swap_b32 v139, v151
  v_max_f32 v136, v136, v148
  v_max_f32 v137, v137, v149
  v_max_f32 v138, v138, v150
  v_max_f32 v139, v139, v151
  v_mov_b32 v148, v136
  v_mov_b32 v149, v137
  v_mov_b32 v150, v138
  v_mov_b32 v151, v139
  s_nop 0
  v_permlane32_swap_b32 v136, v148
  v_permlane32_swap_b32 v137, v149
  v_permlane32_swap_b32 v138, v150
  v_permlane32_swap_b32 v139, v151
  v_max_f32 v136, v136, v148
  v_max_f32 v137, v137, v149
  v_max_f32 v138, v138, v150
  v_max_f32 v139, v139, v151
  v_sub_f32 v136, 0, v136
  v_sub_f32 v137, 0, v137
  v_sub_f32 v138, 0, v138
  v_sub_f32 v139, 0, v139
Lhavem:
.p2align 3
  v_pk_mov_b32 v[224:225], v[136:137], v[136:137] op_sel:[0,0]
  v_pk_mov_b32 v[226:227], v[136:137], v[136:137] op_sel:[0,0]
  v_pk_mov_b32 v[228:229], v[136:137], v[136:137] op_sel:[0,0]
  v_pk_mov_b32 v[230:231], v[136:137], v[136:137] op_sel:[0,0]
  v_pk_mov_b32 v[232:233], v[136:137], v[136:137] op_sel:[1,1]
  v_pk_mov_b32 v[234:235], v[136:137], v[136:137] op_sel:[1,1]
  v_pk_mov_b32 v[236:237], v[136:137], v[136:137] op_sel:[1,1]
  v_pk_mov_b32 v[238:239], v[136:137], v[136:137] op_sel:[1,1]
  v_pk_add_f32 v[32:33], v[32:33], v[136:137] op_sel:[0,0] op_sel_hi:[1,0]
  v_pk_add_f32 v[34:35], v[34:35], v[136:137] op_sel:[0,0] op_sel_hi:[1,0]
  v_pk_add_f32 v[36:37], v[36:37], v[136:137] op_sel:[0,0] op_sel_hi:[1,0]
  v_pk_add_f32 v[38:39], v[38:39], v[136:137] op_sel:[0,0] op_sel_hi:[1,0]
  v_pk_add_f32 v[40:41], v[40:41], v[136:137] op_sel:[0,1] op_sel_hi:[1,1]
  v_pk_add_f32 v[42:43], v[42:43], v[136:137] op_sel:[0,1] op_sel_hi:[1,1]
  v_pk_add_f32 v[44:45], v[44:45], v[136:137] op_sel:[0,1] op_sel_hi:[1,1]
  v_pk_add_f32 v[46:47], v[46:47], v[136:137] op_sel:[0,1] op_sel_hi:[1,1]
  v_pk_add_f32 v[48:49], v[48:49], v[138:139] op_sel:[0,0] op_sel_hi:[1,0]
  v_pk_add_f32 v[50:51], v[50:51], v[138:139] op_sel:[0,0] op_sel_hi:[1,0]
  v_pk_add_f32 v[52:53], v[52:53], v[138:139] op_sel:[0,0] op_sel_hi:[1,0]
  v_pk_add_f32 v[54:55], v[54:55], v[138:139] op_sel:[0,0] op_sel_hi:[1,0]
  v_pk_add_f32 v[56:57], v[56:57], v[138:139] op_sel:[0,1] op_sel_hi:[1,1]
  v_pk_add_f32 v[58:59], v[58:59], v[138:139] op_sel:[0,1] op_sel_hi:[1,1]
  v_pk_add_f32 v[60:61], v[60:61], v[138:139] op_sel:[0,1] op_sel_hi:[1,1]
  v_pk_add_f32 v[62:63], v[62:63], v[138:139] op_sel:[0,1] op_sel_hi:[1,1]
  buffer_store_dwordx4 v[164:167], v1, s[8:11], s63 offen offset:1024 sc1
  s_waitcnt lgkmcnt(0)
  ds_write2st64_b32 v156, v136, v137 offset1:1
  s_sub_u32 s3, 1, s67
  s_cmp_lt_i32 s3, 0
  s_cselect_b32 s100, s90, s91
  s_cmp_gt_i32 s3, 0
  s_cselect_b32 s101, s91, s90
  v_max_f32 v144, s100, v140
  v_max_f32 v145, s100, v141
  v_max_f32 v146, s100, v142
  v_max_f32 v147, s100, v143
  v_min_f32 v244, s100, v138
  v_min_f32 v245, s100, v138
  v_min_f32 v246, s100, v138
  v_min_f32 v247, s100, v138
.p2align 3
  v_min3_f32 v240, v138, v144, s101
  v_min3_f32 v241, v138, v145, s101
  v_min3_f32 v242, v138, v146, s101
  v_min3_f32 v243, v138, v147, s101
  v_min3_f32 v252, v139, v144, s101
  v_min3_f32 v253, v139, v145, s101
  v_min3_f32 v254, v139, v146, s101
  v_min3_f32 v255, v139, v147, s101
  v_min_f32 v248, s101, v139
  v_min_f32 v249, s101, v139
  v_min_f32 v250, s101, v139
  v_min_f32 v251, s101, v139
  s_nop 0
  v_mfma_f32_16x16x32_bf16 v[84:87], a[196:199], a[96:99], v[244:247]
  v_exp_f32 v128, v32
  v_mfma_f32_16x16x32_bf16 v[84:87], a[204:207], a[104:107], v[84:87]
  ds_read_b128 a[160:163], v1 offset:16384
  v_exp_f32 v129, v33
  v_mfma_f32_16x16x32_bf16 v[84:87], a[212:215], a[112:115], v[84:87]
  s_and_b32 s65, s93, 0xffff
  s_add_u32 m0, s65, 65536
  v_cvt_pk_bf16_f32 v96, v128, v129
  v_exp_f32 v130, v34
  v_mfma_f32_16x16x32_bf16 v[84:87], a[220:223], a[120:123], v[84:87]
  ds_read_b128 a[164:167], v1 offset:17408
  v_exp_f32 v131, v35
  v_mfma_f32_16x16x32_bf16 v[92:95], a[220:223], a[124:127], v[252:255]
  buffer_load_dwordx4 v1, s[24:27], s93 offen offset:0 sc1 lds
  v_cvt_pk_bf16_f32 v97, v130, v131
  v_exp_f32 v132, v36
  v_mfma_f32_16x16x32_bf16 v[92:95], a[212:215], a[116:119], v[92:95]
  ds_read_b128 a[168:171], v1 offset:18432
  v_exp_f32 v133, v37
  v_mfma_f32_16x16x32_bf16 v[92:95], a[204:207], a[108:111], v[92:95]
  v_cvt_pk_bf16_f32 v98, v132, v133
  v_exp_f32 v134, v38
  v_mfma_f32_16x16x32_bf16 v[92:95], a[196:199], a[100:103], v[92:95]
  ds_read_b128 a[172:175], v1 offset:19456
  buffer_load_dwordx4 v1, s[24:27], s93 offen offset:1024 sc1 lds
  v_exp_f32 v135, v39
  v_mfma_f32_16x16x32_bf16 v[88:91], a[192:195], a[100:103], v[248:251]
  v_cvt_pk_bf16_f32 v99, v134, v135
  v_exp_f32 v128, v40
  v_mfma_f32_16x16x32_bf16 v[88:91], a[200:203], a[108:111], v[88:91]
  ds_read_b128 a[176:179], v1 offset:20480
  v_exp_f32 v129, v41
  v_mfma_f32_16x16x32_bf16 v[88:91], a[208:211], a[116:119], v[88:91]
  buffer_load_dwordx4 v1, s[24:27], s93 offen offset:2048 sc1 lds
  v_cvt_pk_bf16_f32 v100, v128, v129
  v_exp_f32 v130, v42
  v_mfma_f32_16x16x32_bf16 v[88:91], a[216:219], a[124:127], v[88:91]
  ds_read_b128 a[180:183], v1 offset:21504
  v_exp_f32 v131, v43
  v_mfma_f32_16x16x32_bf16 v[80:83], a[216:219], a[120:123], v[240:243]
  v_cvt_pk_bf16_f32 v101, v130, v131
  v_exp_f32 v132, v44
  v_mfma_f32_16x16x32_bf16 v[80:83], a[208:211], a[112:115], v[80:83]
  ds_read_b128 a[184:187], v1 offset:22528
  buffer_load_dwordx4 v1, s[24:27], s93 offen offset:3072 sc1 lds
  v_exp_f32 v133, v45
  v_mfma_f32_16x16x32_bf16 v[80:83], a[200:203], a[104:107], v[80:83]
  s_add_u32 s93, s93, 16384
  s_and_b32 m0, s92, 0xffff
  s_lshr_b32 s63, s73, 14
  s_mul_i32 s63, s63, 188416
  s_add_u32 s63, s63, s71
  v_cvt_pk_bf16_f32 v102, v132, v133
  v_exp_f32 v134, v46
  v_mfma_f32_16x16x32_bf16 v[80:83], a[192:195], a[96:99], v[80:83]
  ds_read_b128 a[188:191], v1 offset:23552
  v_exp_f32 v135, v47
  s_sub_u32 s3, 2, s67
  s_cmp_lt_i32 s3, 0
  s_cselect_b32 s100, s90, s91
  s_cmp_gt_i32 s3, 0
  s_cselect_b32 s101, s91, s90
  v_max_f32 v144, s100, v140
  v_max_f32 v145, s100, v141
  v_mfma_f32_16x16x32_bf16 v[64:67], a[192:195], a[64:67], v[224:227]
  buffer_store_dwordx4 v[168:171], v1, s[8:11], s63 offen offset:0 sc1
  v_cvt_pk_bf16_f32 v103, v134, v135
  v_exp_f32 v128, v48
  v_mfma_f32_16x16x32_bf16 v[64:67], a[200:203], a[72:75], v[64:67]
  v_exp_f32 v129, v49
  v_max_f32 v146, s100, v142
  v_max_f32 v147, s100, v143
  v_mfma_f32_16x16x32_bf16 v[64:67], a[208:211], a[80:83], v[64:67]
  v_cvt_pk_bf16_f32 v104, v128, v129
  v_exp_f32 v130, v50
  v_min_f32 v244, s100, v138
  v_mfma_f32_16x16x32_bf16 v[64:67], a[216:219], a[88:91], v[64:67]
  buffer_load_dwordx4 v1, s[20:23], s92 offen offset:0 sc1 lds
  v_exp_f32 v131, v51
  v_min_f32 v245, s100, v138
  v_mfma_f32_16x16x32_bf16 v[72:75], a[216:219], a[92:95], v[232:235]
  v_cvt_pk_bf16_f32 v105, v130, v131
  v_exp_f32 v132, v52
  v_min_f32 v246, s100, v138
  v_mfma_f32_16x16x32_bf16 v[72:75], a[208:211], a[84:87], v[72:75]
  v_exp_f32 v133, v53
  v_min_f32 v247, s100, v138
  v_min3_f32 v240, v138, v144, s101
  v_mfma_f32_16x16x32_bf16 v[72:75], a[200:203], a[76:79], v[72:75]
  buffer_load_dwordx4 v1, s[20:23], s92 offen offset:1024 sc1 lds
  v_cvt_pk_bf16_f32 v106, v132, v133
  v_exp_f32 v134, v54
  v_mfma_f32_16x16x32_bf16 v[72:75], a[192:195], a[68:71], v[72:75]
  v_exp_f32 v135, v55
  v_min3_f32 v241, v138, v145, s101
  v_min3_f32 v242, v138, v146, s101
  v_mfma_f32_16x16x32_bf16 v[76:79], a[196:199], a[68:71], v[236:239]
  v_cvt_pk_bf16_f32 v107, v134, v135
  v_exp_f32 v128, v56
  v_min3_f32 v243, v138, v147, s101
  v_min3_f32 v252, v139, v144, s101
  v_mfma_f32_16x16x32_bf16 v[76:79], a[204:207], a[76:79], v[76:79]
  buffer_load_dwordx4 v1, s[20:23], s92 offen offset:2048 sc1 lds
  v_exp_f32 v129, v57
  v_mfma_f32_16x16x32_bf16 v[76:79], a[212:215], a[84:87], v[76:79]
  v_cvt_pk_bf16_f32 v108, v128, v129
  v_exp_f32 v130, v58
  v_min3_f32 v253, v139, v145, s101
  v_mfma_f32_16x16x32_bf16 v[76:79], a[220:223], a[92:95], v[76:79]
  v_exp_f32 v131, v59
  v_min3_f32 v254, v139, v146, s101
  v_min3_f32 v255, v139, v147, s101
  v_min_f32 v248, s101, v139
  v_mfma_f32_16x16x32_bf16 v[68:71], a[220:223], a[88:91], v[228:231]
  buffer_load_dwordx4 v1, s[20:23], s92 offen offset:3072 sc1 lds
  v_cvt_pk_bf16_f32 v109, v130, v131
  v_exp_f32 v132, v60
  v_mfma_f32_16x16x32_bf16 v[68:71], a[212:215], a[80:83], v[68:71]
  s_add_u32 s92, s92, 16384
  v_exp_f32 v133, v61
  v_min_f32 v249, s101, v139
  v_min_f32 v250, s101, v139
  v_mfma_f32_16x16x32_bf16 v[68:71], a[204:207], a[72:75], v[68:71]
  v_cvt_pk_bf16_f32 v110, v132, v133
  v_exp_f32 v134, v62
  v_min_f32 v251, s101, v139
  v_mfma_f32_16x16x32_bf16 v[68:71], a[196:199], a[64:67], v[68:71]
  buffer_store_dwordx4 v[172:175], v1, s[8:11], s63 offen offset:1024 sc1
  v_exp_f32 v135, v63
  s_nop 0
  v_cvt_pk_bf16_f32 v111, v134, v135
  s_waitcnt lgkmcnt(0)
  v_mfma_f32_16x16x32_bf16 v[32:35], a[160:163], a[64:67], v[224:227]
  v_exp_f32 v128, v64
  v_mfma_f32_16x16x32_bf16 v[32:35], a[168:171], a[72:75], v[32:35]
  v_exp_f32 v129, v65
  v_mfma_f32_16x16x32_bf16 v[32:35], a[176:179], a[80:83], v[32:35]
  ds_read_b128 a[192:195], v3 offset:0
  v_cvt_pk_bf16_f32 v112, v128, v129
  v_mfma_f32_16x16x32_bf16 v[32:35], a[184:187], a[88:91], v[32:35]
  ds_read_b128 a[196:199], v3 offset:1024
  v_mfma_f32_16x16x32_bf16 v[40:43], a[184:187], a[92:95], v[232:235]
  s_lshr_b32 s63, s74, 14
  s_mul_i32 s63, s63, 188416
  s_add_u32 s63, s63, s71
  v_exp_f32 v130, v66
  v_mfma_f32_16x16x32_bf16 v[40:43], a[176:179], a[84:87], v[40:43]
  buffer_store_dwordx4 v[176:179], v1, s[8:11], s63 offen offset:0 sc1
  v_exp_f32 v131, v67
  v_mfma_f32_16x16x32_bf16 v[40:43], a[168:171], a[76:79], v[40:43]
  ds_read_b128 a[200:203], v3 offset:2048
  v_cvt_pk_bf16_f32 v113, v130, v131
  v_mfma_f32_16x16x32_bf16 v[40:43], a[160:163], a[68:71], v[40:43]
  ds_read_b128 a[204:207], v3 offset:3072
  v_mfma_f32_16x16x32_bf16 v[48:51], a[160:163], a[96:99], v[240:243]
  v_exp_f32 v132, v68
  v_mfma_f32_16x16x32_bf16 v[48:51], a[168:171], a[104:107], v[48:51]
  s_and_b32 s65, s93, 0xffff
  s_add_u32 m0, s65, 65536
  v_exp_f32 v133, v69
  v_mfma_f32_16x16x32_bf16 v[48:51], a[176:179], a[112:115], v[48:51]
  ds_read_b128 a[208:211], v3 offset:4096
  v_cvt_pk_bf16_f32 v114, v132, v133
  v_mfma_f32_16x16x32_bf16 v[48:51], a[184:187], a[120:123], v[48:51]
  buffer_load_dwordx4 v1, s[24:27], s93 offen offset:0 sc1 lds
  v_mfma_f32_16x16x32_bf16 v[56:59], a[184:187], a[124:127], v[248:251]
  v_exp_f32 v134, v70
  v_mfma_f32_16x16x32_bf16 v[56:59], a[176:179], a[116:119], v[56:59]
  v_exp_f32 v135, v71
  v_mfma_f32_16x16x32_bf16 v[56:59], a[168:171], a[108:111], v[56:59]
  ds_read_b128 a[212:215], v3 offset:5120
  v_cvt_pk_bf16_f32 v115, v134, v135
  v_mfma_f32_16x16x32_bf16 v[56:59], a[160:163], a[100:103], v[56:59]
  buffer_load_dwordx4 v1, s[24:27], s93 offen offset:1024 sc1 lds
  v_mfma_f32_16x16x32_bf16 v[60:63], a[164:167], a[100:103], v[252:255]
  v_exp_f32 v128, v72
  v_mfma_f32_16x16x32_bf16 v[60:63], a[172:175], a[108:111], v[60:63]
  v_exp_f32 v129, v73
  v_mfma_f32_16x16x32_bf16 v[60:63], a[180:183], a[116:119], v[60:63]
  ds_read_b128 a[216:219], v3 offset:6144
  v_cvt_pk_bf16_f32 v116, v128, v129
  v_mfma_f32_16x16x32_bf16 v[60:63], a[188:191], a[124:127], v[60:63]
  buffer_load_dwordx4 v1, s[24:27], s93 offen offset:2048 sc1 lds
  v_mfma_f32_16x16x32_bf16 v[52:55], a[188:191], a[120:123], v[244:247]
  v_exp_f32 v130, v74
  v_mfma_f32_16x16x32_bf16 v[52:55], a[180:183], a[112:115], v[52:55]
  v_exp_f32 v131, v75
  v_mfma_f32_16x16x32_bf16 v[52:55], a[172:175], a[104:107], v[52:55]
  ds_read_b128 a[220:223], v3 offset:7168
  v_cvt_pk_bf16_f32 v117, v130, v131
  v_mfma_f32_16x16x32_bf16 v[52:55], a[164:167], a[96:99], v[52:55]
  buffer_load_dwordx4 v1, s[24:27], s93 offen offset:3072 sc1 lds
  v_mfma_f32_16x16x32_bf16 v[44:47], a[164:167], a[68:71], v[236:239]
  s_add_u32 s93, s93, 16384
  v_exp_f32 v132, v76
  v_mfma_f32_16x16x32_bf16 v[44:47], a[172:175], a[76:79], v[44:47]
  v_exp_f32 v133, v77
  v_mfma_f32_16x16x32_bf16 v[44:47], a[180:183], a[84:87], v[44:47]
  v_cvt_pk_bf16_f32 v118, v132, v133
  v_mfma_f32_16x16x32_bf16 v[44:47], a[188:191], a[92:95], v[44:47]
  buffer_store_dwordx4 v[180:183], v1, s[8:11], s63 offen offset:1024 sc1
  v_add_u32 v2, s88, v1
  v_mfma_f32_16x16x32_bf16 v[36:39], a[188:191], a[88:91], v[228:231]
  s_add_u32 s88, s88, 8192
  s_lshr_b32 s63, s75, 14
  s_mul_i32 s63, s63, 188416
  s_add_u32 s63, s63, s71
  v_exp_f32 v134, v78
  v_mfma_f32_16x16x32_bf16 v[36:39], a[180:183], a[80:83], v[36:39]
  s_and_b32 s88, s88, 0xffff
  v_exp_f32 v135, v79
  v_mfma_f32_16x16x32_bf16 v[36:39], a[172:175], a[72:75], v[36:39]
  v_cvt_pk_bf16_f32 v119, v134, v135
  v_mfma_f32_16x16x32_bf16 v[36:39], a[164:167], a[64:67], v[36:39]
  s_sub_u32 s3, 3, s67
  s_cmp_lt_i32 s3, 0
  s_cselect_b32 s100, s90, s91
  s_cmp_gt_i32 s3, 0
  s_cselect_b32 s101, s91, s90
  v_max_f32 v144, s100, v140
  v_max_f32 v145, s100, v141
  v_max_f32 v146, s100, v142
  s_waitcnt vmcnt(20) lgkmcnt(0)
  s_barrier
  v_mfma_f32_16x16x32_bf16 a[224:227], a[240:243], v[96:99], 0
  ds_read_b128 a[160:163], v2 offset:0
  v_max_f32 v147, s100, v143
  v_mfma_f32_16x16x32_bf16 a[228:231], a[240:243], v[100:103], 0
  ds_read_b128 a[164:167], v2 offset:1024
  v_min_f32 v244, s100, v138
  v_mfma_f32_16x16x32_bf16 a[4:7], a[192:195], v[100:103], 0
  ds_read_b128 a[168:171], v2 offset:2048
  v_min_f32 v245, s100, v138
  v_mfma_f32_16x16x32_bf16 a[0:3], a[192:195], v[96:99], 0
  ds_read_b128 a[172:175], v2 offset:3072
  v_min_f32 v246, s100, v138
  v_mfma_f32_16x16x32_bf16 a[8:11], a[196:199], v[96:99], 0
  s_add_u32 s89, s89, 8192
  buffer_store_dwordx4 v[184:187], v1, s[8:11], s63 offen offset:0 sc1
  v_exp_f32 v128, v80
  v_mfma_f32_16x16x32_bf16 a[12:15], a[196:199], v[100:103], 0
  s_and_b32 s89, s89, 0xffff
  v_exp_f32 v129, v81
  v_mfma_f32_16x16x32_bf16 a[20:23], a[200:203], v[100:103], 0
  ds_read_b128 a[176:179], v2 offset:4096
  v_cvt_pk_bf16_f32 v120, v128, v129
  v_mfma_f32_16x16x32_bf16 a[16:19], a[200:203], v[96:99], 0
  ds_read_b128 a[180:183], v2 offset:5120
  v_min_f32 v247, s100, v138
  v_mfma_f32_16x16x32_bf16 a[24:27], a[204:207], v[96:99], 0
  s_or_b32 s89, s89, 0x10000
  v_exp_f32 v130, v82
  v_mfma_f32_16x16x32_bf16 a[28:31], a[204:207], v[100:103], 0
  v_exp_f32 v131, v83
  v_mfma_f32_16x16x32_bf16 a[36:39], a[208:211], v[100:103], 0
  ds_read_b128 a[184:187], v2 offset:6144
  v_cvt_pk_bf16_f32 v121, v130, v131
  v_mfma_f32_16x16x32_bf16 a[32:35], a[208:211], v[96:99], 0
  ds_read_b128 a[188:191], v2 offset:7168
  v_min3_f32 v240, v138, v144, s101
  v_min3_f32 v241, v138, v145, s101
  v_mfma_f32_16x16x32_bf16 a[40:43], a[212:215], v[96:99], 0
  buffer_store_dwordx4 v[188:191], v1, s[8:11], s63 offen offset:1024 sc1
  v_exp_f32 v132, v84
  v_mfma_f32_16x16x32_bf16 a[44:47], a[212:215], v[100:103], 0
  s_and_b32 m0, s92, 0xffff
  v_exp_f32 v133, v85
  v_mfma_f32_16x16x32_bf16 a[52:55], a[216:219], v[100:103], 0
  v_cvt_pk_bf16_f32 v122, v132, v133
  v_min3_f32 v242, v138, v146, s101
  v_mfma_f32_16x16x32_bf16 a[48:51], a[216:219], v[96:99], 0
  buffer_load_dwordx4 v1, s[20:23], s92 offen offset:0 sc1 lds
  v_mfma_f32_16x16x32_bf16 a[56:59], a[220:223], v[96:99], 0
  v_exp_f32 v134, v86
  v_mfma_f32_16x16x32_bf16 a[60:63], a[220:223], v[100:103], 0
  v_exp_f32 v135, v87
  v_mfma_f32_16x16x32_bf16 a[232:235], a[240:243], v[104:107], 0
  v_cvt_pk_bf16_f32 v123, v134, v135
  v_min3_f32 v243, v138, v147, s101
  v_mfma_f32_16x16x32_bf16 a[236:239], a[240:243], v[108:111], 0
  buffer_load_dwordx4 v1, s[20:23], s92 offen offset:1024 sc1 lds
  v_mfma_f32_16x16x32_bf16 v[164:167], a[192:195], v[108:111], 0
  v_exp_f32 v128, v88
  v_mfma_f32_16x16x32_bf16 v[160:163], a[192:195], v[104:107], 0
  v_exp_f32 v129, v89
  v_mfma_f32_16x16x32_bf16 v[168:171], a[196:199], v[104:107], 0
  v_cvt_pk_bf16_f32 v124, v128, v129
  v_min3_f32 v252, v139, v144, s101
  v_mfma_f32_16x16x32_bf16 v[172:175], a[196:199], v[108:111], 0
  buffer_load_dwordx4 v1, s[20:23], s92 offen offset:2048 sc1 lds
  v_mfma_f32_16x16x32_bf16 v[180:183], a[200:203], v[108:111], 0
  v_exp_f32 v130, v90
  v_min3_f32 v253, v139, v145, s101
  v_mfma_f32_16x16x32_bf16 v[176:179], a[200:203], v[104:107], 0
  v_exp_f32 v131, v91
  v_mfma_f32_16x16x32_bf16 v[184:187], a[204:207], v[104:107], 0
  v_cvt_pk_bf16_f32 v125, v130, v131
  v_min3_f32 v254, v139, v146, s101
  v_mfma_f32_16x16x32_bf16 v[188:191], a[204:207], v[108:111], 0
  buffer_load_dwordx4 v1, s[20:23], s92 offen offset:3072 sc1 lds
  v_mfma_f32_16x16x32_bf16 v[196:199], a[208:211], v[108:111], 0
  s_add_u32 s92, s92, 16384
  v_exp_f32 v132, v92
  v_mfma_f32_16x16x32_bf16 v[192:195], a[208:211], v[104:107], 0
  v_exp_f32 v133, v93
  v_mfma_f32_16x16x32_bf16 v[200:203], a[212:215], v[104:107], 0
  v_cvt_pk_bf16_f32 v126, v132, v133
  v_min3_f32 v255, v139, v147, s101
  v_mfma_f32_16x16x32_bf16 v[204:207], a[212:215], v[108:111], 0
  v_add_u32 v3, s89, v1
  v_min_f32 v248, s101, v139
  v_mfma_f32_16x16x32_bf16 v[212:215], a[216:219], v[108:111], 0
  v_exp_f32 v134, v94
  v_mfma_f32_16x16x32_bf16 v[208:211], a[216:219], v[104:107], 0
  v_exp_f32 v135, v95
  v_mfma_f32_16x16x32_bf16 v[216:219], a[220:223], v[104:107], 0
  v_cvt_pk_bf16_f32 v127, v134, v135
  v_min_f32 v249, s101, v139
  v_mfma_f32_16x16x32_bf16 v[220:223], a[220:223], v[108:111], 0
  v_min_f32 v250, s101, v139
  v_min_f32 v251, s101, v139
  s_cmp_lt_i32 s87, 2
  s_cbranch_scc1 LZ4
  s_cmp_eq_u32 s87, 2
  s_cbranch_scc1 LZ0
.p2align 5
LA:
  s_waitcnt lgkmcnt(0)
  v_mfma_f32_16x16x32_bf16 v[64:67], a[160:163], a[64:67], v[224:227]
  s_cmp_ge_u32 s86, 10
  v_exp_f32 v128, v32
  v_mfma_f32_16x16x32_bf16 v[64:67], a[168:171], a[72:75], v[64:67]
  s_cselect_b32 s63, 0xff00, 0
  v_exp_f32 v129, v33
  v_mfma_f32_16x16x32_bf16 v[64:67], a[176:179], a[80:83], v[64:67]
  ds_read_b128 a[192:195], v3 offset:0
  v_cvt_pk_bf16_f32 v96, v128, v129
  v_mfma_f32_16x16x32_bf16 v[64:67], a[184:187], a[88:91], v[64:67]
  ds_read_b128 a[196:199], v3 offset:1024
  v_cmp_eq_u32 vcc, 0, v25
  v_mfma_f32_16x16x32_bf16 v[72:75], a[184:187], a[92:95], v[232:235]
  s_add_u32 s86, s86, 4
  v_exp_f32 v130, v34
  v_mfma_f32_16x16x32_bf16 v[72:75], a[176:179], a[84:87], v[72:75]
  s_and_b32 s63, vcc_lo, s63
  v_exp_f32 v131, v35
  s_cbranch_scc1 Lslow_A0
Lback_A0:
  v_mfma_f32_16x16x32_bf16 v[72:75], a[168:171], a[76:79], v[72:75]
  ds_read_b128 a[200:203], v3 offset:2048
  v_cvt_pk_bf16_f32 v97, v130, v131
  v_mfma_f32_16x16x32_bf16 v[72:75], a[160:163], a[68:71], v[72:75]
  ds_read_b128 a[204:207], v3 offset:3072
  v_mfma_f32_16x16x32_bf16 v[80:83], a[160:163], a[96:99], v[240:243]
  v_exp_f32 v132, v36
  v_mfma_f32_16x16x32_bf16 v[80:83], a[168:171], a[104:107], v[80:83]
  v_exp_f32 v133, v37
  v_mfma_f32_16x16x32_bf16 v[80:83], a[176:179], a[112:115], v[80:83]
  ds_read_b128 a[208:211], v3 offset:4096
  v_cvt_pk_bf16_f32 v98, v132, v133
  v_mfma_f32_16x16x32_bf16 v[80:83], a[184:187], a[120:123], v[80:83]
  v_mfma_f32_16x16x32_bf16 v[88:91], a[184:187], a[124:127], v[248:251]
  v_exp_f32 v134, v38
  v_mfma_f32_16x16x32_bf16 v[88:91], a[176:179], a[116:119], v[88:91]
  v_exp_f32 v135, v39
  v_mfma_f32_16x16x32_bf16 v[88:91], a[168:171], a[108:111], v[88:91]
  ds_read_b128 a[212:215], v3 offset:5120
  v_cvt_pk_bf16_f32 v99, v134, v135
  v_mfma_f32_16x16x32_bf16 v[88:91], a[160:163], a[100:103], v[88:91]
  v_mfma_f32_16x16x32_bf16 v[92:95], a[164:167], a[100:103], v[252:255]
  v_exp_f32 v128, v40
  v_mfma_f32_16x16x32_bf16 v[92:95], a[172:175], a[108:111], v[92:95]
  v_exp_f32 v129, v41
  v_mfma_f32_16x16x32_bf16 v[92:95], a[180:183], a[116:119], v[92:95]
  ds_read_b128 a[216:219], v3 offset:6144
  v_cvt_pk_bf16_f32 v100, v128, v129
  v_mfma_f32_16x16x32_bf16 v[92:95], a[188:191], a[124:127], v[92:95]
  v_mfma_f32_16x16x32_bf16 v[84:87], a[188:191], a[120:123], v[244:247]
  v_exp_f32 v130, v42
  v_mfma_f32_16x16x32_bf16 v[84:87], a[180:183], a[112:115], v[84:87]
  v_exp_f32 v131, v43
  v_mfma_f32_16x16x32_bf16 v[84:87], a[172:175], a[104:107], v[84:87]
  ds_read_b128 a[220:223], v3 offset:7168
  v_cvt_pk_bf16_f32 v101, v130, v131
  v_mfma_f32_16x16x32_bf16 v[84:87], a[164:167], a[96:99], v[84:87]
  v_mfma_f32_16x16x32_bf16 v[76:79], a[164:167], a[68:71], v[236:239]
  v_exp_f32 v132, v44
  v_mfma_f32_16x16x32_bf16 v[76:79], a[172:175], a[76:79], v[76:79]
  v_exp_f32 v133, v45
  v_mfma_f32_16x16x32_bf16 v[76:79], a[180:183], a[84:87], v[76:79]
  v_cvt_pk_bf16_f32 v102, v132, v133
  v_mfma_f32_16x16x32_bf16 v[76:79], a[188:191], a[92:95], v[76:79]
  v_add_u32 v2, s88, v1
  v_mfma_f32_16x16x32_bf16 v[68:71], a[188:191], a[88:91], v[228:231]
  s_add_u32 s88, s88, 8192
  v_exp_f32 v134, v46
  v_mfma_f32_16x16x32_bf16 v[68:71], a[180:183], a[80:83], v[68:71]
  s_and_b32 s88, s88, 0xffff
  v_exp_f32 v135, v47
  v_mfma_f32_16x16x32_bf16 v[68:71], a[172:175], a[72:75], v[68:71]
  v_cvt_pk_bf16_f32 v103, v134, v135
  v_mfma_f32_16x16x32_bf16 v[68:71], a[164:167], a[64:67], v[68:71]
  s_waitcnt vmcnt(16) lgkmcnt(0)
  s_barrier
  v_mfma_f32_16x16x32_bf16 a[224:227], a[240:243], v[112:115], a[224:227]
  ds_read_b128 a[160:163], v2 offset:0
  v_mfma_f32_16x16x32_bf16 a[228:231], a[240:243], v[116:119], a[228:231]
  ds_read_b128 a[164:167], v2 offset:1024
  v_mfma_f32_16x16x32_bf16 a[232:235], a[240:243], v[120:123], a[232:235]
  ds_read_b128 a[168:171], v2 offset:2048
  v_mfma_f32_16x16x32_bf16 a[236:239], a[240:243], v[124:127], a[236:239]
  ds_read_b128 a[172:175], v2 offset:3072
  v_mfma_f32_16x16x32_bf16 v[164:167], a[192:195], v[124:127], v[164:167]
  s_add_u32 s89, s89, 8192
  v_exp_f32 v128, v48
  v_mfma_f32_16x16x32_bf16 v[160:163], a[192:195], v[120:123], v[160:163]
  s_and_b32 s89, s89, 0xffff
  v_exp_f32 v129, v49
  v_mfma_f32_16x16x32_bf16 a[4:7], a[192:195], v[116:119], a[4:7]
  ds_read_b128 a[176:179], v2 offset:4096
  v_cvt_pk_bf16_f32 v104, v128, v129
  v_mfma_f32_16x16x32_bf16 a[0:3], a[192:195], v[112:115], a[0:3]
  ds_read_b128 a[180:183], v2 offset:5120
  v_mfma_f32_16x16x32_bf16 a[8:11], a[196:199], v[112:115], a[8:11]
  s_or_b32 s89, s89, 0x10000
  v_exp_f32 v130, v50
  v_mfma_f32_16x16x32_bf16 a[12:15], a[196:199], v[116:119], a[12:15]
  v_exp_f32 v131, v51
  v_mfma_f32_16x16x32_bf16 v[168:171], a[196:199], v[120:123], v[168:171]
  ds_read_b128 a[184:187], v2 offset:6144
  v_cvt_pk_bf16_f32 v105, v130, v131
  v_mfma_f32_16x16x32_bf16 v[172:175], a[196:199], v[124:127], v[172:175]
  ds_read_b128 a[188:191], v2 offset:7168
  v_mfma_f32_16x16x32_bf16 v[180:183], a[200:203], v[124:127], v[180:183]
  v_exp_f32 v132, v52
  v_mfma_f32_16x16x32_bf16 v[176:179], a[200:203], v[120:123], v[176:179]
  s_and_b32 m0, s92, 0xffff
  v_exp_f32 v133, v53
  v_mfma_f32_16x16x32_bf16 a[20:23], a[200:203], v[116:119], a[20:23]
  v_cvt_pk_bf16_f32 v106, v132, v133
  v_mfma_f32_16x16x32_bf16 a[16:19], a[200:203], v[112:115], a[16:19]
  buffer_load_dwordx4 v1, s[20:23], s92 offen offset:0 sc1 lds
  v_mfma_f32_16x16x32_bf16 a[24:27], a[204:207], v[112:115], a[24:27]
  v_exp_f32 v134, v54
  v_mfma_f32_16x16x32_bf16 a[28:31], a[204:207], v[116:119], a[28:31]
  v_exp_f32 v135, v55
  v_mfma_f32_16x16x32_bf16 v[184:187], a[204:207], v[120:123], v[184:187]
  v_cvt_pk_bf16_f32 v107, v134, v135
  v_mfma_f32_16x16x32_bf16 v[188:191], a[204:207], v[124:127], v[188:191]
  buffer_load_dwordx4 v1, s[20:23], s92 offen offset:1024 sc1 lds
  v_mfma_f32_16x16x32_bf16 v[196:199], a[208:211], v[124:127], v[196:199]
  v_exp_f32 v128, v56
  v_mfma_f32_16x16x32_bf16 v[192:195], a[208:211], v[120:123], v[192:195]
  v_exp_f32 v129, v57
  v_mfma_f32_16x16x32_bf16 a[36:39], a[208:211], v[116:119], a[36:39]
  v_cvt_pk_bf16_f32 v108, v128, v129
  v_mfma_f32_16x16x32_bf16 a[32:35], a[208:211], v[112:115], a[32:35]
  buffer_load_dwordx4 v1, s[20:23], s92 offen offset:2048 sc1 lds
  v_mfma_f32_16x16x32_bf16 a[40:43], a[212:215], v[112:115], a[40:43]
  v_exp_f32 v130, v58
  v_mfma_f32_16x16x32_bf16 a[44:47], a[212:215], v[116:119], a[44:47]
  v_exp_f32 v131, v59
  v_mfma_f32_16x16x32_bf16 v[200:203], a[212:215], v[120:123], v[200:203]
  v_cvt_pk_bf16_f32 v109, v130, v131
  v_mfma_f32_16x16x32_bf16 v[204:207], a[212:215], v[124:127], v[204:207]
  buffer_load_dwordx4 v1, s[20:23], s92 offen offset:3072 sc1 lds
  v_mfma_f32_16x16x32_bf16 v[212:215], a[216:219], v[124:127], v[212:215]
  s_add_u32 s92, s92, 16384
  v_exp_f32 v132, v60
  v_mfma_f32_16x16x32_bf16 v[208:211], a[216:219], v[120:123], v[208:211]
  v_exp_f32 v133, v61
  v_mfma_f32_16x16x32_bf16 a[52:55], a[216:219], v[116:119], a[52:55]
  v_cvt_pk_bf16_f32 v110, v132, v133
  v_mfma_f32_16x16x32_bf16 a[48:51], a[216:219], v[112:115], a[48:51]
  v_add_u32 v3, s89, v1
  v_mfma_f32_16x16x32_bf16 a[56:59], a[220:223], v[112:115], a[56:59]
  v_exp_f32 v134, v62
  v_mfma_f32_16x16x32_bf16 a[60:63], a[220:223], v[116:119], a[60:63]
  v_exp_f32 v135, v63
  v_mfma_f32_16x16x32_bf16 v[216:219], a[220:223], v[120:123], v[216:219]
  v_cvt_pk_bf16_f32 v111, v134, v135
  v_mfma_f32_16x16x32_bf16 v[220:223], a[220:223], v[124:127], v[220:223]
  buffer_load_dword v25, v0, s[40:43], s66 offen sc1
  s_waitcnt lgkmcnt(0)
  v_mfma_f32_16x16x32_bf16 v[32:35], a[160:163], a[64:67], v[224:227]
  v_exp_f32 v128, v64
  v_mfma_f32_16x16x32_bf16 v[32:35], a[168:171], a[72:75], v[32:35]
  v_exp_f32 v129, v65
  v_mfma_f32_16x16x32_bf16 v[32:35], a[176:179], a[80:83], v[32:35]
  ds_read_b128 a[192:195], v3 offset:0
  v_cvt_pk_bf16_f32 v112, v128, v129
  v_mfma_f32_16x16x32_bf16 v[32:35], a[184:187], a[88:91], v[32:35]
  ds_read_b128 a[196:199], v3 offset:1024
  v_mfma_f32_16x16x32_bf16 v[40:43], a[184:187], a[92:95], v[232:235]
  v_exp_f32 v130, v66
  v_mfma_f32_16x16x32_bf16 v[40:43], a[176:179], a[84:87], v[40:43]
  v_exp_f32 v131, v67
  v_mfma_f32_16x16x32_bf16 v[40:43], a[168:171], a[76:79], v[40:43]
  ds_read_b128 a[200:203], v3 offset:2048
  v_cvt_pk_bf16_f32 v113, v130, v131
  v_mfma_f32_16x16x32_bf16 v[40:43], a[160:163], a[68:71], v[40:43]
  ds_read_b128 a[204:207], v3 offset:3072
  v_mfma_f32_16x16x32_bf16 v[48:51], a[160:163], a[96:99], v[240:243]
  v_exp_f32 v132, v68
  v_mfma_f32_16x16x32_bf16 v[48:51], a[168:171], a[104:107], v[48:51]
  s_and_b32 s65, s93, 0xffff
  s_add_u32 m0, s65, 65536
  v_exp_f32 v133, v69
  v_mfma_f32_16x16x32_bf16 v[48:51], a[176:179], a[112:115], v[48:51]
  ds_read_b128 a[208:211], v3 offset:4096
  v_cvt_pk_bf16_f32 v114, v132, v133
  v_mfma_f32_16x16x32_bf16 v[48:51], a[184:187], a[120:123], v[48:51]
  buffer_load_dwordx4 v1, s[24:27], s93 offen offset:0 sc1 lds
  v_mfma_f32_16x16x32_bf16 v[56:59], a[184:187], a[124:127], v[248:251]
  v_exp_f32 v134, v70
  v_mfma_f32_16x16x32_bf16 v[56:59], a[176:179], a[116:119], v[56:59]
  v_exp_f32 v135, v71
  v_mfma_f32_16x16x32_bf16 v[56:59], a[168:171], a[108:111], v[56:59]
  ds_read_b128 a[212:215], v3 offset:5120
  v_cvt_pk_bf16_f32 v115, v134, v135
  v_mfma_f32_16x16x32_bf16 v[56:59], a[160:163], a[100:103], v[56:59]
  buffer_load_dwordx4 v1, s[24:27], s93 offen offset:1024 sc1 lds
  v_mfma_f32_16x16x32_bf16 v[60:63], a[164:167], a[100:103], v[252:255]
  v_exp_f32 v128, v72
  v_mfma_f32_16x16x32_bf16 v[60:63], a[172:175], a[108:111], v[60:63]
  v_exp_f32 v129, v73
  v_mfma_f32_16x16x32_bf16 v[60:63], a[180:183], a[116:119], v[60:63]
  ds_read_b128 a[216:219], v3 offset:6144
  v_cvt_pk_bf16_f32 v116, v128, v129
  v_mfma_f32_16x16x32_bf16 v[60:63], a[188:191], a[124:127], v[60:63]
  buffer_load_dwordx4 v1, s[24:27], s93 offen offset:2048 sc1 lds
  v_mfma_f32_16x16x32_bf16 v[52:55], a[188:191], a[120:123], v[244:247]
  v_exp_f32 v130, v74
  v_mfma_f32_16x16x32_bf16 v[52:55], a[180:183], a[112:115], v[52:55]
  v_exp_f32 v131, v75
  v_mfma_f32_16x16x32_bf16 v[52:55], a[172:175], a[104:107], v[52:55]
  ds_read_b128 a[220:223], v3 offset:7168
  v_cvt_pk_bf16_f32 v117, v130, v131
  v_mfma_f32_16x16x32_bf16 v[52:55], a[164:167], a[96:99], v[52:55]
  buffer_load_dwordx4 v1, s[24:27], s93 offen offset:3072 sc1 lds
  v_mfma_f32_16x16x32_bf16 v[44:47], a[164:167], a[68:71], v[236:239]
  s_add_u32 s93, s93, 16384
  v_exp_f32 v132, v76
  v_mfma_f32_16x16x32_bf16 v[44:47], a[172:175], a[76:79], v[44:47]
  v_exp_f32 v133, v77
  v_mfma_f32_16x16x32_bf16 v[44:47], a[180:183], a[84:87], v[44:47]
  v_cvt_pk_bf16_f32 v118, v132, v133
  v_mfma_f32_16x16x32_bf16 v[44:47], a[188:191], a[92:95], v[44:47]
  v_add_u32 v2, s88, v1
  v_mfma_f32_16x16x32_bf16 v[36:39], a[188:191], a[88:91], v[228:231]
  s_add_u32 s88, s88, 8192
  v_exp_f32 v134, v78
  v_mfma_f32_16x16x32_bf16 v[36:39], a[180:183], a[80:83], v[36:39]
  s_and_b32 s88, s88, 0xffff
  v_exp_f32 v135, v79
  v_mfma_f32_16x16x32_bf16 v[36:39], a[172:175], a[72:75], v[36:39]
  v_cvt_pk_bf16_f32 v119, v134, v135
  v_mfma_f32_16x16x32_bf16 v[36:39], a[164:167], a[64:67], v[36:39]
  s_waitcnt vmcnt(20) lgkmcnt(0)
  s_barrier
  v_mfma_f32_16x16x32_bf16 a[224:227], a[240:243], v[96:99], a[224:227]
  ds_read_b128 a[160:163], v2 offset:0
  v_mfma_f32_16x16x32_bf16 a[228:231], a[240:243], v[100:103], a[228:231]
  ds_read_b128 a[164:167], v2 offset:1024
  v_mfma_f32_16x16x32_bf16 a[232:235], a[240:243], v[104:107], a[232:235]
  ds_read_b128 a[168:171], v2 offset:2048
  v_mfma_f32_16x16x32_bf16 a[236:239], a[240:243], v[108:111], a[236:239]
  ds_read_b128 a[172:175], v2 offset:3072
  v_mfma_f32_16x16x32_bf16 v[164:167], a[192:195], v[108:111], v[164:167]
  s_add_u32 s89, s89, 8192
  v_exp_f32 v128, v80
  v_mfma_f32_16x16x32_bf16 v[160:163], a[192:195], v[104:107], v[160:163]
  s_and_b32 s89, s89, 0xffff
  v_exp_f32 v129, v81
  v_mfma_f32_16x16x32_bf16 a[4:7], a[192:195], v[100:103], a[4:7]
  ds_read_b128 a[176:179], v2 offset:4096
  v_cvt_pk_bf16_f32 v120, v128, v129
  v_mfma_f32_16x16x32_bf16 a[0:3], a[192:195], v[96:99], a[0:3]
  ds_read_b128 a[180:183], v2 offset:5120
  v_mfma_f32_16x16x32_bf16 a[8:11], a[196:199], v[96:99], a[8:11]
  s_or_b32 s89, s89, 0x10000
  v_exp_f32 v130, v82
  v_mfma_f32_16x16x32_bf16 a[12:15], a[196:199], v[100:103], a[12:15]
  v_exp_f32 v131, v83
  v_mfma_f32_16x16x32_bf16 v[168:171], a[196:199], v[104:107], v[168:171]
  ds_read_b128 a[184:187], v2 offset:6144
  v_cvt_pk_bf16_f32 v121, v130, v131
  v_mfma_f32_16x16x32_bf16 v[172:175], a[196:199], v[108:111], v[172:175]
  ds_read_b128 a[188:191], v2 offset:7168
  v_mfma_f32_16x16x32_bf16 v[180:183], a[200:203], v[108:111], v[180:183]
  v_exp_f32 v132, v84
  v_mfma_f32_16x16x32_bf16 v[176:179], a[200:203], v[104:107], v[176:179]
  v_exp_f32 v133, v85
  v_mfma_f32_16x16x32_bf16 a[20:23], a[200:203], v[100:103], a[20:23]
  v_cvt_pk_bf16_f32 v122, v132, v133
  v_mfma_f32_16x16x32_bf16 a[16:19], a[200:203], v[96:99], a[16:19]
  v_mfma_f32_16x16x32_bf16 a[24:27], a[204:207], v[96:99], a[24:27]
  v_exp_f32 v134, v86
  v_mfma_f32_16x16x32_bf16 a[28:31], a[204:207], v[100:103], a[28:31]
  v_exp_f32 v135, v87
  v_mfma_f32_16x16x32_bf16 v[184:187], a[204:207], v[104:107], v[184:187]
  v_cvt_pk_bf16_f32 v123, v134, v135
  v_mfma_f32_16x16x32_bf16 v[188:191], a[204:207], v[108:111], v[188:191]
  v_mfma_f32_16x16x32_bf16 v[196:199], a[208:211], v[108:111], v[196:199]
  v_exp_f32 v128, v88
  v_mfma_f32_16x16x32_bf16 v[192:195], a[208:211], v[104:107], v[192:195]
  v_exp_f32 v129, v89
  v_mfma_f32_16x16x32_bf16 a[36:39], a[208:211], v[100:103], a[36:39]
  v_cvt_pk_bf16_f32 v124, v128, v129
  v_mfma_f32_16x16x32_bf16 a[32:35], a[208:211], v[96:99], a[32:35]
  v_mfma_f32_16x16x32_bf16 a[40:43], a[212:215], v[96:99], a[40:43]
  v_exp_f32 v130, v90
  v_mfma_f32_16x16x32_bf16 a[44:47], a[212:215], v[100:103], a[44:47]
  v_exp_f32 v131, v91
  v_mfma_f32_16x16x32_bf16 v[200:203], a[212:215], v[104:107], v[200:203]
  v_cvt_pk_bf16_f32 v125, v130, v131
  v_mfma_f32_16x16x32_bf16 v[204:207], a[212:215], v[108:111], v[204:207]
  v_mfma_f32_16x16x32_bf16 v[212:215], a[216:219], v[108:111], v[212:215]
  v_exp_f32 v132, v92
  v_mfma_f32_16x16x32_bf16 v[208:211], a[216:219], v[104:107], v[208:211]
  v_exp_f32 v133, v93
  v_mfma_f32_16x16x32_bf16 a[52:55], a[216:219], v[100:103], a[52:55]
  v_cvt_pk_bf16_f32 v126, v132, v133
  v_mfma_f32_16x16x32_bf16 a[48:51], a[216:219], v[96:99], a[48:51]
  v_add_u32 v3, s89, v1
  v_mfma_f32_16x16x32_bf16 a[56:59], a[220:223], v[96:99], a[56:59]
  v_exp_f32 v134, v94
  v_mfma_f32_16x16x32_bf16 a[60:63], a[220:223], v[100:103], a[60:63]
  v_exp_f32 v135, v95
  v_mfma_f32_16x16x32_bf16 v[216:219], a[220:223], v[104:107], v[216:219]
  v_cvt_pk_bf16_f32 v127, v134, v135
  v_mfma_f32_16x16x32_bf16 v[220:223], a[220:223], v[108:111], v[220:223]
  s_waitcnt lgkmcnt(0)
  v_mfma_f32_16x16x32_bf16 v[64:67], a[160:163], a[64:67], v[224:227]
  v_exp_f32 v128, v32
  v_mfma_f32_16x16x32_bf16 v[64:67], a[168:171], a[72:75], v[64:67]
  v_exp_f32 v129, v33
  v_mfma_f32_16x16x32_bf16 v[64:67], a[176:179], a[80:83], v[64:67]
  ds_read_b128 a[192:195], v3 offset:0
  v_cvt_pk_bf16_f32 v96, v128, v129
  v_mfma_f32_16x16x32_bf16 v[64:67], a[184:187], a[88:91], v[64:67]
  ds_read_b128 a[196:199], v3 offset:1024
  v_mfma_f32_16x16x32_bf16 v[72:75], a[184:187], a[92:95], v[232:235]
  v_exp_f32 v130, v34
  v_mfma_f32_16x16x32_bf16 v[72:75], a[176:179], a[84:87], v[72:75]
  v_exp_f32 v131, v35
  v_mfma_f32_16x16x32_bf16 v[72:75], a[168:171], a[76:79], v[72:75]
  ds_read_b128 a[200:203], v3 offset:2048
  v_cvt_pk_bf16_f32 v97, v130, v131
  v_mfma_f32_16x16x32_bf16 v[72:75], a[160:163], a[68:71], v[72:75]
  ds_read_b128 a[204:207], v3 offset:3072
  v_mfma_f32_16x16x32_bf16 v[80:83], a[160:163], a[96:99], v[240:243]
  v_exp_f32 v132, v36
  v_mfma_f32_16x16x32_bf16 v[80:83], a[168:171], a[104:107], v[80:83]
  v_exp_f32 v133, v37
  v_mfma_f32_16x16x32_bf16 v[80:83], a[176:179], a[112:115], v[80:83]
  ds_read_b128 a[208:211], v3 offset:4096
  v_cvt_pk_bf16_f32 v98, v132, v133
  v_mfma_f32_16x16x32_bf16 v[80:83], a[184:187], a[120:123], v[80:83]
  v_mfma_f32_16x16x32_bf16 v[88:91], a[184:187], a[124:127], v[248:251]
  v_exp_f32 v134, v38
  v_mfma_f32_16x16x32_bf16 v[88:91], a[176:179], a[116:119], v[88:91]
  v_exp_f32 v135, v39
  v_mfma_f32_16x16x32_bf16 v[88:91], a[168:171], a[108:111], v[88:91]
  ds_read_b128 a[212:215], v3 offset:5120
  v_cvt_pk_bf16_f32 v99, v134, v135
  v_mfma_f32_16x16x32_bf16 v[88:91], a[160:163], a[100:103], v[88:91]
  v_mfma_f32_16x16x32_bf16 v[92:95], a[164:167], a[100:103], v[252:255]
  v_exp_f32 v128, v40
  v_mfma_f32_16x16x32_bf16 v[92:95], a[172:175], a[108:111], v[92:95]
  v_exp_f32 v129, v41
  v_mfma_f32_16x16x32_bf16 v[92:95], a[180:183], a[116:119], v[92:95]
  ds_read_b128 a[216:219], v3 offset:6144
  v_cvt_pk_bf16_f32 v100, v128, v129
  v_mfma_f32_16x16x32_bf16 v[92:95], a[188:191], a[124:127], v[92:95]
  v_mfma_f32_16x16x32_bf16 v[84:87], a[188:191], a[120:123], v[244:247]
  v_exp_f32 v130, v42
  v_mfma_f32_16x16x32_bf16 v[84:87], a[180:183], a[112:115], v[84:87]
  v_exp_f32 v131, v43
  v_mfma_f32_16x16x32_bf16 v[84:87], a[172:175], a[104:107], v[84:87]
  ds_read_b128 a[220:223], v3 offset:7168
  v_cvt_pk_bf16_f32 v101, v130, v131
  v_mfma_f32_16x16x32_bf16 v[84:87], a[164:167], a[96:99], v[84:87]
  v_mfma_f32_16x16x32_bf16 v[76:79], a[164:167], a[68:71], v[236:239]
  v_exp_f32 v132, v44
  v_mfma_f32_16x16x32_bf16 v[76:79], a[172:175], a[76:79], v[76:79]
  v_exp_f32 v133, v45
  v_mfma_f32_16x16x32_bf16 v[76:79], a[180:183], a[84:87], v[76:79]
  v_cvt_pk_bf16_f32 v102, v132, v133
  v_mfma_f32_16x16x32_bf16 v[76:79], a[188:191], a[92:95], v[76:79]
  v_add_u32 v2, s88, v1
  v_mfma_f32_16x16x32_bf16 v[68:71], a[188:191], a[88:91], v[228:231]
  s_add_u32 s88, s88, 8192
  v_exp_f32 v134, v46
  v_mfma_f32_16x16x32_bf16 v[68:71], a[180:183], a[80:83], v[68:71]
  s_and_b32 s88, s88, 0xffff
  v_exp_f32 v135, v47
  v_mfma_f32_16x16x32_bf16 v[68:71], a[172:175], a[72:75], v[68:71]
  v_cvt_pk_bf16_f32 v103, v134, v135
  v_mfma_f32_16x16x32_bf16 v[68:71], a[164:167], a[64:67], v[68:71]
  s_waitcnt vmcnt(17) lgkmcnt(0)
  s_barrier
  v_mfma_f32_16x16x32_bf16 a[224:227], a[240:243], v[112:115], a[224:227]
  ds_read_b128 a[160:163], v2 offset:0
  v_mfma_f32_16x16x32_bf16 a[228:231], a[240:243], v[116:119], a[228:231]
  ds_read_b128 a[164:167], v2 offset:1024
  v_mfma_f32_16x16x32_bf16 a[232:235], a[240:243], v[120:123], a[232:235]
  ds_read_b128 a[168:171], v2 offset:2048
  v_mfma_f32_16x16x32_bf16 a[236:239], a[240:243], v[124:127], a[236:239]
  ds_read_b128 a[172:175], v2 offset:3072
  v_mfma_f32_16x16x32_bf16 v[164:167], a[192:195], v[124:127], v[164:167]
  s_add_u32 s89, s89, 8192
  v_exp_f32 v128, v48
  v_mfma_f32_16x16x32_bf16 v[160:163], a[192:195], v[120:123], v[160:163]
  s_and_b32 s89, s89, 0xffff
  v_exp_f32 v129, v49
  v_mfma_f32_16x16x32_bf16 a[4:7], a[192:195], v[116:119], a[4:7]
  ds_read_b128 a[176:179], v2 offset:4096
  v_cvt_pk_bf16_f32 v104, v128, v129
  v_mfma_f32_16x16x32_bf16 a[0:3], a[192:195], v[112:115], a[0:3]
  ds_read_b128 a[180:183], v2 offset:5120
  v_mfma_f32_16x16x32_bf16 a[8:11], a[196:199], v[112:115], a[8:11]
  s_or_b32 s89, s89, 0x10000
  v_exp_f32 v130, v50
  v_mfma_f32_16x16x32_bf16 a[12:15], a[196:199], v[116:119], a[12:15]
  v_exp_f32 v131, v51
  v_mfma_f32_16x16x32_bf16 v[168:171], a[196:199], v[120:123], v[168:171]
  ds_read_b128 a[184:187], v2 offset:6144
  v_cvt_pk_bf16_f32 v105, v130, v131
  v_mfma_f32_16x16x32_bf16 v[172:175], a[196:199], v[124:127], v[172:175]
  ds_read_b128 a[188:191], v2 offset:7168
  v_mfma_f32_16x16x32_bf16 v[180:183], a[200:203], v[124:127], v[180:183]
  v_exp_f32 v132, v52
  v_mfma_f32_16x16x32_bf16 v[176:179], a[200:203], v[120:123], v[176:179]
  s_and_b32 m0, s92, 0xffff
  v_exp_f32 v133, v53
  v_mfma_f32_16x16x32_bf16 a[20:23], a[200:203], v[116:119], a[20:23]
  v_cvt_pk_bf16_f32 v106, v132, v133
  v_mfma_f32_16x16x32_bf16 a[16:19], a[200:203], v[112:115], a[16:19]
  buffer_load_dwordx4 v1, s[20:23], s92 offen offset:0 sc1 lds
  v_mfma_f32_16x16x32_bf16 a[24:27], a[204:207], v[112:115], a[24:27]
  v_exp_f32 v134, v54
  v_mfma_f32_16x16x32_bf16 a[28:31], a[204:207], v[116:119], a[28:31]
  v_exp_f32 v135, v55
  v_mfma_f32_16x16x32_bf16 v[184:187], a[204:207], v[120:123], v[184:187]
  v_cvt_pk_bf16_f32 v107, v134, v135
  v_mfma_f32_16x16x32_bf16 v[188:191], a[204:207], v[124:127], v[188:191]
  buffer_load_dwordx4 v1, s[20:23], s92 offen offset:1024 sc1 lds
  v_mfma_f32_16x16x32_bf16 v[196:199], a[208:211], v[124:127], v[196:199]
  v_exp_f32 v128, v56
  v_mfma_f32_16x16x32_bf16 v[192:195], a[208:211], v[120:123], v[192:195]
  v_exp_f32 v129, v57
  v_mfma_f32_16x16x32_bf16 a[36:39], a[208:211], v[116:119], a[36:39]
  v_cvt_pk_bf16_f32 v108, v128, v129
  v_mfma_f32_16x16x32_bf16 a[32:35], a[208:211], v[112:115], a[32:35]
  buffer_load_dwordx4 v1, s[20:23], s92 offen offset:2048 sc1 lds
  v_mfma_f32_16x16x32_bf16 a[40:43], a[212:215], v[112:115], a[40:43]
  v_exp_f32 v130, v58
  v_mfma_f32_16x16x32_bf16 a[44:47], a[212:215], v[116:119], a[44:47]
  v_exp_f32 v131, v59
  v_mfma_f32_16x16x32_bf16 v[200:203], a[212:215], v[120:123], v[200:203]
  v_cvt_pk_bf16_f32 v109, v130, v131
  v_mfma_f32_16x16x32_bf16 v[204:207], a[212:215], v[124:127], v[204:207]
  buffer_load_dwordx4 v1, s[20:23], s92 offen offset:3072 sc1 lds
  v_mfma_f32_16x16x32_bf16 v[212:215], a[216:219], v[124:127], v[212:215]
  s_add_u32 s92, s92, 16384
  v_exp_f32 v132, v60
  v_mfma_f32_16x16x32_bf16 v[208:211], a[216:219], v[120:123], v[208:211]
  v_exp_f32 v133, v61
  v_mfma_f32_16x16x32_bf16 a[52:55], a[216:219], v[116:119], a[52:55]
  v_cvt_pk_bf16_f32 v110, v132, v133
  v_mfma_f32_16x16x32_bf16 a[48:51], a[216:219], v[112:115], a[48:51]
  v_add_u32 v3, s89, v1
  v_mfma_f32_16x16x32_bf16 a[56:59], a[220:223], v[112:115], a[56:59]
  v_exp_f32 v134, v62
  v_mfma_f32_16x16x32_bf16 a[60:63], a[220:223], v[116:119], a[60:63]
  v_exp_f32 v135, v63
  v_mfma_f32_16x16x32_bf16 v[216:219], a[220:223], v[120:123], v[216:219]
  v_cvt_pk_bf16_f32 v111, v134, v135
  v_mfma_f32_16x16x32_bf16 v[220:223], a[220:223], v[124:127], v[220:223]
  s_waitcnt lgkmcnt(0)
  v_mfma_f32_16x16x32_bf16 v[32:35], a[160:163], a[64:67], v[224:227]
  v_exp_f32 v128, v64
  v_mfma_f32_16x16x32_bf16 v[32:35], a[168:171], a[72:75], v[32:35]
  v_exp_f32 v129, v65
  v_mfma_f32_16x16x32_bf16 v[32:35], a[176:179], a[80:83], v[32:35]
  ds_read_b128 a[192:195], v3 offset:0
  v_cvt_pk_bf16_f32 v112, v128, v129
  v_mfma_f32_16x16x32_bf16 v[32:35], a[184:187], a[88:91], v[32:35]
  ds_read_b128 a[196:199], v3 offset:1024
  v_mfma_f32_16x16x32_bf16 v[40:43], a[184:187], a[92:95], v[232:235]
  v_exp_f32 v130, v66
  v_mfma_f32_16x16x32_bf16 v[40:43], a[176:179], a[84:87], v[40:43]
  v_exp_f32 v131, v67
  v_mfma_f32_16x16x32_bf16 v[40:43], a[168:171], a[76:79], v[40:43]
  ds_read_b128 a[200:203], v3 offset:2048
  v_cvt_pk_bf16_f32 v113, v130, v131
  v_mfma_f32_16x16x32_bf16 v[40:43], a[160:163], a[68:71], v[40:43]
  ds_read_b128 a[204:207], v3 offset:3072
  v_mfma_f32_16x16x32_bf16 v[48:51], a[160:163], a[96:99], v[240:243]
  v_exp_f32 v132, v68
  v_mfma_f32_16x16x32_bf16 v[48:51], a[168:171], a[104:107], v[48:51]
  s_and_b32 s65, s93, 0xffff
  s_add_u32 m0, s65, 65536
  v_exp_f32 v133, v69
  v_mfma_f32_16x16x32_bf16 v[48:51], a[176:179], a[112:115], v[48:51]
  ds_read_b128 a[208:211], v3 offset:4096
  v_cvt_pk_bf16_f32 v114, v132, v133
  v_mfma_f32_16x16x32_bf16 v[48:51], a[184:187], a[120:123], v[48:51]
  buffer_load_dwordx4 v1, s[24:27], s93 offen offset:0 sc1 lds
  v_mfma_f32_16x16x32_bf16 v[56:59], a[184:187], a[124:127], v[248:251]
  v_exp_f32 v134, v70
  v_mfma_f32_16x16x32_bf16 v[56:59], a[176:179], a[116:119], v[56:59]
  v_exp_f32 v135, v71
  v_mfma_f32_16x16x32_bf16 v[56:59], a[168:171], a[108:111], v[56:59]
  ds_read_b128 a[212:215], v3 offset:5120
  v_cvt_pk_bf16_f32 v115, v134, v135
  v_mfma_f32_16x16x32_bf16 v[56:59], a[160:163], a[100:103], v[56:59]
  buffer_load_dwordx4 v1, s[24:27], s93 offen offset:1024 sc1 lds
  v_mfma_f32_16x16x32_bf16 v[60:63], a[164:167], a[100:103], v[252:255]
  v_exp_f32 v128, v72
  v_mfma_f32_16x16x32_bf16 v[60:63], a[172:175], a[108:111], v[60:63]
  v_exp_f32 v129, v73
  v_mfma_f32_16x16x32_bf16 v[60:63], a[180:183], a[116:119], v[60:63]
  ds_read_b128 a[216:219], v3 offset:6144
  v_cvt_pk_bf16_f32 v116, v128, v129
  v_mfma_f32_16x16x32_bf16 v[60:63], a[188:191], a[124:127], v[60:63]
  buffer_load_dwordx4 v1, s[24:27], s93 offen offset:2048 sc1 lds
  v_mfma_f32_16x16x32_bf16 v[52:55], a[188:191], a[120:123], v[244:247]
  v_exp_f32 v130, v74
  v_mfma_f32_16x16x32_bf16 v[52:55], a[180:183], a[112:115], v[52:55]
  v_exp_f32 v131, v75
  v_mfma_f32_16x16x32_bf16 v[52:55], a[172:175], a[104:107], v[52:55]
  ds_read_b128 a[220:223], v3 offset:7168
  v_cvt_pk_bf16_f32 v117, v130, v131
  v_mfma_f32_16x16x32_bf16 v[52:55], a[164:167], a[96:99], v[52:55]
  buffer_load_dwordx4 v1, s[24:27], s93 offen offset:3072 sc1 lds
  v_mfma_f32_16x16x32_bf16 v[44:47], a[164:167], a[68:71], v[236:239]
  s_add_u32 s93, s93, 16384
  v_exp_f32 v132, v76
  v_mfma_f32_16x16x32_bf16 v[44:47], a[172:175], a[76:79], v[44:47]
  v_exp_f32 v133, v77
  v_mfma_f32_16x16x32_bf16 v[44:47], a[180:183], a[84:87], v[44:47]
  v_cvt_pk_bf16_f32 v118, v132, v133
  v_mfma_f32_16x16x32_bf16 v[44:47], a[188:191], a[92:95], v[44:47]
  v_add_u32 v2, s88, v1
  v_mfma_f32_16x16x32_bf16 v[36:39], a[188:191], a[88:91], v[228:231]
  s_add_u32 s88, s88, 8192
  v_exp_f32 v134, v78
  v_mfma_f32_16x16x32_bf16 v[36:39], a[180:183], a[80:83], v[36:39]
  s_and_b32 s88, s88, 0xffff
  v_exp_f32 v135, v79
  v_mfma_f32_16x16x32_bf16 v[36:39], a[172:175], a[72:75], v[36:39]
  v_cvt_pk_bf16_f32 v119, v134, v135
  v_mfma_f32_16x16x32_bf16 v[36:39], a[164:167], a[64:67], v[36:39]
  s_waitcnt vmcnt(20) lgkmcnt(0)
  s_barrier
  v_mfma_f32_16x16x32_bf16 a[224:227], a[240:243], v[96:99], a[224:227]
  ds_read_b128 a[160:163], v2 offset:0
  v_mfma_f32_16x16x32_bf16 a[228:231], a[240:243], v[100:103], a[228:231]
  ds_read_b128 a[164:167], v2 offset:1024
  v_mfma_f32_16x16x32_bf16 a[232:235], a[240:243], v[104:107], a[232:235]
  ds_read_b128 a[168:171], v2 offset:2048
  v_mfma_f32_16x16x32_bf16 a[236:239], a[240:243], v[108:111], a[236:239]
  ds_read_b128 a[172:175], v2 offset:3072
  v_mfma_f32_16x16x32_bf16 v[164:167], a[192:195], v[108:111], v[164:167]
  s_add_u32 s89, s89, 8192
  v_exp_f32 v128, v80
  v_mfma_f32_16x16x32_bf16 v[160:163], a[192:195], v[104:107], v[160:163]
  s_and_b32 s89, s89, 0xffff
  v_exp_f32 v129, v81
  v_mfma_f32_16x16x32_bf16 a[4:7], a[192:195], v[100:103], a[4:7]
  ds_read_b128 a[176:179], v2 offset:4096
  v_cvt_pk_bf16_f32 v120, v128, v129
  v_mfma_f32_16x16x32_bf16 a[0:3], a[192:195], v[96:99], a[0:3]
  ds_read_b128 a[180:183], v2 offset:5120
  v_mfma_f32_16x16x32_bf16 a[8:11], a[196:199], v[96:99], a[8:11]
  s_or_b32 s89, s89, 0x10000
  v_exp_f32 v130, v82
  v_mfma_f32_16x16x32_bf16 a[12:15], a[196:199], v[100:103], a[12:15]
  v_exp_f32 v131, v83
  v_mfma_f32_16x16x32_bf16 v[168:171], a[196:199], v[104:107], v[168:171]
  ds_read_b128 a[184:187], v2 offset:6144
  v_cvt_pk_bf16_f32 v121, v130, v131
  v_mfma_f32_16x16x32_bf16 v[172:175], a[196:199], v[108:111], v[172:175]
  ds_read_b128 a[188:191], v2 offset:7168
  v_mfma_f32_16x16x32_bf16 v[180:183], a[200:203], v[108:111], v[180:183]
  v_exp_f32 v132, v84
  v_mfma_f32_16x16x32_bf16 v[176:179], a[200:203], v[104:107], v[176:179]
  v_exp_f32 v133, v85
  v_mfma_f32_16x16x32_bf16 a[20:23], a[200:203], v[100:103], a[20:23]
  v_cvt_pk_bf16_f32 v122, v132, v133
  v_mfma_f32_16x16x32_bf16 a[16:19], a[200:203], v[96:99], a[16:19]
  v_mfma_f32_16x16x32_bf16 a[24:27], a[204:207], v[96:99], a[24:27]
  v_exp_f32 v134, v86
  v_mfma_f32_16x16x32_bf16 a[28:31], a[204:207], v[100:103], a[28:31]
  v_exp_f32 v135, v87
  v_mfma_f32_16x16x32_bf16 v[184:187], a[204:207], v[104:107], v[184:187]
  v_cvt_pk_bf16_f32 v123, v134, v135
  v_mfma_f32_16x16x32_bf16 v[188:191], a[204:207], v[108:111], v[188:191]
  v_mfma_f32_16x16x32_bf16 v[196:199], a[208:211], v[108:111], v[196:199]
  v_exp_f32 v128, v88
  v_mfma_f32_16x16x32_bf16 v[192:195], a[208:211], v[104:107], v[192:195]
  v_exp_f32 v129, v89
  v_mfma_f32_16x16x32_bf16 a[36:39], a[208:211], v[100:103], a[36:39]
  v_cvt_pk_bf16_f32 v124, v128, v129
  v_mfma_f32_16x16x32_bf16 a[32:35], a[208:211], v[96:99], a[32:35]
  v_mfma_f32_16x16x32_bf16 a[40:43], a[212:215], v[96:99], a[40:43]
  v_exp_f32 v130, v90
  v_mfma_f32_16x16x32_bf16 a[44:47], a[212:215], v[100:103], a[44:47]
  v_exp_f32 v131, v91
  v_mfma_f32_16x16x32_bf16 v[200:203], a[212:215], v[104:107], v[200:203]
  v_cvt_pk_bf16_f32 v125, v130, v131
  v_mfma_f32_16x16x32_bf16 v[204:207], a[212:215], v[108:111], v[204:207]
  v_mfma_f32_16x16x32_bf16 v[212:215], a[216:219], v[108:111], v[212:215]
  v_exp_f32 v132, v92
  v_mfma_f32_16x16x32_bf16 v[208:211], a[216:219], v[104:107], v[208:211]
  v_exp_f32 v133, v93
  v_mfma_f32_16x16x32_bf16 a[52:55], a[216:219], v[100:103], a[52:55]
  v_cvt_pk_bf16_f32 v126, v132, v133
  v_mfma_f32_16x16x32_bf16 a[48:51], a[216:219], v[96:99], a[48:51]
  v_add_u32 v3, s89, v1
  v_mfma_f32_16x16x32_bf16 a[56:59], a[220:223], v[96:99], a[56:59]
  v_exp_f32 v134, v94
  v_mfma_f32_16x16x32_bf16 a[60:63], a[220:223], v[100:103], a[60:63]
  v_exp_f32 v135, v95
  v_mfma_f32_16x16x32_bf16 v[216:219], a[220:223], v[104:107], v[216:219]
  v_cvt_pk_bf16_f32 v127, v134, v135
  v_mfma_f32_16x16x32_bf16 v[220:223], a[220:223], v[108:111], v[220:223]
  s_cmp_lt_u32 s86, s87
  s_cbranch_scc1 LA
.p2align 5
LZ0:
  s_waitcnt lgkmcnt(0)
  v_mfma_f32_16x16x32_bf16 v[64:67], a[160:163], a[64:67], v[224:227]
  s_cmp_ge_u32 s86, 10
  v_exp_f32 v128, v32
  v_mfma_f32_16x16x32_bf16 v[64:67], a[168:171], a[72:75], v[64:67]
  s_cselect_b32 s63, 0xff00, 0
  v_exp_f32 v129, v33
  v_mfma_f32_16x16x32_bf16 v[64:67], a[176:179], a[80:83], v[64:67]
  ds_read_b128 a[192:195], v3 offset:0
  v_cvt_pk_bf16_f32 v96, v128, v129
  v_mfma_f32_16x16x32_bf16 v[64:67], a[184:187], a[88:91], v[64:67]
  ds_read_b128 a[196:199], v3 offset:1024
  v_cmp_eq_u32 vcc, 0, v25
  v_mfma_f32_16x16x32_bf16 v[72:75], a[184:187], a[92:95], v[232:235]
  s_add_u32 s86, s86, 4
  v_exp_f32 v130, v34
  v_mfma_f32_16x16x32_bf16 v[72:75], a[176:179], a[84:87], v[72:75]
  s_and_b32 s63, vcc_lo, s63
  v_exp_f32 v131, v35
  s_cbranch_scc1 Lslow_Z0
Lback_Z0:
  v_mfma_f32_16x16x32_bf16 v[72:75], a[168:171], a[76:79], v[72:75]
  ds_read_b128 a[200:203], v3 offset:2048
  v_cvt_pk_bf16_f32 v97, v130, v131
  v_mfma_f32_16x16x32_bf16 v[72:75], a[160:163], a[68:71], v[72:75]
  ds_read_b128 a[204:207], v3 offset:3072
  v_mfma_f32_16x16x32_bf16 v[80:83], a[160:163], a[96:99], v[240:243]
  v_exp_f32 v132, v36
  v_mfma_f32_16x16x32_bf16 v[80:83], a[168:171], a[104:107], v[80:83]
  v_exp_f32 v133, v37
  v_mfma_f32_16x16x32_bf16 v[80:83], a[176:179], a[112:115], v[80:83]
  ds_read_b128 a[208:211], v3 offset:4096
  v_cvt_pk_bf16_f32 v98, v132, v133
  v_mfma_f32_16x16x32_bf16 v[80:83], a[184:187], a[120:123], v[80:83]
  v_mfma_f32_16x16x32_bf16 v[88:91], a[184:187], a[124:127], v[248:251]
  v_exp_f32 v134, v38
  v_mfma_f32_16x16x32_bf16 v[88:91], a[176:179], a[116:119], v[88:91]
  v_exp_f32 v135, v39
  v_mfma_f32_16x16x32_bf16 v[88:91], a[168:171], a[108:111], v[88:91]
  ds_read_b128 a[212:215], v3 offset:5120
  v_cvt_pk_bf16_f32 v99, v134, v135
  v_mfma_f32_16x16x32_bf16 v[88:91], a[160:163], a[100:103], v[88:91]
  v_mfma_f32_16x16x32_bf16 v[92:95], a[164:167], a[100:103], v[252:255]
  v_exp_f32 v128, v40
  v_mfma_f32_16x16x32_bf16 v[92:95], a[172:175], a[108:111], v[92:95]
  v_exp_f32 v129, v41
  v_mfma_f32_16x16x32_bf16 v[92:95], a[180:183], a[116:119], v[92:95]
  ds_read_b128 a[216:219], v3 offset:6144
  v_cvt_pk_bf16_f32 v100, v128, v129
  v_mfma_f32_16x16x32_bf16 v[92:95], a[188:191], a[124:127], v[92:95]
  v_mfma_f32_16x16x32_bf16 v[84:87], a[188:191], a[120:123], v[244:247]
  v_exp_f32 v130, v42
  v_mfma_f32_16x16x32_bf16 v[84:87], a[180:183], a[112:115], v[84:87]
  v_exp_f32 v131, v43
  v_mfma_f32_16x16x32_bf16 v[84:87], a[172:175], a[104:107], v[84:87]
  ds_read_b128 a[220:223], v3 offset:7168
  v_cvt_pk_bf16_f32 v101, v130, v131
  v_mfma_f32_16x16x32_bf16 v[84:87], a[164:167], a[96:99], v[84:87]
  v_mfma_f32_16x16x32_bf16 v[76:79], a[164:167], a[68:71], v[236:239]
  v_exp_f32 v132, v44
  v_mfma_f32_16x16x32_bf16 v[76:79], a[172:175], a[76:79], v[76:79]
  v_exp_f32 v133, v45
  v_mfma_f32_16x16x32_bf16 v[76:79], a[180:183], a[84:87], v[76:79]
  v_cvt_pk_bf16_f32 v102, v132, v133
  v_mfma_f32_16x16x32_bf16 v[76:79], a[188:191], a[92:95], v[76:79]
  v_add_u32 v2, s88, v1
  v_mfma_f32_16x16x32_bf16 v[68:71], a[188:191], a[88:91], v[228:231]
  s_add_u32 s88, s88, 8192
  v_exp_f32 v134, v46
  v_mfma_f32_16x16x32_bf16 v[68:71], a[180:183], a[80:83], v[68:71]
  s_and_b32 s88, s88, 0xffff
  v_exp_f32 v135, v47
  v_mfma_f32_16x16x32_bf16 v[68:71], a[172:175], a[72:75], v[68:71]
  v_cvt_pk_bf16_f32 v103, v134, v135
  v_mfma_f32_16x16x32_bf16 v[68:71], a[164:167], a[64:67], v[68:71]
  s_sub_u32 s3, 0, s60
  s_cmp_lt_i32 s3, 0
  s_cselect_b32 s100, s90, s91
  s_cmp_gt_i32 s3, 0
  s_cselect_b32 s101, s91, s90
  v_max_f32 v144, s100, v140
  v_max_f32 v145, s100, v141
  v_max_f32 v146, s100, v142
  s_waitcnt vmcnt(16) lgkmcnt(0)
  s_barrier
  v_mfma_f32_16x16x32_bf16 a[224:227], a[240:243], v[112:115], a[224:227]
  ds_read_b128 a[160:163], v2 offset:0
  v_max_f32 v147, s100, v143
  v_mfma_f32_16x16x32_bf16 a[228:231], a[240:243], v[116:119], a[228:231]
  ds_read_b128 a[164:167], v2 offset:1024
  v_min_f32 v244, s100, v138
  v_mfma_f32_16x16x32_bf16 a[232:235], a[240:243], v[120:123], a[232:235]
  ds_read_b128 a[168:171], v2 offset:2048
  v_min_f32 v245, s100, v138
  v_mfma_f32_16x16x32_bf16 a[236:239], a[240:243], v[124:127], a[236:239]
  ds_read_b128 a[172:175], v2 offset:3072
  v_min_f32 v246, s100, v138
  v_mfma_f32_16x16x32_bf16 v[164:167], a[192:195], v[124:127], v[164:167]
  s_add_u32 s89, s89, 8192
  v_exp_f32 v128, v48
  v_mfma_f32_16x16x32_bf16 v[160:163], a[192:195], v[120:123], v[160:163]
  s_and_b32 s89, s89, 0xffff
  v_exp_f32 v129, v49
  v_mfma_f32_16x16x32_bf16 a[4:7], a[192:195], v[116:119], a[4:7]
  ds_read_b128 a[176:179], v2 offset:4096
  v_cvt_pk_bf16_f32 v104, v128, v129
  v_min_f32 v247, s100, v138
  v_mfma_f32_16x16x32_bf16 a[0:3], a[192:195], v[112:115], a[0:3]
  ds_read_b128 a[180:183], v2 offset:5120
  v_min3_f32 v240, v138, v144, s101
  v_mfma_f32_16x16x32_bf16 a[8:11], a[196:199], v[112:115], a[8:11]
  s_or_b32 s89, s89, 0x10000
  v_exp_f32 v130, v50
  v_mfma_f32_16x16x32_bf16 a[12:15], a[196:199], v[116:119], a[12:15]
  v_exp_f32 v131, v51
  v_mfma_f32_16x16x32_bf16 v[168:171], a[196:199], v[120:123], v[168:171]
  ds_read_b128 a[184:187], v2 offset:6144
  v_cvt_pk_bf16_f32 v105, v130, v131
  v_mfma_f32_16x16x32_bf16 v[172:175], a[196:199], v[124:127], v[172:175]
  ds_read_b128 a[188:191], v2 offset:7168
  v_min3_f32 v241, v138, v145, s101
  v_mfma_f32_16x16x32_bf16 v[180:183], a[200:203], v[124:127], v[180:183]
  v_exp_f32 v132, v52
  v_mfma_f32_16x16x32_bf16 v[176:179], a[200:203], v[120:123], v[176:179]
  s_and_b32 m0, s92, 0xffff
  v_exp_f32 v133, v53
  v_min3_f32 v242, v138, v146, s101
  v_mfma_f32_16x16x32_bf16 a[20:23], a[200:203], v[116:119], a[20:23]
  v_cvt_pk_bf16_f32 v106, v132, v133
  v_min3_f32 v243, v138, v147, s101
  v_mfma_f32_16x16x32_bf16 a[16:19], a[200:203], v[112:115], a[16:19]
  buffer_load_dwordx4 v1, s[20:23], s92 offen offset:0 sc1 lds
  v_mfma_f32_16x16x32_bf16 a[24:27], a[204:207], v[112:115], a[24:27]
  v_exp_f32 v134, v54
  v_mfma_f32_16x16x32_bf16 a[28:31], a[204:207], v[116:119], a[28:31]
  v_exp_f32 v135, v55
  v_mfma_f32_16x16x32_bf16 v[184:187], a[204:207], v[120:123], v[184:187]
  v_cvt_pk_bf16_f32 v107, v134, v135
  v_min3_f32 v252, v139, v144, s101
  v_mfma_f32_16x16x32_bf16 v[188:191], a[204:207], v[124:127], v[188:191]
  buffer_load_dwordx4 v1, s[20:23], s92 offen offset:1024 sc1 lds
  v_mfma_f32_16x16x32_bf16 v[196:199], a[208:211], v[124:127], v[196:199]
  v_exp_f32 v128, v56
  v_mfma_f32_16x16x32_bf16 v[192:195], a[208:211], v[120:123], v[192:195]
  v_exp_f32 v129, v57
  v_min3_f32 v253, v139, v145, s101
  v_mfma_f32_16x16x32_bf16 a[36:39], a[208:211], v[116:119], a[36:39]
  v_cvt_pk_bf16_f32 v108, v128, v129
  v_min3_f32 v254, v139, v146, s101
  v_mfma_f32_16x16x32_bf16 a[32:35], a[208:211], v[112:115], a[32:35]
  buffer_load_dwordx4 v1, s[20:23], s92 offen offset:2048 sc1 lds
  v_mfma_f32_16x16x32_bf16 a[40:43], a[212:215], v[112:115], a[40:43]
  v_exp_f32 v130, v58
  v_mfma_f32_16x16x32_bf16 a[44:47], a[212:215], v[116:119], a[44:47]
  v_exp_f32 v131, v59
  v_mfma_f32_16x16x32_bf16 v[200:203], a[212:215], v[120:123], v[200:203]
  v_cvt_pk_bf16_f32 v109, v130, v131
  v_min3_f32 v255, v139, v147, s101
  v_mfma_f32_16x16x32_bf16 v[204:207], a[212:215], v[124:127], v[204:207]
  buffer_load_dwordx4 v1, s[20:23], s92 offen offset:3072 sc1 lds
  v_mfma_f32_16x16x32_bf16 v[212:215], a[216:219], v[124:127], v[212:215]
  s_add_u32 s92, s92, 16384
  v_exp_f32 v132, v60
  v_min_f32 v248, s101, v139
  v_mfma_f32_16x16x32_bf16 v[208:211], a[216:219], v[120:123], v[208:211]
  v_exp_f32 v133, v61
  v_mfma_f32_16x16x32_bf16 a[52:55], a[216:219], v[116:119], a[52:55]
  v_cvt_pk_bf16_f32 v110, v132, v133
  v_min_f32 v249, s101, v139
  v_mfma_f32_16x16x32_bf16 a[48:51], a[216:219], v[112:115], a[48:51]
  v_add_u32 v3, s89, v1
  v_min_f32 v250, s101, v139
  v_mfma_f32_16x16x32_bf16 a[56:59], a[220:223], v[112:115], a[56:59]
  v_exp_f32 v134, v62
  v_mfma_f32_16x16x32_bf16 a[60:63], a[220:223], v[116:119], a[60:63]
  v_exp_f32 v135, v63
  v_mfma_f32_16x16x32_bf16 v[216:219], a[220:223], v[120:123], v[216:219]
  v_cvt_pk_bf16_f32 v111, v134, v135
  v_min_f32 v251, s101, v139
  v_mfma_f32_16x16x32_bf16 v[220:223], a[220:223], v[124:127], v[220:223]
  buffer_load_dword v25, v0, s[40:43], s66 offen sc1
  s_waitcnt lgkmcnt(0)
  v_mfma_f32_16x16x32_bf16 v[32:35], a[160:163], a[64:67], v[224:227]
  v_exp_f32 v128, v64
  v_mfma_f32_16x16x32_bf16 v[32:35], a[168:171], a[72:75], v[32:35]
  v_exp_f32 v129, v65
  v_mfma_f32_16x16x32_bf16 v[32:35], a[176:179], a[80:83], v[32:35]
  ds_read_b128 a[192:195], v3 offset:0
  v_cvt_pk_bf16_f32 v112, v128, v129
  v_mfma_f32_16x16x32_bf16 v[32:35], a[184:187], a[88:91], v[32:35]
  ds_read_b128 a[196:199], v3 offset:1024
  v_mfma_f32_16x16x32_bf16 v[40:43], a[184:187], a[92:95], v[232:235]
  v_exp_f32 v130, v66
  v_mfma_f32_16x16x32_bf16 v[40:43], a[176:179], a[84:87], v[40:43]
  v_exp_f32 v131, v67
  v_mfma_f32_16x16x32_bf16 v[40:43], a[168:171], a[76:79], v[40:43]
  ds_read_b128 a[200:203], v3 offset:2048
  v_cvt_pk_bf16_f32 v113, v130, v131
  v_mfma_f32_16x16x32_bf16 v[40:43], a[160:163], a[68:71], v[40:43]
  ds_read_b128 a[204:207], v3 offset:3072
  v_mfma_f32_16x16x32_bf16 v[48:51], a[160:163], a[96:99], v[240:243]
  v_exp_f32 v132, v68
  v_mfma_f32_16x16x32_bf16 v[48:51], a[168:171], a[104:107], v[48:51]
  s_and_b32 s65, s93, 0xffff
  s_add_u32 m0, s65, 65536
  v_exp_f32 v133, v69
  v_mfma_f32_16x16x32_bf16 v[48:51], a[176:179], a[112:115], v[48:51]
  ds_read_b128 a[208:211], v3 offset:4096
  v_cvt_pk_bf16_f32 v114, v132, v133
  v_mfma_f32_16x16x32_bf16 v[48:51], a[184:187], a[120:123], v[48:51]
  buffer_load_dwordx4 v1, s[24:27], s93 offen offset:0 sc1 lds
  v_mfma_f32_16x16x32_bf16 v[56:59], a[184:187], a[124:127], v[248:251]
  v_exp_f32 v134, v70
  v_mfma_f32_16x16x32_bf16 v[56:59], a[176:179], a[116:119], v[56:59]
  v_exp_f32 v135, v71
  v_mfma_f32_16x16x32_bf16 v[56:59], a[168:171], a[108:111], v[56:59]
  ds_read_b128 a[212:215], v3 offset:5120
  v_cvt_pk_bf16_f32 v115, v134, v135
  v_mfma_f32_16x16x32_bf16 v[56:59], a[160:163], a[100:103], v[56:59]
  buffer_load_dwordx4 v1, s[24:27], s93 offen offset:1024 sc1 lds
  v_mfma_f32_16x16x32_bf16 v[60:63], a[164:167], a[100:103], v[252:255]
  v_exp_f32 v128, v72
  v_mfma_f32_16x16x32_bf16 v[60:63], a[172:175], a[108:111], v[60:63]
  v_exp_f32 v129, v73
  v_mfma_f32_16x16x32_bf16 v[60:63], a[180:183], a[116:119], v[60:63]
  ds_read_b128 a[216:219], v3 offset:6144
  v_cvt_pk_bf16_f32 v116, v128, v129
  v_mfma_f32_16x16x32_bf16 v[60:63], a[188:191], a[124:127], v[60:63]
  buffer_load_dwordx4 v1, s[24:27], s93 offen offset:2048 sc1 lds
  v_mfma_f32_16x16x32_bf16 v[52:55], a[188:191], a[120:123], v[244:247]
  v_exp_f32 v130, v74
  v_mfma_f32_16x16x32_bf16 v[52:55], a[180:183], a[112:115], v[52:55]
  v_exp_f32 v131, v75
  v_mfma_f32_16x16x32_bf16 v[52:55], a[172:175], a[104:107], v[52:55]
  ds_read_b128 a[220:223], v3 offset:7168
  v_cvt_pk_bf16_f32 v117, v130, v131
  v_mfma_f32_16x16x32_bf16 v[52:55], a[164:167], a[96:99], v[52:55]
  buffer_load_dwordx4 v1, s[24:27], s93 offen offset:3072 sc1 lds
  v_mfma_f32_16x16x32_bf16 v[44:47], a[164:167], a[68:71], v[236:239]
  s_add_u32 s93, s93, 16384
  v_exp_f32 v132, v76
  v_mfma_f32_16x16x32_bf16 v[44:47], a[172:175], a[76:79], v[44:47]
  v_exp_f32 v133, v77
  v_mfma_f32_16x16x32_bf16 v[44:47], a[180:183], a[84:87], v[44:47]
  v_cvt_pk_bf16_f32 v118, v132, v133
  v_mfma_f32_16x16x32_bf16 v[44:47], a[188:191], a[92:95], v[44:47]
  v_add_u32 v2, s88, v1
  v_mfma_f32_16x16x32_bf16 v[36:39], a[188:191], a[88:91], v[228:231]
  s_add_u32 s88, s88, 8192
  v_exp_f32 v134, v78
  v_mfma_f32_16x16x32_bf16 v[36:39], a[180:183], a[80:83], v[36:39]
  s_and_b32 s88, s88, 0xffff
  v_exp_f32 v135, v79
  v_mfma_f32_16x16x32_bf16 v[36:39], a[172:175], a[72:75], v[36:39]
  v_cvt_pk_bf16_f32 v119, v134, v135
  v_mfma_f32_16x16x32_bf16 v[36:39], a[164:167], a[64:67], v[36:39]
  s_sub_u32 s3, 1, s60
  s_cmp_lt_i32 s3, 0
  s_cselect_b32 s100, s90, s91
  s_cmp_gt_i32 s3, 0
  s_cselect_b32 s101, s91, s90
  v_max_f32 v144, s100, v140
  v_max_f32 v145, s100, v141
  s_waitcnt vmcnt(20) lgkmcnt(0)
  s_barrier
  v_mfma_f32_16x16x32_bf16 a[224:227], a[240:243], v[96:99], a[224:227]
  ds_read_b128 a[160:163], v2 offset:0
  v_max_f32 v146, s100, v142
  v_mfma_f32_16x16x32_bf16 a[228:231], a[240:243], v[100:103], a[228:231]
  ds_read_b128 a[164:167], v2 offset:1024
  v_max_f32 v147, s100, v143
  v_mfma_f32_16x16x32_bf16 a[232:235], a[240:243], v[104:107], a[232:235]
  ds_read_b128 a[168:171], v2 offset:2048
  v_min_f32 v244, s100, v138
  v_mfma_f32_16x16x32_bf16 a[236:239], a[240:243], v[108:111], a[236:239]
  ds_read_b128 a[172:175], v2 offset:3072
  v_min_f32 v245, s100, v138
  v_mfma_f32_16x16x32_bf16 v[164:167], a[192:195], v[108:111], v[164:167]
  s_add_u32 s89, s89, 8192
  v_exp_f32 v128, v80
  v_mfma_f32_16x16x32_bf16 v[160:163], a[192:195], v[104:107], v[160:163]
  s_and_b32 s89, s89, 0xffff
  v_exp_f32 v129, v81
  v_mfma_f32_16x16x32_bf16 a[4:7], a[192:195], v[100:103], a[4:7]
  ds_read_b128 a[176:179], v2 offset:4096
  v_cvt_pk_bf16_f32 v120, v128, v129
  v_mfma_f32_16x16x32_bf16 a[0:3], a[192:195], v[96:99], a[0:3]
  ds_read_b128 a[180:183], v2 offset:5120
  v_min_f32 v246, s100, v138
  v_mfma_f32_16x16x32_bf16 a[8:11], a[196:199], v[96:99], a[8:11]
  s_or_b32 s89, s89, 0x10000
  v_exp_f32 v130, v82
  v_mfma_f32_16x16x32_bf16 a[12:15], a[196:199], v[100:103], a[12:15]
  v_exp_f32 v131, v83
  v_mfma_f32_16x16x32_bf16 v[168:171], a[196:199], v[104:107], v[168:171]
  ds_read_b128 a[184:187], v2 offset:6144
  v_cvt_pk_bf16_f32 v121, v130, v131
  v_mfma_f32_16x16x32_bf16 v[172:175], a[196:199], v[108:111], v[172:175]
  ds_read_b128 a[188:191], v2 offset:7168
  v_min_f32 v247, s100, v138
  v_mfma_f32_16x16x32_bf16 v[180:183], a[200:203], v[108:111], v[180:183]
  v_exp_f32 v132, v84
  v_mfma_f32_16x16x32_bf16 v[176:179], a[200:203], v[104:107], v[176:179]
  v_exp_f32 v133, v85
  v_mfma_f32_16x16x32_bf16 a[20:23], a[200:203], v[100:103], a[20:23]
  v_cvt_pk_bf16_f32 v122, v132, v133
  v_min3_f32 v240, v138, v144, s101
  v_mfma_f32_16x16x32_bf16 a[16:19], a[200:203], v[96:99], a[16:19]
  v_min3_f32 v241, v138, v145, s101
  v_min3_f32 v242, v138, v146, s101
  v_mfma_f32_16x16x32_bf16 a[24:27], a[204:207], v[96:99], a[24:27]
  v_exp_f32 v134, v86
  v_mfma_f32_16x16x32_bf16 a[28:31], a[204:207], v[100:103], a[28:31]
  v_exp_f32 v135, v87
  v_mfma_f32_16x16x32_bf16 v[184:187], a[204:207], v[104:107], v[184:187]
  v_cvt_pk_bf16_f32 v123, v134, v135
  v_min3_f32 v243, v138, v147, s101
  v_mfma_f32_16x16x32_bf16 v[188:191], a[204:207], v[108:111], v[188:191]
  v_min3_f32 v252, v139, v144, s101
  v_min3_f32 v253, v139, v145, s101
  v_mfma_f32_16x16x32_bf16 v[196:199], a[208:211], v[108:111], v[196:199]
  v_exp_f32 v128, v88
  v_mfma_f32_16x16x32_bf16 v[192:195], a[208:211], v[104:107], v[192:195]
  v_exp_f32 v129, v89
  v_mfma_f32_16x16x32_bf16 a[36:39], a[208:211], v[100:103], a[36:39]
  v_cvt_pk_bf16_f32 v124, v128, v129
  v_min3_f32 v254, v139, v146, s101
  v_mfma_f32_16x16x32_bf16 a[32:35], a[208:211], v[96:99], a[32:35]
  v_min3_f32 v255, v139, v147, s101
  v_min_f32 v248, s101, v139
  v_mfma_f32_16x16x32_bf16 a[40:43], a[212:215], v[96:99], a[40:43]
  v_exp_f32 v130, v90
  v_mfma_f32_16x16x32_bf16 a[44:47], a[212:215], v[100:103], a[44:47]
  v_exp_f32 v131, v91
  v_mfma_f32_16x16x32_bf16 v[200:203], a[212:215], v[104:107], v[200:203]
  v_cvt_pk_bf16_f32 v125, v130, v131
  v_min_f32 v249, s101, v139
  v_mfma_f32_16x16x32_bf16 v[204:207], a[212:215], v[108:111], v[204:207]
  v_min_f32 v250, s101, v139
  v_min_f32 v251, s101, v139
  v_mfma_f32_16x16x32_bf16 v[212:215], a[216:219], v[108:111], v[212:215]
  v_exp_f32 v132, v92
  v_mfma_f32_16x16x32_bf16 v[208:211], a[216:219], v[104:107], v[208:211]
  v_exp_f32 v133, v93
  v_mfma_f32_16x16x32_bf16 a[52:55], a[216:219], v[100:103], a[52:55]
  v_cvt_pk_bf16_f32 v126, v132, v133
  v_mfma_f32_16x16x32_bf16 a[48:51], a[216:219], v[96:99], a[48:51]
  v_add_u32 v3, s89, v1
  v_mfma_f32_16x16x32_bf16 a[56:59], a[220:223], v[96:99], a[56:59]
  v_exp_f32 v134, v94
  v_mfma_f32_16x16x32_bf16 a[60:63], a[220:223], v[100:103], a[60:63]
  v_exp_f32 v135, v95
  v_mfma_f32_16x16x32_bf16 v[216:219], a[220:223], v[104:107], v[216:219]
  v_cvt_pk_bf16_f32 v127, v134, v135
  v_mfma_f32_16x16x32_bf16 v[220:223], a[220:223], v[108:111], v[220:223]
  s_waitcnt lgkmcnt(0)
  v_mfma_f32_16x16x32_bf16 v[64:67], a[160:163], a[64:67], v[224:227]
  v_exp_f32 v128, v32
  v_mfma_f32_16x16x32_bf16 v[64:67], a[168:171], a[72:75], v[64:67]
  v_exp_f32 v129, v33
  v_mfma_f32_16x16x32_bf16 v[64:67], a[176:179], a[80:83], v[64:67]
  ds_read_b128 a[192:195], v3 offset:0
  v_cvt_pk_bf16_f32 v96, v128, v129
  v_mfma_f32_16x16x32_bf16 v[64:67], a[184:187], a[88:91], v[64:67]
  ds_read_b128 a[196:199], v3 offset:1024
  v_mfma_f32_16x16x32_bf16 v[72:75], a[184:187], a[92:95], v[232:235]
  v_exp_f32 v130, v34
  v_mfma_f32_16x16x32_bf16 v[72:75], a[176:179], a[84:87], v[72:75]
  v_exp_f32 v131, v35
  v_mfma_f32_16x16x32_bf16 v[72:75], a[168:171], a[76:79], v[72:75]
  ds_read_b128 a[200:203], v3 offset:2048
  v_cvt_pk_bf16_f32 v97, v130, v131
  v_mfma_f32_16x16x32_bf16 v[72:75], a[160:163], a[68:71], v[72:75]
  ds_read_b128 a[204:207], v3 offset:3072
  v_mfma_f32_16x16x32_bf16 v[80:83], a[160:163], a[96:99], v[240:243]
  v_exp_f32 v132, v36
  v_mfma_f32_16x16x32_bf16 v[80:83], a[168:171], a[104:107], v[80:83]
  v_exp_f32 v133, v37
  v_mfma_f32_16x16x32_bf16 v[80:83], a[176:179], a[112:115], v[80:83]
  ds_read_b128 a[208:211], v3 offset:4096
  v_cvt_pk_bf16_f32 v98, v132, v133
  v_mfma_f32_16x16x32_bf16 v[80:83], a[184:187], a[120:123], v[80:83]
  v_mfma_f32_16x16x32_bf16 v[88:91], a[184:187], a[124:127], v[248:251]
  v_exp_f32 v134, v38
  v_mfma_f32_16x16x32_bf16 v[88:91], a[176:179], a[116:119], v[88:91]
  v_exp_f32 v135, v39
  v_mfma_f32_16x16x32_bf16 v[88:91], a[168:171], a[108:111], v[88:91]
  ds_read_b128 a[212:215], v3 offset:5120
  v_cvt_pk_bf16_f32 v99, v134, v135
  v_mfma_f32_16x16x32_bf16 v[88:91], a[160:163], a[100:103], v[88:91]
  v_mfma_f32_16x16x32_bf16 v[92:95], a[164:167], a[100:103], v[252:255]
  v_exp_f32 v128, v40
  v_mfma_f32_16x16x32_bf16 v[92:95], a[172:175], a[108:111], v[92:95]
  v_exp_f32 v129, v41
  v_mfma_f32_16x16x32_bf16 v[92:95], a[180:183], a[116:119], v[92:95]
  ds_read_b128 a[216:219], v3 offset:6144
  v_cvt_pk_bf16_f32 v100, v128, v129
  v_mfma_f32_16x16x32_bf16 v[92:95], a[188:191], a[124:127], v[92:95]
  v_mfma_f32_16x16x32_bf16 v[84:87], a[188:191], a[120:123], v[244:247]
  v_exp_f32 v130, v42
  v_mfma_f32_16x16x32_bf16 v[84:87], a[180:183], a[112:115], v[84:87]
  v_exp_f32 v131, v43
  v_mfma_f32_16x16x32_bf16 v[84:87], a[172:175], a[104:107], v[84:87]
  ds_read_b128 a[220:223], v3 offset:7168
  v_cvt_pk_bf16_f32 v101, v130, v131
  v_mfma_f32_16x16x32_bf16 v[84:87], a[164:167], a[96:99], v[84:87]
  v_mfma_f32_16x16x32_bf16 v[76:79], a[164:167], a[68:71], v[236:239]
  v_exp_f32 v132, v44
  v_mfma_f32_16x16x32_bf16 v[76:79], a[172:175], a[76:79], v[76:79]
  v_exp_f32 v133, v45
  v_mfma_f32_16x16x32_bf16 v[76:79], a[180:183], a[84:87], v[76:79]
  v_cvt_pk_bf16_f32 v102, v132, v133
  v_mfma_f32_16x16x32_bf16 v[76:79], a[188:191], a[92:95], v[76:79]
  v_add_u32 v2, s88, v1
  v_mfma_f32_16x16x32_bf16 v[68:71], a[188:191], a[88:91], v[228:231]
  s_add_u32 s88, s88, 8192
  v_exp_f32 v134, v46
  v_mfma_f32_16x16x32_bf16 v[68:71], a[180:183], a[80:83], v[68:71]
  s_and_b32 s88, s88, 0xffff
  v_exp_f32 v135, v47
  v_mfma_f32_16x16x32_bf16 v[68:71], a[172:175], a[72:75], v[68:71]
  v_cvt_pk_bf16_f32 v103, v134, v135
  v_mfma_f32_16x16x32_bf16 v[68:71], a[164:167], a[64:67], v[68:71]
  s_sub_u32 s3, 2, s60
  s_cmp_lt_i32 s3, 0
  s_cselect_b32 s100, s90, s91
  s_cmp_gt_i32 s3, 0
  s_cselect_b32 s101, s91, s90
  v_max_f32 v144, s100, v140
  v_max_f32 v145, s100, v141
  v_max_f32 v146, s100, v142
  s_waitcnt vmcnt(17) lgkmcnt(0)
  s_barrier
  v_mfma_f32_16x16x32_bf16 a[224:227], a[240:243], v[112:115], a[224:227]
  ds_read_b128 a[160:163], v2 offset:0
  v_max_f32 v147, s100, v143
  v_mfma_f32_16x16x32_bf16 a[228:231], a[240:243], v[116:119], a[228:231]
  ds_read_b128 a[164:167], v2 offset:1024
  v_min_f32 v244, s100, v138
  v_mfma_f32_16x16x32_bf16 a[232:235], a[240:243], v[120:123], a[232:235]
  ds_read_b128 a[168:171], v2 offset:2048
  v_min_f32 v245, s100, v138
  v_mfma_f32_16x16x32_bf16 a[236:239], a[240:243], v[124:127], a[236:239]
  ds_read_b128 a[172:175], v2 offset:3072
  v_min_f32 v246, s100, v138
  v_mfma_f32_16x16x32_bf16 v[164:167], a[192:195], v[124:127], v[164:167]
  s_add_u32 s89, s89, 8192
  v_exp_f32 v128, v48
  v_mfma_f32_16x16x32_bf16 v[160:163], a[192:195], v[120:123], v[160:163]
  s_and_b32 s89, s89, 0xffff
  v_exp_f32 v129, v49
  v_mfma_f32_16x16x32_bf16 a[4:7], a[192:195], v[116:119], a[4:7]
  ds_read_b128 a[176:179], v2 offset:4096
  v_cvt_pk_bf16_f32 v104, v128, v129
  v_mfma_f32_16x16x32_bf16 a[0:3], a[192:195], v[112:115], a[0:3]
  ds_read_b128 a[180:183], v2 offset:5120
  v_min_f32 v247, s100, v138
  v_mfma_f32_16x16x32_bf16 a[8:11], a[196:199], v[112:115], a[8:11]
  s_or_b32 s89, s89, 0x10000
  v_exp_f32 v130, v50
  v_mfma_f32_16x16x32_bf16 a[12:15], a[196:199], v[116:119], a[12:15]
  v_exp_f32 v131, v51
  v_mfma_f32_16x16x32_bf16 v[168:171], a[196:199], v[120:123], v[168:171]
  ds_read_b128 a[184:187], v2 offset:6144
  v_cvt_pk_bf16_f32 v105, v130, v131
  v_mfma_f32_16x16x32_bf16 v[172:175], a[196:199], v[124:127], v[172:175]
  ds_read_b128 a[188:191], v2 offset:7168
  v_min3_f32 v240, v138, v144, s101
  v_min3_f32 v241, v138, v145, s101
  v_mfma_f32_16x16x32_bf16 v[180:183], a[200:203], v[124:127], v[180:183]
  v_exp_f32 v132, v52
  v_mfma_f32_16x16x32_bf16 v[176:179], a[200:203], v[120:123], v[176:179]
  s_and_b32 m0, s92, 0xffff
  v_exp_f32 v133, v53
  v_mfma_f32_16x16x32_bf16 a[20:23], a[200:203], v[116:119], a[20:23]
  v_cvt_pk_bf16_f32 v106, v132, v133
  v_min3_f32 v242, v138, v146, s101
  v_mfma_f32_16x16x32_bf16 a[16:19], a[200:203], v[112:115], a[16:19]
  buffer_load_dwordx4 v1, s[20:23], s92 offen offset:0 sc1 lds
  v_mfma_f32_16x16x32_bf16 a[24:27], a[204:207], v[112:115], a[24:27]
  v_exp_f32 v134, v54
  v_mfma_f32_16x16x32_bf16 a[28:31], a[204:207], v[116:119], a[28:31]
  v_exp_f32 v135, v55
  v_mfma_f32_16x16x32_bf16 v[184:187], a[204:207], v[120:123], v[184:187]
  v_cvt_pk_bf16_f32 v107, v134, v135
  v_min3_f32 v243, v138, v147, s101
  v_mfma_f32_16x16x32_bf16 v[188:191], a[204:207], v[124:127], v[188:191]
  buffer_load_dwordx4 v1, s[20:23], s92 offen offset:1024 sc1 lds
  v_mfma_f32_16x16x32_bf16 v[196:199], a[208:211], v[124:127], v[196:199]
  v_exp_f32 v128, v56
  v_mfma_f32_16x16x32_bf16 v[192:195], a[208:211], v[120:123], v[192:195]
  v_exp_f32 v129, v57
  v_mfma_f32_16x16x32_bf16 a[36:39], a[208:211], v[116:119], a[36:39]
  v_cvt_pk_bf16_f32 v108, v128, v129
  v_min3_f32 v252, v139, v144, s101
  v_mfma_f32_16x16x32_bf16 a[32:35], a[208:211], v[112:115], a[32:35]
  buffer_load_dwordx4 v1, s[20:23], s92 offen offset:2048 sc1 lds
  v_min3_f32 v253, v139, v145, s101
  v_mfma_f32_16x16x32_bf16 a[40:43], a[212:215], v[112:115], a[40:43]
  v_exp_f32 v130, v58
  v_mfma_f32_16x16x32_bf16 a[44:47], a[212:215], v[116:119], a[44:47]
  v_exp_f32 v131, v59
  v_mfma_f32_16x16x32_bf16 v[200:203], a[212:215], v[120:123], v[200:203]
  v_cvt_pk_bf16_f32 v109, v130, v131
  v_min3_f32 v254, v139, v146, s101
  v_mfma_f32_16x16x32_bf16 v[204:207], a[212:215], v[124:127], v[204:207]
  buffer_load_dwordx4 v1, s[20:23], s92 offen offset:3072 sc1 lds
  v_mfma_f32_16x16x32_bf16 v[212:215], a[216:219], v[124:127], v[212:215]
  s_add_u32 s92, s92, 16384
  v_exp_f32 v132, v60
  v_mfma_f32_16x16x32_bf16 v[208:211], a[216:219], v[120:123], v[208:211]
  v_exp_f32 v133, v61
  v_mfma_f32_16x16x32_bf16 a[52:55], a[216:219], v[116:119], a[52:55]
  v_cvt_pk_bf16_f32 v110, v132, v133
  v_min3_f32 v255, v139, v147, s101
  v_mfma_f32_16x16x32_bf16 a[48:51], a[216:219], v[112:115], a[48:51]
  v_add_u32 v3, s89, v1
  v_min_f32 v248, s101, v139
  v_mfma_f32_16x16x32_bf16 a[56:59], a[220:223], v[112:115], a[56:59]
  v_exp_f32 v134, v62
  v_mfma_f32_16x16x32_bf16 a[60:63], a[220:223], v[116:119], a[60:63]
  v_exp_f32 v135, v63
  v_mfma_f32_16x16x32_bf16 v[216:219], a[220:223], v[120:123], v[216:219]
  v_cvt_pk_bf16_f32 v111, v134, v135
  v_min_f32 v249, s101, v139
  v_mfma_f32_16x16x32_bf16 v[220:223], a[220:223], v[124:127], v[220:223]
  v_min_f32 v250, s101, v139
  v_min_f32 v251, s101, v139
  s_waitcnt lgkmcnt(0)
  v_mfma_f32_16x16x32_bf16 v[32:35], a[160:163], a[64:67], v[224:227]
  v_exp_f32 v128, v64
  v_mfma_f32_16x16x32_bf16 v[32:35], a[168:171], a[72:75], v[32:35]
  v_exp_f32 v129, v65
  v_mfma_f32_16x16x32_bf16 v[32:35], a[176:179], a[80:83], v[32:35]
  ds_read_b128 a[192:195], v3 offset:0
  v_cvt_pk_bf16_f32 v112, v128, v129
  v_mfma_f32_16x16x32_bf16 v[32:35], a[184:187], a[88:91], v[32:35]
  ds_read_b128 a[196:199], v3 offset:1024
  v_mfma_f32_16x16x32_bf16 v[40:43], a[184:187], a[92:95], v[232:235]
  v_exp_f32 v130, v66
  v_mfma_f32_16x16x32_bf16 v[40:43], a[176:179], a[84:87], v[40:43]
  v_exp_f32 v131, v67
  v_mfma_f32_16x16x32_bf16 v[40:43], a[168:171], a[76:79], v[40:43]
  ds_read_b128 a[200:203], v3 offset:2048
  v_cvt_pk_bf16_f32 v113, v130, v131
  v_mfma_f32_16x16x32_bf16 v[40:43], a[160:163], a[68:71], v[40:43]
  ds_read_b128 a[204:207], v3 offset:3072
  v_mfma_f32_16x16x32_bf16 v[48:51], a[160:163], a[96:99], v[240:243]
  v_exp_f32 v132, v68
  v_mfma_f32_16x16x32_bf16 v[48:51], a[168:171], a[104:107], v[48:51]
  s_and_b32 s65, s93, 0xffff
  s_add_u32 m0, s65, 65536
  v_exp_f32 v133, v69
  v_mfma_f32_16x16x32_bf16 v[48:51], a[176:179], a[112:115], v[48:51]
  ds_read_b128 a[208:211], v3 offset:4096
  v_cvt_pk_bf16_f32 v114, v132, v133
  v_mfma_f32_16x16x32_bf16 v[48:51], a[184:187], a[120:123], v[48:51]
  buffer_load_dwordx4 v1, s[24:27], s93 offen offset:0 sc1 lds
  v_mfma_f32_16x16x32_bf16 v[56:59], a[184:187], a[124:127], v[248:251]
  v_exp_f32 v134, v70
  v_mfma_f32_16x16x32_bf16 v[56:59], a[176:179], a[116:119], v[56:59]
  v_exp_f32 v135, v71
  v_mfma_f32_16x16x32_bf16 v[56:59], a[168:171], a[108:111], v[56:59]
  ds_read_b128 a[212:215], v3 offset:5120
  v_cvt_pk_bf16_f32 v115, v134, v135
  v_mfma_f32_16x16x32_bf16 v[56:59], a[160:163], a[100:103], v[56:59]
  buffer_load_dwordx4 v1, s[24:27], s93 offen offset:1024 sc1 lds
  v_mfma_f32_16x16x32_bf16 v[60:63], a[164:167], a[100:103], v[252:255]
  v_exp_f32 v128, v72
  v_mfma_f32_16x16x32_bf16 v[60:63], a[172:175], a[108:111], v[60:63]
  v_exp_f32 v129, v73
  v_mfma_f32_16x16x32_bf16 v[60:63], a[180:183], a[116:119], v[60:63]
  ds_read_b128 a[216:219], v3 offset:6144
  v_cvt_pk_bf16_f32 v116, v128, v129
  v_mfma_f32_16x16x32_bf16 v[60:63], a[188:191], a[124:127], v[60:63]
  buffer_load_dwordx4 v1, s[24:27], s93 offen offset:2048 sc1 lds
  v_mfma_f32_16x16x32_bf16 v[52:55], a[188:191], a[120:123], v[244:247]
  v_exp_f32 v130, v74
  v_mfma_f32_16x16x32_bf16 v[52:55], a[180:183], a[112:115], v[52:55]
  v_exp_f32 v131, v75
  v_mfma_f32_16x16x32_bf16 v[52:55], a[172:175], a[104:107], v[52:55]
  ds_read_b128 a[220:223], v3 offset:7168
  v_cvt_pk_bf16_f32 v117, v130, v131
  v_mfma_f32_16x16x32_bf16 v[52:55], a[164:167], a[96:99], v[52:55]
  buffer_load_dwordx4 v1, s[24:27], s93 offen offset:3072 sc1 lds
  v_mfma_f32_16x16x32_bf16 v[44:47], a[164:167], a[68:71], v[236:239]
  s_add_u32 s93, s93, 16384
  v_exp_f32 v132, v76
  v_mfma_f32_16x16x32_bf16 v[44:47], a[172:175], a[76:79], v[44:47]
  v_exp_f32 v133, v77
  v_mfma_f32_16x16x32_bf16 v[44:47], a[180:183], a[84:87], v[44:47]
  v_cvt_pk_bf16_f32 v118, v132, v133
  v_mfma_f32_16x16x32_bf16 v[44:47], a[188:191], a[92:95], v[44:47]
  v_add_u32 v2, s88, v1
  v_mfma_f32_16x16x32_bf16 v[36:39], a[188:191], a[88:91], v[228:231]
  s_add_u32 s88, s88, 8192
  v_exp_f32 v134, v78
  v_mfma_f32_16x16x32_bf16 v[36:39], a[180:183], a[80:83], v[36:39]
  s_and_b32 s88, s88, 0xffff
  v_exp_f32 v135, v79
  v_mfma_f32_16x16x32_bf16 v[36:39], a[172:175], a[72:75], v[36:39]
  v_cvt_pk_bf16_f32 v119, v134, v135
  v_mfma_f32_16x16x32_bf16 v[36:39], a[164:167], a[64:67], v[36:39]
  s_sub_u32 s3, 3, s60
  s_cmp_lt_i32 s3, 0
  s_cselect_b32 s100, s90, s91
  s_cmp_gt_i32 s3, 0
  s_cselect_b32 s101, s91, s90
  v_max_f32 v144, s100, v140
  v_max_f32 v145, s100, v141
  s_waitcnt vmcnt(20) lgkmcnt(0)
  s_barrier
  v_mfma_f32_16x16x32_bf16 a[224:227], a[240:243], v[96:99], a[224:227]
  ds_read_b128 a[160:163], v2 offset:0
  v_max_f32 v146, s100, v142
  v_mfma_f32_16x16x32_bf16 a[228:231], a[240:243], v[100:103], a[228:231]
  ds_read_b128 a[164:167], v2 offset:1024
  v_max_f32 v147, s100, v143
  v_mfma_f32_16x16x32_bf16 a[232:235], a[240:243], v[104:107], a[232:235]
  ds_read_b128 a[168:171], v2 offset:2048
  v_min_f32 v244, s100, v138
  v_mfma_f32_16x16x32_bf16 a[236:239], a[240:243], v[108:111], a[236:239]
  ds_read_b128 a[172:175], v2 offset:3072
  v_min_f32 v245, s100, v138
  v_mfma_f32_16x16x32_bf16 v[164:167], a[192:195], v[108:111], v[164:167]
  s_add_u32 s89, s89, 8192
  v_exp_f32 v128, v80
  v_mfma_f32_16x16x32_bf16 v[160:163], a[192:195], v[104:107], v[160:163]
  s_and_b32 s89, s89, 0xffff
  v_exp_f32 v129, v81
  v_mfma_f32_16x16x32_bf16 a[4:7], a[192:195], v[100:103], a[4:7]
  ds_read_b128 a[176:179], v2 offset:4096
  v_cvt_pk_bf16_f32 v120, v128, v129
  v_mfma_f32_16x16x32_bf16 a[0:3], a[192:195], v[96:99], a[0:3]
  ds_read_b128 a[180:183], v2 offset:5120
  v_min_f32 v246, s100, v138
  v_mfma_f32_16x16x32_bf16 a[8:11], a[196:199], v[96:99], a[8:11]
  s_or_b32 s89, s89, 0x10000
  v_exp_f32 v130, v82
  v_mfma_f32_16x16x32_bf16 a[12:15], a[196:199], v[100:103], a[12:15]
  v_exp_f32 v131, v83
  v_mfma_f32_16x16x32_bf16 v[168:171], a[196:199], v[104:107], v[168:171]
  ds_read_b128 a[184:187], v2 offset:6144
  v_cvt_pk_bf16_f32 v121, v130, v131
  v_mfma_f32_16x16x32_bf16 v[172:175], a[196:199], v[108:111], v[172:175]
  ds_read_b128 a[188:191], v2 offset:7168
  v_min_f32 v247, s100, v138
  v_mfma_f32_16x16x32_bf16 v[180:183], a[200:203], v[108:111], v[180:183]
  v_exp_f32 v132, v84
  v_mfma_f32_16x16x32_bf16 v[176:179], a[200:203], v[104:107], v[176:179]
  v_exp_f32 v133, v85
  v_mfma_f32_16x16x32_bf16 a[20:23], a[200:203], v[100:103], a[20:23]
  v_cvt_pk_bf16_f32 v122, v132, v133
  v_min3_f32 v240, v138, v144, s101
  v_mfma_f32_16x16x32_bf16 a[16:19], a[200:203], v[96:99], a[16:19]
  v_min3_f32 v241, v138, v145, s101
  v_min3_f32 v242, v138, v146, s101
  v_mfma_f32_16x16x32_bf16 a[24:27], a[204:207], v[96:99], a[24:27]
  v_exp_f32 v134, v86
  v_mfma_f32_16x16x32_bf16 a[28:31], a[204:207], v[100:103], a[28:31]
  v_exp_f32 v135, v87
  v_mfma_f32_16x16x32_bf16 v[184:187], a[204:207], v[104:107], v[184:187]
  v_cvt_pk_bf16_f32 v123, v134, v135
  v_min3_f32 v243, v138, v147, s101
  v_mfma_f32_16x16x32_bf16 v[188:191], a[204:207], v[108:111], v[188:191]
  v_min3_f32 v252, v139, v144, s101
  v_min3_f32 v253, v139, v145, s101
  v_mfma_f32_16x16x32_bf16 v[196:199], a[208:211], v[108:111], v[196:199]
  v_exp_f32 v128, v88
  v_mfma_f32_16x16x32_bf16 v[192:195], a[208:211], v[104:107], v[192:195]
  v_exp_f32 v129, v89
  v_mfma_f32_16x16x32_bf16 a[36:39], a[208:211], v[100:103], a[36:39]
  v_cvt_pk_bf16_f32 v124, v128, v129
  v_min3_f32 v254, v139, v146, s101
  v_mfma_f32_16x16x32_bf16 a[32:35], a[208:211], v[96:99], a[32:35]
  v_min3_f32 v255, v139, v147, s101
  v_min_f32 v248, s101, v139
  v_mfma_f32_16x16x32_bf16 a[40:43], a[212:215], v[96:99], a[40:43]
  v_exp_f32 v130, v90
  v_mfma_f32_16x16x32_bf16 a[44:47], a[212:215], v[100:103], a[44:47]
  v_exp_f32 v131, v91
  v_mfma_f32_16x16x32_bf16 v[200:203], a[212:215], v[104:107], v[200:203]
  v_cvt_pk_bf16_f32 v125, v130, v131
  v_min_f32 v249, s101, v139
  v_mfma_f32_16x16x32_bf16 v[204:207], a[212:215], v[108:111], v[204:207]
  v_min_f32 v250, s101, v139
  v_min_f32 v251, s101, v139
  v_mfma_f32_16x16x32_bf16 v[212:215], a[216:219], v[108:111], v[212:215]
  v_exp_f32 v132, v92
  v_mfma_f32_16x16x32_bf16 v[208:211], a[216:219], v[104:107], v[208:211]
  v_exp_f32 v133, v93
  v_mfma_f32_16x16x32_bf16 a[52:55], a[216:219], v[100:103], a[52:55]
  v_cvt_pk_bf16_f32 v126, v132, v133
  v_mfma_f32_16x16x32_bf16 a[48:51], a[216:219], v[96:99], a[48:51]
  v_add_u32 v3, s89, v1
  v_mfma_f32_16x16x32_bf16 a[56:59], a[220:223], v[96:99], a[56:59]
  v_exp_f32 v134, v94
  v_mfma_f32_16x16x32_bf16 a[60:63], a[220:223], v[100:103], a[60:63]
  v_exp_f32 v135, v95
  v_mfma_f32_16x16x32_bf16 v[216:219], a[220:223], v[104:107], v[216:219]
  v_cvt_pk_bf16_f32 v127, v134, v135
  v_mfma_f32_16x16x32_bf16 v[220:223], a[220:223], v[108:111], v[220:223]
  s_cmp_eq_u32 s62, 7
  s_cbranch_scc1 LW0
.p2align 5
LZ4:
  s_waitcnt lgkmcnt(0)
  v_mfma_f32_16x16x32_bf16 v[64:67], a[160:163], a[64:67], v[224:227]
  s_cmp_ge_u32 s86, 10
  v_exp_f32 v128, v32
  v_mfma_f32_16x16x32_bf16 v[64:67], a[168:171], a[72:75], v[64:67]
  s_cselect_b32 s63, 0xff00, 0
  v_exp_f32 v129, v33
  v_mfma_f32_16x16x32_bf16 v[64:67], a[176:179], a[80:83], v[64:67]
  ds_read_b128 a[192:195], v3 offset:0
  v_cvt_pk_bf16_f32 v96, v128, v129
  v_mfma_f32_16x16x32_bf16 v[64:67], a[184:187], a[88:91], v[64:67]
  ds_read_b128 a[196:199], v3 offset:1024
  v_cmp_eq_u32 vcc, 0, v25
  v_mfma_f32_16x16x32_bf16 v[72:75], a[184:187], a[92:95], v[232:235]
  s_add_u32 s86, s86, 4
  v_exp_f32 v130, v34
  v_mfma_f32_16x16x32_bf16 v[72:75], a[176:179], a[84:87], v[72:75]
  s_and_b32 s63, vcc_lo, s63
  v_exp_f32 v131, v35
  s_cbranch_scc1 Lslow_Z4
Lback_Z4:
  v_mfma_f32_16x16x32_bf16 v[72:75], a[168:171], a[76:79], v[72:75]
  ds_read_b128 a[200:203], v3 offset:2048
  v_accvgpr_write_b32 a244, -1
  v_cvt_pk_bf16_f32 v97, v130, v131
  v_mfma_f32_16x16x32_bf16 v[72:75], a[160:163], a[68:71], v[72:75]
  ds_read_b128 a[204:207], v3 offset:3072
  v_accvgpr_write_b32 a245, -1
  v_mfma_f32_16x16x32_bf16 v[80:83], a[160:163], a[96:99], v[240:243]
  v_accvgpr_write_b32 a246, -1
  v_exp_f32 v132, v36
  v_mfma_f32_16x16x32_bf16 v[80:83], a[168:171], a[104:107], v[80:83]
  v_accvgpr_write_b32 a247, -1
  v_exp_f32 v133, v37
  v_mfma_f32_16x16x32_bf16 v[80:83], a[176:179], a[112:115], v[80:83]
  ds_read_b128 a[208:211], v3 offset:4096
  v_cvt_pk_bf16_f32 v98, v132, v133
  v_mfma_f32_16x16x32_bf16 v[80:83], a[184:187], a[120:123], v[80:83]
  buffer_store_dwordx4 a[244:247], v1, s[40:43], s14 offen offset:0 sc1
  v_mfma_f32_16x16x32_bf16 v[88:91], a[184:187], a[124:127], v[248:251]
  v_sub_u32 v156, v5, v1
  v_exp_f32 v134, v38
  v_mfma_f32_16x16x32_bf16 v[88:91], a[176:179], a[116:119], v[88:91]
  v_add_u32 v156, v156, v0
  v_exp_f32 v135, v39
  v_mfma_f32_16x16x32_bf16 v[88:91], a[168:171], a[108:111], v[88:91]
  ds_read_b128 a[212:215], v3 offset:5120
  v_cvt_pk_bf16_f32 v99, v134, v135
  v_mfma_f32_16x16x32_bf16 v[88:91], a[160:163], a[100:103], v[88:91]
  buffer_store_dwordx4 a[244:247], v1, s[40:43], s14 offen offset:1024 sc1
  v_mfma_f32_16x16x32_bf16 v[92:95], a[164:167], a[100:103], v[252:255]
  v_exp_f32 v128, v40
  v_mfma_f32_16x16x32_bf16 v[92:95], a[172:175], a[108:111], v[92:95]
  v_exp_f32 v129, v41
  v_mfma_f32_16x16x32_bf16 v[92:95], a[180:183], a[116:119], v[92:95]
  ds_read_b128 a[216:219], v3 offset:6144
  v_cvt_pk_bf16_f32 v100, v128, v129
  v_mfma_f32_16x16x32_bf16 v[92:95], a[188:191], a[124:127], v[92:95]
  buffer_store_dwordx4 a[244:247], v1, s[40:43], s15 offen offset:0 sc1
  v_mfma_f32_16x16x32_bf16 v[84:87], a[188:191], a[120:123], v[244:247]
  v_exp_f32 v130, v42
  v_mfma_f32_16x16x32_bf16 v[84:87], a[180:183], a[112:115], v[84:87]
  v_exp_f32 v131, v43
  v_mfma_f32_16x16x32_bf16 v[84:87], a[172:175], a[104:107], v[84:87]
  ds_read_b128 a[220:223], v3 offset:7168
  v_cvt_pk_bf16_f32 v101, v130, v131
  v_mfma_f32_16x16x32_bf16 v[84:87], a[164:167], a[96:99], v[84:87]
  buffer_store_dwordx4 a[244:247], v1, s[40:43], s15 offen offset:1024 sc1
  v_mfma_f32_16x16x32_bf16 v[76:79], a[164:167], a[68:71], v[236:239]
  s_add_u32 s88, s88, s4
  v_exp_f32 v132, v44
  v_mfma_f32_16x16x32_bf16 v[76:79], a[172:175], a[76:79], v[76:79]
  v_exp_f32 v133, v45
  v_mfma_f32_16x16x32_bf16 v[76:79], a[180:183], a[84:87], v[76:79]
  ds_read2st64_b32 v[138:139], v156 offset1:1
  v_cvt_pk_bf16_f32 v102, v132, v133
  v_mfma_f32_16x16x32_bf16 v[76:79], a[188:191], a[92:95], v[76:79]
  v_add_u32 v2, s88, v1
  v_mfma_f32_16x16x32_bf16 v[68:71], a[188:191], a[88:91], v[228:231]
  s_add_u32 s88, s88, 16384
  v_exp_f32 v134, v46
  v_mfma_f32_16x16x32_bf16 v[68:71], a[180:183], a[80:83], v[68:71]
  s_and_b32 s88, s88, 0xffff
  v_exp_f32 v135, v47
  v_mfma_f32_16x16x32_bf16 v[68:71], a[172:175], a[72:75], v[68:71]
  v_cvt_pk_bf16_f32 v103, v134, v135
  v_mfma_f32_16x16x32_bf16 v[68:71], a[164:167], a[64:67], v[68:71]
  buffer_store_dwordx4 a[244:247], v1, s[40:43], s16 offen offset:0 sc1
  s_waitcnt vmcnt(16) lgkmcnt(0)
  s_barrier
  v_mfma_f32_16x16x32_bf16 a[224:227], a[240:243], v[112:115], a[224:227]
  ds_read_b128 a[160:163], v2 offset:0
  v_mov_b32 v240, v138
  v_mov_b32 v241, v138
  v_mfma_f32_16x16x32_bf16 a[228:231], a[240:243], v[116:119], a[228:231]
  ds_read_b128 a[164:167], v2 offset:1024
  v_mov_b32 v242, v138
  v_mfma_f32_16x16x32_bf16 a[232:235], a[240:243], v[120:123], a[232:235]
  ds_read_b128 a[168:171], v2 offset:2048
  v_mov_b32 v243, v138
  v_mfma_f32_16x16x32_bf16 a[236:239], a[240:243], v[124:127], a[236:239]
  ds_read_b128 a[172:175], v2 offset:3072
  v_mov_b32 v244, v138
  v_mfma_f32_16x16x32_bf16 v[164:167], a[192:195], v[124:127], v[164:167]
  s_add_u32 s89, s89, 8192
  v_exp_f32 v128, v48
  v_mfma_f32_16x16x32_bf16 v[160:163], a[192:195], v[120:123], v[160:163]
  s_and_b32 s89, s89, 0xffff
  v_exp_f32 v129, v49
  v_mfma_f32_16x16x32_bf16 a[4:7], a[192:195], v[116:119], a[4:7]
  ds_read_b128 a[176:179], v2 offset:4096
  v_cvt_pk_bf16_f32 v104, v128, v129
  v_mfma_f32_16x16x32_bf16 a[0:3], a[192:195], v[112:115], a[0:3]
  ds_read_b128 a[180:183], v2 offset:5120
  v_mov_b32 v245, v138
  v_mfma_f32_16x16x32_bf16 a[8:11], a[196:199], v[112:115], a[8:11]
  s_or_b32 s89, s89, 0x10000
  v_exp_f32 v130, v50
  v_mov_b32 v246, v138
  v_mfma_f32_16x16x32_bf16 a[12:15], a[196:199], v[116:119], a[12:15]
  v_exp_f32 v131, v51
  v_mfma_f32_16x16x32_bf16 v[168:171], a[196:199], v[120:123], v[168:171]
  ds_read_b128 a[184:187], v2 offset:6144
  v_cvt_pk_bf16_f32 v105, v130, v131
  v_mfma_f32_16x16x32_bf16 v[172:175], a[196:199], v[124:127], v[172:175]
  ds_read_b128 a[188:191], v2 offset:7168
  v_mov_b32 v247, v138
  v_mfma_f32_16x16x32_bf16 v[180:183], a[200:203], v[124:127], v[180:183]
  v_exp_f32 v132, v52
  v_mfma_f32_16x16x32_bf16 v[176:179], a[200:203], v[120:123], v[176:179]
  s_and_b32 m0, s92, 0xffff
  v_exp_f32 v133, v53
  v_mfma_f32_16x16x32_bf16 a[20:23], a[200:203], v[116:119], a[20:23]
  v_cvt_pk_bf16_f32 v106, v132, v133
  v_mov_b32 v248, v139
  v_mfma_f32_16x16x32_bf16 a[16:19], a[200:203], v[112:115], a[16:19]
  buffer_load_dwordx4 v1, s[20:23], s92 offen offset:0 sc1 lds
  v_mfma_f32_16x16x32_bf16 a[24:27], a[204:207], v[112:115], a[24:27]
  v_exp_f32 v134, v54
  v_mfma_f32_16x16x32_bf16 a[28:31], a[204:207], v[116:119], a[28:31]
  v_exp_f32 v135, v55
  v_mov_b32 v249, v139
  v_mfma_f32_16x16x32_bf16 v[184:187], a[204:207], v[120:123], v[184:187]
  v_cvt_pk_bf16_f32 v107, v134, v135
  v_mov_b32 v250, v139
  v_mfma_f32_16x16x32_bf16 v[188:191], a[204:207], v[124:127], v[188:191]
  buffer_load_dwordx4 v1, s[20:23], s92 offen offset:1024 sc1 lds
  v_mfma_f32_16x16x32_bf16 v[196:199], a[208:211], v[124:127], v[196:199]
  v_exp_f32 v128, v56
  v_mfma_f32_16x16x32_bf16 v[192:195], a[208:211], v[120:123], v[192:195]
  v_exp_f32 v129, v57
  v_mfma_f32_16x16x32_bf16 a[36:39], a[208:211], v[116:119], a[36:39]
  v_cvt_pk_bf16_f32 v108, v128, v129
  v_mov_b32 v251, v139
  v_mfma_f32_16x16x32_bf16 a[32:35], a[208:211], v[112:115], a[32:35]
  buffer_load_dwordx4 v1, s[20:23], s92 offen offset:2048 sc1 lds
  v_mfma_f32_16x16x32_bf16 a[40:43], a[212:215], v[112:115], a[40:43]
  v_exp_f32 v130, v58
  v_mfma_f32_16x16x32_bf16 a[44:47], a[212:215], v[116:119], a[44:47]
  v_exp_f32 v131, v59
  v_mfma_f32_16x16x32_bf16 v[200:203], a[212:215], v[120:123], v[200:203]
  v_cvt_pk_bf16_f32 v109, v130, v131
  v_mov_b32 v252, v139
  v_mov_b32 v253, v139
  v_mfma_f32_16x16x32_bf16 v[204:207], a[212:215], v[124:127], v[204:207]
  buffer_load_dwordx4 v1, s[20:23], s92 offen offset:3072 sc1 lds
  v_mfma_f32_16x16x32_bf16 v[212:215], a[216:219], v[124:127], v[212:215]
  s_add_u32 s92, s92, 16384
  v_exp_f32 v132, v60
  v_mfma_f32_16x16x32_bf16 v[208:211], a[216:219], v[120:123], v[208:211]
  v_exp_f32 v133, v61
  v_mfma_f32_16x16x32_bf16 a[52:55], a[216:219], v[116:119], a[52:55]
  v_cvt_pk_bf16_f32 v110, v132, v133
  v_mov_b32 v254, v139
  v_mfma_f32_16x16x32_bf16 a[48:51], a[216:219], v[112:115], a[48:51]
  buffer_store_dwordx4 a[244:247], v1, s[40:43], s16 offen offset:1024 sc1
  v_add_u32 v3, s89, v1
  v_mfma_f32_16x16x32_bf16 a[56:59], a[220:223], v[112:115], a[56:59]
  v_exp_f32 v134, v62
  v_mfma_f32_16x16x32_bf16 a[60:63], a[220:223], v[116:119], a[60:63]
  v_exp_f32 v135, v63
  v_mfma_f32_16x16x32_bf16 v[216:219], a[220:223], v[120:123], v[216:219]
  v_cvt_pk_bf16_f32 v111, v134, v135
  v_mov_b32 v255, v139
  v_mfma_f32_16x16x32_bf16 v[220:223], a[220:223], v[124:127], v[220:223]
  buffer_load_dword v25, v0, s[40:43], s66 offen sc1
  s_waitcnt lgkmcnt(0)
  v_mfma_f32_16x16x32_bf16 v[32:35], a[160:163], a[64:67], v[224:227]
  v_exp_f32 v128, v64
  v_mfma_f32_16x16x32_bf16 v[32:35], a[168:171], a[72:75], v[32:35]
  v_exp_f32 v129, v65
  v_mfma_f32_16x16x32_bf16 v[32:35], a[176:179], a[80:83], v[32:35]
  ds_read_b128 a[192:195], v3 offset:0
  v_cvt_pk_bf16_f32 v112, v128, v129
  v_mfma_f32_16x16x32_bf16 v[32:35], a[184:187], a[88:91], v[32:35]
  ds_read_b128 a[196:199], v3 offset:1024
  v_mfma_f32_16x16x32_bf16 v[40:43], a[184:187], a[92:95], v[232:235]
  v_exp_f32 v130, v66
  v_mfma_f32_16x16x32_bf16 v[40:43], a[176:179], a[84:87], v[40:43]
  v_exp_f32 v131, v67
  v_mfma_f32_16x16x32_bf16 v[40:43], a[168:171], a[76:79], v[40:43]
  ds_read_b128 a[200:203], v3 offset:2048
  v_cvt_pk_bf16_f32 v113, v130, v131
  v_mfma_f32_16x16x32_bf16 v[40:43], a[160:163], a[68:71], v[40:43]
  ds_read_b128 a[204:207], v3 offset:3072
  v_mfma_f32_16x16x32_bf16 v[48:51], a[160:163], a[128:131], v[240:243]
  v_exp_f32 v132, v68
  v_mfma_f32_16x16x32_bf16 v[48:51], a[168:171], a[136:139], v[48:51]
  s_and_b32 s65, s93, 0xffff
  s_add_u32 m0, s65, 65536
  v_exp_f32 v133, v69
  v_mfma_f32_16x16x32_bf16 v[48:51], a[176:179], a[144:147], v[48:51]
  ds_read_b128 a[208:211], v3 offset:4096
  v_cvt_pk_bf16_f32 v114, v132, v133
  v_mfma_f32_16x16x32_bf16 v[48:51], a[184:187], a[152:155], v[48:51]
  buffer_load_dwordx4 v1, s[24:27], s93 offen offset:0 sc1 lds
  v_mfma_f32_16x16x32_bf16 v[56:59], a[184:187], a[156:159], v[248:251]
  v_exp_f32 v134, v70
  v_mfma_f32_16x16x32_bf16 v[56:59], a[176:179], a[148:151], v[56:59]
  v_exp_f32 v135, v71
  v_mfma_f32_16x16x32_bf16 v[56:59], a[168:171], a[140:143], v[56:59]
  ds_read_b128 a[212:215], v3 offset:5120
  v_cvt_pk_bf16_f32 v115, v134, v135
  v_mfma_f32_16x16x32_bf16 v[56:59], a[160:163], a[132:135], v[56:59]
  buffer_load_dwordx4 v1, s[24:27], s93 offen offset:1024 sc1 lds
  v_mfma_f32_16x16x32_bf16 v[60:63], a[164:167], a[132:135], v[252:255]
  v_exp_f32 v128, v72
  v_mfma_f32_16x16x32_bf16 v[60:63], a[172:175], a[140:143], v[60:63]
  v_exp_f32 v129, v73
  v_mfma_f32_16x16x32_bf16 v[60:63], a[180:183], a[148:151], v[60:63]
  ds_read_b128 a[216:219], v3 offset:6144
  v_cvt_pk_bf16_f32 v116, v128, v129
  v_mfma_f32_16x16x32_bf16 v[60:63], a[188:191], a[156:159], v[60:63]
  buffer_load_dwordx4 v1, s[24:27], s93 offen offset:2048 sc1 lds
  v_mfma_f32_16x16x32_bf16 v[52:55], a[188:191], a[152:155], v[244:247]
  v_exp_f32 v130, v74
  v_mfma_f32_16x16x32_bf16 v[52:55], a[180:183], a[144:147], v[52:55]
  v_exp_f32 v131, v75
  v_mfma_f32_16x16x32_bf16 v[52:55], a[172:175], a[136:139], v[52:55]
  ds_read_b128 a[220:223], v3 offset:7168
  v_cvt_pk_bf16_f32 v117, v130, v131
  v_mfma_f32_16x16x32_bf16 v[52:55], a[164:167], a[128:131], v[52:55]
  buffer_load_dwordx4 v1, s[24:27], s93 offen offset:3072 sc1 lds
  v_mfma_f32_16x16x32_bf16 v[44:47], a[164:167], a[68:71], v[236:239]
  s_add_u32 s93, s93, 16384
  v_exp_f32 v132, v76
  v_mfma_f32_16x16x32_bf16 v[44:47], a[172:175], a[76:79], v[44:47]
  v_exp_f32 v133, v77
  v_mfma_f32_16x16x32_bf16 v[44:47], a[180:183], a[84:87], v[44:47]
  v_cvt_pk_bf16_f32 v118, v132, v133
  v_mfma_f32_16x16x32_bf16 v[44:47], a[188:191], a[92:95], v[44:47]
  v_add_u32 v2, s88, v1
  v_mfma_f32_16x16x32_bf16 v[36:39], a[188:191], a[88:91], v[228:231]
  s_add_u32 s88, s88, 16384
  v_exp_f32 v134, v78
  v_mfma_f32_16x16x32_bf16 v[36:39], a[180:183], a[80:83], v[36:39]
  s_and_b32 s88, s88, 0xffff
  v_exp_f32 v135, v79
  v_mfma_f32_16x16x32_bf16 v[36:39], a[172:175], a[72:75], v[36:39]
  v_cvt_pk_bf16_f32 v119, v134, v135
  v_mfma_f32_16x16x32_bf16 v[36:39], a[164:167], a[64:67], v[36:39]
  s_waitcnt vmcnt(17) lgkmcnt(0)
  s_barrier
  v_mfma_f32_16x16x32_bf16 a[224:227], a[240:243], v[96:99], a[224:227]
  ds_read_b128 a[160:163], v2 offset:0
  v_mfma_f32_16x16x32_bf16 a[228:231], a[240:243], v[100:103], a[228:231]
  ds_read_b128 a[164:167], v2 offset:1024
  v_mfma_f32_16x16x32_bf16 a[232:235], a[240:243], v[104:107], a[232:235]
  ds_read_b128 a[168:171], v2 offset:2048
  v_mfma_f32_16x16x32_bf16 a[236:239], a[240:243], v[108:111], a[236:239]
  ds_read_b128 a[172:175], v2 offset:3072
  v_mfma_f32_16x16x32_bf16 v[164:167], a[192:195], v[108:111], v[164:167]
  s_add_u32 s89, s89, 8192
  v_exp_f32 v128, v80
  v_mfma_f32_16x16x32_bf16 v[160:163], a[192:195], v[104:107], v[160:163]
  s_and_b32 s89, s89, 0xffff
  v_exp_f32 v129, v81
  v_mfma_f32_16x16x32_bf16 a[4:7], a[192:195], v[100:103], a[4:7]
  ds_read_b128 a[176:179], v2 offset:4096
  v_cvt_pk_bf16_f32 v120, v128, v129
  v_mfma_f32_16x16x32_bf16 a[0:3], a[192:195], v[96:99], a[0:3]
  ds_read_b128 a[180:183], v2 offset:5120
  v_mfma_f32_16x16x32_bf16 a[8:11], a[196:199], v[96:99], a[8:11]
  s_or_b32 s89, s89, 0x10000
  v_exp_f32 v130, v82
  v_mfma_f32_16x16x32_bf16 a[12:15], a[196:199], v[100:103], a[12:15]
  v_exp_f32 v131, v83
  v_mfma_f32_16x16x32_bf16 v[168:171], a[196:199], v[104:107], v[168:171]
  ds_read_b128 a[184:187], v2 offset:6144
  v_cvt_pk_bf16_f32 v121, v130, v131
  v_mfma_f32_16x16x32_bf16 v[172:175], a[196:199], v[108:111], v[172:175]
  ds_read_b128 a[188:191], v2 offset:7168
  v_mfma_f32_16x16x32_bf16 v[180:183], a[200:203], v[108:111], v[180:183]
  v_exp_f32 v132, v84
  v_mfma_f32_16x16x32_bf16 v[176:179], a[200:203], v[104:107], v[176:179]
  v_exp_f32 v133, v85
  v_mfma_f32_16x16x32_bf16 a[20:23], a[200:203], v[100:103], a[20:23]
  v_cvt_pk_bf16_f32 v122, v132, v133
  v_mfma_f32_16x16x32_bf16 a[16:19], a[200:203], v[96:99], a[16:19]
  v_lshlrev_b32 v22, 2, v23
  v_mfma_f32_16x16x32_bf16 a[24:27], a[204:207], v[96:99], a[24:27]
  v_exp_f32 v134, v86
  v_mfma_f32_16x16x32_bf16 a[28:31], a[204:207], v[100:103], a[28:31]
  v_exp_f32 v135, v87
  v_mfma_f32_16x16x32_bf16 v[184:187], a[204:207], v[104:107], v[184:187]
  v_cvt_pk_bf16_f32 v123, v134, v135
  v_mfma_f32_16x16x32_bf16 v[188:191], a[204:207], v[108:111], v[188:191]
  buffer_load_dword v26, v22, s[28:31], 0 offen
  v_mfma_f32_16x16x32_bf16 v[196:199], a[208:211], v[108:111], v[196:199]
  v_exp_f32 v128, v88
  v_mfma_f32_16x16x32_bf16 v[192:195], a[208:211], v[104:107], v[192:195]
  v_exp_f32 v129, v89
  v_mfma_f32_16x16x32_bf16 a[36:39], a[208:211], v[100:103], a[36:39]
  v_cvt_pk_bf16_f32 v124, v128, v129
  v_mfma_f32_16x16x32_bf16 a[32:35], a[208:211], v[96:99], a[32:35]
  buffer_load_dword v26, v22, s[36:39], 0 offen
  v_mfma_f32_16x16x32_bf16 a[40:43], a[212:215], v[96:99], a[40:43]
  v_exp_f32 v130, v90
  v_mfma_f32_16x16x32_bf16 a[44:47], a[212:215], v[100:103], a[44:47]
  v_exp_f32 v131, v91
  v_mfma_f32_16x16x32_bf16 v[200:203], a[212:215], v[104:107], v[200:203]
  v_cvt_pk_bf16_f32 v125, v130, v131
  v_mfma_f32_16x16x32_bf16 v[204:207], a[212:215], v[108:111], v[204:207]
  v_mfma_f32_16x16x32_bf16 v[212:215], a[216:219], v[108:111], v[212:215]
  v_exp_f32 v132, v92
  v_mfma_f32_16x16x32_bf16 v[208:211], a[216:219], v[104:107], v[208:211]
  v_exp_f32 v133, v93
  v_mfma_f32_16x16x32_bf16 a[52:55], a[216:219], v[100:103], a[52:55]
  v_cvt_pk_bf16_f32 v126, v132, v133
  v_mfma_f32_16x16x32_bf16 a[48:51], a[216:219], v[96:99], a[48:51]
  v_add_u32 v3, s89, v1
  v_mfma_f32_16x16x32_bf16 a[56:59], a[220:223], v[96:99], a[56:59]
  v_exp_f32 v134, v94
  v_mfma_f32_16x16x32_bf16 a[60:63], a[220:223], v[100:103], a[60:63]
  v_exp_f32 v135, v95
  v_mfma_f32_16x16x32_bf16 v[216:219], a[220:223], v[104:107], v[216:219]
  v_cvt_pk_bf16_f32 v127, v134, v135
  v_mfma_f32_16x16x32_bf16 v[220:223], a[220:223], v[108:111], v[220:223]
  s_waitcnt lgkmcnt(0)
  v_mfma_f32_16x16x32_bf16 v[64:67], a[160:163], a[64:67], v[224:227]
  v_exp_f32 v128, v32
  v_mfma_f32_16x16x32_bf16 v[64:67], a[168:171], a[72:75], v[64:67]
  v_exp_f32 v129, v33
  v_mfma_f32_16x16x32_bf16 v[64:67], a[176:179], a[80:83], v[64:67]
  ds_read_b128 a[192:195], v3 offset:0
  v_cvt_pk_bf16_f32 v96, v128, v129
  v_mfma_f32_16x16x32_bf16 v[64:67], a[184:187], a[88:91], v[64:67]
  ds_read_b128 a[196:199], v3 offset:1024
  v_mfma_f32_16x16x32_bf16 v[72:75], a[184:187], a[92:95], v[232:235]
  v_exp_f32 v130, v34
  v_mfma_f32_16x16x32_bf16 v[72:75], a[176:179], a[84:87], v[72:75]
  v_exp_f32 v131, v35
  v_mfma_f32_16x16x32_bf16 v[72:75], a[168:171], a[76:79], v[72:75]
  ds_read_b128 a[200:203], v3 offset:2048
  v_cvt_pk_bf16_f32 v97, v130, v131
  v_mfma_f32_16x16x32_bf16 v[72:75], a[160:163], a[68:71], v[72:75]
  ds_read_b128 a[204:207], v3 offset:3072
  v_mfma_f32_16x16x32_bf16 v[80:83], a[160:163], a[128:131], v[240:243]
  v_exp_f32 v132, v36
  v_mfma_f32_16x16x32_bf16 v[80:83], a[168:171], a[136:139], v[80:83]
  s_and_b32 m0, s92, 0xffff
  v_exp_f32 v133, v37
  v_mfma_f32_16x16x32_bf16 v[80:83], a[176:179], a[144:147], v[80:83]
  ds_read_b128 a[208:211], v3 offset:4096
  v_cvt_pk_bf16_f32 v98, v132, v133
  v_mfma_f32_16x16x32_bf16 v[80:83], a[184:187], a[152:155], v[80:83]
  buffer_load_dwordx4 v1, s[20:23], s92 offen offset:0 sc1 lds
  v_mfma_f32_16x16x32_bf16 v[88:91], a[184:187], a[156:159], v[248:251]
  v_exp_f32 v134, v38
  v_mfma_f32_16x16x32_bf16 v[88:91], a[176:179], a[148:151], v[88:91]
  v_exp_f32 v135, v39
  v_mfma_f32_16x16x32_bf16 v[88:91], a[168:171], a[140:143], v[88:91]
  ds_read_b128 a[212:215], v3 offset:5120
  v_cvt_pk_bf16_f32 v99, v134, v135
  v_mfma_f32_16x16x32_bf16 v[88:91], a[160:163], a[132:135], v[88:91]
  buffer_load_dwordx4 v1, s[20:23], s92 offen offset:1024 sc1 lds
  v_mfma_f32_16x16x32_bf16 v[92:95], a[164:167], a[132:135], v[252:255]
  v_exp_f32 v128, v40
  v_mfma_f32_16x16x32_bf16 v[92:95], a[172:175], a[140:143], v[92:95]
  v_exp_f32 v129, v41
  v_mfma_f32_16x16x32_bf16 v[92:95], a[180:183], a[148:151], v[92:95]
  ds_read_b128 a[216:219], v3 offset:6144
  v_cvt_pk_bf16_f32 v100, v128, v129
  v_mfma_f32_16x16x32_bf16 v[92:95], a[188:191], a[156:159], v[92:95]
  buffer_load_dwordx4 v1, s[20:23], s92 offen offset:2048 sc1 lds
  v_mfma_f32_16x16x32_bf16 v[84:87], a[188:191], a[152:155], v[244:247]
  v_exp_f32 v130, v42
  v_mfma_f32_16x16x32_bf16 v[84:87], a[180:183], a[144:147], v[84:87]
  v_exp_f32 v131, v43
  v_mfma_f32_16x16x32_bf16 v[84:87], a[172:175], a[136:139], v[84:87]
  ds_read_b128 a[220:223], v3 offset:7168
  v_cvt_pk_bf16_f32 v101, v130, v131
  v_mfma_f32_16x16x32_bf16 v[84:87], a[164:167], a[128:131], v[84:87]
  buffer_load_dwordx4 v1, s[20:23], s92 offen offset:3072 sc1 lds
  v_mfma_f32_16x16x32_bf16 v[76:79], a[164:167], a[68:71], v[236:239]
  s_add_u32 s92, s92, 16384
  v_exp_f32 v132, v44
  v_mfma_f32_16x16x32_bf16 v[76:79], a[172:175], a[76:79], v[76:79]
  v_exp_f32 v133, v45
  v_mfma_f32_16x16x32_bf16 v[76:79], a[180:183], a[84:87], v[76:79]
  v_cvt_pk_bf16_f32 v102, v132, v133
  v_mfma_f32_16x16x32_bf16 v[76:79], a[188:191], a[92:95], v[76:79]
  v_add_u32 v2, s88, v1
  v_mfma_f32_16x16x32_bf16 v[68:71], a[188:191], a[88:91], v[228:231]
  s_add_u32 s88, s88, 16384
  v_exp_f32 v134, v46
  v_mfma_f32_16x16x32_bf16 v[68:71], a[180:183], a[80:83], v[68:71]
  s_and_b32 s88, s88, 0xffff
  v_exp_f32 v135, v47
  v_mfma_f32_16x16x32_bf16 v[68:71], a[172:175], a[72:75], v[68:71]
  v_cvt_pk_bf16_f32 v103, v134, v135
  v_mfma_f32_16x16x32_bf16 v[68:71], a[164:167], a[64:67], v[68:71]
  s_waitcnt vmcnt(13) lgkmcnt(0)
  s_barrier
  v_mfma_f32_16x16x32_bf16 a[232:235], a[240:243], v[120:123], a[232:235]
  ds_read_b128 a[160:163], v2 offset:0
  v_mfma_f32_16x16x32_bf16 a[236:239], a[240:243], v[124:127], a[236:239]
  ds_read_b128 a[164:167], v2 offset:1024
  v_mfma_f32_16x16x32_bf16 v[164:167], a[192:195], v[124:127], v[164:167]
  ds_read_b128 a[168:171], v2 offset:2048
  v_mfma_f32_16x16x32_bf16 v[160:163], a[192:195], v[120:123], v[160:163]
  ds_read_b128 a[172:175], v2 offset:3072
  v_mfma_f32_16x16x32_bf16 v[168:171], a[196:199], v[120:123], v[168:171]
  s_add_u32 s89, s89, 8192
  v_exp_f32 v128, v48
  v_mfma_f32_16x16x32_bf16 v[172:175], a[196:199], v[124:127], v[172:175]
  s_and_b32 s89, s89, 0xffff
  v_exp_f32 v129, v49
  v_mfma_f32_16x16x32_bf16 v[180:183], a[200:203], v[124:127], v[180:183]
  ds_read_b128 a[176:179], v2 offset:4096
  v_cvt_pk_bf16_f32 v104, v128, v129
  v_mfma_f32_16x16x32_bf16 v[176:179], a[200:203], v[120:123], v[176:179]
  ds_read_b128 a[180:183], v2 offset:5120
  v_mfma_f32_16x16x32_bf16 v[184:187], a[204:207], v[120:123], v[184:187]
  s_or_b32 s89, s89, 0x10000
  v_exp_f32 v130, v50
  v_mfma_f32_16x16x32_bf16 v[188:191], a[204:207], v[124:127], v[188:191]
  s_add_u32 s89, s89, s4
  v_exp_f32 v131, v51
  v_mfma_f32_16x16x32_bf16 v[196:199], a[208:211], v[124:127], v[196:199]
  ds_read_b128 a[184:187], v2 offset:6144
  v_cvt_pk_bf16_f32 v105, v130, v131
  s_mov_b32 s100, 0x4e800000
  v_mfma_f32_16x16x32_bf16 v[192:195], a[208:211], v[120:123], v[192:195]
  ds_read_b128 a[188:191], v2 offset:7168
  v_accvgpr_read_b32 v152, a232
  v_mfma_f32_16x16x32_bf16 v[200:203], a[212:215], v[120:123], v[200:203]
  v_exp_f32 v132, v52
  v_mfma_f32_16x16x32_bf16 v[204:207], a[212:215], v[124:127], v[204:207]
  s_and_b32 s65, s93, 0xffff
  s_add_u32 m0, s65, 65536
  v_exp_f32 v133, v53
  v_mfma_f32_16x16x32_bf16 v[212:215], a[216:219], v[124:127], v[212:215]
  v_cvt_pk_bf16_f32 v106, v132, v133
  v_accvgpr_read_b32 v153, a236
  v_mfma_f32_16x16x32_bf16 v[208:211], a[216:219], v[120:123], v[208:211]
  buffer_load_dwordx4 v1, s[24:27], s93 offen offset:0 sc1 lds
  v_mfma_f32_16x16x32_bf16 v[216:219], a[220:223], v[120:123], v[216:219]
  v_exp_f32 v134, v54
  v_mfma_f32_16x16x32_bf16 v[220:223], a[220:223], v[124:127], v[220:223]
  v_exp_f32 v135, v55
  v_mfma_f32_16x16x32_bf16 a[224:227], a[240:243], v[112:115], a[224:227]
  v_cvt_pk_bf16_f32 v107, v134, v135
  v_rcp_f32 v148, v152
  v_mfma_f32_16x16x32_bf16 a[228:231], a[240:243], v[116:119], a[228:231]
  buffer_load_dwordx4 v1, s[24:27], s93 offen offset:1024 sc1 lds
  v_mfma_f32_16x16x32_bf16 a[4:7], a[192:195], v[116:119], a[4:7]
  v_exp_f32 v128, v56
  v_mfma_f32_16x16x32_bf16 a[0:3], a[192:195], v[112:115], a[0:3]
  v_exp_f32 v129, v57
  v_mfma_f32_16x16x32_bf16 a[8:11], a[196:199], v[112:115], a[8:11]
  v_cvt_pk_bf16_f32 v108, v128, v129
  v_rcp_f32 v150, v153
  v_mfma_f32_16x16x32_bf16 a[12:15], a[196:199], v[116:119], a[12:15]
  buffer_load_dwordx4 v1, s[24:27], s93 offen offset:2048 sc1 lds
  v_mfma_f32_16x16x32_bf16 a[20:23], a[200:203], v[116:119], a[20:23]
  v_exp_f32 v130, v58
  v_mfma_f32_16x16x32_bf16 a[16:19], a[200:203], v[112:115], a[16:19]
  v_exp_f32 v131, v59
  v_mfma_f32_16x16x32_bf16 a[24:27], a[204:207], v[112:115], a[24:27]
  v_cvt_pk_bf16_f32 v109, v130, v131
  v_cmp_nge_f32 vcc, s100, v152
  s_or_b64 s[68:69], s[68:69], vcc
  v_mfma_f32_16x16x32_bf16 a[28:31], a[204:207], v[116:119], a[28:31]
  buffer_load_dwordx4 v1, s[24:27], s93 offen offset:3072 sc1 lds
  v_mfma_f32_16x16x32_bf16 a[36:39], a[208:211], v[116:119], a[36:39]
  s_add_u32 s93, s93, 16384
  v_exp_f32 v132, v60
  v_mfma_f32_16x16x32_bf16 a[32:35], a[208:211], v[112:115], a[32:35]
  v_exp_f32 v133, v61
  v_mfma_f32_16x16x32_bf16 a[40:43], a[212:215], v[112:115], a[40:43]
  v_cvt_pk_bf16_f32 v110, v132, v133
  v_cmp_nge_f32 vcc, s100, v153
  s_or_b64 s[68:69], s[68:69], vcc
  v_mfma_f32_16x16x32_bf16 a[44:47], a[212:215], v[116:119], a[44:47]
  v_add_u32 v3, s89, v1
  v_mov_b32 v149, v148
  v_mfma_f32_16x16x32_bf16 a[52:55], a[216:219], v[116:119], a[52:55]
  v_exp_f32 v134, v62
  v_mfma_f32_16x16x32_bf16 a[48:51], a[216:219], v[112:115], a[48:51]
  v_exp_f32 v135, v63
  v_mfma_f32_16x16x32_bf16 a[56:59], a[220:223], v[112:115], a[56:59]
  v_cvt_pk_bf16_f32 v111, v134, v135
  v_mov_b32 v151, v150
  v_mfma_f32_16x16x32_bf16 a[60:63], a[220:223], v[116:119], a[60:63]
.p2align 3
  v_pk_mul_f32 v[160:161], v[160:161], v[148:149]
  v_pk_mul_f32 v[162:163], v[162:163], v[148:149]
  v_pk_mul_f32 v[168:169], v[168:169], v[148:149]
  v_pk_mul_f32 v[170:171], v[170:171], v[148:149]
  v_pk_mul_f32 v[176:177], v[176:177], v[148:149]
  v_pk_mul_f32 v[178:179], v[178:179], v[148:149]
  v_pk_mul_f32 v[184:185], v[184:185], v[148:149]
  v_pk_mul_f32 v[186:187], v[186:187], v[148:149]
  v_pk_mul_f32 v[192:193], v[192:193], v[148:149]
  v_pk_mul_f32 v[194:195], v[194:195], v[148:149]
  v_pk_mul_f32 v[200:201], v[200:201], v[148:149]
  v_pk_mul_f32 v[202:203], v[202:203], v[148:149]
  v_pk_mul_f32 v[208:209], v[208:209], v[148:149]
  v_pk_mul_f32 v[210:211], v[210:211], v[148:149]
  v_pk_mul_f32 v[216:217], v[216:217], v[148:149]
  v_pk_mul_f32 v[218:219], v[218:219], v[148:149]
  v_pk_mul_f32 v[164:165], v[164:165], v[150:151]
  v_pk_mul_f32 v[166:167], v[166:167], v[150:151]
  v_pk_mul_f32 v[172:173], v[172:173], v[150:151]
  v_pk_mul_f32 v[174:175], v[174:175], v[150:151]
  v_pk_mul_f32 v[180:181], v[180:181], v[150:151]
  v_pk_mul_f32 v[182:183], v[182:183], v[150:151]
  v_pk_mul_f32 v[188:189], v[188:189], v[150:151]
  v_pk_mul_f32 v[190:191], v[190:191], v[150:151]
  v_pk_mul_f32 v[196:197], v[196:197], v[150:151]
  v_pk_mul_f32 v[198:199], v[198:199], v[150:151]
  v_pk_mul_f32 v[204:205], v[204:205], v[150:151]
  v_pk_mul_f32 v[206:207], v[206:207], v[150:151]
  v_pk_mul_f32 v[212:213], v[212:213], v[150:151]
  v_pk_mul_f32 v[214:215], v[214:215], v[150:151]
  v_pk_mul_f32 v[220:221], v[220:221], v[150:151]
  v_pk_mul_f32 v[222:223], v[222:223], v[150:151]
  s_waitcnt lgkmcnt(0)
  v_mfma_f32_16x16x32_bf16 v[32:35], a[160:163], a[64:67], v[224:227]
  v_exp_f32 v128, v64
  v_cvt_pk_bf16_f32 v160, v160, v161
  v_mfma_f32_16x16x32_bf16 v[32:35], a[168:171], a[72:75], v[32:35]
  v_exp_f32 v129, v65
  v_mfma_f32_16x16x32_bf16 v[32:35], a[176:179], a[80:83], v[32:35]
  ds_read_b128 a[192:195], v3 offset:0
  v_cvt_pk_bf16_f32 v112, v128, v129
  v_cvt_pk_bf16_f32 v161, v162, v163
  v_mfma_f32_16x16x32_bf16 v[32:35], a[184:187], a[88:91], v[32:35]
  ds_read_b128 a[196:199], v3 offset:1024
  v_cvt_pk_bf16_f32 v162, v168, v169
  v_mfma_f32_16x16x32_bf16 v[40:43], a[184:187], a[92:95], v[232:235]
  v_exp_f32 v130, v66
  v_mfma_f32_16x16x32_bf16 v[40:43], a[176:179], a[84:87], v[40:43]
  v_exp_f32 v131, v67
  v_cvt_pk_bf16_f32 v163, v170, v171
  s_lshr_b32 s63, s74, 14
  s_mul_i32 s63, s63, 188416
  s_lshl_b32 s64, s61, 12
  s_add_u32 s63, s63, s64
  s_add_u32 s63, s63, 33554432
  v_mfma_f32_16x16x32_bf16 v[40:43], a[168:171], a[76:79], v[40:43]
  buffer_store_dwordx4 v[160:163], v1, s[40:43], s63 offen offset:0 sc1
  ds_read_b128 a[200:203], v3 offset:2048
  v_cvt_pk_bf16_f32 v113, v130, v131
  v_mfma_f32_16x16x32_bf16 v[40:43], a[160:163], a[68:71], v[40:43]
  ds_read_b128 a[204:207], v3 offset:3072
  v_cvt_pk_bf16_f32 v176, v176, v177
  v_mfma_f32_16x16x32_bf16 v[48:51], a[160:163], a[128:131], v[240:243]
  v_exp_f32 v132, v68
  v_cvt_pk_bf16_f32 v177, v178, v179
  v_mfma_f32_16x16x32_bf16 v[48:51], a[168:171], a[136:139], v[48:51]
  s_and_b32 m0, s92, 0xffff
  v_exp_f32 v133, v69
  v_mfma_f32_16x16x32_bf16 v[48:51], a[176:179], a[144:147], v[48:51]
  ds_read_b128 a[208:211], v3 offset:4096
  v_cvt_pk_bf16_f32 v114, v132, v133
  v_cvt_pk_bf16_f32 v178, v184, v185
  v_mfma_f32_16x16x32_bf16 v[48:51], a[184:187], a[152:155], v[48:51]
  buffer_load_dwordx4 v1, s[20:23], s92 offen offset:0 sc1 lds
  v_mfma_f32_16x16x32_bf16 v[56:59], a[184:187], a[156:159], v[248:251]
  v_exp_f32 v134, v70
  v_mfma_f32_16x16x32_bf16 v[56:59], a[176:179], a[148:151], v[56:59]
  v_exp_f32 v135, v71
  v_cvt_pk_bf16_f32 v179, v186, v187
  v_mfma_f32_16x16x32_bf16 v[56:59], a[168:171], a[140:143], v[56:59]
  buffer_store_dwordx4 v[176:179], v1, s[40:43], s63 offen offset:1024 sc1
  ds_read_b128 a[212:215], v3 offset:5120
  v_cvt_pk_bf16_f32 v115, v134, v135
  v_mfma_f32_16x16x32_bf16 v[56:59], a[160:163], a[132:135], v[56:59]
  buffer_load_dwordx4 v1, s[20:23], s92 offen offset:1024 sc1 lds
  v_mfma_f32_16x16x32_bf16 v[60:63], a[164:167], a[132:135], v[252:255]
  v_exp_f32 v128, v72
  v_cvt_pk_bf16_f32 v192, v192, v193
  v_mfma_f32_16x16x32_bf16 v[60:63], a[172:175], a[140:143], v[60:63]
  v_exp_f32 v129, v73
  v_mfma_f32_16x16x32_bf16 v[60:63], a[180:183], a[148:151], v[60:63]
  ds_read_b128 a[216:219], v3 offset:6144
  v_cvt_pk_bf16_f32 v116, v128, v129
  v_mfma_f32_16x16x32_bf16 v[60:63], a[188:191], a[156:159], v[60:63]
  buffer_load_dwordx4 v1, s[20:23], s92 offen offset:2048 sc1 lds
  v_cvt_pk_bf16_f32 v193, v194, v195
  v_mfma_f32_16x16x32_bf16 v[52:55], a[188:191], a[152:155], v[244:247]
  v_exp_f32 v130, v74
  v_mfma_f32_16x16x32_bf16 v[52:55], a[180:183], a[144:147], v[52:55]
  v_exp_f32 v131, v75
  v_cvt_pk_bf16_f32 v194, v200, v201
  v_mfma_f32_16x16x32_bf16 v[52:55], a[172:175], a[136:139], v[52:55]
  ds_read_b128 a[220:223], v3 offset:7168
  v_cvt_pk_bf16_f32 v117, v130, v131
  v_mfma_f32_16x16x32_bf16 v[52:55], a[164:167], a[128:131], v[52:55]
  buffer_load_dwordx4 v1, s[20:23], s92 offen offset:3072 sc1 lds
  v_mfma_f32_16x16x32_bf16 v[44:47], a[164:167], a[68:71], v[236:239]
  s_add_u32 s92, s92, 16384
  v_exp_f32 v132, v76
  v_cvt_pk_bf16_f32 v195, v202, v203
  v_mfma_f32_16x16x32_bf16 v[44:47], a[172:175], a[76:79], v[44:47]
  buffer_store_dwordx4 v[192:195], v1, s[40:43], s63 offen offset:2048 sc1
  v_exp_f32 v133, v77
  v_mfma_f32_16x16x32_bf16 v[44:47], a[180:183], a[84:87], v[44:47]
  v_cvt_pk_bf16_f32 v118, v132, v133
  v_cvt_pk_bf16_f32 v208, v208, v209
  v_mfma_f32_16x16x32_bf16 v[44:47], a[188:191], a[92:95], v[44:47]
  v_add_u32 v2, s88, v1
  v_cvt_pk_bf16_f32 v209, v210, v211
  v_cvt_pk_bf16_f32 v210, v216, v217
  v_mfma_f32_16x16x32_bf16 v[36:39], a[188:191], a[88:91], v[228:231]
  s_add_u32 s88, s88, 16384
  v_exp_f32 v134, v78
  v_mfma_f32_16x16x32_bf16 v[36:39], a[180:183], a[80:83], v[36:39]
  s_and_b32 s88, s88, 0xffff
  v_exp_f32 v135, v79
  v_cvt_pk_bf16_f32 v211, v218, v219
  v_mfma_f32_16x16x32_bf16 v[36:39], a[172:175], a[72:75], v[36:39]
  buffer_store_dwordx4 v[208:211], v1, s[40:43], s63 offen offset:3072 sc1
  v_cvt_pk_bf16_f32 v119, v134, v135
  v_cvt_pk_bf16_f32 v164, v164, v165
  v_mfma_f32_16x16x32_bf16 v[36:39], a[164:167], a[64:67], v[36:39]
  v_cvt_pk_bf16_f32 v165, v166, v167
  v_cvt_pk_bf16_f32 v166, v172, v173
  s_waitcnt vmcnt(17) lgkmcnt(0)
  s_barrier
  v_mfma_f32_16x16x32_bf16 a[224:227], a[240:243], v[96:99], a[224:227]
  ds_read_b128 a[160:163], v2 offset:0
  v_cvt_pk_bf16_f32 v167, v174, v175
  s_lshr_b32 s63, s75, 14
  s_mul_i32 s63, s63, 188416
  s_lshl_b32 s64, s61, 12
  s_add_u32 s63, s63, s64
  s_add_u32 s63, s63, 33554432
  v_cvt_pk_bf16_f32 v180, v180, v181
  v_mfma_f32_16x16x32_bf16 a[228:231], a[240:243], v[100:103], a[228:231]
  buffer_store_dwordx4 v[164:167], v1, s[40:43], s63 offen offset:0 sc1
  ds_read_b128 a[164:167], v2 offset:1024
  v_cvt_pk_bf16_f32 v181, v182, v183
  v_mfma_f32_16x16x32_bf16 a[4:7], a[192:195], v[100:103], a[4:7]
  ds_read_b128 a[168:171], v2 offset:2048
  v_cvt_pk_bf16_f32 v182, v188, v189
  v_mfma_f32_16x16x32_bf16 a[0:3], a[192:195], v[96:99], a[0:3]
  ds_read_b128 a[172:175], v2 offset:3072
  v_cvt_pk_bf16_f32 v183, v190, v191
  v_cvt_pk_bf16_f32 v196, v196, v197
  v_mfma_f32_16x16x32_bf16 a[8:11], a[196:199], v[96:99], a[8:11]
  buffer_store_dwordx4 v[180:183], v1, s[40:43], s63 offen offset:1024 sc1
  s_add_u32 s89, s89, 16384
  v_exp_f32 v128, v80
  v_mfma_f32_16x16x32_bf16 a[12:15], a[196:199], v[100:103], a[12:15]
  s_and_b32 s89, s89, 0xffff
  v_exp_f32 v129, v81
  v_mfma_f32_16x16x32_bf16 a[20:23], a[200:203], v[100:103], a[20:23]
  ds_read_b128 a[176:179], v2 offset:4096
  v_cvt_pk_bf16_f32 v120, v128, v129
  v_cvt_pk_bf16_f32 v197, v198, v199
  v_mfma_f32_16x16x32_bf16 a[16:19], a[200:203], v[96:99], a[16:19]
  ds_read_b128 a[180:183], v2 offset:5120
  v_cvt_pk_bf16_f32 v198, v204, v205
  v_mfma_f32_16x16x32_bf16 a[24:27], a[204:207], v[96:99], a[24:27]
  s_or_b32 s89, s89, 0x10000
  v_exp_f32 v130, v82
  v_cvt_pk_bf16_f32 v199, v206, v207
  v_mfma_f32_16x16x32_bf16 a[28:31], a[204:207], v[100:103], a[28:31]
  buffer_store_dwordx4 v[196:199], v1, s[40:43], s63 offen offset:2048 sc1
  v_exp_f32 v131, v83
  v_mfma_f32_16x16x32_bf16 a[36:39], a[208:211], v[100:103], a[36:39]
  ds_read_b128 a[184:187], v2 offset:6144
  v_cvt_pk_bf16_f32 v121, v130, v131
  v_mfma_f32_16x16x32_bf16 a[32:35], a[208:211], v[96:99], a[32:35]
  ds_read_b128 a[188:191], v2 offset:7168
  v_cvt_pk_bf16_f32 v212, v212, v213
  v_cvt_pk_bf16_f32 v213, v214, v215
  v_mfma_f32_16x16x32_bf16 a[40:43], a[212:215], v[96:99], a[40:43]
  v_exp_f32 v132, v84
  v_mfma_f32_16x16x32_bf16 a[44:47], a[212:215], v[100:103], a[44:47]
  s_and_b32 s65, s93, 0xffff
  s_add_u32 m0, s65, 65536
  v_exp_f32 v133, v85
  v_mfma_f32_16x16x32_bf16 a[52:55], a[216:219], v[100:103], a[52:55]
  v_cvt_pk_bf16_f32 v122, v132, v133
  v_cvt_pk_bf16_f32 v214, v220, v221
  v_cvt_pk_bf16_f32 v215, v222, v223
  v_mfma_f32_16x16x32_bf16 a[48:51], a[216:219], v[96:99], a[48:51]
  buffer_store_dwordx4 v[212:215], v1, s[40:43], s63 offen offset:3072 sc1
  buffer_load_dwordx4 v1, s[24:27], s93 offen offset:0 sc1 lds
  v_mfma_f32_16x16x32_bf16 a[56:59], a[220:223], v[96:99], a[56:59]
  v_exp_f32 v134, v86
  v_mfma_f32_16x16x32_bf16 a[60:63], a[220:223], v[100:103], a[60:63]
  v_exp_f32 v135, v87
  v_mfma_f32_16x16x32_bf16 a[232:235], a[240:243], v[104:107], 0
  v_cvt_pk_bf16_f32 v123, v134, v135
  v_mfma_f32_16x16x32_bf16 a[236:239], a[240:243], v[108:111], 0
  buffer_load_dwordx4 v1, s[24:27], s93 offen offset:1024 sc1 lds
  v_mfma_f32_16x16x32_bf16 v[164:167], a[192:195], v[108:111], 0
  v_exp_f32 v128, v88
  v_mfma_f32_16x16x32_bf16 v[160:163], a[192:195], v[104:107], 0
  v_exp_f32 v129, v89
  v_mfma_f32_16x16x32_bf16 v[168:171], a[196:199], v[104:107], 0
  v_cvt_pk_bf16_f32 v124, v128, v129
  v_mfma_f32_16x16x32_bf16 v[172:175], a[196:199], v[108:111], 0
  buffer_load_dwordx4 v1, s[24:27], s93 offen offset:2048 sc1 lds
  v_mfma_f32_16x16x32_bf16 v[180:183], a[200:203], v[108:111], 0
  v_exp_f32 v130, v90
  v_mfma_f32_16x16x32_bf16 v[176:179], a[200:203], v[104:107], 0
  v_exp_f32 v131, v91
  v_mfma_f32_16x16x32_bf16 v[184:187], a[204:207], v[104:107], 0
  v_cvt_pk_bf16_f32 v125, v130, v131
  v_mfma_f32_16x16x32_bf16 v[188:191], a[204:207], v[108:111], 0
  buffer_load_dwordx4 v1, s[24:27], s93 offen offset:3072 sc1 lds
  v_mfma_f32_16x16x32_bf16 v[196:199], a[208:211], v[108:111], 0
  s_add_u32 s93, s93, 16384
  v_exp_f32 v132, v92
  v_mfma_f32_16x16x32_bf16 v[192:195], a[208:211], v[104:107], 0
  v_exp_f32 v133, v93
  v_mfma_f32_16x16x32_bf16 v[200:203], a[212:215], v[104:107], 0
  s_add_u32 s63, s61, 0
  v_cvt_pk_bf16_f32 v126, v132, v133
  v_mfma_f32_16x16x32_bf16 v[204:207], a[212:215], v[108:111], 0
  v_add_u32 v3, s89, v1
  v_mfma_f32_16x16x32_bf16 v[212:215], a[216:219], v[108:111], 0
  v_exp_f32 v134, v94
  v_mfma_f32_16x16x32_bf16 v[208:211], a[216:219], v[104:107], 0
  v_exp_f32 v135, v95
  v_mfma_f32_16x16x32_bf16 v[216:219], a[220:223], v[104:107], 0
  v_cvt_pk_bf16_f32 v127, v134, v135
  v_mfma_f32_16x16x32_bf16 v[220:223], a[220:223], v[108:111], 0
  s_lshl_b64 exec, s[94:95], s63
  buffer_store_dword v27, v0, s[40:43], s82 offen sc1
  s_mov_b64 exec, -1
  s_cmp_eq_u32 s62, 6
  s_cbranch_scc1 LY0
.p2align 5
LB:
  s_waitcnt lgkmcnt(0)
  v_mfma_f32_16x16x32_bf16 v[64:67], a[160:163], a[64:67], v[224:227]
  s_cmp_ge_u32 s86, 10
  v_exp_f32 v128, v32
  v_mfma_f32_16x16x32_bf16 v[64:67], a[168:171], a[72:75], v[64:67]
  s_cselect_b32 s63, 0xff00, 0
  v_exp_f32 v129, v33
  v_mfma_f32_16x16x32_bf16 v[64:67], a[176:179], a[80:83], v[64:67]
  ds_read_b128 a[192:195], v3 offset:0
  v_cvt_pk_bf16_f32 v96, v128, v129
  v_mfma_f32_16x16x32_bf16 v[64:67], a[184:187], a[88:91], v[64:67]
  ds_read_b128 a[196:199], v3 offset:1024
  v_cmp_eq_u32 vcc, 0, v25
  v_mfma_f32_16x16x32_bf16 v[72:75], a[184:187], a[92:95], v[232:235]
  s_add_u32 s86, s86, 4
  v_exp_f32 v130, v34
  v_mfma_f32_16x16x32_bf16 v[72:75], a[176:179], a[84:87], v[72:75]
  s_and_b32 s63, vcc_lo, s63
  v_exp_f32 v131, v35
  s_cbranch_scc1 Lslow_B0
Lback_B0:
  v_mfma_f32_16x16x32_bf16 v[72:75], a[168:171], a[76:79], v[72:75]
  ds_read_b128 a[200:203], v3 offset:2048
  v_cvt_pk_bf16_f32 v97, v130, v131
  v_mfma_f32_16x16x32_bf16 v[72:75], a[160:163], a[68:71], v[72:75]
  ds_read_b128 a[204:207], v3 offset:3072
  v_mfma_f32_16x16x32_bf16 v[80:83], a[160:163], a[128:131], v[240:243]
  v_exp_f32 v132, v36
  v_mfma_f32_16x16x32_bf16 v[80:83], a[168:171], a[136:139], v[80:83]
  s_and_b32 m0, s92, 0xffff
  v_exp_f32 v133, v37
  v_mfma_f32_16x16x32_bf16 v[80:83], a[176:179], a[144:147], v[80:83]
  ds_read_b128 a[208:211], v3 offset:4096
  v_cvt_pk_bf16_f32 v98, v132, v133
  v_mfma_f32_16x16x32_bf16 v[80:83], a[184:187], a[152:155], v[80:83]
  buffer_load_dwordx4 v1, s[20:23], s92 offen offset:0 sc1 lds
  v_mfma_f32_16x16x32_bf16 v[88:91], a[184:187], a[156:159], v[248:251]
  v_exp_f32 v134, v38
  v_mfma_f32_16x16x32_bf16 v[88:91], a[176:179], a[148:151], v[88:91]
  v_exp_f32 v135, v39
  v_mfma_f32_16x16x32_bf16 v[88:91], a[168:171], a[140:143], v[88:91]
  ds_read_b128 a[212:215], v3 offset:5120
  v_cvt_pk_bf16_f32 v99, v134, v135
  v_mfma_f32_16x16x32_bf16 v[88:91], a[160:163], a[132:135], v[88:91]
  buffer_load_dwordx4 v1, s[20:23], s92 offen offset:1024 sc1 lds
  v_mfma_f32_16x16x32_bf16 v[92:95], a[164:167], a[132:135], v[252:255]
  v_exp_f32 v128, v40
  v_mfma_f32_16x16x32_bf16 v[92:95], a[172:175], a[140:143], v[92:95]
  v_exp_f32 v129, v41
  v_mfma_f32_16x16x32_bf16 v[92:95], a[180:183], a[148:151], v[92:95]
  ds_read_b128 a[216:219], v3 offset:6144
  v_cvt_pk_bf16_f32 v100, v128, v129
  v_mfma_f32_16x16x32_bf16 v[92:95], a[188:191], a[156:159], v[92:95]
  buffer_load_dwordx4 v1, s[20:23], s92 offen offset:2048 sc1 lds
  v_mfma_f32_16x16x32_bf16 v[84:87], a[188:191], a[152:155], v[244:247]
  v_exp_f32 v130, v42
  v_mfma_f32_16x16x32_bf16 v[84:87], a[180:183], a[144:147], v[84:87]
  v_exp_f32 v131, v43
  v_mfma_f32_16x16x32_bf16 v[84:87], a[172:175], a[136:139], v[84:87]
  ds_read_b128 a[220:223], v3 offset:7168
  v_cvt_pk_bf16_f32 v101, v130, v131
  v_mfma_f32_16x16x32_bf16 v[84:87], a[164:167], a[128:131], v[84:87]
  buffer_load_dwordx4 v1, s[20:23], s92 offen offset:3072 sc1 lds
  v_mfma_f32_16x16x32_bf16 v[76:79], a[164:167], a[68:71], v[236:239]
  s_add_u32 s92, s92, 16384
  v_exp_f32 v132, v44
  v_mfma_f32_16x16x32_bf16 v[76:79], a[172:175], a[76:79], v[76:79]
  v_exp_f32 v133, v45
  v_mfma_f32_16x16x32_bf16 v[76:79], a[180:183], a[84:87], v[76:79]
  v_cvt_pk_bf16_f32 v102, v132, v133
  v_mfma_f32_16x16x32_bf16 v[76:79], a[188:191], a[92:95], v[76:79]
  v_add_u32 v2, s88, v1
  v_mfma_f32_16x16x32_bf16 v[68:71], a[188:191], a[88:91], v[228:231]
  s_add_u32 s88, s88, 16384
  v_exp_f32 v134, v46
  v_mfma_f32_16x16x32_bf16 v[68:71], a[180:183], a[80:83], v[68:71]
  s_and_b32 s88, s88, 0xffff
  v_exp_f32 v135, v47
  v_mfma_f32_16x16x32_bf16 v[68:71], a[172:175], a[72:75], v[68:71]
  v_cvt_pk_bf16_f32 v103, v134, v135
  v_mfma_f32_16x16x32_bf16 v[68:71], a[164:167], a[64:67], v[68:71]
  s_waitcnt vmcnt(16) lgkmcnt(0)
  s_barrier
  v_mfma_f32_16x16x32_bf16 a[224:227], a[240:243], v[112:115], a[224:227]
  ds_read_b128 a[160:163], v2 offset:0
  v_mfma_f32_16x16x32_bf16 a[228:231], a[240:243], v[116:119], a[228:231]
  ds_read_b128 a[164:167], v2 offset:1024
  v_mfma_f32_16x16x32_bf16 a[232:235], a[240:243], v[120:123], a[232:235]
  ds_read_b128 a[168:171], v2 offset:2048
  v_mfma_f32_16x16x32_bf16 a[236:239], a[240:243], v[124:127], a[236:239]
  ds_read_b128 a[172:175], v2 offset:3072
  v_mfma_f32_16x16x32_bf16 v[164:167], a[192:195], v[124:127], v[164:167]
  s_add_u32 s89, s89, 16384
  v_exp_f32 v128, v48
  v_mfma_f32_16x16x32_bf16 v[160:163], a[192:195], v[120:123], v[160:163]
  s_and_b32 s89, s89, 0xffff
  v_exp_f32 v129, v49
  v_mfma_f32_16x16x32_bf16 a[4:7], a[192:195], v[116:119], a[4:7]
  ds_read_b128 a[176:179], v2 offset:4096
  v_cvt_pk_bf16_f32 v104, v128, v129
  v_mfma_f32_16x16x32_bf16 a[0:3], a[192:195], v[112:115], a[0:3]
  ds_read_b128 a[180:183], v2 offset:5120
  v_mfma_f32_16x16x32_bf16 a[8:11], a[196:199], v[112:115], a[8:11]
  s_or_b32 s89, s89, 0x10000
  v_exp_f32 v130, v50
  v_mfma_f32_16x16x32_bf16 a[12:15], a[196:199], v[116:119], a[12:15]
  v_exp_f32 v131, v51
  v_mfma_f32_16x16x32_bf16 v[168:171], a[196:199], v[120:123], v[168:171]
  ds_read_b128 a[184:187], v2 offset:6144
  v_cvt_pk_bf16_f32 v105, v130, v131
  v_mfma_f32_16x16x32_bf16 v[172:175], a[196:199], v[124:127], v[172:175]
  ds_read_b128 a[188:191], v2 offset:7168
  v_mfma_f32_16x16x32_bf16 v[180:183], a[200:203], v[124:127], v[180:183]
  v_exp_f32 v132, v52
  v_mfma_f32_16x16x32_bf16 v[176:179], a[200:203], v[120:123], v[176:179]
  s_and_b32 s65, s93, 0xffff
  s_add_u32 m0, s65, 65536
  v_exp_f32 v133, v53
  v_mfma_f32_16x16x32_bf16 a[20:23], a[200:203], v[116:119], a[20:23]
  v_cvt_pk_bf16_f32 v106, v132, v133
  v_mfma_f32_16x16x32_bf16 a[16:19], a[200:203], v[112:115], a[16:19]
  buffer_load_dwordx4 v1, s[24:27], s93 offen offset:0 sc1 lds
  v_mfma_f32_16x16x32_bf16 a[24:27], a[204:207], v[112:115], a[24:27]
  v_exp_f32 v134, v54
  v_mfma_f32_16x16x32_bf16 a[28:31], a[204:207], v[116:119], a[28:31]
  v_exp_f32 v135, v55
  v_mfma_f32_16x16x32_bf16 v[184:187], a[204:207], v[120:123], v[184:187]
  v_cvt_pk_bf16_f32 v107, v134, v135
  v_mfma_f32_16x16x32_bf16 v[188:191], a[204:207], v[124:127], v[188:191]
  buffer_load_dwordx4 v1, s[24:27], s93 offen offset:1024 sc1 lds
  v_mfma_f32_16x16x32_bf16 v[196:199], a[208:211], v[124:127], v[196:199]
  v_exp_f32 v128, v56
  v_mfma_f32_16x16x32_bf16 v[192:195], a[208:211], v[120:123], v[192:195]
  v_exp_f32 v129, v57
  v_mfma_f32_16x16x32_bf16 a[36:39], a[208:211], v[116:119], a[36:39]
  v_cvt_pk_bf16_f32 v108, v128, v129
  v_mfma_f32_16x16x32_bf16 a[32:35], a[208:211], v[112:115], a[32:35]
  buffer_load_dwordx4 v1, s[24:27], s93 offen offset:2048 sc1 lds
  v_mfma_f32_16x16x32_bf16 a[40:43], a[212:215], v[112:115], a[40:43]
  v_exp_f32 v130, v58
  v_mfma_f32_16x16x32_bf16 a[44:47], a[212:215], v[116:119], a[44:47]
  v_exp_f32 v131, v59
  v_mfma_f32_16x16x32_bf16 v[200:203], a[212:215], v[120:123], v[200:203]
  v_cvt_pk_bf16_f32 v109, v130, v131
  v_mfma_f32_16x16x32_bf16 v[204:207], a[212:215], v[124:127], v[204:207]
  buffer_load_dwordx4 v1, s[24:27], s93 offen offset:3072 sc1 lds
  v_mfma_f32_16x16x32_bf16 v[212:215], a[216:219], v[124:127], v[212:215]
  s_add_u32 s93, s93, 16384
  v_exp_f32 v132, v60
  v_mfma_f32_16x16x32_bf16 v[208:211], a[216:219], v[120:123], v[208:211]
  v_exp_f32 v133, v61
  v_mfma_f32_16x16x32_bf16 a[52:55], a[216:219], v[116:119], a[52:55]
  v_cvt_pk_bf16_f32 v110, v132, v133
  v_mfma_f32_16x16x32_bf16 a[48:51], a[216:219], v[112:115], a[48:51]
  v_add_u32 v3, s89, v1
  v_mfma_f32_16x16x32_bf16 a[56:59], a[220:223], v[112:115], a[56:59]
  v_exp_f32 v134, v62
  v_mfma_f32_16x16x32_bf16 a[60:63], a[220:223], v[116:119], a[60:63]
  v_exp_f32 v135, v63
  v_mfma_f32_16x16x32_bf16 v[216:219], a[220:223], v[120:123], v[216:219]
  v_cvt_pk_bf16_f32 v111, v134, v135
  v_mfma_f32_16x16x32_bf16 v[220:223], a[220:223], v[124:127], v[220:223]
  buffer_load_dword v25, v0, s[40:43], s66 offen sc1
  s_waitcnt lgkmcnt(0)
  v_mfma_f32_16x16x32_bf16 v[32:35], a[160:163], a[64:67], v[224:227]
  v_exp_f32 v128, v64
  v_mfma_f32_16x16x32_bf16 v[32:35], a[168:171], a[72:75], v[32:35]
  v_exp_f32 v129, v65
  v_mfma_f32_16x16x32_bf16 v[32:35], a[176:179], a[80:83], v[32:35]
  ds_read_b128 a[192:195], v3 offset:0
  v_cvt_pk_bf16_f32 v112, v128, v129
  v_mfma_f32_16x16x32_bf16 v[32:35], a[184:187], a[88:91], v[32:35]
  ds_read_b128 a[196:199], v3 offset:1024
  v_mfma_f32_16x16x32_bf16 v[40:43], a[184:187], a[92:95], v[232:235]
  v_exp_f32 v130, v66
  v_mfma_f32_16x16x32_bf16 v[40:43], a[176:179], a[84:87], v[40:43]
  v_exp_f32 v131, v67
  v_mfma_f32_16x16x32_bf16 v[40:43], a[168:171], a[76:79], v[40:43]
  ds_read_b128 a[200:203], v3 offset:2048
  v_cvt_pk_bf16_f32 v113, v130, v131
  v_mfma_f32_16x16x32_bf16 v[40:43], a[160:163], a[68:71], v[40:43]
  ds_read_b128 a[204:207], v3 offset:3072
  v_mfma_f32_16x16x32_bf16 v[48:51], a[160:163], a[128:131], v[240:243]
  v_exp_f32 v132, v68
  v_mfma_f32_16x16x32_bf16 v[48:51], a[168:171], a[136:139], v[48:51]
  s_and_b32 m0, s92, 0xffff
  v_exp_f32 v133, v69
  v_mfma_f32_16x16x32_bf16 v[48:51], a[176:179], a[144:147], v[48:51]
  ds_read_b128 a[208:211], v3 offset:4096
  v_cvt_pk_bf16_f32 v114, v132, v133
  v_mfma_f32_16x16x32_bf16 v[48:51], a[184:187], a[152:155], v[48:51]
  buffer_load_dwordx4 v1, s[20:23], s92 offen offset:0 sc1 lds
  v_mfma_f32_16x16x32_bf16 v[56:59], a[184:187], a[156:159], v[248:251]
  v_exp_f32 v134, v70
  v_mfma_f32_16x16x32_bf16 v[56:59], a[176:179], a[148:151], v[56:59]
  v_exp_f32 v135, v71
  v_mfma_f32_16x16x32_bf16 v[56:59], a[168:171], a[140:143], v[56:59]
  ds_read_b128 a[212:215], v3 offset:5120
  v_cvt_pk_bf16_f32 v115, v134, v135
  v_mfma_f32_16x16x32_bf16 v[56:59], a[160:163], a[132:135], v[56:59]
  buffer_load_dwordx4 v1, s[20:23], s92 offen offset:1024 sc1 lds
  v_mfma_f32_16x16x32_bf16 v[60:63], a[164:167], a[132:135], v[252:255]
  v_exp_f32 v128, v72
  v_mfma_f32_16x16x32_bf16 v[60:63], a[172:175], a[140:143], v[60:63]
  v_exp_f32 v129, v73
  v_mfma_f32_16x16x32_bf16 v[60:63], a[180:183], a[148:151], v[60:63]
  ds_read_b128 a[216:219], v3 offset:6144
  v_cvt_pk_bf16_f32 v116, v128, v129
  v_mfma_f32_16x16x32_bf16 v[60:63], a[188:191], a[156:159], v[60:63]
  buffer_load_dwordx4 v1, s[20:23], s92 offen offset:2048 sc1 lds
  v_mfma_f32_16x16x32_bf16 v[52:55], a[188:191], a[152:155], v[244:247]
  v_exp_f32 v130, v74
  v_mfma_f32_16x16x32_bf16 v[52:55], a[180:183], a[144:147], v[52:55]
  v_exp_f32 v131, v75
  v_mfma_f32_16x16x32_bf16 v[52:55], a[172:175], a[136:139], v[52:55]
  ds_read_b128 a[220:223], v3 offset:7168
  v_cvt_pk_bf16_f32 v117, v130, v131
  v_mfma_f32_16x16x32_bf16 v[52:55], a[164:167], a[128:131], v[52:55]
  buffer_load_dwordx4 v1, s[20:23], s92 offen offset:3072 sc1 lds
  v_mfma_f32_16x16x32_bf16 v[44:47], a[164:167], a[68:71], v[236:239]
  s_add_u32 s92, s92, 16384
  v_exp_f32 v132, v76
  v_mfma_f32_16x16x32_bf16 v[44:47], a[172:175], a[76:79], v[44:47]
  v_exp_f32 v133, v77
  v_mfma_f32_16x16x32_bf16 v[44:47], a[180:183], a[84:87], v[44:47]
  v_cvt_pk_bf16_f32 v118, v132, v133
  v_mfma_f32_16x16x32_bf16 v[44:47], a[188:191], a[92:95], v[44:47]
  v_add_u32 v2, s88, v1
  v_mfma_f32_16x16x32_bf16 v[36:39], a[188:191], a[88:91], v[228:231]
  s_add_u32 s88, s88, 16384
  v_exp_f32 v134, v78
  v_mfma_f32_16x16x32_bf16 v[36:39], a[180:183], a[80:83], v[36:39]
  s_and_b32 s88, s88, 0xffff
  v_exp_f32 v135, v79
  v_mfma_f32_16x16x32_bf16 v[36:39], a[172:175], a[72:75], v[36:39]
  v_cvt_pk_bf16_f32 v119, v134, v135
  v_mfma_f32_16x16x32_bf16 v[36:39], a[164:167], a[64:67], v[36:39]
  s_waitcnt vmcnt(17) lgkmcnt(0)
  s_barrier
  v_mfma_f32_16x16x32_bf16 a[224:227], a[240:243], v[96:99], a[224:227]
  ds_read_b128 a[160:163], v2 offset:0
  v_mfma_f32_16x16x32_bf16 a[228:231], a[240:243], v[100:103], a[228:231]
  ds_read_b128 a[164:167], v2 offset:1024
  v_mfma_f32_16x16x32_bf16 a[232:235], a[240:243], v[104:107], a[232:235]
  ds_read_b128 a[168:171], v2 offset:2048
  v_mfma_f32_16x16x32_bf16 a[236:239], a[240:243], v[108:111], a[236:239]
  ds_read_b128 a[172:175], v2 offset:3072
  v_mfma_f32_16x16x32_bf16 v[164:167], a[192:195], v[108:111], v[164:167]
  s_add_u32 s89, s89, 16384
  v_exp_f32 v128, v80
  v_mfma_f32_16x16x32_bf16 v[160:163], a[192:195], v[104:107], v[160:163]
  s_and_b32 s89, s89, 0xffff
  v_exp_f32 v129, v81
  v_mfma_f32_16x16x32_bf16 a[4:7], a[192:195], v[100:103], a[4:7]
  ds_read_b128 a[176:179], v2 offset:4096
  v_cvt_pk_bf16_f32 v120, v128, v129
  v_mfma_f32_16x16x32_bf16 a[0:3], a[192:195], v[96:99], a[0:3]
  ds_read_b128 a[180:183], v2 offset:5120
  v_mfma_f32_16x16x32_bf16 a[8:11], a[196:199], v[96:99], a[8:11]
  s_or_b32 s89, s89, 0x10000
  v_exp_f32 v130, v82
  v_mfma_f32_16x16x32_bf16 a[12:15], a[196:199], v[100:103], a[12:15]
  v_exp_f32 v131, v83
  v_mfma_f32_16x16x32_bf16 v[168:171], a[196:199], v[104:107], v[168:171]
  ds_read_b128 a[184:187], v2 offset:6144
  v_cvt_pk_bf16_f32 v121, v130, v131
  v_mfma_f32_16x16x32_bf16 v[172:175], a[196:199], v[108:111], v[172:175]
  ds_read_b128 a[188:191], v2 offset:7168
  v_mfma_f32_16x16x32_bf16 v[180:183], a[200:203], v[108:111], v[180:183]
  v_exp_f32 v132, v84
  v_mfma_f32_16x16x32_bf16 v[176:179], a[200:203], v[104:107], v[176:179]
  s_and_b32 s65, s93, 0xffff
  s_add_u32 m0, s65, 65536
  v_exp_f32 v133, v85
  v_mfma_f32_16x16x32_bf16 a[20:23], a[200:203], v[100:103], a[20:23]
  v_cvt_pk_bf16_f32 v122, v132, v133
  v_mfma_f32_16x16x32_bf16 a[16:19], a[200:203], v[96:99], a[16:19]
  buffer_load_dwordx4 v1, s[24:27], s93 offen offset:0 sc1 lds
  v_mfma_f32_16x16x32_bf16 a[24:27], a[204:207], v[96:99], a[24:27]
  v_exp_f32 v134, v86
  v_mfma_f32_16x16x32_bf16 a[28:31], a[204:207], v[100:103], a[28:31]
  v_exp_f32 v135, v87
  v_mfma_f32_16x16x32_bf16 v[184:187], a[204:207], v[104:107], v[184:187]
  v_cvt_pk_bf16_f32 v123, v134, v135
  v_mfma_f32_16x16x32_bf16 v[188:191], a[204:207], v[108:111], v[188:191]
  buffer_load_dwordx4 v1, s[24:27], s93 offen offset:1024 sc1 lds
  v_mfma_f32_16x16x32_bf16 v[196:199], a[208:211], v[108:111], v[196:199]
  v_exp_f32 v128, v88
  v_mfma_f32_16x16x32_bf16 v[192:195], a[208:211], v[104:107], v[192:195]
  v_exp_f32 v129, v89
  v_mfma_f32_16x16x32_bf16 a[36:39], a[208:211], v[100:103], a[36:39]
  v_cvt_pk_bf16_f32 v124, v128, v129
  v_mfma_f32_16x16x32_bf16 a[32:35], a[208:211], v[96:99], a[32:35]
  buffer_load_dwordx4 v1, s[24:27], s93 offen offset:2048 sc1 lds
  v_mfma_f32_16x16x32_bf16 a[40:43], a[212:215], v[96:99], a[40:43]
  v_exp_f32 v130, v90
  v_mfma_f32_16x16x32_bf16 a[44:47], a[212:215], v[100:103], a[44:47]
  v_exp_f32 v131, v91
  v_mfma_f32_16x16x32_bf16 v[200:203], a[212:215], v[104:107], v[200:203]
  v_cvt_pk_bf16_f32 v125, v130, v131
  v_mfma_f32_16x16x32_bf16 v[204:207], a[212:215], v[108:111], v[204:207]
  buffer_load_dwordx4 v1, s[24:27], s93 offen offset:3072 sc1 lds
  v_mfma_f32_16x16x32_bf16 v[212:215], a[216:219], v[108:111], v[212:215]
  s_add_u32 s93, s93, 16384
  v_exp_f32 v132, v92
  v_mfma_f32_16x16x32_bf16 v[208:211], a[216:219], v[104:107], v[208:211]
  v_exp_f32 v133, v93
  v_mfma_f32_16x16x32_bf16 a[52:55], a[216:219], v[100:103], a[52:55]
  v_cvt_pk_bf16_f32 v126, v132, v133
  v_mfma_f32_16x16x32_bf16 a[48:51], a[216:219], v[96:99], a[48:51]
  v_add_u32 v3, s89, v1
  v_mfma_f32_16x16x32_bf16 a[56:59], a[220:223], v[96:99], a[56:59]
  v_exp_f32 v134, v94
  v_mfma_f32_16x16x32_bf16 a[60:63], a[220:223], v[100:103], a[60:63]
  v_exp_f32 v135, v95
  v_mfma_f32_16x16x32_bf16 v[216:219], a[220:223], v[104:107], v[216:219]
  v_cvt_pk_bf16_f32 v127, v134, v135
  v_mfma_f32_16x16x32_bf16 v[220:223], a[220:223], v[108:111], v[220:223]
  s_waitcnt lgkmcnt(0)
  v_mfma_f32_16x16x32_bf16 v[64:67], a[160:163], a[64:67], v[224:227]
  v_exp_f32 v128, v32
  v_mfma_f32_16x16x32_bf16 v[64:67], a[168:171], a[72:75], v[64:67]
  v_exp_f32 v129, v33
  v_mfma_f32_16x16x32_bf16 v[64:67], a[176:179], a[80:83], v[64:67]
  ds_read_b128 a[192:195], v3 offset:0
  v_cvt_pk_bf16_f32 v96, v128, v129
  v_mfma_f32_16x16x32_bf16 v[64:67], a[184:187], a[88:91], v[64:67]
  ds_read_b128 a[196:199], v3 offset:1024
  v_mfma_f32_16x16x32_bf16 v[72:75], a[184:187], a[92:95], v[232:235]
  v_exp_f32 v130, v34
  v_mfma_f32_16x16x32_bf16 v[72:75], a[176:179], a[84:87], v[72:75]
  v_exp_f32 v131, v35
  v_mfma_f32_16x16x32_bf16 v[72:75], a[168:171], a[76:79], v[72:75]
  ds_read_b128 a[200:203], v3 offset:2048
  v_cvt_pk_bf16_f32 v97, v130, v131
  v_mfma_f32_16x16x32_bf16 v[72:75], a[160:163], a[68:71], v[72:75]
  ds_read_b128 a[204:207], v3 offset:3072
  v_mfma_f32_16x16x32_bf16 v[80:83], a[160:163], a[128:131], v[240:243]
  v_exp_f32 v132, v36
  v_mfma_f32_16x16x32_bf16 v[80:83], a[168:171], a[136:139], v[80:83]
  s_and_b32 m0, s92, 0xffff
  v_exp_f32 v133, v37
  v_mfma_f32_16x16x32_bf16 v[80:83], a[176:179], a[144:147], v[80:83]
  ds_read_b128 a[208:211], v3 offset:4096
  v_cvt_pk_bf16_f32 v98, v132, v133
  v_mfma_f32_16x16x32_bf16 v[80:83], a[184:187], a[152:155], v[80:83]
  buffer_load_dwordx4 v1, s[20:23], s92 offen offset:0 sc1 lds
  v_mfma_f32_16x16x32_bf16 v[88:91], a[184:187], a[156:159], v[248:251]
  v_exp_f32 v134, v38
  v_mfma_f32_16x16x32_bf16 v[88:91], a[176:179], a[148:151], v[88:91]
  v_exp_f32 v135, v39
  v_mfma_f32_16x16x32_bf16 v[88:91], a[168:171], a[140:143], v[88:91]
  ds_read_b128 a[212:215], v3 offset:5120
  v_cvt_pk_bf16_f32 v99, v134, v135
  v_mfma_f32_16x16x32_bf16 v[88:91], a[160:163], a[132:135], v[88:91]
  buffer_load_dwordx4 v1, s[20:23], s92 offen offset:1024 sc1 lds
  v_mfma_f32_16x16x32_bf16 v[92:95], a[164:167], a[132:135], v[252:255]
  v_exp_f32 v128, v40
  v_mfma_f32_16x16x32_bf16 v[92:95], a[172:175], a[140:143], v[92:95]
  v_exp_f32 v129, v41
  v_mfma_f32_16x16x32_bf16 v[92:95], a[180:183], a[148:151], v[92:95]
  ds_read_b128 a[216:219], v3 offset:6144
  v_cvt_pk_bf16_f32 v100, v128, v129
  v_mfma_f32_16x16x32_bf16 v[92:95], a[188:191], a[156:159], v[92:95]
  buffer_load_dwordx4 v1, s[20:23], s92 offen offset:2048 sc1 lds
  v_mfma_f32_16x16x32_bf16 v[84:87], a[188:191], a[152:155], v[244:247]
  v_exp_f32 v130, v42
  v_mfma_f32_16x16x32_bf16 v[84:87], a[180:183], a[144:147], v[84:87]
  v_exp_f32 v131, v43
  v_mfma_f32_16x16x32_bf16 v[84:87], a[172:175], a[136:139], v[84:87]
  ds_read_b128 a[220:223], v3 offset:7168
  v_cvt_pk_bf16_f32 v101, v130, v131
  v_mfma_f32_16x16x32_bf16 v[84:87], a[164:167], a[128:131], v[84:87]
  buffer_load_dwordx4 v1, s[20:23], s92 offen offset:3072 sc1 lds
  v_mfma_f32_16x16x32_bf16 v[76:79], a[164:167], a[68:71], v[236:239]
  s_add_u32 s92, s92, 16384
  v_exp_f32 v132, v44
  v_mfma_f32_16x16x32_bf16 v[76:79], a[172:175], a[76:79], v[76:79]
  v_exp_f32 v133, v45
  v_mfma_f32_16x16x32_bf16 v[76:79], a[180:183], a[84:87], v[76:79]
  v_cvt_pk_bf16_f32 v102, v132, v133
  v_mfma_f32_16x16x32_bf16 v[76:79], a[188:191], a[92:95], v[76:79]
  v_add_u32 v2, s88, v1
  v_mfma_f32_16x16x32_bf16 v[68:71], a[188:191], a[88:91], v[228:231]
  s_add_u32 s88, s88, 16384
  v_exp_f32 v134, v46
  v_mfma_f32_16x16x32_bf16 v[68:71], a[180:183], a[80:83], v[68:71]
  s_and_b32 s88, s88, 0xffff
  v_exp_f32 v135, v47
  v_mfma_f32_16x16x32_bf16 v[68:71], a[172:175], a[72:75], v[68:71]
  v_cvt_pk_bf16_f32 v103, v134, v135
  v_mfma_f32_16x16x32_bf16 v[68:71], a[164:167], a[64:67], v[68:71]
  s_waitcnt vmcnt(17) lgkmcnt(0)
  s_barrier
  v_mfma_f32_16x16x32_bf16 a[224:227], a[240:243], v[112:115], a[224:227]
  ds_read_b128 a[160:163], v2 offset:0
  v_mfma_f32_16x16x32_bf16 a[228:231], a[240:243], v[116:119], a[228:231]
  ds_read_b128 a[164:167], v2 offset:1024
  v_mfma_f32_16x16x32_bf16 a[232:235], a[240:243], v[120:123], a[232:235]
  ds_read_b128 a[168:171], v2 offset:2048
  v_mfma_f32_16x16x32_bf16 a[236:239], a[240:243], v[124:127], a[236:239]
  ds_read_b128 a[172:175], v2 offset:3072
  v_mfma_f32_16x16x32_bf16 v[164:167], a[192:195], v[124:127], v[164:167]
  s_add_u32 s89, s89, 16384
  v_exp_f32 v128, v48
  v_mfma_f32_16x16x32_bf16 v[160:163], a[192:195], v[120:123], v[160:163]
  s_and_b32 s89, s89, 0xffff
  v_exp_f32 v129, v49
  v_mfma_f32_16x16x32_bf16 a[4:7], a[192:195], v[116:119], a[4:7]
  ds_read_b128 a[176:179], v2 offset:4096
  v_cvt_pk_bf16_f32 v104, v128, v129
  v_mfma_f32_16x16x32_bf16 a[0:3], a[192:195], v[112:115], a[0:3]
  ds_read_b128 a[180:183], v2 offset:5120
  v_mfma_f32_16x16x32_bf16 a[8:11], a[196:199], v[112:115], a[8:11]
  s_or_b32 s89, s89, 0x10000
  v_exp_f32 v130, v50
  v_mfma_f32_16x16x32_bf16 a[12:15], a[196:199], v[116:119], a[12:15]
  v_exp_f32 v131, v51
  v_mfma_f32_16x16x32_bf16 v[168:171], a[196:199], v[120:123], v[168:171]
  ds_read_b128 a[184:187], v2 offset:6144
  v_cvt_pk_bf16_f32 v105, v130, v131
  v_mfma_f32_16x16x32_bf16 v[172:175], a[196:199], v[124:127], v[172:175]
  ds_read_b128 a[188:191], v2 offset:7168
  v_mfma_f32_16x16x32_bf16 v[180:183], a[200:203], v[124:127], v[180:183]
  v_exp_f32 v132, v52
  v_mfma_f32_16x16x32_bf16 v[176:179], a[200:203], v[120:123], v[176:179]
  s_and_b32 s65, s93, 0xffff
  s_add_u32 m0, s65, 65536
  v_exp_f32 v133, v53
  v_mfma_f32_16x16x32_bf16 a[20:23], a[200:203], v[116:119], a[20:23]
  v_cvt_pk_bf16_f32 v106, v132, v133
  v_mfma_f32_16x16x32_bf16 a[16:19], a[200:203], v[112:115], a[16:19]
  buffer_load_dwordx4 v1, s[24:27], s93 offen offset:0 sc1 lds
  v_mfma_f32_16x16x32_bf16 a[24:27], a[204:207], v[112:115], a[24:27]
  v_exp_f32 v134, v54
  v_mfma_f32_16x16x32_bf16 a[28:31], a[204:207], v[116:119], a[28:31]
  v_exp_f32 v135, v55
  v_mfma_f32_16x16x32_bf16 v[184:187], a[204:207], v[120:123], v[184:187]
  v_cvt_pk_bf16_f32 v107, v134, v135
  v_mfma_f32_16x16x32_bf16 v[188:191], a[204:207], v[124:127], v[188:191]
  buffer_load_dwordx4 v1, s[24:27], s93 offen offset:1024 sc1 lds
  v_mfma_f32_16x16x32_bf16 v[196:199], a[208:211], v[124:127], v[196:199]
  v_exp_f32 v128, v56
  v_mfma_f32_16x16x32_bf16 v[192:195], a[208:211], v[120:123], v[192:195]
  v_exp_f32 v129, v57
  v_mfma_f32_16x16x32_bf16 a[36:39], a[208:211], v[116:119], a[36:39]
  v_cvt_pk_bf16_f32 v108, v128, v129
  v_mfma_f32_16x16x32_bf16 a[32:35], a[208:211], v[112:115], a[32:35]
  buffer_load_dwordx4 v1, s[24:27], s93 offen offset:2048 sc1 lds
  v_mfma_f32_16x16x32_bf16 a[40:43], a[212:215], v[112:115], a[40:43]
  v_exp_f32 v130, v58
  v_mfma_f32_16x16x32_bf16 a[44:47], a[212:215], v[116:119], a[44:47]
  v_exp_f32 v131, v59
  v_mfma_f32_16x16x32_bf16 v[200:203], a[212:215], v[120:123], v[200:203]
  v_cvt_pk_bf16_f32 v109, v130, v131
  v_mfma_f32_16x16x32_bf16 v[204:207], a[212:215], v[124:127], v[204:207]
  buffer_load_dwordx4 v1, s[24:27], s93 offen offset:3072 sc1 lds
  v_mfma_f32_16x16x32_bf16 v[212:215], a[216:219], v[124:127], v[212:215]
  s_add_u32 s93, s93, 16384
  v_exp_f32 v132, v60
  v_mfma_f32_16x16x32_bf16 v[208:211], a[216:219], v[120:123], v[208:211]
  v_exp_f32 v133, v61
  v_mfma_f32_16x16x32_bf16 a[52:55], a[216:219], v[116:119], a[52:55]
  v_cvt_pk_bf16_f32 v110, v132, v133
  v_mfma_f32_16x16x32_bf16 a[48:51], a[216:219], v[112:115], a[48:51]
  v_add_u32 v3, s89, v1
  v_mfma_f32_16x16x32_bf16 a[56:59], a[220:223], v[112:115], a[56:59]
  v_exp_f32 v134, v62
  v_mfma_f32_16x16x32_bf16 a[60:63], a[220:223], v[116:119], a[60:63]
  v_exp_f32 v135, v63
  v_mfma_f32_16x16x32_bf16 v[216:219], a[220:223], v[120:123], v[216:219]
  v_cvt_pk_bf16_f32 v111, v134, v135
  v_mfma_f32_16x16x32_bf16 v[220:223], a[220:223], v[124:127], v[220:223]
  s_waitcnt lgkmcnt(0)
  v_mfma_f32_16x16x32_bf16 v[32:35], a[160:163], a[64:67], v[224:227]
  v_exp_f32 v128, v64
  v_mfma_f32_16x16x32_bf16 v[32:35], a[168:171], a[72:75], v[32:35]
  v_exp_f32 v129, v65
  v_mfma_f32_16x16x32_bf16 v[32:35], a[176:179], a[80:83], v[32:35]
  ds_read_b128 a[192:195], v3 offset:0
  v_cvt_pk_bf16_f32 v112, v128, v129
  v_mfma_f32_16x16x32_bf16 v[32:35], a[184:187], a[88:91], v[32:35]
  ds_read_b128 a[196:199], v3 offset:1024
  v_mfma_f32_16x16x32_bf16 v[40:43], a[184:187], a[92:95], v[232:235]
  v_exp_f32 v130, v66
  v_mfma_f32_16x16x32_bf16 v[40:43], a[176:179], a[84:87], v[40:43]
  v_exp_f32 v131, v67
  v_mfma_f32_16x16x32_bf16 v[40:43], a[168:171], a[76:79], v[40:43]
  ds_read_b128 a[200:203], v3 offset:2048
  v_cvt_pk_bf16_f32 v113, v130, v131
  v_mfma_f32_16x16x32_bf16 v[40:43], a[160:163], a[68:71], v[40:43]
  ds_read_b128 a[204:207], v3 offset:3072
  v_mfma_f32_16x16x32_bf16 v[48:51], a[160:163], a[128:131], v[240:243]
  v_exp_f32 v132, v68
  v_mfma_f32_16x16x32_bf16 v[48:51], a[168:171], a[136:139], v[48:51]
  s_and_b32 m0, s92, 0xffff
  v_exp_f32 v133, v69
  v_mfma_f32_16x16x32_bf16 v[48:51], a[176:179], a[144:147], v[48:51]
  ds_read_b128 a[208:211], v3 offset:4096
  v_cvt_pk_bf16_f32 v114, v132, v133
  v_mfma_f32_16x16x32_bf16 v[48:51], a[184:187], a[152:155], v[48:51]
  buffer_load_dwordx4 v1, s[20:23], s92 offen offset:0 sc1 lds
  v_mfma_f32_16x16x32_bf16 v[56:59], a[184:187], a[156:159], v[248:251]
  v_exp_f32 v134, v70
  v_mfma_f32_16x16x32_bf16 v[56:59], a[176:179], a[148:151], v[56:59]
  v_exp_f32 v135, v71
  v_mfma_f32_16x16x32_bf16 v[56:59], a[168:171], a[140:143], v[56:59]
  ds_read_b128 a[212:215], v3 offset:5120
  v_cvt_pk_bf16_f32 v115, v134, v135
  v_mfma_f32_16x16x32_bf16 v[56:59], a[160:163], a[132:135], v[56:59]
  buffer_load_dwordx4 v1, s[20:23], s92 offen offset:1024 sc1 lds
  v_mfma_f32_16x16x32_bf16 v[60:63], a[164:167], a[132:135], v[252:255]
  v_exp_f32 v128, v72
  v_mfma_f32_16x16x32_bf16 v[60:63], a[172:175], a[140:143], v[60:63]
  v_exp_f32 v129, v73
  v_mfma_f32_16x16x32_bf16 v[60:63], a[180:183], a[148:151], v[60:63]
  ds_read_b128 a[216:219], v3 offset:6144
  v_cvt_pk_bf16_f32 v116, v128, v129
  v_mfma_f32_16x16x32_bf16 v[60:63], a[188:191], a[156:159], v[60:63]
  buffer_load_dwordx4 v1, s[20:23], s92 offen offset:2048 sc1 lds
  v_mfma_f32_16x16x32_bf16 v[52:55], a[188:191], a[152:155], v[244:247]
  v_exp_f32 v130, v74
  v_mfma_f32_16x16x32_bf16 v[52:55], a[180:183], a[144:147], v[52:55]
  v_exp_f32 v131, v75
  v_mfma_f32_16x16x32_bf16 v[52:55], a[172:175], a[136:139], v[52:55]
  ds_read_b128 a[220:223], v3 offset:7168
  v_cvt_pk_bf16_f32 v117, v130, v131
  v_mfma_f32_16x16x32_bf16 v[52:55], a[164:167], a[128:131], v[52:55]
  buffer_load_dwordx4 v1, s[20:23], s92 offen offset:3072 sc1 lds
  v_mfma_f32_16x16x32_bf16 v[44:47], a[164:167], a[68:71], v[236:239]
  s_add_u32 s92, s92, 16384
  v_exp_f32 v132, v76
  v_mfma_f32_16x16x32_bf16 v[44:47], a[172:175], a[76:79], v[44:47]
  v_exp_f32 v133, v77
  v_mfma_f32_16x16x32_bf16 v[44:47], a[180:183], a[84:87], v[44:47]
  v_cvt_pk_bf16_f32 v118, v132, v133
  v_mfma_f32_16x16x32_bf16 v[44:47], a[188:191], a[92:95], v[44:47]
  v_add_u32 v2, s88, v1
  v_mfma_f32_16x16x32_bf16 v[36:39], a[188:191], a[88:91], v[228:231]
  s_add_u32 s88, s88, 16384
  v_exp_f32 v134, v78
  v_mfma_f32_16x16x32_bf16 v[36:39], a[180:183], a[80:83], v[36:39]
  s_and_b32 s88, s88, 0xffff
  v_exp_f32 v135, v79
  v_mfma_f32_16x16x32_bf16 v[36:39], a[172:175], a[72:75], v[36:39]
  v_cvt_pk_bf16_f32 v119, v134, v135
  v_mfma_f32_16x16x32_bf16 v[36:39], a[164:167], a[64:67], v[36:39]
  s_waitcnt vmcnt(16) lgkmcnt(0)
  s_barrier
  v_mfma_f32_16x16x32_bf16 a[224:227], a[240:243], v[96:99], a[224:227]
  ds_read_b128 a[160:163], v2 offset:0
  v_mfma_f32_16x16x32_bf16 a[228:231], a[240:243], v[100:103], a[228:231]
  ds_read_b128 a[164:167], v2 offset:1024
  v_mfma_f32_16x16x32_bf16 a[232:235], a[240:243], v[104:107], a[232:235]
  ds_read_b128 a[168:171], v2 offset:2048
  v_mfma_f32_16x16x32_bf16 a[236:239], a[240:243], v[108:111], a[236:239]
  ds_read_b128 a[172:175], v2 offset:3072
  v_mfma_f32_16x16x32_bf16 v[164:167], a[192:195], v[108:111], v[164:167]
  s_add_u32 s89, s89, 16384
  v_exp_f32 v128, v80
  v_mfma_f32_16x16x32_bf16 v[160:163], a[192:195], v[104:107], v[160:163]
  s_and_b32 s89, s89, 0xffff
  v_exp_f32 v129, v81
  v_mfma_f32_16x16x32_bf16 a[4:7], a[192:195], v[100:103], a[4:7]
  ds_read_b128 a[176:179], v2 offset:4096
  v_cvt_pk_bf16_f32 v120, v128, v129
  v_mfma_f32_16x16x32_bf16 a[0:3], a[192:195], v[96:99], a[0:3]
  ds_read_b128 a[180:183], v2 offset:5120
  v_mfma_f32_16x16x32_bf16 a[8:11], a[196:199], v[96:99], a[8:11]
  s_or_b32 s89, s89, 0x10000
  v_exp_f32 v130, v82
  v_mfma_f32_16x16x32_bf16 a[12:15], a[196:199], v[100:103], a[12:15]
  v_exp_f32 v131, v83
  v_mfma_f32_16x16x32_bf16 v[168:171], a[196:199], v[104:107], v[168:171]
  ds_read_b128 a[184:187], v2 offset:6144
  v_cvt_pk_bf16_f32 v121, v130, v131
  v_mfma_f32_16x16x32_bf16 v[172:175], a[196:199], v[108:111], v[172:175]
  ds_read_b128 a[188:191], v2 offset:7168
  v_mfma_f32_16x16x32_bf16 v[180:183], a[200:203], v[108:111], v[180:183]
  v_exp_f32 v132, v84
  v_mfma_f32_16x16x32_bf16 v[176:179], a[200:203], v[104:107], v[176:179]
  s_and_b32 s65, s93, 0xffff
  s_add_u32 m0, s65, 65536
  v_exp_f32 v133, v85
  v_mfma_f32_16x16x32_bf16 a[20:23], a[200:203], v[100:103], a[20:23]
  v_cvt_pk_bf16_f32 v122, v132, v133
  v_mfma_f32_16x16x32_bf16 a[16:19], a[200:203], v[96:99], a[16:19]
  buffer_load_dwordx4 v1, s[24:27], s93 offen offset:0 sc1 lds
  v_mfma_f32_16x16x32_bf16 a[24:27], a[204:207], v[96:99], a[24:27]
  v_exp_f32 v134, v86
  v_mfma_f32_16x16x32_bf16 a[28:31], a[204:207], v[100:103], a[28:31]
  v_exp_f32 v135, v87
  v_mfma_f32_16x16x32_bf16 v[184:187], a[204:207], v[104:107], v[184:187]
  v_cvt_pk_bf16_f32 v123, v134, v135
  v_mfma_f32_16x16x32_bf16 v[188:191], a[204:207], v[108:111], v[188:191]
  buffer_load_dwordx4 v1, s[24:27], s93 offen offset:1024 sc1 lds
  v_mfma_f32_16x16x32_bf16 v[196:199], a[208:211], v[108:111], v[196:199]
  v_exp_f32 v128, v88
  v_mfma_f32_16x16x32_bf16 v[192:195], a[208:211], v[104:107], v[192:195]
  v_exp_f32 v129, v89
  v_mfma_f32_16x16x32_bf16 a[36:39], a[208:211], v[100:103], a[36:39]
  v_cvt_pk_bf16_f32 v124, v128, v129
  v_mfma_f32_16x16x32_bf16 a[32:35], a[208:211], v[96:99], a[32:35]
  buffer_load_dwordx4 v1, s[24:27], s93 offen offset:2048 sc1 lds
  v_mfma_f32_16x16x32_bf16 a[40:43], a[212:215], v[96:99], a[40:43]
  v_exp_f32 v130, v90
  v_mfma_f32_16x16x32_bf16 a[44:47], a[212:215], v[100:103], a[44:47]
  v_exp_f32 v131, v91
  v_mfma_f32_16x16x32_bf16 v[200:203], a[212:215], v[104:107], v[200:203]
  v_cvt_pk_bf16_f32 v125, v130, v131
  v_mfma_f32_16x16x32_bf16 v[204:207], a[212:215], v[108:111], v[204:207]
  buffer_load_dwordx4 v1, s[24:27], s93 offen offset:3072 sc1 lds
  v_mfma_f32_16x16x32_bf16 v[212:215], a[216:219], v[108:111], v[212:215]
  s_add_u32 s93, s93, 16384
  v_exp_f32 v132, v92
  v_mfma_f32_16x16x32_bf16 v[208:211], a[216:219], v[104:107], v[208:211]
  v_exp_f32 v133, v93
  v_mfma_f32_16x16x32_bf16 a[52:55], a[216:219], v[100:103], a[52:55]
  v_cvt_pk_bf16_f32 v126, v132, v133
  v_mfma_f32_16x16x32_bf16 a[48:51], a[216:219], v[96:99], a[48:51]
  v_add_u32 v3, s89, v1
  v_mfma_f32_16x16x32_bf16 a[56:59], a[220:223], v[96:99], a[56:59]
  v_exp_f32 v134, v94
  v_mfma_f32_16x16x32_bf16 a[60:63], a[220:223], v[100:103], a[60:63]
  v_exp_f32 v135, v95
  v_mfma_f32_16x16x32_bf16 v[216:219], a[220:223], v[104:107], v[216:219]
  v_cvt_pk_bf16_f32 v127, v134, v135
  v_mfma_f32_16x16x32_bf16 v[220:223], a[220:223], v[108:111], v[220:223]
  s_cmp_lt_u32 s86, 30
  s_cbranch_scc1 LB
.p2align 5
LY0:
  s_waitcnt lgkmcnt(0)
  v_mfma_f32_16x16x32_bf16 v[64:67], a[160:163], a[64:67], v[224:227]
  s_lshr_b32 s54, s2, 3
  v_exp_f32 v128, v32
  v_mfma_f32_16x16x32_bf16 v[64:67], a[168:171], a[72:75], v[64:67]
  s_lshl_b32 s54, s54, 2
  v_exp_f32 v129, v33
  v_mfma_f32_16x16x32_bf16 v[64:67], a[176:179], a[80:83], v[64:67]
  ds_read_b128 a[192:195], v3 offset:0
  v_cvt_pk_bf16_f32 v96, v128, v129
  v_mfma_f32_16x16x32_bf16 v[64:67], a[184:187], a[88:91], v[64:67]
  ds_read_b128 a[196:199], v3 offset:1024
  v_mfma_f32_16x16x32_bf16 v[72:75], a[184:187], a[92:95], v[232:235]
  s_add_u32 s54, s54, s60
  v_exp_f32 v130, v34
  v_mfma_f32_16x16x32_bf16 v[72:75], a[176:179], a[84:87], v[72:75]
  s_lshl_b32 s54, s54, 8
  v_exp_f32 v131, v35
  v_mfma_f32_16x16x32_bf16 v[72:75], a[168:171], a[76:79], v[72:75]
  ds_read_b128 a[200:203], v3 offset:2048
  v_cvt_pk_bf16_f32 v97, v130, v131
  v_mfma_f32_16x16x32_bf16 v[72:75], a[160:163], a[68:71], v[72:75]
  ds_read_b128 a[204:207], v3 offset:3072
  v_mfma_f32_16x16x32_bf16 v[76:79], a[164:167], a[68:71], v[236:239]
  s_add_u32 s54, s54, LY1-Lcw5
  v_exp_f32 v132, v36
  v_mfma_f32_16x16x32_bf16 v[76:79], a[172:175], a[76:79], v[76:79]
  v_exp_f32 v133, v37
  v_mfma_f32_16x16x32_bf16 v[76:79], a[180:183], a[84:87], v[76:79]
  ds_read_b128 a[208:211], v3 offset:4096
  v_cvt_pk_bf16_f32 v98, v132, v133
  v_mfma_f32_16x16x32_bf16 v[76:79], a[188:191], a[92:95], v[76:79]
  v_add_u32 v22, s54, v0
  v_min_u32 v22, Lcodeend-Lcw5-4, v22
  v_mfma_f32_16x16x32_bf16 v[68:71], a[188:191], a[88:91], v[228:231]
  v_exp_f32 v134, v38
  v_mfma_f32_16x16x32_bf16 v[68:71], a[180:183], a[80:83], v[68:71]
  s_getpc_b64 s[54:55]
Lcw5:
  v_exp_f32 v135, v39
  v_mfma_f32_16x16x32_bf16 v[68:71], a[172:175], a[72:75], v[68:71]
  ds_read_b128 a[212:215], v3 offset:5120
  v_cvt_pk_bf16_f32 v99, v134, v135
  v_mfma_f32_16x16x32_bf16 v[68:71], a[164:167], a[64:67], v[68:71]
  global_load_dword v26, v22, s[54:55]
  s_bfe_u32 s63, s72, 0x2000f
  s_and_b32 s3, s60, 1
  s_sub_u32 s3, s3, s63
  s_cmp_lt_i32 s3, 0
  s_cselect_b32 s100, s90, s91
  s_cmp_gt_i32 s3, 0
  s_cselect_b32 s101, s91, s90
  v_max_f32 v144, s100, v140
  v_max_f32 v145, s100, v141
  v_max_f32 v146, s100, v142
  v_mfma_f32_16x16x32_bf16 v[84:87], a[164:167], a[128:131], v[244:247]
  v_exp_f32 v128, v40
  v_max_f32 v147, s100, v143
  v_mfma_f32_16x16x32_bf16 v[84:87], a[172:175], a[136:139], v[84:87]
  v_exp_f32 v129, v41
  v_min_f32 v228, s100, v136
  v_mfma_f32_16x16x32_bf16 v[84:87], a[180:183], a[144:147], v[84:87]
  ds_read_b128 a[216:219], v3 offset:6144
  v_cvt_pk_bf16_f32 v100, v128, v129
  v_mfma_f32_16x16x32_bf16 v[84:87], a[188:191], a[152:155], v[84:87]
  v_min_f32 v229, s100, v136
  v_min_f32 v230, s100, v136
  v_min_f32 v231, s100, v136
  v_mfma_f32_16x16x32_bf16 v[92:95], a[188:191], a[156:159], v[252:255]
  v_exp_f32 v130, v42
  v_min3_f32 v224, v136, v144, s101
  v_mfma_f32_16x16x32_bf16 v[92:95], a[180:183], a[148:151], v[92:95]
  v_exp_f32 v131, v43
  v_mfma_f32_16x16x32_bf16 v[92:95], a[172:175], a[140:143], v[92:95]
  ds_read_b128 a[220:223], v3 offset:7168
  v_cvt_pk_bf16_f32 v101, v130, v131
  v_min3_f32 v225, v136, v145, s101
  v_mfma_f32_16x16x32_bf16 v[92:95], a[164:167], a[132:135], v[92:95]
  v_min3_f32 v226, v136, v146, s101
  v_min3_f32 v227, v136, v147, s101
  v_min3_f32 v236, v137, v144, s101
  v_mfma_f32_16x16x32_bf16 v[88:91], a[160:163], a[132:135], v[248:251]
  v_exp_f32 v132, v44
  v_mfma_f32_16x16x32_bf16 v[88:91], a[168:171], a[140:143], v[88:91]
  v_exp_f32 v133, v45
  v_min3_f32 v237, v137, v145, s101
  v_mfma_f32_16x16x32_bf16 v[88:91], a[176:179], a[148:151], v[88:91]
  v_cvt_pk_bf16_f32 v102, v132, v133
  v_min3_f32 v238, v137, v146, s101
  v_min3_f32 v239, v137, v147, s101
  v_mfma_f32_16x16x32_bf16 v[88:91], a[184:187], a[156:159], v[88:91]
  v_add_u32 v2, s88, v1
  v_min_f32 v232, s101, v137
  v_mfma_f32_16x16x32_bf16 v[80:83], a[184:187], a[152:155], v[240:243]
  s_add_u32 s88, s88, 16384
  v_exp_f32 v134, v46
  v_min_f32 v233, s101, v137
  v_mfma_f32_16x16x32_bf16 v[80:83], a[176:179], a[144:147], v[80:83]
  s_and_b32 s88, s88, 0xffff
  v_exp_f32 v135, v47
  v_min_f32 v234, s101, v137
  v_mfma_f32_16x16x32_bf16 v[80:83], a[168:171], a[136:139], v[80:83]
  v_cvt_pk_bf16_f32 v103, v134, v135
  v_min_f32 v235, s101, v137
  v_mfma_f32_16x16x32_bf16 v[80:83], a[160:163], a[128:131], v[80:83]
  s_bfe_u32 s63, s72, 0x2000f
  s_xor_b32 s63, s63, 3
  s_and_b32 s3, s60, 1
  s_sub_u32 s3, s3, s63
  s_cmp_lt_i32 s3, 0
  s_cselect_b32 s100, s90, s91
  s_cmp_gt_i32 s3, 0
  s_cselect_b32 s101, s91, s90
  v_max_f32 v144, s100, v140
  v_max_f32 v145, s100, v141
  v_max_f32 v146, s100, v142
  s_waitcnt vmcnt(12) lgkmcnt(0)
  s_barrier
  v_mfma_f32_16x16x32_bf16 a[224:227], a[240:243], v[112:115], a[224:227]
  ds_read_b128 a[160:163], v2 offset:0
  v_max_f32 v147, s100, v143
  v_mfma_f32_16x16x32_bf16 a[228:231], a[240:243], v[116:119], a[228:231]
  ds_read_b128 a[164:167], v2 offset:1024
  v_min_f32 v244, s100, v138
  v_mfma_f32_16x16x32_bf16 a[232:235], a[240:243], v[120:123], a[232:235]
  ds_read_b128 a[168:171], v2 offset:2048
  v_min_f32 v245, s100, v138
  v_mfma_f32_16x16x32_bf16 a[236:239], a[240:243], v[124:127], a[236:239]
  ds_read_b128 a[172:175], v2 offset:3072
  v_min_f32 v246, s100, v138
  v_mfma_f32_16x16x32_bf16 v[164:167], a[192:195], v[124:127], v[164:167]
  s_add_u32 s89, s89, 16384
  v_exp_f32 v128, v48
  v_mfma_f32_16x16x32_bf16 v[160:163], a[192:195], v[120:123], v[160:163]
  s_and_b32 s89, s89, 0xffff
  v_exp_f32 v129, v49
  v_mfma_f32_16x16x32_bf16 a[4:7], a[192:195], v[116:119], a[4:7]
  ds_read_b128 a[176:179], v2 offset:4096
  v_cvt_pk_bf16_f32 v104, v128, v129
  v_mfma_f32_16x16x32_bf16 a[0:3], a[192:195], v[112:115], a[0:3]
  ds_read_b128 a[180:183], v2 offset:5120
  v_min_f32 v247, s100, v138
  v_mfma_f32_16x16x32_bf16 a[8:11], a[196:199], v[112:115], a[8:11]
  s_or_b32 s89, s89, 0x10000
  v_exp_f32 v130, v50
  v_mfma_f32_16x16x32_bf16 a[12:15], a[196:199], v[116:119], a[12:15]
  v_exp_f32 v131, v51
  v_mfma_f32_16x16x32_bf16 v[168:171], a[196:199], v[120:123], v[168:171]
  ds_read_b128 a[184:187], v2 offset:6144
  v_cvt_pk_bf16_f32 v105, v130, v131
  v_mfma_f32_16x16x32_bf16 v[172:175], a[196:199], v[124:127], v[172:175]
  ds_read_b128 a[188:191], v2 offset:7168
  v_min3_f32 v240, v138, v144, s101
  v_min3_f32 v241, v138, v145, s101
  v_mfma_f32_16x16x32_bf16 v[180:183], a[200:203], v[124:127], v[180:183]
  v_exp_f32 v132, v52
  v_mfma_f32_16x16x32_bf16 v[176:179], a[200:203], v[120:123], v[176:179]
  s_and_b32 s65, s93, 0xffff
  s_add_u32 m0, s65, 65536
  v_exp_f32 v133, v53
  v_mfma_f32_16x16x32_bf16 a[20:23], a[200:203], v[116:119], a[20:23]
  v_cvt_pk_bf16_f32 v106, v132, v133
  v_min3_f32 v242, v138, v146, s101
  v_mfma_f32_16x16x32_bf16 a[16:19], a[200:203], v[112:115], a[16:19]
  buffer_load_dwordx4 v1, s[24:27], s93 offen offset:0 sc1 lds
  v_mfma_f32_16x16x32_bf16 a[24:27], a[204:207], v[112:115], a[24:27]
  v_exp_f32 v134, v54
  v_mfma_f32_16x16x32_bf16 a[28:31], a[204:207], v[116:119], a[28:31]
  v_exp_f32 v135, v55
  v_mfma_f32_16x16x32_bf16 v[184:187], a[204:207], v[120:123], v[184:187]
  v_cvt_pk_bf16_f32 v107, v134, v135
  v_min3_f32 v243, v138, v147, s101
  v_mfma_f32_16x16x32_bf16 v[188:191], a[204:207], v[124:127], v[188:191]
  buffer_load_dwordx4 v1, s[24:27], s93 offen offset:1024 sc1 lds
  v_mfma_f32_16x16x32_bf16 v[196:199], a[208:211], v[124:127], v[196:199]
  v_exp_f32 v128, v56
  v_mfma_f32_16x16x32_bf16 v[192:195], a[208:211], v[120:123], v[192:195]
  v_exp_f32 v129, v57
  v_mfma_f32_16x16x32_bf16 a[36:39], a[208:211], v[116:119], a[36:39]
  v_cvt_pk_bf16_f32 v108, v128, v129
  v_min3_f32 v252, v139, v144, s101
  v_mfma_f32_16x16x32_bf16 a[32:35], a[208:211], v[112:115], a[32:35]
  buffer_load_dwordx4 v1, s[24:27], s93 offen offset:2048 sc1 lds
  v_min3_f32 v253, v139, v145, s101
  v_mfma_f32_16x16x32_bf16 a[40:43], a[212:215], v[112:115], a[40:43]
  v_exp_f32 v130, v58
  v_mfma_f32_16x16x32_bf16 a[44:47], a[212:215], v[116:119], a[44:47]
  v_exp_f32 v131, v59
  v_mfma_f32_16x16x32_bf16 v[200:203], a[212:215], v[120:123], v[200:203]
  v_cvt_pk_bf16_f32 v109, v130, v131
  v_min3_f32 v254, v139, v146, s101
  v_mfma_f32_16x16x32_bf16 v[204:207], a[212:215], v[124:127], v[204:207]
  buffer_load_dwordx4 v1, s[24:27], s93 offen offset:3072 sc1 lds
  v_mfma_f32_16x16x32_bf16 v[212:215], a[216:219], v[124:127], v[212:215]
  s_add_u32 s93, s93, 16384
  v_exp_f32 v132, v60
  v_mfma_f32_16x16x32_bf16 v[208:211], a[216:219], v[120:123], v[208:211]
  v_exp_f32 v133, v61
  v_mfma_f32_16x16x32_bf16 a[52:55], a[216:219], v[116:119], a[52:55]
  v_cvt_pk_bf16_f32 v110, v132, v133
  v_min3_f32 v255, v139, v147, s101
  v_mfma_f32_16x16x32_bf16 a[48:51], a[216:219], v[112:115], a[48:51]
  v_add_u32 v3, s89, v1
  v_min_f32 v248, s101, v139
  v_mfma_f32_16x16x32_bf16 a[56:59], a[220:223], v[112:115], a[56:59]
  v_exp_f32 v134, v62
  v_mfma_f32_16x16x32_bf16 a[60:63], a[220:223], v[116:119], a[60:63]
  v_exp_f32 v135, v63
  v_mfma_f32_16x16x32_bf16 v[216:219], a[220:223], v[120:123], v[216:219]
  v_cvt_pk_bf16_f32 v111, v134, v135
  v_min_f32 v249, s101, v139
  v_mfma_f32_16x16x32_bf16 v[220:223], a[220:223], v[124:127], v[220:223]
  v_min_f32 v250, s101, v139
  v_min_f32 v251, s101, v139
.p2align 5
LY1:
  s_waitcnt lgkmcnt(0)
  v_mfma_f32_16x16x32_bf16 v[32:35], a[160:163], a[64:67], v[224:227]
  v_exp_f32 v128, v64
  v_mfma_f32_16x16x32_bf16 v[32:35], a[168:171], a[72:75], v[32:35]
  v_exp_f32 v129, v65
  v_mfma_f32_16x16x32_bf16 v[32:35], a[176:179], a[80:83], v[32:35]
  ds_read_b128 a[192:195], v3 offset:0
  v_cvt_pk_bf16_f32 v112, v128, v129
  v_mfma_f32_16x16x32_bf16 v[32:35], a[184:187], a[88:91], v[32:35]
  ds_read_b128 a[196:199], v3 offset:1024
  v_mfma_f32_16x16x32_bf16 v[40:43], a[184:187], a[92:95], v[232:235]
  v_exp_f32 v130, v66
  v_mfma_f32_16x16x32_bf16 v[40:43], a[176:179], a[84:87], v[40:43]
  v_exp_f32 v131, v67
  v_mfma_f32_16x16x32_bf16 v[40:43], a[168:171], a[76:79], v[40:43]
  ds_read_b128 a[200:203], v3 offset:2048
  v_cvt_pk_bf16_f32 v113, v130, v131
  v_mfma_f32_16x16x32_bf16 v[40:43], a[160:163], a[68:71], v[40:43]
  ds_read_b128 a[204:207], v3 offset:3072
  v_mfma_f32_16x16x32_bf16 v[44:47], a[164:167], a[68:71], v[236:239]
  v_exp_f32 v132, v68
  v_mfma_f32_16x16x32_bf16 v[44:47], a[172:175], a[76:79], v[44:47]
  v_exp_f32 v133, v69
  v_mfma_f32_16x16x32_bf16 v[44:47], a[180:183], a[84:87], v[44:47]
  ds_read_b128 a[208:211], v3 offset:4096
  v_cvt_pk_bf16_f32 v114, v132, v133
  v_mfma_f32_16x16x32_bf16 v[44:47], a[188:191], a[92:95], v[44:47]
  buffer_load_dword v25, v0, s[40:43], s83 offen sc1
  v_mfma_f32_16x16x32_bf16 v[36:39], a[188:191], a[88:91], v[228:231]
  v_exp_f32 v134, v70
  v_mfma_f32_16x16x32_bf16 v[36:39], a[180:183], a[80:83], v[36:39]
  v_exp_f32 v135, v71
  v_mfma_f32_16x16x32_bf16 v[36:39], a[172:175], a[72:75], v[36:39]
  ds_read_b128 a[212:215], v3 offset:5120
  v_cvt_pk_bf16_f32 v115, v134, v135
  v_mfma_f32_16x16x32_bf16 v[36:39], a[164:167], a[64:67], v[36:39]
  s_bitcmp0_b32 s60, 0
  s_cselect_b64 vcc, -1, 0
  v_cndmask_b32 v136, v136, v138, vcc
  v_cndmask_b32 v137, v137, v139, vcc
  s_bcnt1_i32_b32 s3, s60
  s_sub_u32 s3, s3, 1
  s_cmp_lt_i32 s3, 0
  s_cselect_b32 s100, s90, s91
  s_cmp_gt_i32 s3, 0
  s_cselect_b32 s101, s91, s90
  v_max_f32 v144, s100, v140
  v_mfma_f32_16x16x32_bf16 v[52:55], a[164:167], a[128:131], v[244:247]
  v_exp_f32 v128, v72
  v_max_f32 v145, s100, v141
  v_mfma_f32_16x16x32_bf16 v[52:55], a[172:175], a[136:139], v[52:55]
  v_exp_f32 v129, v73
  v_max_f32 v146, s100, v142
  v_mfma_f32_16x16x32_bf16 v[52:55], a[180:183], a[144:147], v[52:55]
  ds_read_b128 a[216:219], v3 offset:6144
  v_cvt_pk_bf16_f32 v116, v128, v129
  v_max_f32 v147, s100, v143
  v_mfma_f32_16x16x32_bf16 v[52:55], a[188:191], a[152:155], v[52:55]
  v_min_f32 v228, s100, v136
  v_min_f32 v229, s100, v136
  v_min_f32 v230, s100, v136
  v_mfma_f32_16x16x32_bf16 v[60:63], a[188:191], a[156:159], v[252:255]
  v_exp_f32 v130, v74
  v_mfma_f32_16x16x32_bf16 v[60:63], a[180:183], a[148:151], v[60:63]
  v_exp_f32 v131, v75
  v_min_f32 v231, s100, v136
  v_mfma_f32_16x16x32_bf16 v[60:63], a[172:175], a[140:143], v[60:63]
  ds_read_b128 a[220:223], v3 offset:7168
  v_cvt_pk_bf16_f32 v117, v130, v131
  v_min3_f32 v224, v136, v144, s101
  v_mfma_f32_16x16x32_bf16 v[60:63], a[164:167], a[132:135], v[60:63]
  v_min3_f32 v225, v136, v145, s101
  v_min3_f32 v226, v136, v146, s101
  v_min3_f32 v227, v136, v147, s101
  v_mfma_f32_16x16x32_bf16 v[56:59], a[160:163], a[132:135], v[248:251]
  v_exp_f32 v132, v76
  v_min3_f32 v236, v137, v144, s101
  v_mfma_f32_16x16x32_bf16 v[56:59], a[168:171], a[140:143], v[56:59]
  v_exp_f32 v133, v77
  v_mfma_f32_16x16x32_bf16 v[56:59], a[176:179], a[148:151], v[56:59]
  v_cvt_pk_bf16_f32 v118, v132, v133
  v_min3_f32 v237, v137, v145, s101
  v_min3_f32 v238, v137, v146, s101
  v_mfma_f32_16x16x32_bf16 v[56:59], a[184:187], a[156:159], v[56:59]
  v_add_u32 v2, s88, v1
  v_min3_f32 v239, v137, v147, s101
  v_min_f32 v232, s101, v137
  v_mfma_f32_16x16x32_bf16 v[48:51], a[184:187], a[152:155], v[240:243]
  s_add_u32 s88, s88, 16384
  v_exp_f32 v134, v78
  v_min_f32 v233, s101, v137
  v_mfma_f32_16x16x32_bf16 v[48:51], a[176:179], a[144:147], v[48:51]
  s_and_b32 s88, s88, 0xffff
  v_exp_f32 v135, v79
  v_min_f32 v234, s101, v137
  v_mfma_f32_16x16x32_bf16 v[48:51], a[168:171], a[136:139], v[48:51]
  v_cvt_pk_bf16_f32 v119, v134, v135
  v_min_f32 v235, s101, v137
  v_mfma_f32_16x16x32_bf16 v[48:51], a[160:163], a[128:131], v[48:51]
  v_lshrrev_b32 v20, 4, v1
  v_lshrrev_b32 v15, 4, v20
  v_and_b32 v16, 15, v20
  s_waitcnt vmcnt(8) lgkmcnt(0)
  s_barrier
  v_mfma_f32_16x16x32_bf16 a[224:227], a[240:243], v[96:99], a[224:227]
  ds_read_b128 a[160:163], v2 offset:0
  v_lshlrev_b32 v21, 1, v15
  v_mfma_f32_16x16x32_bf16 a[228:231], a[240:243], v[100:103], a[228:231]
  ds_read_b128 a[164:167], v2 offset:1024
  v_xor_b32 v21, v16, v21
  v_mfma_f32_16x16x32_bf16 a[232:235], a[240:243], v[104:107], a[232:235]
  ds_read_b128 a[168:171], v2 offset:2048
  v_lshlrev_b32 v21, 4, v21
  v_mfma_f32_16x16x32_bf16 a[236:239], a[240:243], v[108:111], a[236:239]
  ds_read_b128 a[172:175], v2 offset:3072
  v_lshl_add_u32 v6, v15, 10, v21
  v_mfma_f32_16x16x32_bf16 v[164:167], a[192:195], v[108:111], v[164:167]
  s_add_u32 s89, s89, s52
  v_exp_f32 v128, v80
  v_mfma_f32_16x16x32_bf16 v[160:163], a[192:195], v[104:107], v[160:163]
  s_and_b32 s89, s89, 0xffff
  v_exp_f32 v129, v81
  v_mfma_f32_16x16x32_bf16 a[4:7], a[192:195], v[100:103], a[4:7]
  ds_read_b128 a[176:179], v2 offset:4096
  v_cvt_pk_bf16_f32 v120, v128, v129
  v_mfma_f32_16x16x32_bf16 a[0:3], a[192:195], v[96:99], a[0:3]
  ds_read_b128 a[180:183], v2 offset:5120
  v_xor_b32 v21, 128, v6
  v_mfma_f32_16x16x32_bf16 a[8:11], a[196:199], v[96:99], a[8:11]
  s_or_b32 s89, s89, 0x10000
  v_exp_f32 v130, v82
  v_mfma_f32_16x16x32_bf16 a[12:15], a[196:199], v[100:103], a[12:15]
  v_exp_f32 v131, v83
  v_mfma_f32_16x16x32_bf16 v[168:171], a[196:199], v[104:107], v[168:171]
  ds_read_b128 a[184:187], v2 offset:6144
  v_cvt_pk_bf16_f32 v121, v130, v131
  v_mfma_f32_16x16x32_bf16 v[172:175], a[196:199], v[108:111], v[172:175]
  ds_read_b128 a[188:191], v2 offset:7168
  v_add_u32 v7, 3072, v21
  v_mfma_f32_16x16x32_bf16 v[180:183], a[200:203], v[108:111], v[180:183]
  v_exp_f32 v132, v84
  v_mfma_f32_16x16x32_bf16 v[176:179], a[200:203], v[104:107], v[176:179]
  v_exp_f32 v133, v85
  v_mfma_f32_16x16x32_bf16 a[20:23], a[200:203], v[100:103], a[20:23]
  v_cvt_pk_bf16_f32 v122, v132, v133
  v_add_u32 v8, 6144, v6
  v_mfma_f32_16x16x32_bf16 a[16:19], a[200:203], v[96:99], a[16:19]
  v_add_u32 v9, 9216, v21
  v_lshrrev_b32 v21, 2, v20
  v_mfma_f32_16x16x32_bf16 a[24:27], a[204:207], v[96:99], a[24:27]
  v_exp_f32 v134, v86
  v_mfma_f32_16x16x32_bf16 a[28:31], a[204:207], v[100:103], a[28:31]
  v_exp_f32 v135, v87
  v_mfma_f32_16x16x32_bf16 v[184:187], a[204:207], v[104:107], v[184:187]
  v_cvt_pk_bf16_f32 v123, v134, v135
  v_and_b32 v22, 7, v21
  v_mfma_f32_16x16x32_bf16 v[188:191], a[204:207], v[108:111], v[188:191]
  v_and_b32 v24, 3, v20
  v_lshlrev_b32 v24, 3, v24
  v_mfma_f32_16x16x32_bf16 v[196:199], a[208:211], v[108:111], v[196:199]
  v_exp_f32 v128, v88
  v_mfma_f32_16x16x32_bf16 v[192:195], a[208:211], v[104:107], v[192:195]
  v_exp_f32 v129, v89
  v_mfma_f32_16x16x32_bf16 a[36:39], a[208:211], v[100:103], a[36:39]
  v_cvt_pk_bf16_f32 v124, v128, v129
  v_lshl_add_u32 v24, v21, 8, v24
  s_and_b32 s100, s60, 1
  s_and_b32 s101, s0, 1
  s_lshl_b32 s101, s101, 1
  s_or_b32 s100, s100, s101
  s_lshl_b32 s100, s100, 1
  v_mfma_f32_16x16x32_bf16 a[32:35], a[208:211], v[96:99], a[32:35]
  v_xor_b32 v22, s100, v22
  v_xor_b32 v21, 0, v22
  v_mfma_f32_16x16x32_bf16 a[40:43], a[212:215], v[96:99], a[40:43]
  v_exp_f32 v130, v90
  v_mfma_f32_16x16x32_bf16 a[44:47], a[212:215], v[100:103], a[44:47]
  v_exp_f32 v131, v91
  v_mfma_f32_16x16x32_bf16 v[200:203], a[212:215], v[104:107], v[200:203]
  v_cvt_pk_bf16_f32 v125, v130, v131
  v_lshl_add_u32 v10, v21, 5, v24
  v_mfma_f32_16x16x32_bf16 v[204:207], a[212:215], v[108:111], v[204:207]
  v_xor_b32 v21, 1, v22
  v_lshl_add_u32 v11, v21, 5, v24
  v_mfma_f32_16x16x32_bf16 v[212:215], a[216:219], v[108:111], v[212:215]
  v_exp_f32 v132, v92
  v_mfma_f32_16x16x32_bf16 v[208:211], a[216:219], v[104:107], v[208:211]
  v_exp_f32 v133, v93
  v_mfma_f32_16x16x32_bf16 a[52:55], a[216:219], v[100:103], a[52:55]
  v_cvt_pk_bf16_f32 v126, v132, v133
  v_xor_b32 v21, 4, v22
  v_mfma_f32_16x16x32_bf16 a[48:51], a[216:219], v[96:99], a[48:51]
  v_add_u32 v3, s89, v1
  v_lshl_add_u32 v12, v21, 5, v24
  v_mfma_f32_16x16x32_bf16 a[56:59], a[220:223], v[96:99], a[56:59]
  v_exp_f32 v134, v94
  v_mfma_f32_16x16x32_bf16 a[60:63], a[220:223], v[100:103], a[60:63]
  v_exp_f32 v135, v95
  v_mfma_f32_16x16x32_bf16 v[216:219], a[220:223], v[104:107], v[216:219]
  v_cvt_pk_bf16_f32 v127, v134, v135
  v_xor_b32 v21, 5, v22
  v_mfma_f32_16x16x32_bf16 v[220:223], a[220:223], v[108:111], v[220:223]
  v_lshl_add_u32 v13, v21, 5, v24
  s_lshr_b32 s100, s60, 1
  s_lshl_b32 s100, s100, 12
  v_add_u32 v14, s100, v1
  s_bitcmp1_b32 s60, 0
  s_cbranch_scc1 Ltail_o
  s_waitcnt lgkmcnt(0)
  v_mfma_f32_16x16x32_bf16 v[80:83], a[160:163], a[128:131], v[224:227]
  ds_read_b128 a[192:195], v3 offset:0
  v_exp_f32 v128, v32
  v_mfma_f32_16x16x32_bf16 v[80:83], a[168:171], a[136:139], v[80:83]
  ds_read_b128 a[196:199], v3 offset:1024
  v_exp_f32 v129, v33
  v_mfma_f32_16x16x32_bf16 v[80:83], a[176:179], a[144:147], v[80:83]
  ds_read_b128 a[200:203], v3 offset:2048
  ds_read_b128 a[204:207], v3 offset:3072
  s_lshl_b32 s63, s84, 2
  v_cvt_pk_bf16_f32 v96, v128, v129
  v_mfma_f32_16x16x32_bf16 v[80:83], a[184:187], a[152:155], v[80:83]
  ds_read_b128 a[208:211], v3 offset:4096
  s_and_b32 s64, s0, 2
  v_exp_f32 v130, v34
  v_mfma_f32_16x16x32_bf16 v[88:91], a[184:187], a[156:159], v[232:235]
  s_xor_b32 s64, s64, s60
  v_exp_f32 v131, v35
  v_mfma_f32_16x16x32_bf16 v[88:91], a[176:179], a[148:151], v[88:91]
  ds_read_b128 a[212:215], v3 offset:5120
  ds_read_b128 a[216:219], v3 offset:6144
  s_add_u32 s63, s63, s64
  v_cvt_pk_bf16_f32 v97, v130, v131
  v_mfma_f32_16x16x32_bf16 v[88:91], a[168:171], a[140:143], v[88:91]
  s_mul_i32 s63, s63, 376832
  v_exp_f32 v132, v36
  v_mfma_f32_16x16x32_bf16 v[88:91], a[160:163], a[132:135], v[88:91]
  s_mul_i32 s64, s0, 14336
  v_exp_f32 v133, v37
  v_mfma_f32_16x16x32_bf16 v[92:95], a[164:167], a[132:135], v[236:239]
  ds_read_b128 a[220:223], v3 offset:7168
  s_add_u32 s63, s63, s64
  v_cvt_pk_bf16_f32 v98, v132, v133
  v_mfma_f32_16x16x32_bf16 v[92:95], a[172:175], a[140:143], v[92:95]
  s_add_u32 s76, s63, 33685504
  s_add_u32 s89, s89, s53
  s_and_b32 s89, s89, 0xffff
  s_or_b32 s89, s89, 0x10000
  v_exp_f32 v134, v38
  v_mfma_f32_16x16x32_bf16 v[92:95], a[180:183], a[148:151], v[92:95]
  s_mul_i32 s79, s0, 458752
  v_exp_f32 v135, v39
  v_mfma_f32_16x16x32_bf16 v[92:95], a[188:191], a[156:159], v[92:95]
  s_lshl_b32 s64, s60, 14
  v_cvt_pk_bf16_f32 v99, v134, v135
  v_mfma_f32_16x16x32_bf16 v[84:87], a[188:191], a[152:155], v[228:231]
  s_add_u32 s79, s79, s64
  v_exp_f32 v128, v40
  v_mfma_f32_16x16x32_bf16 v[84:87], a[180:183], a[144:147], v[84:87]
  s_lshl_b32 s64, s1, 8
  v_exp_f32 v129, v41
  v_mfma_f32_16x16x32_bf16 v[84:87], a[172:175], a[136:139], v[84:87]
  s_add_u32 s79, s79, s64
  v_cvt_pk_bf16_f32 v100, v128, v129
  v_mfma_f32_16x16x32_bf16 v[84:87], a[164:167], a[128:131], v[84:87]
  v_add_u32 v3, s89, v1
  s_waitcnt vmcnt(0) lgkmcnt(0)
  s_barrier
  v_mfma_f32_16x16x32_bf16 a[232:235], a[240:243], v[120:123], a[232:235]
  v_cmp_eq_u32 vcc, 0, v25
  v_mfma_f32_16x16x32_bf16 a[236:239], a[240:243], v[124:127], a[236:239]
  s_cmp_lg_u32 vcc_lo, 0
  s_cbranch_scc1 Lslow_Te
Lback_Te:
  v_mfma_f32_16x16x32_bf16 v[164:167], a[192:195], v[124:127], v[164:167]
  s_add_u32 s70, s76, 0
  s_add_u32 m0, s78, 0
  v_exp_f32 v130, v42
  v_mfma_f32_16x16x32_bf16 v[160:163], a[192:195], v[120:123], v[160:163]
  v_exp_f32 v131, v43
  v_mfma_f32_16x16x32_bf16 v[168:171], a[196:199], v[120:123], v[168:171]
  buffer_load_dwordx4 v1, s[40:43], s70 offen offset:0 sc1 lds
  v_cvt_pk_bf16_f32 v101, v130, v131
  v_mfma_f32_16x16x32_bf16 v[172:175], a[196:199], v[124:127], v[172:175]
  v_exp_f32 v132, v44
  v_mfma_f32_16x16x32_bf16 v[180:183], a[200:203], v[124:127], v[180:183]
  v_exp_f32 v133, v45
  v_mfma_f32_16x16x32_bf16 v[176:179], a[200:203], v[120:123], v[176:179]
  buffer_load_dwordx4 v1, s[40:43], s70 offen offset:1024 sc1 lds
  v_cvt_pk_bf16_f32 v102, v132, v133
  v_mfma_f32_16x16x32_bf16 v[184:187], a[204:207], v[120:123], v[184:187]
  s_add_u32 s70, s70, 188416
  s_add_u32 m0, s78, 2048
  v_exp_f32 v134, v46
  v_mfma_f32_16x16x32_bf16 v[188:191], a[204:207], v[124:127], v[188:191]
  v_exp_f32 v135, v47
  v_mfma_f32_16x16x32_bf16 v[196:199], a[208:211], v[124:127], v[196:199]
  buffer_load_dwordx4 v1, s[40:43], s70 offen offset:0 sc1 lds
  v_cvt_pk_bf16_f32 v103, v134, v135
  v_mfma_f32_16x16x32_bf16 v[192:195], a[208:211], v[120:123], v[192:195]
  v_exp_f32 v128, v48
  v_mfma_f32_16x16x32_bf16 v[200:203], a[212:215], v[120:123], v[200:203]
  v_exp_f32 v129, v49
  v_mfma_f32_16x16x32_bf16 v[204:207], a[212:215], v[124:127], v[204:207]
  buffer_load_dwordx4 v1, s[40:43], s70 offen offset:1024 sc1 lds
  v_cvt_pk_bf16_f32 v104, v128, v129
  v_mfma_f32_16x16x32_bf16 v[212:215], a[216:219], v[124:127], v[212:215]
  s_add_u32 s81, s79, 0
  s_add_u32 m0, s78, 16384
  v_exp_f32 v130, v50
  v_mfma_f32_16x16x32_bf16 v[208:211], a[216:219], v[120:123], v[208:211]
  v_exp_f32 v131, v51
  v_mfma_f32_16x16x32_bf16 v[216:219], a[220:223], v[120:123], v[216:219]
  buffer_load_dwordx4 v6, s[36:39], s81 offen offset:0 lds
  v_cvt_pk_bf16_f32 v105, v130, v131
  v_mfma_f32_16x16x32_bf16 v[220:223], a[220:223], v[124:127], v[220:223]
  v_exp_f32 v132, v52
  v_mfma_f32_16x16x32_bf16 a[224:227], a[240:243], v[112:115], a[224:227]
  v_exp_f32 v133, v53
  v_mfma_f32_16x16x32_bf16 a[228:231], a[240:243], v[116:119], a[228:231]
  buffer_load_dwordx4 v7, s[36:39], s81 offen offset:1024 lds
  v_cvt_pk_bf16_f32 v106, v132, v133
  v_mfma_f32_16x16x32_bf16 a[4:7], a[192:195], v[116:119], a[4:7]
  v_exp_f32 v134, v54
  v_mfma_f32_16x16x32_bf16 a[0:3], a[192:195], v[112:115], a[0:3]
  v_exp_f32 v135, v55
  v_mfma_f32_16x16x32_bf16 a[8:11], a[196:199], v[112:115], a[8:11]
  buffer_load_dwordx4 v8, s[36:39], s81 offen offset:2048 lds
  v_cvt_pk_bf16_f32 v107, v134, v135
  v_mfma_f32_16x16x32_bf16 a[12:15], a[196:199], v[116:119], a[12:15]
  v_exp_f32 v128, v56
  v_mfma_f32_16x16x32_bf16 a[20:23], a[200:203], v[116:119], a[20:23]
  v_exp_f32 v129, v57
  v_mfma_f32_16x16x32_bf16 a[16:19], a[200:203], v[112:115], a[16:19]
  buffer_load_dwordx4 v9, s[36:39], s81 offen offset:3072 lds
  v_cvt_pk_bf16_f32 v108, v128, v129
  v_mfma_f32_16x16x32_bf16 a[24:27], a[204:207], v[112:115], a[24:27]
  s_add_u32 s81, s79, 65536
  s_add_u32 m0, s78, 49152
  v_exp_f32 v130, v58
  v_mfma_f32_16x16x32_bf16 a[28:31], a[204:207], v[116:119], a[28:31]
  v_exp_f32 v131, v59
  v_mfma_f32_16x16x32_bf16 a[36:39], a[208:211], v[116:119], a[36:39]
  buffer_load_dwordx4 v6, s[36:39], s81 offen offset:0 lds
  v_cvt_pk_bf16_f32 v109, v130, v131
  v_mfma_f32_16x16x32_bf16 a[32:35], a[208:211], v[112:115], a[32:35]
  v_exp_f32 v132, v60
  v_mfma_f32_16x16x32_bf16 a[40:43], a[212:215], v[112:115], a[40:43]
  v_exp_f32 v133, v61
  v_mfma_f32_16x16x32_bf16 a[44:47], a[212:215], v[116:119], a[44:47]
  buffer_load_dwordx4 v7, s[36:39], s81 offen offset:1024 lds
  v_cvt_pk_bf16_f32 v110, v132, v133
  v_mfma_f32_16x16x32_bf16 a[52:55], a[216:219], v[116:119], a[52:55]
  v_exp_f32 v134, v62
  v_mfma_f32_16x16x32_bf16 a[48:51], a[216:219], v[112:115], a[48:51]
  v_exp_f32 v135, v63
  v_mfma_f32_16x16x32_bf16 a[56:59], a[220:223], v[112:115], a[56:59]
  buffer_load_dwordx4 v8, s[36:39], s81 offen offset:2048 lds
  v_cvt_pk_bf16_f32 v111, v134, v135
  v_mfma_f32_16x16x32_bf16 a[60:63], a[220:223], v[116:119], a[60:63]
  buffer_load_dwordx4 v9, s[36:39], s81 offen offset:3072 lds
  ds_read_b128 a[192:195], v3 offset:0
  ds_read_b128 a[196:199], v3 offset:1024
  ds_read_b128 a[200:203], v3 offset:2048
  ds_read_b128 a[204:207], v3 offset:3072
  ds_read_b128 a[208:211], v3 offset:4096
  ds_read_b128 a[212:215], v3 offset:5120
  ds_read_b128 a[216:219], v3 offset:6144
  ds_read_b128 a[220:223], v3 offset:7168
  s_cmp_eq_u32 s62, 7
  s_cbranch_scc1 Llow_e
Llowb_e:
  s_add_u32 s89, s89, 16384
  s_and_b32 s89, s89, 0xffff
  s_or_b32 s89, s89, 0x10000
  v_add_u32 v4, s89, v1
  v_exp_f32 v128, v80
  s_and_b32 s63, s22, 0xffff
  s_add_u32 s63, s63, 65536
  v_exp_f32 v129, v81
  s_xor_b32 s3, s63, 0x8000
  s_cmp_lt_u32 s60, 2
  s_cselect_b32 s63, 131072, s63
  v_exp_f32 v130, v82
  s_lshl_b32 s64, s4, 1
  s_add_u32 s63, s63, s64
  v_exp_f32 v131, v83
  s_lshl_b32 s64, s60, 10
  s_add_u32 s64, s64, s3
  v_add_u32 v2, s63, v1
  v_add_u32 v3, s64, v1
  v_cvt_pk_bf16_f32 v120, v128, v129
  v_cvt_pk_bf16_f32 v121, v130, v131
  s_mov_b32 s100, 0x4e800000
  s_waitcnt lgkmcnt(0)
  s_barrier
  v_mfma_f32_16x16x32_bf16 a[224:227], a[240:243], v[96:99], a[224:227]
  ds_read_b128 a[160:163], v4 offset:0
  v_exp_f32 v132, v84
  v_mfma_f32_16x16x32_bf16 a[228:231], a[240:243], v[100:103], a[228:231]
  ds_read_b128 a[164:167], v4 offset:1024
  v_exp_f32 v133, v85
  v_mfma_f32_16x16x32_bf16 a[0:3], a[192:195], v[96:99], a[0:3]
  ds_read_b128 a[168:171], v4 offset:2048
  v_cvt_pk_bf16_f32 v122, v132, v133
  v_mfma_f32_16x16x32_bf16 a[4:7], a[192:195], v[100:103], a[4:7]
  ds_read_b128 a[172:175], v4 offset:3072
  v_mfma_f32_16x16x32_bf16 a[8:11], a[196:199], v[96:99], a[8:11]
  ds_read_b128 a[176:179], v4 offset:4096
  v_exp_f32 v134, v86
  v_mfma_f32_16x16x32_bf16 a[12:15], a[196:199], v[100:103], a[12:15]
  ds_read_b128 a[180:183], v4 offset:5120
  v_exp_f32 v135, v87
  v_mfma_f32_16x16x32_bf16 a[16:19], a[200:203], v[96:99], a[16:19]
  ds_read_b128 a[184:187], v4 offset:6144
  v_cvt_pk_bf16_f32 v123, v134, v135
  v_mfma_f32_16x16x32_bf16 a[20:23], a[200:203], v[100:103], a[20:23]
  ds_read_b128 a[188:191], v4 offset:7168
  v_mfma_f32_16x16x32_bf16 a[24:27], a[204:207], v[96:99], a[24:27]
  v_exp_f32 v128, v88
  v_mfma_f32_16x16x32_bf16 a[28:31], a[204:207], v[100:103], a[28:31]
  ds_write_b128 v2, a[0:3] offset:0
  v_exp_f32 v129, v89
  v_mfma_f32_16x16x32_bf16 a[32:35], a[208:211], v[96:99], a[32:35]
  s_add_u32 s70, s76, 2048
  s_add_u32 m0, s78, 32768
  v_cvt_pk_bf16_f32 v124, v128, v129
  v_mfma_f32_16x16x32_bf16 a[36:39], a[208:211], v[100:103], a[36:39]
  ds_write_b128 v2, a[4:7] offset:1024
  v_mfma_f32_16x16x32_bf16 a[40:43], a[212:215], v[96:99], a[40:43]
  buffer_load_dwordx4 v1, s[40:43], s70 offen offset:0 sc1 lds
  v_exp_f32 v130, v90
  v_mfma_f32_16x16x32_bf16 a[44:47], a[212:215], v[100:103], a[44:47]
  v_exp_f32 v131, v91
  v_mfma_f32_16x16x32_bf16 a[48:51], a[216:219], v[96:99], a[48:51]
  ds_write_b128 v2, a[8:11] offset:2048
  v_cvt_pk_bf16_f32 v125, v130, v131
  v_mfma_f32_16x16x32_bf16 a[52:55], a[216:219], v[100:103], a[52:55]
  v_mfma_f32_16x16x32_bf16 a[56:59], a[220:223], v[96:99], a[56:59]
  ds_write_b128 v2, a[12:15] offset:3072
  v_exp_f32 v132, v92
  v_mfma_f32_16x16x32_bf16 a[60:63], a[220:223], v[100:103], a[60:63]
  v_exp_f32 v133, v93
  v_mfma_f32_16x16x32_bf16 a[232:235], a[240:243], v[104:107], a[232:235]
  v_cvt_pk_bf16_f32 v126, v132, v133
  v_mfma_f32_16x16x32_bf16 a[236:239], a[240:243], v[108:111], a[236:239]
  ds_write_b128 v2, a[16:19] offset:4096
  v_mfma_f32_16x16x32_bf16 v[160:163], a[192:195], v[104:107], v[160:163]
  v_exp_f32 v134, v94
  v_mfma_f32_16x16x32_bf16 v[164:167], a[192:195], v[108:111], v[164:167]
  buffer_load_dwordx4 v1, s[40:43], s70 offen offset:1024 sc1 lds
  ds_write_b128 v2, a[20:23] offset:5120
  v_exp_f32 v135, v95
  v_mfma_f32_16x16x32_bf16 v[168:171], a[196:199], v[104:107], v[168:171]
  s_add_u32 s70, s70, 188416
  s_add_u32 m0, s78, 34816
  v_cvt_pk_bf16_f32 v127, v134, v135
  v_mfma_f32_16x16x32_bf16 v[172:175], a[196:199], v[108:111], v[172:175]
  v_mfma_f32_16x16x32_bf16 v[176:179], a[200:203], v[104:107], v[176:179]
  ds_write_b128 v2, a[24:27] offset:6144
  v_mfma_f32_16x16x32_bf16 v[180:183], a[200:203], v[108:111], v[180:183]
  v_mfma_f32_16x16x32_bf16 v[184:187], a[204:207], v[104:107], v[184:187]
  ds_write_b128 v2, a[28:31] offset:7168
  v_mfma_f32_16x16x32_bf16 v[188:191], a[204:207], v[108:111], v[188:191]
  v_mov_b32 v144, v5
  v_mfma_f32_16x16x32_bf16 v[192:195], a[208:211], v[104:107], v[192:195]
  v_xor_b32 v5, 0x400, v3
  v_mfma_f32_16x16x32_bf16 v[196:199], a[208:211], v[108:111], v[196:199]
  ds_write_b128 v2, a[32:35] offset:8192
  v_xor_b32 v28, 0x4000, v2
  v_mfma_f32_16x16x32_bf16 v[200:203], a[212:215], v[104:107], v[200:203]
  buffer_load_dwordx4 v1, s[40:43], s70 offen offset:0 sc1 lds
  v_mov_b32 v4, s3
  v_mfma_f32_16x16x32_bf16 v[204:207], a[212:215], v[108:111], v[204:207]
  ds_write_b128 v2, a[36:39] offset:9216
  v_mfma_f32_16x16x32_bf16 v[208:211], a[216:219], v[104:107], v[208:211]
  v_mfma_f32_16x16x32_bf16 v[212:215], a[216:219], v[108:111], v[212:215]
  v_mfma_f32_16x16x32_bf16 v[216:219], a[220:223], v[104:107], v[216:219]
  ds_write_b128 v2, a[40:43] offset:10240
  v_mfma_f32_16x16x32_bf16 v[220:223], a[220:223], v[108:111], v[220:223]
  s_waitcnt lgkmcnt(11)
  v_mfma_f32_16x16x32_bf16 a[232:235], a[240:243], v[120:123], a[232:235]
  ds_write_b128 v2, a[44:47] offset:11264
  v_mfma_f32_16x16x32_bf16 a[236:239], a[240:243], v[124:127], a[236:239]
  v_mfma_f32_16x16x32_bf16 v[160:163], a[160:163], v[120:123], v[160:163]
  v_mfma_f32_16x16x32_bf16 v[164:167], a[160:163], v[124:127], v[164:167]
  buffer_load_dwordx4 v1, s[40:43], s70 offen offset:1024 sc1 lds
  ds_write_b128 v2, a[48:51] offset:12288
  v_mfma_f32_16x16x32_bf16 v[168:171], a[164:167], v[120:123], v[168:171]
  v_mfma_f32_16x16x32_bf16 v[172:175], a[164:167], v[124:127], v[172:175]
  ds_write_b128 v2, a[52:55] offset:13312
  v_mfma_f32_16x16x32_bf16 v[176:179], a[168:171], v[120:123], v[176:179]
  v_mfma_f32_16x16x32_bf16 v[180:183], a[168:171], v[124:127], v[180:183]
  v_mfma_f32_16x16x32_bf16 v[184:187], a[172:175], v[120:123], v[184:187]
  ds_write_b128 v2, a[56:59] offset:14336
  v_mfma_f32_16x16x32_bf16 v[188:191], a[172:175], v[124:127], v[188:191]
  v_mfma_f32_16x16x32_bf16 v[192:195], a[176:179], v[120:123], v[192:195]
  ds_write_b128 v2, a[60:63] offset:15360
  v_accvgpr_read_b32 v156, a224
  v_mfma_f32_16x16x32_bf16 v[196:199], a[176:179], v[124:127], v[196:199]
  v_accvgpr_read_b32 v157, a228
  v_mfma_f32_16x16x32_bf16 v[200:203], a[180:183], v[120:123], v[200:203]
  v_accvgpr_read_b32 v152, a232
  v_mfma_f32_16x16x32_bf16 v[204:207], a[180:183], v[124:127], v[204:207]
  v_accvgpr_read_b32 v154, a236
  v_mfma_f32_16x16x32_bf16 v[208:211], a[184:187], v[120:123], v[208:211]
  v_cmp_nge_f32 vcc, s100, v156
  s_or_b64 s[68:69], s[68:69], vcc
  v_mfma_f32_16x16x32_bf16 v[212:215], a[184:187], v[124:127], v[212:215]
  v_cmp_nge_f32 vcc, s100, v157
  s_or_b64 s[68:69], s[68:69], vcc
  v_mfma_f32_16x16x32_bf16 v[216:219], a[188:191], v[120:123], v[216:219]
  v_cmp_nge_f32 vcc, s100, v152
  s_or_b64 s[68:69], s[68:69], vcc
  v_mfma_f32_16x16x32_bf16 v[220:223], a[188:191], v[124:127], v[220:223]
  v_cmp_nge_f32 vcc, s100, v154
  s_or_b64 s[68:69], s[68:69], vcc
  s_cselect_b32 s65, 1, 0
  v_mov_b32 v158, s65
  ds_write_b96 v3, v[156:158]
  s_branch Ltend
.p2align 5
Ltail_o:
  s_waitcnt lgkmcnt(0)
  v_mfma_f32_16x16x32_bf16 v[64:67], a[160:163], a[64:67], v[224:227]
  ds_read_b128 a[192:195], v3 offset:0
  v_exp_f32 v128, v32
  v_mfma_f32_16x16x32_bf16 v[64:67], a[168:171], a[72:75], v[64:67]
  ds_read_b128 a[196:199], v3 offset:1024
  v_exp_f32 v129, v33
  v_mfma_f32_16x16x32_bf16 v[64:67], a[176:179], a[80:83], v[64:67]
  ds_read_b128 a[200:203], v3 offset:2048
  ds_read_b128 a[204:207], v3 offset:3072
  s_lshl_b32 s63, s84, 2
  v_cvt_pk_bf16_f32 v96, v128, v129
  v_mfma_f32_16x16x32_bf16 v[64:67], a[184:187], a[88:91], v[64:67]
  ds_read_b128 a[208:211], v3 offset:4096
  s_and_b32 s64, s0, 2
  v_exp_f32 v130, v34
  v_mfma_f32_16x16x32_bf16 v[72:75], a[184:187], a[92:95], v[232:235]
  s_xor_b32 s64, s64, s60
  v_exp_f32 v131, v35
  v_mfma_f32_16x16x32_bf16 v[72:75], a[176:179], a[84:87], v[72:75]
  ds_read_b128 a[212:215], v3 offset:5120
  ds_read_b128 a[216:219], v3 offset:6144
  s_add_u32 s63, s63, s64
  v_cvt_pk_bf16_f32 v97, v130, v131
  v_mfma_f32_16x16x32_bf16 v[72:75], a[168:171], a[76:79], v[72:75]
  s_mul_i32 s63, s63, 376832
  v_exp_f32 v132, v36
  v_mfma_f32_16x16x32_bf16 v[72:75], a[160:163], a[68:71], v[72:75]
  s_mul_i32 s64, s0, 14336
  v_exp_f32 v133, v37
  v_mfma_f32_16x16x32_bf16 v[76:79], a[164:167], a[68:71], v[236:239]
  ds_read_b128 a[220:223], v3 offset:7168
  s_add_u32 s63, s63, s64
  v_cvt_pk_bf16_f32 v98, v132, v133
  v_mfma_f32_16x16x32_bf16 v[76:79], a[172:175], a[76:79], v[76:79]
  s_add_u32 s76, s63, 33685504
  s_add_u32 s89, s89, s53
  s_and_b32 s89, s89, 0xffff
  s_or_b32 s89, s89, 0x10000
  v_exp_f32 v134, v38
  v_mfma_f32_16x16x32_bf16 v[76:79], a[180:183], a[84:87], v[76:79]
  s_mul_i32 s79, s0, 458752
  v_exp_f32 v135, v39
  v_mfma_f32_16x16x32_bf16 v[76:79], a[188:191], a[92:95], v[76:79]
  s_lshl_b32 s64, s60, 14
  v_cvt_pk_bf16_f32 v99, v134, v135
  v_mfma_f32_16x16x32_bf16 v[68:71], a[188:191], a[88:91], v[228:231]
  s_add_u32 s79, s79, s64
  v_exp_f32 v128, v40
  v_mfma_f32_16x16x32_bf16 v[68:71], a[180:183], a[80:83], v[68:71]
  s_lshl_b32 s64, s1, 8
  v_exp_f32 v129, v41
  v_mfma_f32_16x16x32_bf16 v[68:71], a[172:175], a[72:75], v[68:71]
  s_add_u32 s79, s79, s64
  v_cvt_pk_bf16_f32 v100, v128, v129
  v_mfma_f32_16x16x32_bf16 v[68:71], a[164:167], a[64:67], v[68:71]
  v_add_u32 v3, s89, v1
  s_waitcnt vmcnt(0) lgkmcnt(0)
  s_barrier
  v_mfma_f32_16x16x32_bf16 a[232:235], a[240:243], v[120:123], a[232:235]
  v_cmp_eq_u32 vcc, 0, v25
  v_mfma_f32_16x16x32_bf16 a[236:239], a[240:243], v[124:127], a[236:239]
  s_cmp_lg_u32 vcc_lo, 0
  s_cbranch_scc1 Lslow_To
Lback_To:
  v_mfma_f32_16x16x32_bf16 v[164:167], a[192:195], v[124:127], v[164:167]
  s_add_u32 s70, s76, 0
  s_add_u32 m0, s78, 0
  v_exp_f32 v130, v42
  v_mfma_f32_16x16x32_bf16 v[160:163], a[192:195], v[120:123], v[160:163]
  v_exp_f32 v131, v43
  v_mfma_f32_16x16x32_bf16 v[168:171], a[196:199], v[120:123], v[168:171]
  buffer_load_dwordx4 v1, s[40:43], s70 offen offset:0 sc1 lds
  v_cvt_pk_bf16_f32 v101, v130, v131
  v_mfma_f32_16x16x32_bf16 v[172:175], a[196:199], v[124:127], v[172:175]
  v_exp_f32 v132, v44
  v_mfma_f32_16x16x32_bf16 v[180:183], a[200:203], v[124:127], v[180:183]
  v_exp_f32 v133, v45
  v_mfma_f32_16x16x32_bf16 v[176:179], a[200:203], v[120:123], v[176:179]
  buffer_load_dwordx4 v1, s[40:43], s70 offen offset:1024 sc1 lds
  v_cvt_pk_bf16_f32 v102, v132, v133
  v_mfma_f32_16x16x32_bf16 v[184:187], a[204:207], v[120:123], v[184:187]
  s_add_u32 s70, s70, 188416
  s_add_u32 m0, s78, 2048
  v_exp_f32 v134, v46
  v_mfma_f32_16x16x32_bf16 v[188:191], a[204:207], v[124:127], v[188:191]
  v_exp_f32 v135, v47
  v_mfma_f32_16x16x32_bf16 v[196:199], a[208:211], v[124:127], v[196:199]
  buffer_load_dwordx4 v1, s[40:43], s70 offen offset:0 sc1 lds
  v_cvt_pk_bf16_f32 v103, v134, v135
  v_mfma_f32_16x16x32_bf16 v[192:195], a[208:211], v[120:123], v[192:195]
  v_exp_f32 v128, v48
  v_mfma_f32_16x16x32_bf16 v[200:203], a[212:215], v[120:123], v[200:203]
  v_exp_f32 v129, v49
  v_mfma_f32_16x16x32_bf16 v[204:207], a[212:215], v[124:127], v[204:207]
  buffer_load_dwordx4 v1, s[40:43], s70 offen offset:1024 sc1 lds
  v_cvt_pk_bf16_f32 v104, v128, v129
  v_mfma_f32_16x16x32_bf16 v[212:215], a[216:219], v[124:127], v[212:215]
  s_add_u32 s81, s79, 0
  s_add_u32 m0, s78, 16384
  v_exp_f32 v130, v50
  v_mfma_f32_16x16x32_bf16 v[208:211], a[216:219], v[120:123], v[208:211]
  v_exp_f32 v131, v51
  v_mfma_f32_16x16x32_bf16 v[216:219], a[220:223], v[120:123], v[216:219]
  buffer_load_dwordx4 v6, s[36:39], s81 offen offset:0 lds
  v_cvt_pk_bf16_f32 v105, v130, v131
  v_mfma_f32_16x16x32_bf16 v[220:223], a[220:223], v[124:127], v[220:223]
  v_exp_f32 v132, v52
  v_mfma_f32_16x16x32_bf16 a[224:227], a[240:243], v[112:115], a[224:227]
  v_exp_f32 v133, v53
  v_mfma_f32_16x16x32_bf16 a[228:231], a[240:243], v[116:119], a[228:231]
  buffer_load_dwordx4 v7, s[36:39], s81 offen offset:1024 lds
  v_cvt_pk_bf16_f32 v106, v132, v133
  v_mfma_f32_16x16x32_bf16 a[4:7], a[192:195], v[116:119], a[4:7]
  v_exp_f32 v134, v54
  v_mfma_f32_16x16x32_bf16 a[0:3], a[192:195], v[112:115], a[0:3]
  v_exp_f32 v135, v55
  v_mfma_f32_16x16x32_bf16 a[8:11], a[196:199], v[112:115], a[8:11]
  buffer_load_dwordx4 v8, s[36:39], s81 offen offset:2048 lds
  v_cvt_pk_bf16_f32 v107, v134, v135
  v_mfma_f32_16x16x32_bf16 a[12:15], a[196:199], v[116:119], a[12:15]
  v_exp_f32 v128, v56
  v_mfma_f32_16x16x32_bf16 a[20:23], a[200:203], v[116:119], a[20:23]
  v_exp_f32 v129, v57
  v_mfma_f32_16x16x32_bf16 a[16:19], a[200:203], v[112:115], a[16:19]
  buffer_load_dwordx4 v9, s[36:39], s81 offen offset:3072 lds
  v_cvt_pk_bf16_f32 v108, v128, v129
  v_mfma_f32_16x16x32_bf16 a[24:27], a[204:207], v[112:115], a[24:27]
  s_add_u32 s81, s79, 65536
  s_add_u32 m0, s78, 49152
  v_exp_f32 v130, v58
  v_mfma_f32_16x16x32_bf16 a[28:31], a[204:207], v[116:119], a[28:31]
  v_exp_f32 v131, v59
  v_mfma_f32_16x16x32_bf16 a[36:39], a[208:211], v[116:119], a[36:39]
  buffer_load_dwordx4 v6, s[36:39], s81 offen offset:0 lds
  v_cvt_pk_bf16_f32 v109, v130, v131
  v_mfma_f32_16x16x32_bf16 a[32:35], a[208:211], v[112:115], a[32:35]
  v_exp_f32 v132, v60
  v_mfma_f32_16x16x32_bf16 a[40:43], a[212:215], v[112:115], a[40:43]
  v_exp_f32 v133, v61
  v_mfma_f32_16x16x32_bf16 a[44:47], a[212:215], v[116:119], a[44:47]
  buffer_load_dwordx4 v7, s[36:39], s81 offen offset:1024 lds
  v_cvt_pk_bf16_f32 v110, v132, v133
  v_mfma_f32_16x16x32_bf16 a[52:55], a[216:219], v[116:119], a[52:55]
  v_exp_f32 v134, v62
  v_mfma_f32_16x16x32_bf16 a[48:51], a[216:219], v[112:115], a[48:51]
  v_exp_f32 v135, v63
  v_mfma_f32_16x16x32_bf16 a[56:59], a[220:223], v[112:115], a[56:59]
  buffer_load_dwordx4 v8, s[36:39], s81 offen offset:2048 lds
  v_cvt_pk_bf16_f32 v111, v134, v135
  v_mfma_f32_16x16x32_bf16 a[60:63], a[220:223], v[116:119], a[60:63]
  buffer_load_dwordx4 v9, s[36:39], s81 offen offset:3072 lds
  ds_read_b128 a[192:195], v3 offset:0
  ds_read_b128 a[196:199], v3 offset:1024
  ds_read_b128 a[200:203], v3 offset:2048
  ds_read_b128 a[204:207], v3 offset:3072
  ds_read_b128 a[208:211], v3 offset:4096
  ds_read_b128 a[212:215], v3 offset:5120
  ds_read_b128 a[216:219], v3 offset:6144
  ds_read_b128 a[220:223], v3 offset:7168
  s_cmp_eq_u32 s62, 7
  s_cbranch_scc1 Llow_o
Llowb_o:
  s_add_u32 s89, s89, 16384
  s_and_b32 s89, s89, 0xffff
  s_or_b32 s89, s89, 0x10000
  v_add_u32 v4, s89, v1
  v_exp_f32 v128, v64
  s_and_b32 s63, s22, 0xffff
  s_add_u32 s63, s63, 65536
  v_exp_f32 v129, v65
  s_xor_b32 s3, s63, 0x8000
  s_cmp_lt_u32 s60, 2
  s_cselect_b32 s63, 131072, s63
  v_exp_f32 v130, v66
  s_lshl_b32 s64, s4, 1
  s_add_u32 s63, s63, s64
  v_exp_f32 v131, v67
  s_lshl_b32 s64, s60, 10
  s_add_u32 s64, s64, s3
  v_add_u32 v2, s63, v1
  v_add_u32 v3, s64, v1
  v_cvt_pk_bf16_f32 v112, v128, v129
  v_cvt_pk_bf16_f32 v113, v130, v131
  s_mov_b32 s100, 0x4e800000
  s_waitcnt lgkmcnt(0)
  s_barrier
  v_mfma_f32_16x16x32_bf16 a[232:235], a[240:243], v[104:107], a[232:235]
  ds_read_b128 a[160:163], v4 offset:0
  v_mfma_f32_16x16x32_bf16 a[236:239], a[240:243], v[108:111], a[236:239]
  ds_read_b128 a[164:167], v4 offset:1024
  v_mfma_f32_16x16x32_bf16 v[160:163], a[192:195], v[104:107], v[160:163]
  ds_read_b128 a[168:171], v4 offset:2048
  v_mfma_f32_16x16x32_bf16 v[164:167], a[192:195], v[108:111], v[164:167]
  ds_read_b128 a[172:175], v4 offset:3072
  v_mfma_f32_16x16x32_bf16 v[168:171], a[196:199], v[104:107], v[168:171]
  ds_read_b128 a[176:179], v4 offset:4096
  v_mfma_f32_16x16x32_bf16 v[172:175], a[196:199], v[108:111], v[172:175]
  ds_read_b128 a[180:183], v4 offset:5120
  v_mfma_f32_16x16x32_bf16 v[176:179], a[200:203], v[104:107], v[176:179]
  ds_read_b128 a[184:187], v4 offset:6144
  v_mfma_f32_16x16x32_bf16 v[180:183], a[200:203], v[108:111], v[180:183]
  ds_read_b128 a[188:191], v4 offset:7168
  v_mfma_f32_16x16x32_bf16 v[184:187], a[204:207], v[104:107], v[184:187]
  v_exp_f32 v132, v68
  v_mfma_f32_16x16x32_bf16 v[188:191], a[204:207], v[108:111], v[188:191]
  v_exp_f32 v133, v69
  v_mfma_f32_16x16x32_bf16 v[192:195], a[208:211], v[104:107], v[192:195]
  v_cvt_pk_bf16_f32 v114, v132, v133
  v_mfma_f32_16x16x32_bf16 v[196:199], a[208:211], v[108:111], v[196:199]
  v_exp_f32 v134, v70
  v_mfma_f32_16x16x32_bf16 v[200:203], a[212:215], v[104:107], v[200:203]
  v_exp_f32 v135, v71
  v_mfma_f32_16x16x32_bf16 v[204:207], a[212:215], v[108:111], v[204:207]
  v_cvt_pk_bf16_f32 v115, v134, v135
  v_mfma_f32_16x16x32_bf16 v[208:211], a[216:219], v[104:107], v[208:211]
  v_exp_f32 v128, v72
  v_mfma_f32_16x16x32_bf16 v[212:215], a[216:219], v[108:111], v[212:215]
  v_exp_f32 v129, v73
  v_mfma_f32_16x16x32_bf16 v[216:219], a[220:223], v[104:107], v[216:219]
  v_cvt_pk_bf16_f32 v116, v128, v129
  v_mfma_f32_16x16x32_bf16 v[220:223], a[220:223], v[108:111], v[220:223]
  v_exp_f32 v130, v74
  v_mfma_f32_16x16x32_bf16 a[224:227], a[240:243], v[96:99], a[224:227]
  v_exp_f32 v131, v75
  v_mfma_f32_16x16x32_bf16 a[228:231], a[240:243], v[100:103], a[228:231]
  v_cvt_pk_bf16_f32 v117, v130, v131
  v_mfma_f32_16x16x32_bf16 a[0:3], a[192:195], v[96:99], a[0:3]
  v_exp_f32 v132, v76
  v_mfma_f32_16x16x32_bf16 a[4:7], a[192:195], v[100:103], a[4:7]
  v_exp_f32 v133, v77
  v_mfma_f32_16x16x32_bf16 a[8:11], a[196:199], v[96:99], a[8:11]
  v_cvt_pk_bf16_f32 v118, v132, v133
  v_mfma_f32_16x16x32_bf16 a[12:15], a[196:199], v[100:103], a[12:15]
  v_exp_f32 v134, v78
  v_mfma_f32_16x16x32_bf16 a[16:19], a[200:203], v[96:99], a[16:19]
  s_add_u32 s70, s76, 2048
  s_add_u32 m0, s78, 32768
  v_exp_f32 v135, v79
  v_mfma_f32_16x16x32_bf16 a[20:23], a[200:203], v[100:103], a[20:23]
  v_cvt_pk_bf16_f32 v119, v134, v135
  v_mfma_f32_16x16x32_bf16 a[24:27], a[204:207], v[96:99], a[24:27]
  buffer_load_dwordx4 v1, s[40:43], s70 offen offset:0 sc1 lds
  v_mfma_f32_16x16x32_bf16 a[28:31], a[204:207], v[100:103], a[28:31]
  v_mov_b32 v144, v5
  v_mfma_f32_16x16x32_bf16 a[32:35], a[208:211], v[96:99], a[32:35]
  v_xor_b32 v5, 0x400, v3
  v_mfma_f32_16x16x32_bf16 a[36:39], a[208:211], v[100:103], a[36:39]
  buffer_load_dwordx4 v1, s[40:43], s70 offen offset:1024 sc1 lds
  v_xor_b32 v28, 0x4000, v2
  v_mfma_f32_16x16x32_bf16 a[40:43], a[212:215], v[96:99], a[40:43]
  s_add_u32 s70, s70, 188416
  s_add_u32 m0, s78, 34816
  v_mov_b32 v4, s3
  v_mfma_f32_16x16x32_bf16 a[44:47], a[212:215], v[100:103], a[44:47]
  v_mfma_f32_16x16x32_bf16 a[48:51], a[216:219], v[96:99], a[48:51]
  buffer_load_dwordx4 v1, s[40:43], s70 offen offset:0 sc1 lds
  v_mfma_f32_16x16x32_bf16 a[52:55], a[216:219], v[100:103], a[52:55]
  v_mfma_f32_16x16x32_bf16 a[56:59], a[220:223], v[96:99], a[56:59]
  v_mfma_f32_16x16x32_bf16 a[60:63], a[220:223], v[100:103], a[60:63]
  buffer_load_dwordx4 v1, s[40:43], s70 offen offset:1024 sc1 lds
  s_waitcnt lgkmcnt(0)
  v_mfma_f32_16x16x32_bf16 a[224:227], a[240:243], v[112:115], a[224:227]
  v_mfma_f32_16x16x32_bf16 a[228:231], a[240:243], v[116:119], a[228:231]
  v_mfma_f32_16x16x32_bf16 a[0:3], a[160:163], v[112:115], a[0:3]
  v_mfma_f32_16x16x32_bf16 a[4:7], a[160:163], v[116:119], a[4:7]
  v_mfma_f32_16x16x32_bf16 a[8:11], a[164:167], v[112:115], a[8:11]
  v_mfma_f32_16x16x32_bf16 a[12:15], a[164:167], v[116:119], a[12:15]
  v_mfma_f32_16x16x32_bf16 a[16:19], a[168:171], v[112:115], a[16:19]
  v_mfma_f32_16x16x32_bf16 a[20:23], a[168:171], v[116:119], a[20:23]
  v_mfma_f32_16x16x32_bf16 a[24:27], a[172:175], v[112:115], a[24:27]
  v_accvgpr_read_b32 v152, a232
  v_mfma_f32_16x16x32_bf16 a[28:31], a[172:175], v[116:119], a[28:31]
  ds_write_b128 v2, a[0:3] offset:0
  v_accvgpr_read_b32 v154, a236
  v_mfma_f32_16x16x32_bf16 a[32:35], a[176:179], v[112:115], a[32:35]
  v_accvgpr_read_b32 v156, a224
  v_mfma_f32_16x16x32_bf16 a[36:39], a[176:179], v[116:119], a[36:39]
  ds_write_b128 v2, a[4:7] offset:1024
  v_accvgpr_read_b32 v157, a228
  v_mfma_f32_16x16x32_bf16 a[40:43], a[180:183], v[112:115], a[40:43]
  v_mfma_f32_16x16x32_bf16 a[44:47], a[180:183], v[116:119], a[44:47]
  ds_write_b128 v2, a[8:11] offset:2048
  v_mfma_f32_16x16x32_bf16 a[48:51], a[184:187], v[112:115], a[48:51]
  v_cmp_nge_f32 vcc, s100, v156
  s_or_b64 s[68:69], s[68:69], vcc
  v_mfma_f32_16x16x32_bf16 a[52:55], a[184:187], v[116:119], a[52:55]
  ds_write_b128 v2, a[12:15] offset:3072
  v_cmp_nge_f32 vcc, s100, v157
  s_or_b64 s[68:69], s[68:69], vcc
  v_mfma_f32_16x16x32_bf16 a[56:59], a[188:191], v[112:115], a[56:59]
  v_cmp_nge_f32 vcc, s100, v152
  s_or_b64 s[68:69], s[68:69], vcc
  v_mfma_f32_16x16x32_bf16 a[60:63], a[188:191], v[116:119], a[60:63]
  ds_write_b128 v2, a[16:19] offset:4096
  v_cmp_nge_f32 vcc, s100, v154
  s_or_b64 s[68:69], s[68:69], vcc
  s_cselect_b32 s65, 1, 0
  v_mov_b32 v158, s65
  ds_write_b128 v2, a[20:23] offset:5120
  ds_write_b128 v2, a[24:27] offset:6144
  ds_write_b128 v2, a[28:31] offset:7168
  ds_write_b128 v2, a[32:35] offset:8192
  ds_write_b128 v2, a[36:39] offset:9216
  ds_write_b128 v2, a[40:43] offset:10240
  ds_write_b128 v2, a[44:47] offset:11264
  ds_write_b128 v2, a[48:51] offset:12288
  ds_write_b128 v2, a[52:55] offset:13312
  ds_write_b128 v2, a[56:59] offset:14336
  ds_write_b128 v2, a[60:63] offset:15360
  ds_write_b96 v3, v[156:158]
Ltend:
  s_waitcnt lgkmcnt(0)
  s_barrier
  ds_read_b32 v128, v4 offset:8
  ds_read_b32 v129, v4 offset:1032
  ds_read_b32 v130, v4 offset:2056
  ds_read_b32 v131, v4 offset:3080
  ds_read_b64 v[156:157], v5
  ds_read_b128 v[32:35], v28 offset:0
  ds_read_b128 v[36:39], v28 offset:1024
  ds_read_b128 v[40:43], v28 offset:2048
  ds_read_b128 v[44:47], v28 offset:3072
  ds_read_b128 v[48:51], v28 offset:4096
  ds_read_b128 v[52:55], v28 offset:5120
  ds_read_b128 v[56:59], v28 offset:6144
  ds_read_b128 v[60:63], v28 offset:7168
  ds_read_b128 v[64:67], v28 offset:8192
  s_waitcnt lgkmcnt(9)
  ds_read_b128 v[68:71], v28 offset:9216
  ds_read_b128 v[72:75], v28 offset:10240
  ds_read_b128 v[76:79], v28 offset:11264
  ds_read_b128 v[80:83], v28 offset:12288
  ds_read_b128 v[84:87], v28 offset:13312
  ds_read_b128 v[88:91], v28 offset:14336
  ds_read_b128 v[92:95], v28 offset:15360
  v_or3_b32 v128, v128, v129, v130
  v_or_b32 v128, v128, v131
  v_add_f32 v152, v152, v156
  v_add_f32 v154, v154, v157
  v_readfirstlane_b32 s65, v128
  v_rcp_f32 v148, v152
  v_rcp_f32 v150, v154
  s_andn2_b32 s65, s65, s5
  s_cbranch_scc1 Lredo
  v_mov_b32 v149, v148
  v_mov_b32 v151, v150
  s_waitcnt lgkmcnt(12)
.p2align 3
  v_pk_add_f32 v[160:161], v[160:161], v[32:33]
  v_pk_add_f32 v[162:163], v[162:163], v[34:35]
  v_pk_add_f32 v[168:169], v[168:169], v[40:41]
  v_pk_add_f32 v[170:171], v[170:171], v[42:43]
  v_pk_mul_f32 v[160:161], v[160:161], v[148:149]
  v_pk_mul_f32 v[162:163], v[162:163], v[148:149]
  v_pk_mul_f32 v[168:169], v[168:169], v[148:149]
  v_pk_mul_f32 v[170:171], v[170:171], v[148:149]
  v_cvt_pk_bf16_f32 v160, v160, v161
  v_cvt_pk_bf16_f32 v161, v162, v163
  v_cvt_pk_bf16_f32 v162, v168, v169
  v_cvt_pk_bf16_f32 v163, v170, v171
  s_lshr_b32 s63, s72, 14
  s_xor_b32 s63, s63, 6
  s_mul_i32 s63, s63, 188416
  s_lshl_b32 s64, s61, 12
  s_add_u32 s63, s63, s64
  s_add_u32 s63, s63, 33554432
  buffer_store_dwordx4 v[160:163], v1, s[40:43], s63 offen offset:0 sc1
  s_waitcnt lgkmcnt(8)
.p2align 3
  v_pk_add_f32 v[176:177], v[176:177], v[48:49]
  v_pk_add_f32 v[178:179], v[178:179], v[50:51]
  v_pk_add_f32 v[184:185], v[184:185], v[56:57]
  v_pk_add_f32 v[186:187], v[186:187], v[58:59]
  v_pk_mul_f32 v[176:177], v[176:177], v[148:149]
  v_pk_mul_f32 v[178:179], v[178:179], v[148:149]
  v_pk_mul_f32 v[184:185], v[184:185], v[148:149]
  v_pk_mul_f32 v[186:187], v[186:187], v[148:149]
  v_cvt_pk_bf16_f32 v176, v176, v177
  v_cvt_pk_bf16_f32 v177, v178, v179
  v_cvt_pk_bf16_f32 v178, v184, v185
  v_cvt_pk_bf16_f32 v179, v186, v187
  buffer_store_dwordx4 v[176:179], v1, s[40:43], s63 offen offset:1024 sc1
  s_waitcnt lgkmcnt(4)
.p2align 3
  v_pk_add_f32 v[192:193], v[192:193], v[64:65]
  v_pk_add_f32 v[194:195], v[194:195], v[66:67]
  v_pk_add_f32 v[200:201], v[200:201], v[72:73]
  v_pk_add_f32 v[202:203], v[202:203], v[74:75]
  v_pk_mul_f32 v[192:193], v[192:193], v[148:149]
  v_pk_mul_f32 v[194:195], v[194:195], v[148:149]
  v_pk_mul_f32 v[200:201], v[200:201], v[148:149]
  v_pk_mul_f32 v[202:203], v[202:203], v[148:149]
  v_cvt_pk_bf16_f32 v192, v192, v193
  v_cvt_pk_bf16_f32 v193, v194, v195
  v_cvt_pk_bf16_f32 v194, v200, v201
  v_cvt_pk_bf16_f32 v195, v202, v203
  buffer_store_dwordx4 v[192:195], v1, s[40:43], s63 offen offset:2048 sc1
  s_waitcnt lgkmcnt(0)
.p2align 3
  v_pk_add_f32 v[208:209], v[208:209], v[80:81]
  v_pk_add_f32 v[210:211], v[210:211], v[82:83]
  v_pk_add_f32 v[216:217], v[216:217], v[88:89]
  v_pk_add_f32 v[218:219], v[218:219], v[90:91]
  v_pk_mul_f32 v[208:209], v[208:209], v[148:149]
  v_pk_mul_f32 v[210:211], v[210:211], v[148:149]
  v_pk_mul_f32 v[216:217], v[216:217], v[148:149]
  v_pk_mul_f32 v[218:219], v[218:219], v[148:149]
  v_cvt_pk_bf16_f32 v208, v208, v209
  v_cvt_pk_bf16_f32 v209, v210, v211
  v_cvt_pk_bf16_f32 v210, v216, v217
  v_cvt_pk_bf16_f32 v211, v218, v219
  buffer_store_dwordx4 v[208:211], v1, s[40:43], s63 offen offset:3072 sc1
  v_pk_add_f32 v[164:165], v[164:165], v[36:37]
  v_pk_add_f32 v[166:167], v[166:167], v[38:39]
  v_pk_add_f32 v[172:173], v[172:173], v[44:45]
  v_pk_add_f32 v[174:175], v[174:175], v[46:47]
  v_pk_mul_f32 v[164:165], v[164:165], v[150:151]
  v_pk_mul_f32 v[166:167], v[166:167], v[150:151]
  v_pk_mul_f32 v[172:173], v[172:173], v[150:151]
  v_pk_mul_f32 v[174:175], v[174:175], v[150:151]
  v_cvt_pk_bf16_f32 v164, v164, v165
  v_cvt_pk_bf16_f32 v165, v166, v167
  v_cvt_pk_bf16_f32 v166, v172, v173
  v_cvt_pk_bf16_f32 v167, v174, v175
  s_lshr_b32 s63, s73, 14
  s_xor_b32 s63, s63, 6
  s_mul_i32 s63, s63, 188416
  s_lshl_b32 s64, s61, 12
  s_add_u32 s63, s63, s64
  s_add_u32 s63, s63, 33554432
.p2align 3
  buffer_store_dwordx4 v[164:167], v1, s[40:43], s63 offen offset:0 sc1
  v_pk_add_f32 v[180:181], v[180:181], v[52:53]
  v_pk_add_f32 v[182:183], v[182:183], v[54:55]
  v_pk_add_f32 v[188:189], v[188:189], v[60:61]
  v_pk_add_f32 v[190:191], v[190:191], v[62:63]
  v_pk_mul_f32 v[180:181], v[180:181], v[150:151]
  v_pk_mul_f32 v[182:183], v[182:183], v[150:151]
  v_pk_mul_f32 v[188:189], v[188:189], v[150:151]
  v_pk_mul_f32 v[190:191], v[190:191], v[150:151]
  v_cvt_pk_bf16_f32 v180, v180, v181
  v_cvt_pk_bf16_f32 v181, v182, v183
  v_cvt_pk_bf16_f32 v182, v188, v189
  v_cvt_pk_bf16_f32 v183, v190, v191
  buffer_store_dwordx4 v[180:183], v1, s[40:43], s63 offen offset:1024 sc1
  v_pk_add_f32 v[196:197], v[196:197], v[68:69]
  v_pk_add_f32 v[198:199], v[198:199], v[70:71]
  v_pk_add_f32 v[204:205], v[204:205], v[76:77]
  v_pk_add_f32 v[206:207], v[206:207], v[78:79]
  v_pk_mul_f32 v[196:197], v[196:197], v[150:151]
  v_pk_mul_f32 v[198:199], v[198:199], v[150:151]
  v_pk_mul_f32 v[204:205], v[204:205], v[150:151]
  v_pk_mul_f32 v[206:207], v[206:207], v[150:151]
  v_cvt_pk_bf16_f32 v196, v196, v197
  v_cvt_pk_bf16_f32 v197, v198, v199
  v_cvt_pk_bf16_f32 v198, v204, v205
  v_cvt_pk_bf16_f32 v199, v206, v207
  buffer_store_dwordx4 v[196:199], v1, s[40:43], s63 offen offset:2048 sc1
  v_pk_add_f32 v[212:213], v[212:213], v[84:85]
  v_pk_add_f32 v[214:215], v[214:215], v[86:87]
  v_pk_add_f32 v[220:221], v[220:221], v[92:93]
  v_pk_add_f32 v[222:223], v[222:223], v[94:95]
  v_pk_mul_f32 v[212:213], v[212:213], v[150:151]
  v_pk_mul_f32 v[214:215], v[214:215], v[150:151]
  v_pk_mul_f32 v[220:221], v[220:221], v[150:151]
  v_pk_mul_f32 v[222:223], v[222:223], v[150:151]
  v_cvt_pk_bf16_f32 v212, v212, v213
  v_cvt_pk_bf16_f32 v213, v214, v215
  v_cvt_pk_bf16_f32 v214, v220, v221
  v_cvt_pk_bf16_f32 v215, v222, v223
  buffer_store_dwordx4 v[212:215], v1, s[40:43], s63 offen offset:3072 sc1
  s_waitcnt vmcnt(8)
  s_barrier
  ds_read_b128 a[0:3], v14 offset:0
  ds_read_b128 a[4:7], v14 offset:1024
  ds_read_b128 a[8:11], v14 offset:2048
  ds_read_b128 a[12:15], v14 offset:3072
  ds_read_b128 a[16:19], v14 offset:8192
  ds_read_b128 a[20:23], v14 offset:9216
  ds_read_b128 a[24:27], v14 offset:10240
  ds_read_b128 a[28:31], v14 offset:11264
  ds_read_b64_tr_b16 a[32:33], v10 offset:16384
  ds_read_b64_tr_b16 a[34:35], v10 offset:20480
  ds_read_b64_tr_b16 a[36:37], v10 offset:24576
  ds_read_b64_tr_b16 a[38:39], v10 offset:28672
  ds_read_b64_tr_b16 a[40:41], v11 offset:16384
  ds_read_b64_tr_b16 a[42:43], v11 offset:20480
  ds_read_b64_tr_b16 a[44:45], v11 offset:24576
  ds_read_b64_tr_b16 a[46:47], v11 offset:28672
  ds_read_b64_tr_b16 a[48:49], v12 offset:16384
  ds_read_b64_tr_b16 a[50:51], v12 offset:20480
  ds_read_b64_tr_b16 a[52:53], v12 offset:24576
  ds_read_b64_tr_b16 a[54:55], v12 offset:28672
  ds_read_b64_tr_b16 a[56:57], v13 offset:16384
  ds_read_b64_tr_b16 a[58:59], v13 offset:20480
  ds_read_b64_tr_b16 a[60:61], v13 offset:24576
  ds_read_b64_tr_b16 a[62:63], v13 offset:28672
  s_lshl_b32 s63, s84, 2
  s_and_b32 s64, s0, 2
  s_add_u32 s63, s63, s64
  s_lshr_b32 s64, s60, 1
  s_add_u32 s7, s63, s64
  s_lshl_b32 s63, s7, 7
  s_add_u32 s6, s63, 58720256
  s_xor_b32 s3, s6, 256
  v_lshlrev_b32 v22, 2, v16
  s_waitcnt lgkmcnt(12)
  v_mfma_f32_16x16x32_bf16 v[96:99], a[32:35], a[0:3], 0
  ds_read_b128 a[64:67], v14 offset:32768
  s_add_u32 s81, s79, 131072
  s_add_u32 m0, s78, 81920
  v_mfma_f32_16x16x32_bf16 v[96:99], a[36:39], a[4:7], v[96:99]
  buffer_load_dwordx4 v6, s[36:39], s81 offen offset:0 lds
  v_mfma_f32_16x16x32_bf16 v[112:115], a[36:39], a[12:15], 0
  ds_read_b128 a[68:71], v14 offset:33792
  v_mfma_f32_16x16x32_bf16 v[112:115], a[32:35], a[8:11], v[112:115]
  ds_read_b128 a[72:75], v14 offset:34816
  buffer_load_dwordx4 v7, s[36:39], s81 offen offset:1024 lds
  v_mfma_f32_16x16x32_bf16 v[128:131], a[32:35], a[16:19], 0
  ds_read_b128 a[76:79], v14 offset:35840
  v_mfma_f32_16x16x32_bf16 v[128:131], a[36:39], a[20:23], v[128:131]
  buffer_load_dwordx4 v8, s[36:39], s81 offen offset:2048 lds
  v_mfma_f32_16x16x32_bf16 v[144:147], a[36:39], a[28:31], 0
  ds_read_b128 a[80:83], v14 offset:40960
  v_mfma_f32_16x16x32_bf16 v[144:147], a[32:35], a[24:27], v[144:147]
  ds_read_b128 a[84:87], v14 offset:41984
  buffer_load_dwordx4 v9, s[36:39], s81 offen offset:3072 lds
  s_add_u32 s70, s76, 4096
  s_add_u32 m0, s78, 65536
  s_waitcnt lgkmcnt(14)
  v_mfma_f32_16x16x32_bf16 v[100:103], a[40:43], a[0:3], 0
  ds_read_b128 a[88:91], v14 offset:43008
  v_mfma_f32_16x16x32_bf16 v[100:103], a[44:47], a[4:7], v[100:103]
  buffer_load_dwordx4 v1, s[40:43], s70 offen offset:0 sc1 lds
  v_mfma_f32_16x16x32_bf16 v[116:119], a[44:47], a[12:15], 0
  ds_read_b128 a[92:95], v14 offset:44032
  v_mfma_f32_16x16x32_bf16 v[116:119], a[40:43], a[8:11], v[116:119]
  ds_read_b64_tr_b16 a[96:97], v10 offset:49152
  buffer_load_dwordx4 v1, s[40:43], s70 offen offset:1024 sc1 lds
  s_add_u32 s70, s70, 188416
  s_add_u32 m0, s78, 67584
  v_add_u32 v14, 0x10000, v14
  v_mfma_f32_16x16x32_bf16 v[132:135], a[40:43], a[16:19], 0
  ds_read_b64_tr_b16 a[98:99], v10 offset:53248
  v_mfma_f32_16x16x32_bf16 v[132:135], a[44:47], a[20:23], v[132:135]
  buffer_load_dwordx4 v1, s[40:43], s70 offen offset:0 sc1 lds
  v_mfma_f32_16x16x32_bf16 v[148:151], a[44:47], a[28:31], 0
  ds_read_b64_tr_b16 a[100:101], v10 offset:57344
  v_mfma_f32_16x16x32_bf16 v[148:151], a[40:43], a[24:27], v[148:151]
  ds_read_b64_tr_b16 a[102:103], v10 offset:61440
  buffer_load_dwordx4 v1, s[40:43], s70 offen offset:1024 sc1 lds
  s_waitcnt lgkmcnt(14)
  v_mfma_f32_16x16x32_bf16 v[104:107], a[48:51], a[0:3], 0
  ds_read_b64_tr_b16 a[104:105], v11 offset:49152
  s_add_u32 s81, s79, 196608
  s_add_u32 m0, s78, 114688
  v_add_u32 v10, 0x10000, v10
  v_mfma_f32_16x16x32_bf16 v[104:107], a[52:55], a[4:7], v[104:107]
  buffer_load_dwordx4 v6, s[36:39], s81 offen offset:0 lds
  v_mfma_f32_16x16x32_bf16 v[120:123], a[52:55], a[12:15], 0
  ds_read_b64_tr_b16 a[106:107], v11 offset:53248
  v_mfma_f32_16x16x32_bf16 v[120:123], a[48:51], a[8:11], v[120:123]
  ds_read_b64_tr_b16 a[108:109], v11 offset:57344
  buffer_load_dwordx4 v7, s[36:39], s81 offen offset:1024 lds
  v_mfma_f32_16x16x32_bf16 v[136:139], a[48:51], a[16:19], 0
  ds_read_b64_tr_b16 a[110:111], v11 offset:61440
  v_mfma_f32_16x16x32_bf16 v[136:139], a[52:55], a[20:23], v[136:139]
  buffer_load_dwordx4 v8, s[36:39], s81 offen offset:2048 lds
  v_mfma_f32_16x16x32_bf16 v[152:155], a[52:55], a[28:31], 0
  ds_read_b64_tr_b16 a[112:113], v12 offset:49152
  v_add_u32 v11, 0x10000, v11
  v_mfma_f32_16x16x32_bf16 v[152:155], a[48:51], a[24:27], v[152:155]
  ds_read_b64_tr_b16 a[114:115], v12 offset:53248
  buffer_load_dwordx4 v9, s[36:39], s81 offen offset:3072 lds
  s_add_u32 s70, s76, 6144
  s_add_u32 m0, s78, 98304
  s_waitcnt lgkmcnt(14)
  v_mfma_f32_16x16x32_bf16 v[108:111], a[56:59], a[0:3], 0
  ds_read_b64_tr_b16 a[116:117], v12 offset:57344
  v_mfma_f32_16x16x32_bf16 v[108:111], a[60:63], a[4:7], v[108:111]
  buffer_load_dwordx4 v1, s[40:43], s70 offen offset:0 sc1 lds
  v_mfma_f32_16x16x32_bf16 v[124:127], a[60:63], a[12:15], 0
  ds_read_b64_tr_b16 a[118:119], v12 offset:61440
  v_mfma_f32_16x16x32_bf16 v[124:127], a[56:59], a[8:11], v[124:127]
  ds_read_b64_tr_b16 a[120:121], v13 offset:49152
  buffer_load_dwordx4 v1, s[40:43], s70 offen offset:1024 sc1 lds
  s_add_u32 s70, s70, 188416
  s_add_u32 m0, s78, 100352
  v_add_u32 v12, 0x10000, v12
  v_mfma_f32_16x16x32_bf16 v[140:143], a[56:59], a[16:19], 0
  ds_read_b64_tr_b16 a[122:123], v13 offset:53248
  v_mfma_f32_16x16x32_bf16 v[140:143], a[60:63], a[20:23], v[140:143]
  buffer_load_dwordx4 v1, s[40:43], s70 offen offset:0 sc1 lds
  v_mfma_f32_16x16x32_bf16 v[156:159], a[60:63], a[28:31], 0
  ds_read_b64_tr_b16 a[124:125], v13 offset:57344
  v_mfma_f32_16x16x32_bf16 v[156:159], a[56:59], a[24:27], v[156:159]
  ds_read_b64_tr_b16 a[126:127], v13 offset:61440
  buffer_load_dwordx4 v1, s[40:43], s70 offen offset:1024 sc1 lds
  v_add_u32 v13, 0x10000, v13
  s_waitcnt vmcnt(8)
  s_barrier
  s_add_u32 s63, s61, 32
  s_lshl_b64 exec, s[94:95], s63
  buffer_store_dword v27, v0, s[40:43], s82 offen sc1
  s_mov_b64 exec, -1
  s_lshl_b64 exec, s[94:95], s0
  buffer_store_dword v27, v0, s[40:43], s12 offen sc1
  s_mov_b64 exec, -1
  s_waitcnt lgkmcnt(12)
  v_mfma_f32_16x16x32_bf16 v[96:99], a[96:99], a[64:67], v[96:99]
  ds_read_b128 a[0:3], v14 offset:0
  s_add_u32 s81, s79, 262144
  s_add_u32 m0, s78, 147456
  v_mfma_f32_16x16x32_bf16 v[96:99], a[100:103], a[68:71], v[96:99]
  buffer_load_dwordx4 v6, s[36:39], s81 offen offset:0 lds
  v_mfma_f32_16x16x32_bf16 v[112:115], a[100:103], a[76:79], v[112:115]
  ds_read_b128 a[4:7], v14 offset:1024
  v_mfma_f32_16x16x32_bf16 v[112:115], a[96:99], a[72:75], v[112:115]
  ds_read_b128 a[8:11], v14 offset:2048
  buffer_load_dwordx4 v7, s[36:39], s81 offen offset:1024 lds
  v_mfma_f32_16x16x32_bf16 v[128:131], a[96:99], a[80:83], v[128:131]
  ds_read_b128 a[12:15], v14 offset:3072
  v_mfma_f32_16x16x32_bf16 v[128:131], a[100:103], a[84:87], v[128:131]
  buffer_load_dwordx4 v8, s[36:39], s81 offen offset:2048 lds
  v_mfma_f32_16x16x32_bf16 v[144:147], a[100:103], a[92:95], v[144:147]
  ds_read_b128 a[16:19], v14 offset:8192
  v_mfma_f32_16x16x32_bf16 v[144:147], a[96:99], a[88:91], v[144:147]
  ds_read_b128 a[20:23], v14 offset:9216
  buffer_load_dwordx4 v9, s[36:39], s81 offen offset:3072 lds
  s_add_u32 s70, s76, 8192
  s_add_u32 m0, s78, 131072
  s_waitcnt lgkmcnt(14)
  v_mfma_f32_16x16x32_bf16 v[100:103], a[104:107], a[64:67], v[100:103]
  ds_read_b128 a[24:27], v14 offset:10240
  v_mfma_f32_16x16x32_bf16 v[100:103], a[108:111], a[68:71], v[100:103]
  buffer_load_dwordx4 v1, s[40:43], s70 offen offset:0 sc1 lds
  v_mfma_f32_16x16x32_bf16 v[116:119], a[108:111], a[76:79], v[116:119]
  ds_read_b128 a[28:31], v14 offset:11264
  v_mfma_f32_16x16x32_bf16 v[116:119], a[104:107], a[72:75], v[116:119]
  ds_read_b64_tr_b16 a[32:33], v10 offset:16384
  buffer_load_dwordx4 v1, s[40:43], s70 offen offset:1024 sc1 lds
  s_add_u32 s70, s70, 188416
  s_add_u32 m0, s78, 133120
  v_mfma_f32_16x16x32_bf16 v[132:135], a[104:107], a[80:83], v[132:135]
  ds_read_b64_tr_b16 a[34:35], v10 offset:20480
  v_mfma_f32_16x16x32_bf16 v[132:135], a[108:111], a[84:87], v[132:135]
  buffer_load_dwordx4 v1, s[40:43], s70 offen offset:0 sc1 lds
  v_mfma_f32_16x16x32_bf16 v[148:151], a[108:111], a[92:95], v[148:151]
  ds_read_b64_tr_b16 a[36:37], v10 offset:24576
  v_mfma_f32_16x16x32_bf16 v[148:151], a[104:107], a[88:91], v[148:151]
  ds_read_b64_tr_b16 a[38:39], v10 offset:28672
  buffer_load_dwordx4 v1, s[40:43], s70 offen offset:1024 sc1 lds
  s_waitcnt lgkmcnt(14)
  v_mfma_f32_16x16x32_bf16 v[104:107], a[112:115], a[64:67], v[104:107]
  ds_read_b64_tr_b16 a[40:41], v11 offset:16384
  s_add_u32 s81, s79, 327680
  s_add_u32 m0, s78, 16384
  v_mfma_f32_16x16x32_bf16 v[104:107], a[116:119], a[68:71], v[104:107]
  buffer_load_dwordx4 v6, s[36:39], s81 offen offset:0 lds
  v_mfma_f32_16x16x32_bf16 v[120:123], a[116:119], a[76:79], v[120:123]
  ds_read_b64_tr_b16 a[42:43], v11 offset:20480
  v_mfma_f32_16x16x32_bf16 v[120:123], a[112:115], a[72:75], v[120:123]
  ds_read_b64_tr_b16 a[44:45], v11 offset:24576
  buffer_load_dwordx4 v7, s[36:39], s81 offen offset:1024 lds
  v_mfma_f32_16x16x32_bf16 v[136:139], a[112:115], a[80:83], v[136:139]
  ds_read_b64_tr_b16 a[46:47], v11 offset:28672
  v_mfma_f32_16x16x32_bf16 v[136:139], a[116:119], a[84:87], v[136:139]
  buffer_load_dwordx4 v8, s[36:39], s81 offen offset:2048 lds
  v_mfma_f32_16x16x32_bf16 v[152:155], a[116:119], a[92:95], v[152:155]
  ds_read_b64_tr_b16 a[48:49], v12 offset:16384
  v_mfma_f32_16x16x32_bf16 v[152:155], a[112:115], a[88:91], v[152:155]
  ds_read_b64_tr_b16 a[50:51], v12 offset:20480
  buffer_load_dwordx4 v9, s[36:39], s81 offen offset:3072 lds
  s_add_u32 s70, s76, 10240
  s_add_u32 m0, s78, 0
  s_waitcnt lgkmcnt(14)
  v_mfma_f32_16x16x32_bf16 v[108:111], a[120:123], a[64:67], v[108:111]
  ds_read_b64_tr_b16 a[52:53], v12 offset:24576
  v_mfma_f32_16x16x32_bf16 v[108:111], a[124:127], a[68:71], v[108:111]
  buffer_load_dwordx4 v1, s[40:43], s70 offen offset:0 sc1 lds
  v_mfma_f32_16x16x32_bf16 v[124:127], a[124:127], a[76:79], v[124:127]
  ds_read_b64_tr_b16 a[54:55], v12 offset:28672
  v_mfma_f32_16x16x32_bf16 v[124:127], a[120:123], a[72:75], v[124:127]
  ds_read_b64_tr_b16 a[56:57], v13 offset:16384
  buffer_load_dwordx4 v1, s[40:43], s70 offen offset:1024 sc1 lds
  s_add_u32 s70, s70, 188416
  s_add_u32 m0, s78, 2048
  v_mfma_f32_16x16x32_bf16 v[140:143], a[120:123], a[80:83], v[140:143]
  ds_read_b64_tr_b16 a[58:59], v13 offset:20480
  v_mfma_f32_16x16x32_bf16 v[140:143], a[124:127], a[84:87], v[140:143]
  buffer_load_dwordx4 v1, s[40:43], s70 offen offset:0 sc1 lds
  v_mfma_f32_16x16x32_bf16 v[156:159], a[124:127], a[92:95], v[156:159]
  ds_read_b64_tr_b16 a[60:61], v13 offset:24576
  v_mfma_f32_16x16x32_bf16 v[156:159], a[120:123], a[88:91], v[156:159]
  ds_read_b64_tr_b16 a[62:63], v13 offset:28672
  buffer_load_dwordx4 v1, s[40:43], s70 offen offset:1024 sc1 lds
  s_waitcnt vmcnt(16)
  s_barrier
  s_waitcnt lgkmcnt(12)
  v_mfma_f32_16x16x32_bf16 v[96:99], a[32:35], a[0:3], v[96:99]
  ds_read_b128 a[64:67], v14 offset:32768
  s_add_u32 s81, s79, 393216
  s_add_u32 m0, s78, 49152
  v_mfma_f32_16x16x32_bf16 v[96:99], a[36:39], a[4:7], v[96:99]
  buffer_load_dwordx4 v6, s[36:39], s81 offen offset:0 lds
  v_mfma_f32_16x16x32_bf16 v[112:115], a[36:39], a[12:15], v[112:115]
  ds_read_b128 a[68:71], v14 offset:33792
  v_mfma_f32_16x16x32_bf16 v[112:115], a[32:35], a[8:11], v[112:115]
  ds_read_b128 a[72:75], v14 offset:34816
  v_mfma_f32_16x16x32_bf16 v[128:131], a[32:35], a[16:19], v[128:131]
  ds_read_b128 a[76:79], v14 offset:35840
  v_mfma_f32_16x16x32_bf16 v[128:131], a[36:39], a[20:23], v[128:131]
  buffer_load_dwordx4 v7, s[36:39], s81 offen offset:1024 lds
  v_mfma_f32_16x16x32_bf16 v[144:147], a[36:39], a[28:31], v[144:147]
  ds_read_b128 a[80:83], v14 offset:40960
  v_mfma_f32_16x16x32_bf16 v[144:147], a[32:35], a[24:27], v[144:147]
  ds_read_b128 a[84:87], v14 offset:41984
  s_waitcnt lgkmcnt(14)
  v_mfma_f32_16x16x32_bf16 v[100:103], a[40:43], a[0:3], v[100:103]
  ds_read_b128 a[88:91], v14 offset:43008
  v_mfma_f32_16x16x32_bf16 v[100:103], a[44:47], a[4:7], v[100:103]
  buffer_load_dwordx4 v8, s[36:39], s81 offen offset:2048 lds
  v_mfma_f32_16x16x32_bf16 v[116:119], a[44:47], a[12:15], v[116:119]
  ds_read_b128 a[92:95], v14 offset:44032
  v_mfma_f32_16x16x32_bf16 v[116:119], a[40:43], a[8:11], v[116:119]
  ds_read_b64_tr_b16 a[96:97], v10 offset:49152
  v_add_u32 v14, 0x10000, v14
  v_mfma_f32_16x16x32_bf16 v[132:135], a[40:43], a[16:19], v[132:135]
  ds_read_b64_tr_b16 a[98:99], v10 offset:53248
  v_mfma_f32_16x16x32_bf16 v[132:135], a[44:47], a[20:23], v[132:135]
  buffer_load_dwordx4 v9, s[36:39], s81 offen offset:3072 lds
  v_mfma_f32_16x16x32_bf16 v[148:151], a[44:47], a[28:31], v[148:151]
  ds_read_b64_tr_b16 a[100:101], v10 offset:57344
  v_mfma_f32_16x16x32_bf16 v[148:151], a[40:43], a[24:27], v[148:151]
  ds_read_b64_tr_b16 a[102:103], v10 offset:61440
  s_waitcnt lgkmcnt(14)
  v_mfma_f32_16x16x32_bf16 v[104:107], a[48:51], a[0:3], v[104:107]
  ds_read_b64_tr_b16 a[104:105], v11 offset:49152
  s_add_u32 s70, s76, 12288
  s_add_u32 m0, s78, 32768
  v_add_u32 v10, 0x10000, v10
  v_mfma_f32_16x16x32_bf16 v[104:107], a[52:55], a[4:7], v[104:107]
  buffer_load_dwordx4 v1, s[40:43], s70 offen offset:0 sc1 lds
  v_mfma_f32_16x16x32_bf16 v[120:123], a[52:55], a[12:15], v[120:123]
  ds_read_b64_tr_b16 a[106:107], v11 offset:53248
  v_mfma_f32_16x16x32_bf16 v[120:123], a[48:51], a[8:11], v[120:123]
  ds_read_b64_tr_b16 a[108:109], v11 offset:57344
  v_mfma_f32_16x16x32_bf16 v[136:139], a[48:51], a[16:19], v[136:139]
  ds_read_b64_tr_b16 a[110:111], v11 offset:61440
  v_mfma_f32_16x16x32_bf16 v[136:139], a[52:55], a[20:23], v[136:139]
  buffer_load_dwordx4 v1, s[40:43], s70 offen offset:1024 sc1 lds
  s_add_u32 s70, s70, 188416
  s_add_u32 m0, s78, 34816
  v_mfma_f32_16x16x32_bf16 v[152:155], a[52:55], a[28:31], v[152:155]
  ds_read_b64_tr_b16 a[112:113], v12 offset:49152
  v_add_u32 v11, 0x10000, v11
  v_mfma_f32_16x16x32_bf16 v[152:155], a[48:51], a[24:27], v[152:155]
  ds_read_b64_tr_b16 a[114:115], v12 offset:53248
  s_waitcnt lgkmcnt(14)
  v_mfma_f32_16x16x32_bf16 v[108:111], a[56:59], a[0:3], v[108:111]
  ds_read_b64_tr_b16 a[116:117], v12 offset:57344
  v_mfma_f32_16x16x32_bf16 v[108:111], a[60:63], a[4:7], v[108:111]
  buffer_load_dwordx4 v1, s[40:43], s70 offen offset:0 sc1 lds
  v_mfma_f32_16x16x32_bf16 v[124:127], a[60:63], a[12:15], v[124:127]
  ds_read_b64_tr_b16 a[118:119], v12 offset:61440
  v_mfma_f32_16x16x32_bf16 v[124:127], a[56:59], a[8:11], v[124:127]
  ds_read_b64_tr_b16 a[120:121], v13 offset:49152
  v_add_u32 v12, 0x10000, v12
  v_mfma_f32_16x16x32_bf16 v[140:143], a[56:59], a[16:19], v[140:143]
  ds_read_b64_tr_b16 a[122:123], v13 offset:53248
  v_mfma_f32_16x16x32_bf16 v[140:143], a[60:63], a[20:23], v[140:143]
  buffer_load_dwordx4 v1, s[40:43], s70 offen offset:1024 sc1 lds
  v_mfma_f32_16x16x32_bf16 v[156:159], a[60:63], a[28:31], v[156:159]
  ds_read_b64_tr_b16 a[124:125], v13 offset:57344
  v_mfma_f32_16x16x32_bf16 v[156:159], a[56:59], a[24:27], v[156:159]
  ds_read_b64_tr_b16 a[126:127], v13 offset:61440
  v_add_u32 v13, 0x10000, v13
  s_waitcnt vmcnt(16)
  s_barrier
  s_waitcnt lgkmcnt(12)
  v_mfma_f32_16x16x32_bf16 v[96:99], a[96:99], a[64:67], v[96:99]
  ds_read_b128 a[0:3], v14 offset:0
  s_mul_i32 s65, s0, 589824
  s_add_u32 s79, s79, s65
  s_add_u32 s81, s79, 0
  s_add_u32 m0, s78, 81920
  v_mfma_f32_16x16x32_bf16 v[96:99], a[100:103], a[68:71], v[96:99]
  buffer_load_dwordx4 v6, s[28:31], s81 offen offset:0 lds
  v_mfma_f32_16x16x32_bf16 v[112:115], a[100:103], a[76:79], v[112:115]
  ds_read_b128 a[4:7], v14 offset:1024
  v_mfma_f32_16x16x32_bf16 v[112:115], a[96:99], a[72:75], v[112:115]
  ds_read_b128 a[8:11], v14 offset:2048
  v_mfma_f32_16x16x32_bf16 v[128:131], a[96:99], a[80:83], v[128:131]
  ds_read_b128 a[12:15], v14 offset:3072
  v_mfma_f32_16x16x32_bf16 v[128:131], a[100:103], a[84:87], v[128:131]
  buffer_load_dwordx4 v7, s[28:31], s81 offen offset:1024 lds
  v_mfma_f32_16x16x32_bf16 v[144:147], a[100:103], a[92:95], v[144:147]
  ds_read_b128 a[16:19], v14 offset:8192
  v_mfma_f32_16x16x32_bf16 v[144:147], a[96:99], a[88:91], v[144:147]
  ds_read_b128 a[20:23], v14 offset:9216
  s_waitcnt lgkmcnt(14)
  v_mfma_f32_16x16x32_bf16 v[100:103], a[104:107], a[64:67], v[100:103]
  ds_read_b128 a[24:27], v14 offset:10240
  v_mfma_f32_16x16x32_bf16 v[100:103], a[108:111], a[68:71], v[100:103]
  buffer_load_dwordx4 v8, s[28:31], s81 offen offset:2048 lds
  v_mfma_f32_16x16x32_bf16 v[116:119], a[108:111], a[76:79], v[116:119]
  ds_read_b128 a[28:31], v14 offset:11264
  v_mfma_f32_16x16x32_bf16 v[116:119], a[104:107], a[72:75], v[116:119]
  ds_read_b64_tr_b16 a[32:33], v10 offset:16384
  v_add_u32 v14, 0xfffe0000, v14
  v_mfma_f32_16x16x32_bf16 v[132:135], a[104:107], a[80:83], v[132:135]
  ds_read_b64_tr_b16 a[34:35], v10 offset:20480
  v_mfma_f32_16x16x32_bf16 v[132:135], a[108:111], a[84:87], v[132:135]
  buffer_load_dwordx4 v9, s[28:31], s81 offen offset:3072 lds
  v_mfma_f32_16x16x32_bf16 v[148:151], a[108:111], a[92:95], v[148:151]
  ds_read_b64_tr_b16 a[36:37], v10 offset:24576
  v_mfma_f32_16x16x32_bf16 v[148:151], a[104:107], a[88:91], v[148:151]
  ds_read_b64_tr_b16 a[38:39], v10 offset:28672
  s_waitcnt lgkmcnt(14)
  v_mfma_f32_16x16x32_bf16 v[104:107], a[112:115], a[64:67], v[104:107]
  ds_read_b64_tr_b16 a[40:41], v11 offset:16384
  v_add_u32 v10, 0xfffe0000, v10
  v_mfma_f32_16x16x32_bf16 v[104:107], a[116:119], a[68:71], v[104:107]
  v_mfma_f32_16x16x32_bf16 v[120:123], a[116:119], a[76:79], v[120:123]
  ds_read_b64_tr_b16 a[42:43], v11 offset:20480
  v_mfma_f32_16x16x32_bf16 v[120:123], a[112:115], a[72:75], v[120:123]
  ds_read_b64_tr_b16 a[44:45], v11 offset:24576
  v_mfma_f32_16x16x32_bf16 v[136:139], a[112:115], a[80:83], v[136:139]
  ds_read_b64_tr_b16 a[46:47], v11 offset:28672
  v_mfma_f32_16x16x32_bf16 v[136:139], a[116:119], a[84:87], v[136:139]
  v_mfma_f32_16x16x32_bf16 v[152:155], a[116:119], a[92:95], v[152:155]
  ds_read_b64_tr_b16 a[48:49], v12 offset:16384
  v_add_u32 v11, 0xfffe0000, v11
  v_mfma_f32_16x16x32_bf16 v[152:155], a[112:115], a[88:91], v[152:155]
  ds_read_b64_tr_b16 a[50:51], v12 offset:20480
  s_waitcnt lgkmcnt(14)
  v_mfma_f32_16x16x32_bf16 v[108:111], a[120:123], a[64:67], v[108:111]
  ds_read_b64_tr_b16 a[52:53], v12 offset:24576
  v_mfma_f32_16x16x32_bf16 v[108:111], a[124:127], a[68:71], v[108:111]
  v_mfma_f32_16x16x32_bf16 v[124:127], a[124:127], a[76:79], v[124:127]
  ds_read_b64_tr_b16 a[54:55], v12 offset:28672
  v_mfma_f32_16x16x32_bf16 v[124:127], a[120:123], a[72:75], v[124:127]
  ds_read_b64_tr_b16 a[56:57], v13 offset:16384
  v_add_u32 v12, 0xfffe0000, v12
  v_mfma_f32_16x16x32_bf16 v[140:143], a[120:123], a[80:83], v[140:143]
  ds_read_b64_tr_b16 a[58:59], v13 offset:20480
  v_mfma_f32_16x16x32_bf16 v[140:143], a[124:127], a[84:87], v[140:143]
  v_mfma_f32_16x16x32_bf16 v[156:159], a[124:127], a[92:95], v[156:159]
  ds_read_b64_tr_b16 a[60:61], v13 offset:24576
  v_mfma_f32_16x16x32_bf16 v[156:159], a[120:123], a[88:91], v[156:159]
  ds_read_b64_tr_b16 a[62:63], v13 offset:28672
  v_add_u32 v13, 0xfffe0000, v13
  s_waitcnt vmcnt(12)
  s_barrier
  s_waitcnt lgkmcnt(12)
  v_mfma_f32_16x16x32_bf16 v[96:99], a[32:35], a[0:3], v[96:99]
  ds_read_b128 a[64:67], v14 offset:0
  s_add_u32 s81, s79, 65536
  s_add_u32 m0, s78, 114688
  v_mfma_f32_16x16x32_bf16 v[96:99], a[36:39], a[4:7], v[96:99]
  buffer_load_dwordx4 v6, s[28:31], s81 offen offset:0 lds
  v_mfma_f32_16x16x32_bf16 v[112:115], a[36:39], a[12:15], v[112:115]
  ds_read_b128 a[68:71], v14 offset:1024
  v_mfma_f32_16x16x32_bf16 v[112:115], a[32:35], a[8:11], v[112:115]
  ds_read_b128 a[72:75], v14 offset:2048
  v_mfma_f32_16x16x32_bf16 v[128:131], a[32:35], a[16:19], v[128:131]
  ds_read_b128 a[76:79], v14 offset:3072
  v_mfma_f32_16x16x32_bf16 v[128:131], a[36:39], a[20:23], v[128:131]
  buffer_load_dwordx4 v7, s[28:31], s81 offen offset:1024 lds
  v_mfma_f32_16x16x32_bf16 v[144:147], a[36:39], a[28:31], v[144:147]
  ds_read_b128 a[80:83], v14 offset:8192
  v_mfma_f32_16x16x32_bf16 v[144:147], a[32:35], a[24:27], v[144:147]
  ds_read_b128 a[84:87], v14 offset:9216
  s_waitcnt lgkmcnt(14)
  v_mfma_f32_16x16x32_bf16 v[100:103], a[40:43], a[0:3], v[100:103]
  ds_read_b128 a[88:91], v14 offset:10240
  v_mfma_f32_16x16x32_bf16 v[100:103], a[44:47], a[4:7], v[100:103]
  buffer_load_dwordx4 v8, s[28:31], s81 offen offset:2048 lds
  v_mfma_f32_16x16x32_bf16 v[116:119], a[44:47], a[12:15], v[116:119]
  ds_read_b128 a[92:95], v14 offset:11264
  v_mfma_f32_16x16x32_bf16 v[116:119], a[40:43], a[8:11], v[116:119]
  ds_read_b64_tr_b16 a[96:97], v10 offset:16384
  v_mfma_f32_16x16x32_bf16 v[132:135], a[40:43], a[16:19], v[132:135]
  ds_read_b64_tr_b16 a[98:99], v10 offset:20480
  v_mfma_f32_16x16x32_bf16 v[132:135], a[44:47], a[20:23], v[132:135]
  buffer_load_dwordx4 v9, s[28:31], s81 offen offset:3072 lds
  v_mfma_f32_16x16x32_bf16 v[148:151], a[44:47], a[28:31], v[148:151]
  ds_read_b64_tr_b16 a[100:101], v10 offset:24576
  v_mfma_f32_16x16x32_bf16 v[148:151], a[40:43], a[24:27], v[148:151]
  ds_read_b64_tr_b16 a[102:103], v10 offset:28672
  s_waitcnt lgkmcnt(14)
  v_mfma_f32_16x16x32_bf16 v[104:107], a[48:51], a[0:3], v[104:107]
  ds_read_b64_tr_b16 a[104:105], v11 offset:16384
  v_mfma_f32_16x16x32_bf16 v[104:107], a[52:55], a[4:7], v[104:107]
  buffer_load_dword v25, v0, s[40:43], s83 offen sc1
  v_mfma_f32_16x16x32_bf16 v[120:123], a[52:55], a[12:15], v[120:123]
  ds_read_b64_tr_b16 a[106:107], v11 offset:20480
  v_mfma_f32_16x16x32_bf16 v[120:123], a[48:51], a[8:11], v[120:123]
  ds_read_b64_tr_b16 a[108:109], v11 offset:24576
  v_mfma_f32_16x16x32_bf16 v[136:139], a[48:51], a[16:19], v[136:139]
  ds_read_b64_tr_b16 a[110:111], v11 offset:28672
  v_mfma_f32_16x16x32_bf16 v[136:139], a[52:55], a[20:23], v[136:139]
  v_mfma_f32_16x16x32_bf16 v[152:155], a[52:55], a[28:31], v[152:155]
  ds_read_b64_tr_b16 a[112:113], v12 offset:16384
  v_mfma_f32_16x16x32_bf16 v[152:155], a[48:51], a[24:27], v[152:155]
  ds_read_b64_tr_b16 a[114:115], v12 offset:20480
  s_waitcnt lgkmcnt(14)
  v_mfma_f32_16x16x32_bf16 v[108:111], a[56:59], a[0:3], v[108:111]
  ds_read_b64_tr_b16 a[116:117], v12 offset:24576
  v_mfma_f32_16x16x32_bf16 v[108:111], a[60:63], a[4:7], v[108:111]
  v_mfma_f32_16x16x32_bf16 v[124:127], a[60:63], a[12:15], v[124:127]
  ds_read_b64_tr_b16 a[118:119], v12 offset:28672
  v_mfma_f32_16x16x32_bf16 v[124:127], a[56:59], a[8:11], v[124:127]
  ds_read_b64_tr_b16 a[120:121], v13 offset:16384
  v_mfma_f32_16x16x32_bf16 v[140:143], a[56:59], a[16:19], v[140:143]
  ds_read_b64_tr_b16 a[122:123], v13 offset:20480
  v_mfma_f32_16x16x32_bf16 v[140:143], a[60:63], a[20:23], v[140:143]
  v_mfma_f32_16x16x32_bf16 v[156:159], a[60:63], a[28:31], v[156:159]
  ds_read_b64_tr_b16 a[124:125], v13 offset:24576
  v_mfma_f32_16x16x32_bf16 v[156:159], a[56:59], a[24:27], v[156:159]
  ds_read_b64_tr_b16 a[126:127], v13 offset:28672
  s_waitcnt vmcnt(9)
  s_barrier
  s_waitcnt lgkmcnt(12)
  v_mfma_f32_16x16x32_bf16 v[96:99], a[96:99], a[64:67], v[96:99]
  ds_read_b128 a[0:3], v14 offset:32768
  s_add_u32 s81, s79, 131072
  s_add_u32 m0, s78, 147456
  v_mfma_f32_16x16x32_bf16 v[96:99], a[100:103], a[68:71], v[96:99]
  buffer_load_dwordx4 v6, s[28:31], s81 offen offset:0 lds
  v_mfma_f32_16x16x32_bf16 v[112:115], a[100:103], a[76:79], v[112:115]
  ds_read_b128 a[4:7], v14 offset:33792
  v_mfma_f32_16x16x32_bf16 v[112:115], a[96:99], a[72:75], v[112:115]
  ds_read_b128 a[8:11], v14 offset:34816
  v_mfma_f32_16x16x32_bf16 v[128:131], a[96:99], a[80:83], v[128:131]
  ds_read_b128 a[12:15], v14 offset:35840
  v_mfma_f32_16x16x32_bf16 v[128:131], a[100:103], a[84:87], v[128:131]
  buffer_load_dwordx4 v7, s[28:31], s81 offen offset:1024 lds
  v_mfma_f32_16x16x32_bf16 v[144:147], a[100:103], a[92:95], v[144:147]
  ds_read_b128 a[16:19], v14 offset:40960
  v_mfma_f32_16x16x32_bf16 v[144:147], a[96:99], a[88:91], v[144:147]
  ds_read_b128 a[20:23], v14 offset:41984
  s_waitcnt lgkmcnt(14)
  v_mfma_f32_16x16x32_bf16 v[100:103], a[104:107], a[64:67], v[100:103]
  ds_read_b128 a[24:27], v14 offset:43008
  v_mfma_f32_16x16x32_bf16 v[100:103], a[108:111], a[68:71], v[100:103]
  buffer_load_dwordx4 v8, s[28:31], s81 offen offset:2048 lds
  v_mfma_f32_16x16x32_bf16 v[116:119], a[108:111], a[76:79], v[116:119]
  ds_read_b128 a[28:31], v14 offset:44032
  v_mfma_f32_16x16x32_bf16 v[116:119], a[104:107], a[72:75], v[116:119]
  ds_read_b64_tr_b16 a[32:33], v10 offset:49152
  v_add_u32 v14, 0x10000, v14
  v_mfma_f32_16x16x32_bf16 v[132:135], a[104:107], a[80:83], v[132:135]
  ds_read_b64_tr_b16 a[34:35], v10 offset:53248
  v_mfma_f32_16x16x32_bf16 v[132:135], a[108:111], a[84:87], v[132:135]
  buffer_load_dwordx4 v9, s[28:31], s81 offen offset:3072 lds
  v_mfma_f32_16x16x32_bf16 v[148:151], a[108:111], a[92:95], v[148:151]
  ds_read_b64_tr_b16 a[36:37], v10 offset:57344
  v_mfma_f32_16x16x32_bf16 v[148:151], a[104:107], a[88:91], v[148:151]
  ds_read_b64_tr_b16 a[38:39], v10 offset:61440
  s_waitcnt vmcnt(4)
  s_lshl_b32 s63, s0, 3
  s_lshl_b32 s85, 0xff, s63
  v_cmp_eq_u32 vcc, 0, v25
  s_and_b32 s63, vcc_hi, s85
  s_cbranch_scc1 Lspin6
Lpok6:
  s_mul_i32 s65, s0, 18432
  s_sub_u32 s65, s65, 131072
  s_add_u32 s76, s76, s65
  s_add_u32 s70, s76, 0
  s_add_u32 m0, s78, 65536
  s_nop 0
  buffer_load_dwordx4 v1, s[40:43], s70 offen offset:0 sc1 lds
  buffer_load_dwordx4 v1, s[40:43], s70 offen offset:1024 sc1 lds
  s_add_u32 s70, s70, 188416
  s_add_u32 m0, s78, 67584
  s_nop 0
  buffer_load_dwordx4 v1, s[40:43], s70 offen offset:0 sc1 lds
  buffer_load_dwordx4 v1, s[40:43], s70 offen offset:1024 sc1 lds
  s_add_u32 s70, s76, 2048
  s_add_u32 m0, s78, 98304
  s_nop 0
  buffer_load_dwordx4 v1, s[40:43], s70 offen offset:0 sc1 lds
  buffer_load_dwordx4 v1, s[40:43], s70 offen offset:1024 sc1 lds
  s_add_u32 s70, s70, 188416
  s_add_u32 m0, s78, 100352
  s_nop 0
  buffer_load_dwordx4 v1, s[40:43], s70 offen offset:0 sc1 lds
  buffer_load_dwordx4 v1, s[40:43], s70 offen offset:1024 sc1 lds
  s_add_u32 s70, s76, 4096
  s_add_u32 m0, s78, 131072
  s_nop 0
  buffer_load_dwordx4 v1, s[40:43], s70 offen offset:0 sc1 lds
  buffer_load_dwordx4 v1, s[40:43], s70 offen offset:1024 sc1 lds
  s_add_u32 s70, s70, 188416
  s_add_u32 m0, s78, 133120
  s_nop 0
  buffer_load_dwordx4 v1, s[40:43], s70 offen offset:0 sc1 lds
  buffer_load_dwordx4 v1, s[40:43], s70 offen offset:1024 sc1 lds
  s_waitcnt lgkmcnt(14)
  v_mfma_f32_16x16x32_bf16 v[104:107], a[112:115], a[64:67], v[104:107]
  ds_read_b64_tr_b16 a[40:41], v11 offset:49152
  v_add_u32 v10, 0x10000, v10
  v_mfma_f32_16x16x32_bf16 v[104:107], a[116:119], a[68:71], v[104:107]
  v_mfma_f32_16x16x32_bf16 v[120:123], a[116:119], a[76:79], v[120:123]
  ds_read_b64_tr_b16 a[42:43], v11 offset:53248
  v_mfma_f32_16x16x32_bf16 v[120:123], a[112:115], a[72:75], v[120:123]
  ds_read_b64_tr_b16 a[44:45], v11 offset:57344
  v_mfma_f32_16x16x32_bf16 v[136:139], a[112:115], a[80:83], v[136:139]
  ds_read_b64_tr_b16 a[46:47], v11 offset:61440
  v_mfma_f32_16x16x32_bf16 v[136:139], a[116:119], a[84:87], v[136:139]
  v_mfma_f32_16x16x32_bf16 v[152:155], a[116:119], a[92:95], v[152:155]
  ds_read_b64_tr_b16 a[48:49], v12 offset:49152
  v_add_u32 v11, 0x10000, v11
  v_mfma_f32_16x16x32_bf16 v[152:155], a[112:115], a[88:91], v[152:155]
  ds_read_b64_tr_b16 a[50:51], v12 offset:53248
  s_waitcnt lgkmcnt(14)
  v_mfma_f32_16x16x32_bf16 v[108:111], a[120:123], a[64:67], v[108:111]
  ds_read_b64_tr_b16 a[52:53], v12 offset:57344
  v_mfma_f32_16x16x32_bf16 v[108:111], a[124:127], a[68:71], v[108:111]
  v_mfma_f32_16x16x32_bf16 v[124:127], a[124:127], a[76:79], v[124:127]
  ds_read_b64_tr_b16 a[54:55], v12 offset:61440
  v_mfma_f32_16x16x32_bf16 v[124:127], a[120:123], a[72:75], v[124:127]
  ds_read_b64_tr_b16 a[56:57], v13 offset:49152
  v_add_u32 v12, 0x10000, v12
  v_mfma_f32_16x16x32_bf16 v[140:143], a[120:123], a[80:83], v[140:143]
  ds_read_b64_tr_b16 a[58:59], v13 offset:53248
  v_mfma_f32_16x16x32_bf16 v[140:143], a[124:127], a[84:87], v[140:143]
  v_mfma_f32_16x16x32_bf16 v[156:159], a[124:127], a[92:95], v[156:159]
  ds_read_b64_tr_b16 a[60:61], v13 offset:57344
  v_mfma_f32_16x16x32_bf16 v[156:159], a[120:123], a[88:91], v[156:159]
  ds_read_b64_tr_b16 a[62:63], v13 offset:61440
  v_add_u32 v13, 0x10000, v13
  s_waitcnt vmcnt(8)
  s_barrier
  s_waitcnt lgkmcnt(12)
  v_mfma_f32_16x16x32_bf16 v[96:99], a[32:35], a[0:3], v[96:99]
  ds_read_b128 a[64:67], v14 offset:0
  s_add_u32 s81, s79, 196608
  s_add_u32 m0, s78, 16384
  v_mfma_f32_16x16x32_bf16 v[96:99], a[36:39], a[4:7], v[96:99]
  buffer_load_dwordx4 v6, s[28:31], s81 offen offset:0 lds
  v_mfma_f32_16x16x32_bf16 v[112:115], a[36:39], a[12:15], v[112:115]
  ds_read_b128 a[68:71], v14 offset:1024
  v_mfma_f32_16x16x32_bf16 v[112:115], a[32:35], a[8:11], v[112:115]
  ds_read_b128 a[72:75], v14 offset:2048
  v_mfma_f32_16x16x32_bf16 v[128:131], a[32:35], a[16:19], v[128:131]
  ds_read_b128 a[76:79], v14 offset:3072
  v_mfma_f32_16x16x32_bf16 v[128:131], a[36:39], a[20:23], v[128:131]
  buffer_load_dwordx4 v7, s[28:31], s81 offen offset:1024 lds
  v_mfma_f32_16x16x32_bf16 v[144:147], a[36:39], a[28:31], v[144:147]
  ds_read_b128 a[80:83], v14 offset:8192
  v_mfma_f32_16x16x32_bf16 v[144:147], a[32:35], a[24:27], v[144:147]
  ds_read_b128 a[84:87], v14 offset:9216
  s_waitcnt lgkmcnt(14)
  v_mfma_f32_16x16x32_bf16 v[100:103], a[40:43], a[0:3], v[100:103]
  ds_read_b128 a[88:91], v14 offset:10240
  v_mfma_f32_16x16x32_bf16 v[100:103], a[44:47], a[4:7], v[100:103]
  buffer_load_dwordx4 v8, s[28:31], s81 offen offset:2048 lds
  v_mfma_f32_16x16x32_bf16 v[116:119], a[44:47], a[12:15], v[116:119]
  ds_read_b128 a[92:95], v14 offset:11264
  v_mfma_f32_16x16x32_bf16 v[116:119], a[40:43], a[8:11], v[116:119]
  ds_read_b64_tr_b16 a[96:97], v10 offset:16384
  v_mfma_f32_16x16x32_bf16 v[132:135], a[40:43], a[16:19], v[132:135]
  ds_read_b64_tr_b16 a[98:99], v10 offset:20480
  v_mfma_f32_16x16x32_bf16 v[132:135], a[44:47], a[20:23], v[132:135]
  buffer_load_dwordx4 v9, s[28:31], s81 offen offset:3072 lds
  v_mfma_f32_16x16x32_bf16 v[148:151], a[44:47], a[28:31], v[148:151]
  ds_read_b64_tr_b16 a[100:101], v10 offset:24576
  v_mfma_f32_16x16x32_bf16 v[148:151], a[40:43], a[24:27], v[148:151]
  ds_read_b64_tr_b16 a[102:103], v10 offset:28672
  s_waitcnt lgkmcnt(14)
  v_mfma_f32_16x16x32_bf16 v[104:107], a[48:51], a[0:3], v[104:107]
  ds_read_b64_tr_b16 a[104:105], v11 offset:16384
  s_add_u32 s70, s76, 6144
  s_add_u32 m0, s78, 0
  v_mfma_f32_16x16x32_bf16 v[104:107], a[52:55], a[4:7], v[104:107]
  buffer_load_dwordx4 v1, s[40:43], s70 offen offset:0 sc1 lds
  v_mfma_f32_16x16x32_bf16 v[120:123], a[52:55], a[12:15], v[120:123]
  ds_read_b64_tr_b16 a[106:107], v11 offset:20480
  v_mfma_f32_16x16x32_bf16 v[120:123], a[48:51], a[8:11], v[120:123]
  ds_read_b64_tr_b16 a[108:109], v11 offset:24576
  v_mfma_f32_16x16x32_bf16 v[136:139], a[48:51], a[16:19], v[136:139]
  ds_read_b64_tr_b16 a[110:111], v11 offset:28672
  v_mfma_f32_16x16x32_bf16 v[136:139], a[52:55], a[20:23], v[136:139]
  buffer_load_dwordx4 v1, s[40:43], s70 offen offset:1024 sc1 lds
  s_add_u32 s70, s70, 188416
  s_add_u32 m0, s78, 2048
  v_mfma_f32_16x16x32_bf16 v[152:155], a[52:55], a[28:31], v[152:155]
  ds_read_b64_tr_b16 a[112:113], v12 offset:16384
  v_mfma_f32_16x16x32_bf16 v[152:155], a[48:51], a[24:27], v[152:155]
  ds_read_b64_tr_b16 a[114:115], v12 offset:20480
  s_waitcnt lgkmcnt(14)
  v_mfma_f32_16x16x32_bf16 v[108:111], a[56:59], a[0:3], v[108:111]
  ds_read_b64_tr_b16 a[116:117], v12 offset:24576
  v_mfma_f32_16x16x32_bf16 v[108:111], a[60:63], a[4:7], v[108:111]
  buffer_load_dwordx4 v1, s[40:43], s70 offen offset:0 sc1 lds
  v_mfma_f32_16x16x32_bf16 v[124:127], a[60:63], a[12:15], v[124:127]
  ds_read_b64_tr_b16 a[118:119], v12 offset:28672
  v_mfma_f32_16x16x32_bf16 v[124:127], a[56:59], a[8:11], v[124:127]
  ds_read_b64_tr_b16 a[120:121], v13 offset:16384
  v_mfma_f32_16x16x32_bf16 v[140:143], a[56:59], a[16:19], v[140:143]
  ds_read_b64_tr_b16 a[122:123], v13 offset:20480
  v_mfma_f32_16x16x32_bf16 v[140:143], a[60:63], a[20:23], v[140:143]
  buffer_load_dwordx4 v1, s[40:43], s70 offen offset:1024 sc1 lds
  v_mfma_f32_16x16x32_bf16 v[156:159], a[60:63], a[28:31], v[156:159]
  ds_read_b64_tr_b16 a[124:125], v13 offset:24576
  v_mfma_f32_16x16x32_bf16 v[156:159], a[56:59], a[24:27], v[156:159]
  ds_read_b64_tr_b16 a[126:127], v13 offset:28672
  s_waitcnt vmcnt(12)
  s_barrier
  s_waitcnt lgkmcnt(12)
  v_mfma_f32_16x16x32_bf16 v[32:35], a[96:99], a[64:67], 0
  ds_read_b128 a[0:3], v14 offset:32768
  v_mfma_f32_16x16x32_bf16 v[32:35], a[100:103], a[68:71], v[32:35]
  buffer_load_dword v18, v22, s[40:43], s6 offen offset:0 sc1
  v_mfma_f32_16x16x32_bf16 v[48:51], a[100:103], a[76:79], 0
  ds_read_b128 a[4:7], v14 offset:33792
  v_mfma_f32_16x16x32_bf16 v[48:51], a[96:99], a[72:75], v[48:51]
  ds_read_b128 a[8:11], v14 offset:34816
  buffer_load_dword v19, v22, s[40:43], s6 offen offset:64 sc1
  v_mfma_f32_16x16x32_bf16 v[64:67], a[96:99], a[80:83], 0
  ds_read_b128 a[12:15], v14 offset:35840
  v_mfma_f32_16x16x32_bf16 v[64:67], a[100:103], a[84:87], v[64:67]
  buffer_load_dword v20, v22, s[40:43], s3 offen offset:0 sc1
  v_mfma_f32_16x16x32_bf16 v[80:83], a[100:103], a[92:95], 0
  ds_read_b128 a[16:19], v14 offset:40960
  v_mfma_f32_16x16x32_bf16 v[80:83], a[96:99], a[88:91], v[80:83]
  ds_read_b128 a[20:23], v14 offset:41984
  buffer_load_dword v21, v22, s[40:43], s3 offen offset:64 sc1
  s_add_u32 s81, s79, 262144
  s_add_u32 m0, s78, 49152
  s_waitcnt lgkmcnt(14)
  v_mfma_f32_16x16x32_bf16 v[36:39], a[104:107], a[64:67], 0
  ds_read_b128 a[24:27], v14 offset:43008
  v_mfma_f32_16x16x32_bf16 v[36:39], a[108:111], a[68:71], v[36:39]
  buffer_load_dwordx4 v6, s[28:31], s81 offen offset:0 lds
  v_mfma_f32_16x16x32_bf16 v[52:55], a[108:111], a[76:79], 0
  ds_read_b128 a[28:31], v14 offset:44032
  v_mfma_f32_16x16x32_bf16 v[52:55], a[104:107], a[72:75], v[52:55]
  ds_read_b64_tr_b16 a[32:33], v10 offset:49152
  buffer_load_dwordx4 v7, s[28:31], s81 offen offset:1024 lds
  v_add_u32 v14, 0x10000, v14
  v_mfma_f32_16x16x32_bf16 v[68:71], a[104:107], a[80:83], 0
  ds_read_b64_tr_b16 a[34:35], v10 offset:53248
  v_mfma_f32_16x16x32_bf16 v[68:71], a[108:111], a[84:87], v[68:71]
  buffer_load_dwordx4 v8, s[28:31], s81 offen offset:2048 lds
  v_mfma_f32_16x16x32_bf16 v[84:87], a[108:111], a[92:95], 0
  ds_read_b64_tr_b16 a[36:37], v10 offset:57344
  v_mfma_f32_16x16x32_bf16 v[84:87], a[104:107], a[88:91], v[84:87]
  ds_read_b64_tr_b16 a[38:39], v10 offset:61440
  buffer_load_dwordx4 v9, s[28:31], s81 offen offset:3072 lds
  s_waitcnt lgkmcnt(14)
  v_mfma_f32_16x16x32_bf16 v[40:43], a[112:115], a[64:67], 0
  ds_read_b64_tr_b16 a[40:41], v11 offset:49152
  s_add_u32 s70, s76, 8192
  s_add_u32 m0, s78, 32768
  v_add_u32 v10, 0x10000, v10
  v_mfma_f32_16x16x32_bf16 v[40:43], a[116:119], a[68:71], v[40:43]
  buffer_load_dwordx4 v1, s[40:43], s70 offen offset:0 sc1 lds
  v_mfma_f32_16x16x32_bf16 v[56:59], a[116:119], a[76:79], 0
  ds_read_b64_tr_b16 a[42:43], v11 offset:53248
  v_mfma_f32_16x16x32_bf16 v[56:59], a[112:115], a[72:75], v[56:59]
  ds_read_b64_tr_b16 a[44:45], v11 offset:57344
  v_mfma_f32_16x16x32_bf16 v[72:75], a[112:115], a[80:83], 0
  ds_read_b64_tr_b16 a[46:47], v11 offset:61440
  v_mfma_f32_16x16x32_bf16 v[72:75], a[116:119], a[84:87], v[72:75]
  buffer_load_dwordx4 v1, s[40:43], s70 offen offset:1024 sc1 lds
  s_add_u32 s70, s70, 188416
  s_add_u32 m0, s78, 34816
  v_mfma_f32_16x16x32_bf16 v[88:91], a[116:119], a[92:95], 0
  ds_read_b64_tr_b16 a[48:49], v12 offset:49152
  v_add_u32 v11, 0x10000, v11
  v_mfma_f32_16x16x32_bf16 v[88:91], a[112:115], a[88:91], v[88:91]
  ds_read_b64_tr_b16 a[50:51], v12 offset:53248
  s_waitcnt lgkmcnt(14)
  v_mfma_f32_16x16x32_bf16 v[44:47], a[120:123], a[64:67], 0
  ds_read_b64_tr_b16 a[52:53], v12 offset:57344
  v_mfma_f32_16x16x32_bf16 v[44:47], a[124:127], a[68:71], v[44:47]
  buffer_load_dwordx4 v1, s[40:43], s70 offen offset:0 sc1 lds
  v_mfma_f32_16x16x32_bf16 v[60:63], a[124:127], a[76:79], 0
  ds_read_b64_tr_b16 a[54:55], v12 offset:61440
  v_mfma_f32_16x16x32_bf16 v[60:63], a[120:123], a[72:75], v[60:63]
  ds_read_b64_tr_b16 a[56:57], v13 offset:49152
  v_add_u32 v12, 0x10000, v12
  v_mfma_f32_16x16x32_bf16 v[76:79], a[120:123], a[80:83], 0
  ds_read_b64_tr_b16 a[58:59], v13 offset:53248
  v_mfma_f32_16x16x32_bf16 v[76:79], a[124:127], a[84:87], v[76:79]
  buffer_load_dwordx4 v1, s[40:43], s70 offen offset:1024 sc1 lds
  v_mfma_f32_16x16x32_bf16 v[92:95], a[124:127], a[92:95], 0
  ds_read_b64_tr_b16 a[60:61], v13 offset:57344
  v_mfma_f32_16x16x32_bf16 v[92:95], a[120:123], a[88:91], v[92:95]
  ds_read_b64_tr_b16 a[62:63], v13 offset:61440
  v_add_u32 v13, 0x10000, v13
  s_waitcnt vmcnt(20)
  s_barrier
  s_waitcnt lgkmcnt(12)
  v_mfma_f32_16x16x32_bf16 v[32:35], a[32:35], a[0:3], v[32:35]
  ds_read_b128 a[64:67], v14 offset:0
  s_add_u32 s81, s79, 327680
  s_add_u32 m0, s78, 81920
  v_mfma_f32_16x16x32_bf16 v[32:35], a[36:39], a[4:7], v[32:35]
  buffer_load_dwordx4 v6, s[28:31], s81 offen offset:0 lds
  v_mfma_f32_16x16x32_bf16 v[48:51], a[36:39], a[12:15], v[48:51]
  ds_read_b128 a[68:71], v14 offset:1024
  v_mfma_f32_16x16x32_bf16 v[48:51], a[32:35], a[8:11], v[48:51]
  ds_read_b128 a[72:75], v14 offset:2048
  v_mfma_f32_16x16x32_bf16 v[64:67], a[32:35], a[16:19], v[64:67]
  ds_read_b128 a[76:79], v14 offset:3072
  v_mfma_f32_16x16x32_bf16 v[64:67], a[36:39], a[20:23], v[64:67]
  buffer_load_dwordx4 v7, s[28:31], s81 offen offset:1024 lds
  v_mfma_f32_16x16x32_bf16 v[80:83], a[36:39], a[28:31], v[80:83]
  ds_read_b128 a[80:83], v14 offset:8192
  v_mfma_f32_16x16x32_bf16 v[80:83], a[32:35], a[24:27], v[80:83]
  ds_read_b128 a[84:87], v14 offset:9216
  s_waitcnt lgkmcnt(14)
  v_mfma_f32_16x16x32_bf16 v[36:39], a[40:43], a[0:3], v[36:39]
  ds_read_b128 a[88:91], v14 offset:10240
  v_mfma_f32_16x16x32_bf16 v[36:39], a[44:47], a[4:7], v[36:39]
  buffer_load_dwordx4 v8, s[28:31], s81 offen offset:2048 lds
  v_mfma_f32_16x16x32_bf16 v[52:55], a[44:47], a[12:15], v[52:55]
  ds_read_b128 a[92:95], v14 offset:11264
  v_mfma_f32_16x16x32_bf16 v[52:55], a[40:43], a[8:11], v[52:55]
  ds_read_b64_tr_b16 a[96:97], v10 offset:16384
  v_add_u32 v14, 0xfffe0000, v14
  v_mfma_f32_16x16x32_bf16 v[68:71], a[40:43], a[16:19], v[68:71]
  ds_read_b64_tr_b16 a[98:99], v10 offset:20480
  v_mfma_f32_16x16x32_bf16 v[68:71], a[44:47], a[20:23], v[68:71]
  buffer_load_dwordx4 v9, s[28:31], s81 offen offset:3072 lds
  v_mfma_f32_16x16x32_bf16 v[84:87], a[44:47], a[28:31], v[84:87]
  ds_read_b64_tr_b16 a[100:101], v10 offset:24576
  v_mfma_f32_16x16x32_bf16 v[84:87], a[40:43], a[24:27], v[84:87]
  ds_read_b64_tr_b16 a[102:103], v10 offset:28672
  s_waitcnt lgkmcnt(14)
  v_mfma_f32_16x16x32_bf16 v[40:43], a[48:51], a[0:3], v[40:43]
  ds_read_b64_tr_b16 a[104:105], v11 offset:16384
  s_add_u32 s70, s76, 10240
  s_add_u32 m0, s78, 65536
  v_add_u32 v10, 0xfffe0000, v10
  v_mfma_f32_16x16x32_bf16 v[40:43], a[52:55], a[4:7], v[40:43]
  buffer_load_dwordx4 v1, s[40:43], s70 offen offset:0 sc1 lds
  v_mfma_f32_16x16x32_bf16 v[56:59], a[52:55], a[12:15], v[56:59]
  ds_read_b64_tr_b16 a[106:107], v11 offset:20480
  v_mfma_f32_16x16x32_bf16 v[56:59], a[48:51], a[8:11], v[56:59]
  ds_read_b64_tr_b16 a[108:109], v11 offset:24576
  v_mfma_f32_16x16x32_bf16 v[72:75], a[48:51], a[16:19], v[72:75]
  ds_read_b64_tr_b16 a[110:111], v11 offset:28672
  v_mfma_f32_16x16x32_bf16 v[72:75], a[52:55], a[20:23], v[72:75]
  buffer_load_dwordx4 v1, s[40:43], s70 offen offset:1024 sc1 lds
  s_add_u32 s70, s70, 188416
  s_add_u32 m0, s78, 67584
  v_mfma_f32_16x16x32_bf16 v[88:91], a[52:55], a[28:31], v[88:91]
  ds_read_b64_tr_b16 a[112:113], v12 offset:16384
  v_add_u32 v11, 0xfffe0000, v11
  v_mfma_f32_16x16x32_bf16 v[88:91], a[48:51], a[24:27], v[88:91]
  ds_read_b64_tr_b16 a[114:115], v12 offset:20480
  s_waitcnt lgkmcnt(14)
  v_mfma_f32_16x16x32_bf16 v[44:47], a[56:59], a[0:3], v[44:47]
  ds_read_b64_tr_b16 a[116:117], v12 offset:24576
  v_mfma_f32_16x16x32_bf16 v[44:47], a[60:63], a[4:7], v[44:47]
  buffer_load_dwordx4 v1, s[40:43], s70 offen offset:0 sc1 lds
  v_mfma_f32_16x16x32_bf16 v[60:63], a[60:63], a[12:15], v[60:63]
  ds_read_b64_tr_b16 a[118:119], v12 offset:28672
  v_mfma_f32_16x16x32_bf16 v[60:63], a[56:59], a[8:11], v[60:63]
  ds_read_b64_tr_b16 a[120:121], v13 offset:16384
  v_add_u32 v12, 0xfffe0000, v12
  v_mfma_f32_16x16x32_bf16 v[76:79], a[56:59], a[16:19], v[76:79]
  ds_read_b64_tr_b16 a[122:123], v13 offset:20480
  v_mfma_f32_16x16x32_bf16 v[76:79], a[60:63], a[20:23], v[76:79]
  buffer_load_dwordx4 v1, s[40:43], s70 offen offset:1024 sc1 lds
  v_mfma_f32_16x16x32_bf16 v[92:95], a[60:63], a[28:31], v[92:95]
  ds_read_b64_tr_b16 a[124:125], v13 offset:24576
  v_mfma_f32_16x16x32_bf16 v[92:95], a[56:59], a[24:27], v[92:95]
  ds_read_b64_tr_b16 a[126:127], v13 offset:28672
  v_add_u32 v13, 0xfffe0000, v13
  s_waitcnt vmcnt(20)
  s_barrier
  s_waitcnt lgkmcnt(12)
  v_mfma_f32_16x16x32_bf16 v[32:35], a[96:99], a[64:67], v[32:35]
  ds_read_b128 a[0:3], v14 offset:0
  s_add_u32 s81, s79, 393216
  s_add_u32 m0, s78, 114688
  v_mfma_f32_16x16x32_bf16 v[32:35], a[100:103], a[68:71], v[32:35]
  buffer_load_dwordx4 v6, s[28:31], s81 offen offset:0 lds
  v_mfma_f32_16x16x32_bf16 v[48:51], a[100:103], a[76:79], v[48:51]
  ds_read_b128 a[4:7], v14 offset:1024
  v_mfma_f32_16x16x32_bf16 v[48:51], a[96:99], a[72:75], v[48:51]
  ds_read_b128 a[8:11], v14 offset:2048
  v_mfma_f32_16x16x32_bf16 v[64:67], a[96:99], a[80:83], v[64:67]
  ds_read_b128 a[12:15], v14 offset:3072
  v_mfma_f32_16x16x32_bf16 v[64:67], a[100:103], a[84:87], v[64:67]
  buffer_load_dwordx4 v7, s[28:31], s81 offen offset:1024 lds
  v_mfma_f32_16x16x32_bf16 v[80:83], a[100:103], a[92:95], v[80:83]
  ds_read_b128 a[16:19], v14 offset:8192
  v_mfma_f32_16x16x32_bf16 v[80:83], a[96:99], a[88:91], v[80:83]
  ds_read_b128 a[20:23], v14 offset:9216
  s_waitcnt lgkmcnt(14)
  v_mfma_f32_16x16x32_bf16 v[36:39], a[104:107], a[64:67], v[36:39]
  ds_read_b128 a[24:27], v14 offset:10240
  v_mfma_f32_16x16x32_bf16 v[36:39], a[108:111], a[68:71], v[36:39]
  buffer_load_dwordx4 v8, s[28:31], s81 offen offset:2048 lds
  v_mfma_f32_16x16x32_bf16 v[52:55], a[108:111], a[76:79], v[52:55]
  ds_read_b128 a[28:31], v14 offset:11264
  v_mfma_f32_16x16x32_bf16 v[52:55], a[104:107], a[72:75], v[52:55]
  ds_read_b64_tr_b16 a[32:33], v10 offset:16384
  v_mfma_f32_16x16x32_bf16 v[68:71], a[104:107], a[80:83], v[68:71]
  ds_read_b64_tr_b16 a[34:35], v10 offset:20480
  v_mfma_f32_16x16x32_bf16 v[68:71], a[108:111], a[84:87], v[68:71]
  buffer_load_dwordx4 v9, s[28:31], s81 offen offset:3072 lds
  v_mfma_f32_16x16x32_bf16 v[84:87], a[108:111], a[92:95], v[84:87]
  ds_read_b64_tr_b16 a[36:37], v10 offset:24576
  v_mfma_f32_16x16x32_bf16 v[84:87], a[104:107], a[88:91], v[84:87]
  ds_read_b64_tr_b16 a[38:39], v10 offset:28672
  s_waitcnt lgkmcnt(14)
  v_mfma_f32_16x16x32_bf16 v[40:43], a[112:115], a[64:67], v[40:43]
  ds_read_b64_tr_b16 a[40:41], v11 offset:16384
  s_add_u32 s70, s76, 12288
  s_add_u32 m0, s78, 98304
  v_mfma_f32_16x16x32_bf16 v[40:43], a[116:119], a[68:71], v[40:43]
  buffer_load_dwordx4 v1, s[40:43], s70 offen offset:0 sc1 lds
  v_mfma_f32_16x16x32_bf16 v[56:59], a[116:119], a[76:79], v[56:59]
  ds_read_b64_tr_b16 a[42:43], v11 offset:20480
  v_mfma_f32_16x16x32_bf16 v[56:59], a[112:115], a[72:75], v[56:59]
  ds_read_b64_tr_b16 a[44:45], v11 offset:24576
  v_mfma_f32_16x16x32_bf16 v[72:75], a[112:115], a[80:83], v[72:75]
  ds_read_b64_tr_b16 a[46:47], v11 offset:28672
  v_mfma_f32_16x16x32_bf16 v[72:75], a[116:119], a[84:87], v[72:75]
  buffer_load_dwordx4 v1, s[40:43], s70 offen offset:1024 sc1 lds
  s_add_u32 s70, s70, 188416
  s_add_u32 m0, s78, 100352
  v_mfma_f32_16x16x32_bf16 v[88:91], a[116:119], a[92:95], v[88:91]
  ds_read_b64_tr_b16 a[48:49], v12 offset:16384
  v_mfma_f32_16x16x32_bf16 v[88:91], a[112:115], a[88:91], v[88:91]
  ds_read_b64_tr_b16 a[50:51], v12 offset:20480
  s_waitcnt lgkmcnt(14)
  v_mfma_f32_16x16x32_bf16 v[44:47], a[120:123], a[64:67], v[44:47]
  ds_read_b64_tr_b16 a[52:53], v12 offset:24576
  v_mfma_f32_16x16x32_bf16 v[44:47], a[124:127], a[68:71], v[44:47]
  buffer_load_dwordx4 v1, s[40:43], s70 offen offset:0 sc1 lds
  v_mfma_f32_16x16x32_bf16 v[60:63], a[124:127], a[76:79], v[60:63]
  ds_read_b64_tr_b16 a[54:55], v12 offset:28672
  v_mfma_f32_16x16x32_bf16 v[60:63], a[120:123], a[72:75], v[60:63]
  ds_read_b64_tr_b16 a[56:57], v13 offset:16384
  v_mfma_f32_16x16x32_bf16 v[76:79], a[120:123], a[80:83], v[76:79]
  ds_read_b64_tr_b16 a[58:59], v13 offset:20480
  v_mfma_f32_16x16x32_bf16 v[76:79], a[124:127], a[84:87], v[76:79]
  buffer_load_dwordx4 v1, s[40:43], s70 offen offset:1024 sc1 lds
  v_mfma_f32_16x16x32_bf16 v[92:95], a[124:127], a[92:95], v[92:95]
  ds_read_b64_tr_b16 a[60:61], v13 offset:24576
  v_mfma_f32_16x16x32_bf16 v[92:95], a[120:123], a[88:91], v[92:95]
  ds_read_b64_tr_b16 a[62:63], v13 offset:28672
  s_waitcnt vmcnt(16)
  s_barrier
  s_waitcnt lgkmcnt(12)
  v_mfma_f32_16x16x32_bf16 v[32:35], a[32:35], a[0:3], v[32:35]
  ds_read_b128 a[64:67], v14 offset:32768
  s_add_u32 s81, s79, 458752
  s_add_u32 m0, s78, 147456
  v_mfma_f32_16x16x32_bf16 v[32:35], a[36:39], a[4:7], v[32:35]
  buffer_load_dwordx4 v6, s[28:31], s81 offen offset:0 lds
  v_mfma_f32_16x16x32_bf16 v[48:51], a[36:39], a[12:15], v[48:51]
  ds_read_b128 a[68:71], v14 offset:33792
  v_mfma_f32_16x16x32_bf16 v[48:51], a[32:35], a[8:11], v[48:51]
  ds_read_b128 a[72:75], v14 offset:34816
  v_mfma_f32_16x16x32_bf16 v[64:67], a[32:35], a[16:19], v[64:67]
  ds_read_b128 a[76:79], v14 offset:35840
  v_mfma_f32_16x16x32_bf16 v[64:67], a[36:39], a[20:23], v[64:67]
  buffer_load_dwordx4 v7, s[28:31], s81 offen offset:1024 lds
  v_mfma_f32_16x16x32_bf16 v[80:83], a[36:39], a[28:31], v[80:83]
  ds_read_b128 a[80:83], v14 offset:40960
  v_mfma_f32_16x16x32_bf16 v[80:83], a[32:35], a[24:27], v[80:83]
  ds_read_b128 a[84:87], v14 offset:41984
  s_waitcnt lgkmcnt(14)
  v_mfma_f32_16x16x32_bf16 v[36:39], a[40:43], a[0:3], v[36:39]
  ds_read_b128 a[88:91], v14 offset:43008
  v_mfma_f32_16x16x32_bf16 v[36:39], a[44:47], a[4:7], v[36:39]
  buffer_load_dwordx4 v8, s[28:31], s81 offen offset:2048 lds
  v_mfma_f32_16x16x32_bf16 v[52:55], a[44:47], a[12:15], v[52:55]
  ds_read_b128 a[92:95], v14 offset:44032
  v_mfma_f32_16x16x32_bf16 v[52:55], a[40:43], a[8:11], v[52:55]
  ds_read_b64_tr_b16 a[96:97], v10 offset:49152
  v_add_u32 v14, 0x10000, v14
  v_mfma_f32_16x16x32_bf16 v[68:71], a[40:43], a[16:19], v[68:71]
  ds_read_b64_tr_b16 a[98:99], v10 offset:53248
  v_mfma_f32_16x16x32_bf16 v[68:71], a[44:47], a[20:23], v[68:71]
  buffer_load_dwordx4 v9, s[28:31], s81 offen offset:3072 lds
  v_mfma_f32_16x16x32_bf16 v[84:87], a[44:47], a[28:31], v[84:87]
  ds_read_b64_tr_b16 a[100:101], v10 offset:57344
  v_mfma_f32_16x16x32_bf16 v[84:87], a[40:43], a[24:27], v[84:87]
  ds_read_b64_tr_b16 a[102:103], v10 offset:61440
  s_waitcnt lgkmcnt(14)
  v_mfma_f32_16x16x32_bf16 v[40:43], a[48:51], a[0:3], v[40:43]
  ds_read_b64_tr_b16 a[104:105], v11 offset:49152
  s_add_u32 s70, s76, 14336
  s_add_u32 m0, s78, 131072
  v_add_u32 v10, 0x10000, v10
  v_mfma_f32_16x16x32_bf16 v[40:43], a[52:55], a[4:7], v[40:43]
  buffer_load_dwordx4 v1, s[40:43], s70 offen offset:0 sc1 lds
  v_mfma_f32_16x16x32_bf16 v[56:59], a[52:55], a[12:15], v[56:59]
  ds_read_b64_tr_b16 a[106:107], v11 offset:53248
  v_mfma_f32_16x16x32_bf16 v[56:59], a[48:51], a[8:11], v[56:59]
  ds_read_b64_tr_b16 a[108:109], v11 offset:57344
  v_mfma_f32_16x16x32_bf16 v[72:75], a[48:51], a[16:19], v[72:75]
  ds_read_b64_tr_b16 a[110:111], v11 offset:61440
  v_mfma_f32_16x16x32_bf16 v[72:75], a[52:55], a[20:23], v[72:75]
  buffer_load_dwordx4 v1, s[40:43], s70 offen offset:1024 sc1 lds
  s_add_u32 s70, s70, 188416
  s_add_u32 m0, s78, 133120
  v_mfma_f32_16x16x32_bf16 v[88:91], a[52:55], a[28:31], v[88:91]
  ds_read_b64_tr_b16 a[112:113], v12 offset:49152
  v_add_u32 v11, 0x10000, v11
  v_mfma_f32_16x16x32_bf16 v[88:91], a[48:51], a[24:27], v[88:91]
  ds_read_b64_tr_b16 a[114:115], v12 offset:53248
  s_waitcnt lgkmcnt(14)
  v_mfma_f32_16x16x32_bf16 v[44:47], a[56:59], a[0:3], v[44:47]
  ds_read_b64_tr_b16 a[116:117], v12 offset:57344
  v_mfma_f32_16x16x32_bf16 v[44:47], a[60:63], a[4:7], v[44:47]
  buffer_load_dwordx4 v1, s[40:43], s70 offen offset:0 sc1 lds
  v_mfma_f32_16x16x32_bf16 v[60:63], a[60:63], a[12:15], v[60:63]
  ds_read_b64_tr_b16 a[118:119], v12 offset:61440
  v_mfma_f32_16x16x32_bf16 v[60:63], a[56:59], a[8:11], v[60:63]
  ds_read_b64_tr_b16 a[120:121], v13 offset:49152
  v_add_u32 v12, 0x10000, v12
  v_mfma_f32_16x16x32_bf16 v[76:79], a[56:59], a[16:19], v[76:79]
  ds_read_b64_tr_b16 a[122:123], v13 offset:53248
  v_mfma_f32_16x16x32_bf16 v[76:79], a[60:63], a[20:23], v[76:79]
  buffer_load_dwordx4 v1, s[40:43], s70 offen offset:1024 sc1 lds
  v_mfma_f32_16x16x32_bf16 v[92:95], a[60:63], a[28:31], v[92:95]
  ds_read_b64_tr_b16 a[124:125], v13 offset:57344
  v_mfma_f32_16x16x32_bf16 v[92:95], a[56:59], a[24:27], v[92:95]
  ds_read_b64_tr_b16 a[126:127], v13 offset:61440
  v_add_u32 v13, 0x10000, v13
  s_waitcnt vmcnt(16)
  s_barrier
  s_waitcnt lgkmcnt(12)
  v_mfma_f32_16x16x32_bf16 v[32:35], a[96:99], a[64:67], v[32:35]
  ds_read_b128 a[0:3], v14 offset:0
  s_add_u32 s81, s79, 524288
  s_add_u32 m0, s78, 16384
  v_mfma_f32_16x16x32_bf16 v[32:35], a[100:103], a[68:71], v[32:35]
  buffer_load_dwordx4 v6, s[28:31], s81 offen offset:0 lds
  v_mfma_f32_16x16x32_bf16 v[48:51], a[100:103], a[76:79], v[48:51]
  ds_read_b128 a[4:7], v14 offset:1024
  v_sub_f32 v2, 1.0, v18
  v_mfma_f32_16x16x32_bf16 v[48:51], a[96:99], a[72:75], v[48:51]
  ds_read_b128 a[8:11], v14 offset:2048
  v_mfma_f32_16x16x32_bf16 v[64:67], a[96:99], a[80:83], v[64:67]
  ds_read_b128 a[12:15], v14 offset:3072
  v_mfma_f32_16x16x32_bf16 v[64:67], a[100:103], a[84:87], v[64:67]
  buffer_load_dwordx4 v7, s[28:31], s81 offen offset:1024 lds
  v_mfma_f32_16x16x32_bf16 v[80:83], a[100:103], a[92:95], v[80:83]
  ds_read_b128 a[16:19], v14 offset:8192
  v_sub_f32 v3, 1.0, v19
  v_mfma_f32_16x16x32_bf16 v[80:83], a[96:99], a[88:91], v[80:83]
  ds_read_b128 a[20:23], v14 offset:9216
  s_waitcnt lgkmcnt(14)
  v_mfma_f32_16x16x32_bf16 v[36:39], a[104:107], a[64:67], v[36:39]
  ds_read_b128 a[24:27], v14 offset:10240
  v_mfma_f32_16x16x32_bf16 v[36:39], a[108:111], a[68:71], v[36:39]
  buffer_load_dwordx4 v8, s[28:31], s81 offen offset:2048 lds
  v_mfma_f32_16x16x32_bf16 v[52:55], a[108:111], a[76:79], v[52:55]
  ds_read_b128 a[28:31], v14 offset:11264
  v_sub_f32 v4, 1.0, v20
  v_mfma_f32_16x16x32_bf16 v[52:55], a[104:107], a[72:75], v[52:55]
  ds_read_b64_tr_b16 a[32:33], v10 offset:16384
  v_mfma_f32_16x16x32_bf16 v[68:71], a[104:107], a[80:83], v[68:71]
  ds_read_b64_tr_b16 a[34:35], v10 offset:20480
  v_mfma_f32_16x16x32_bf16 v[68:71], a[108:111], a[84:87], v[68:71]
  buffer_load_dwordx4 v9, s[28:31], s81 offen offset:3072 lds
  v_mfma_f32_16x16x32_bf16 v[84:87], a[108:111], a[92:95], v[84:87]
  ds_read_b64_tr_b16 a[36:37], v10 offset:24576
  v_sub_f32 v5, 1.0, v21
  v_mfma_f32_16x16x32_bf16 v[84:87], a[104:107], a[88:91], v[84:87]
  ds_read_b64_tr_b16 a[38:39], v10 offset:28672
  s_waitcnt lgkmcnt(14)
  v_mfma_f32_16x16x32_bf16 v[40:43], a[112:115], a[64:67], v[40:43]
  ds_read_b64_tr_b16 a[40:41], v11 offset:16384
  s_add_u32 s70, s76, 16384
  s_add_u32 m0, s78, 0
  v_mfma_f32_16x16x32_bf16 v[40:43], a[116:119], a[68:71], v[40:43]
  buffer_load_dwordx4 v1, s[40:43], s70 offen offset:0 sc1 lds
  v_mfma_f32_16x16x32_bf16 v[56:59], a[116:119], a[76:79], v[56:59]
  ds_read_b64_tr_b16 a[42:43], v11 offset:20480
  v_mul_f32 v96, v2, v96
  v_mfma_f32_16x16x32_bf16 v[56:59], a[112:115], a[72:75], v[56:59]
  ds_read_b64_tr_b16 a[44:45], v11 offset:24576
  v_mfma_f32_16x16x32_bf16 v[72:75], a[112:115], a[80:83], v[72:75]
  ds_read_b64_tr_b16 a[46:47], v11 offset:28672
  v_mfma_f32_16x16x32_bf16 v[72:75], a[116:119], a[84:87], v[72:75]
  buffer_load_dwordx4 v1, s[40:43], s70 offen offset:1024 sc1 lds
  s_add_u32 s70, s70, 188416
  s_add_u32 m0, s78, 2048
  v_mfma_f32_16x16x32_bf16 v[88:91], a[116:119], a[92:95], v[88:91]
  ds_read_b64_tr_b16 a[48:49], v12 offset:16384
  v_mul_f32 v97, v2, v97
  v_mfma_f32_16x16x32_bf16 v[88:91], a[112:115], a[88:91], v[88:91]
  ds_read_b64_tr_b16 a[50:51], v12 offset:20480
  s_waitcnt lgkmcnt(14)
  v_mfma_f32_16x16x32_bf16 v[44:47], a[120:123], a[64:67], v[44:47]
  ds_read_b64_tr_b16 a[52:53], v12 offset:24576
  v_mfma_f32_16x16x32_bf16 v[44:47], a[124:127], a[68:71], v[44:47]
  buffer_load_dwordx4 v1, s[40:43], s70 offen offset:0 sc1 lds
  v_mfma_f32_16x16x32_bf16 v[60:63], a[124:127], a[76:79], v[60:63]
  ds_read_b64_tr_b16 a[54:55], v12 offset:28672
  v_mul_f32 v98, v2, v98
  v_mfma_f32_16x16x32_bf16 v[60:63], a[120:123], a[72:75], v[60:63]
  ds_read_b64_tr_b16 a[56:57], v13 offset:16384
  v_mfma_f32_16x16x32_bf16 v[76:79], a[120:123], a[80:83], v[76:79]
  ds_read_b64_tr_b16 a[58:59], v13 offset:20480
  v_mfma_f32_16x16x32_bf16 v[76:79], a[124:127], a[84:87], v[76:79]
  buffer_load_dwordx4 v1, s[40:43], s70 offen offset:1024 sc1 lds
  v_mfma_f32_16x16x32_bf16 v[92:95], a[124:127], a[92:95], v[92:95]
  ds_read_b64_tr_b16 a[60:61], v13 offset:24576
  v_mul_f32 v99, v2, v99
  v_mfma_f32_16x16x32_bf16 v[92:95], a[120:123], a[88:91], v[92:95]
  ds_read_b64_tr_b16 a[62:63], v13 offset:28672
  s_waitcnt vmcnt(16)
  s_barrier
  s_waitcnt lgkmcnt(12)
  v_mfma_f32_16x16x32_bf16 v[32:35], a[32:35], a[0:3], v[32:35]
  ds_read_b128 a[64:67], v14 offset:32768
  s_add_u32 s81, s79, 589824
  s_add_u32 m0, s78, 49152
  v_mfma_f32_16x16x32_bf16 v[32:35], a[36:39], a[4:7], v[32:35]
  buffer_load_dwordx4 v6, s[28:31], s81 offen offset:0 lds
  v_mfma_f32_16x16x32_bf16 v[48:51], a[36:39], a[12:15], v[48:51]
  ds_read_b128 a[68:71], v14 offset:33792
  v_mul_f32 v100, v2, v100
  v_mfma_f32_16x16x32_bf16 v[48:51], a[32:35], a[8:11], v[48:51]
  ds_read_b128 a[72:75], v14 offset:34816
  v_mfma_f32_16x16x32_bf16 v[64:67], a[32:35], a[16:19], v[64:67]
  ds_read_b128 a[76:79], v14 offset:35840
  v_mfma_f32_16x16x32_bf16 v[64:67], a[36:39], a[20:23], v[64:67]
  buffer_load_dwordx4 v7, s[28:31], s81 offen offset:1024 lds
  v_mfma_f32_16x16x32_bf16 v[80:83], a[36:39], a[28:31], v[80:83]
  ds_read_b128 a[80:83], v14 offset:40960
  v_mul_f32 v101, v2, v101
  v_mfma_f32_16x16x32_bf16 v[80:83], a[32:35], a[24:27], v[80:83]
  ds_read_b128 a[84:87], v14 offset:41984
  s_waitcnt lgkmcnt(14)
  v_mfma_f32_16x16x32_bf16 v[36:39], a[40:43], a[0:3], v[36:39]
  ds_read_b128 a[88:91], v14 offset:43008
  v_mfma_f32_16x16x32_bf16 v[36:39], a[44:47], a[4:7], v[36:39]
  buffer_load_dwordx4 v8, s[28:31], s81 offen offset:2048 lds
  v_mfma_f32_16x16x32_bf16 v[52:55], a[44:47], a[12:15], v[52:55]
  ds_read_b128 a[92:95], v14 offset:44032
  v_mul_f32 v102, v2, v102
  v_mfma_f32_16x16x32_bf16 v[52:55], a[40:43], a[8:11], v[52:55]
  ds_read_b64_tr_b16 a[96:97], v10 offset:49152
  v_add_u32 v14, 0x10000, v14
  v_mfma_f32_16x16x32_bf16 v[68:71], a[40:43], a[16:19], v[68:71]
  ds_read_b64_tr_b16 a[98:99], v10 offset:53248
  v_mfma_f32_16x16x32_bf16 v[68:71], a[44:47], a[20:23], v[68:71]
  buffer_load_dwordx4 v9, s[28:31], s81 offen offset:3072 lds
  v_mfma_f32_16x16x32_bf16 v[84:87], a[44:47], a[28:31], v[84:87]
  ds_read_b64_tr_b16 a[100:101], v10 offset:57344
  v_mul_f32 v103, v2, v103
  v_mfma_f32_16x16x32_bf16 v[84:87], a[40:43], a[24:27], v[84:87]
  ds_read_b64_tr_b16 a[102:103], v10 offset:61440
  s_waitcnt lgkmcnt(14)
  v_mfma_f32_16x16x32_bf16 v[40:43], a[48:51], a[0:3], v[40:43]
  ds_read_b64_tr_b16 a[104:105], v11 offset:49152
  s_add_u32 s70, s76, 18432
  s_add_u32 m0, s78, 32768
  v_add_u32 v10, 0x10000, v10
  v_mfma_f32_16x16x32_bf16 v[40:43], a[52:55], a[4:7], v[40:43]
  buffer_load_dwordx4 v1, s[40:43], s70 offen offset:0 sc1 lds
  v_mfma_f32_16x16x32_bf16 v[56:59], a[52:55], a[12:15], v[56:59]
  ds_read_b64_tr_b16 a[106:107], v11 offset:53248
  v_mul_f32 v104, v2, v104
  v_mfma_f32_16x16x32_bf16 v[56:59], a[48:51], a[8:11], v[56:59]
  ds_read_b64_tr_b16 a[108:109], v11 offset:57344
  v_mfma_f32_16x16x32_bf16 v[72:75], a[48:51], a[16:19], v[72:75]
  ds_read_b64_tr_b16 a[110:111], v11 offset:61440
  v_mfma_f32_16x16x32_bf16 v[72:75], a[52:55], a[20:23], v[72:75]
  buffer_load_dwordx4 v1, s[40:43], s70 offen offset:1024 sc1 lds
  s_add_u32 s70, s70, 188416
  s_add_u32 m0, s78, 34816
  v_mfma_f32_16x16x32_bf16 v[88:91], a[52:55], a[28:31], v[88:91]
  ds_read_b64_tr_b16 a[112:113], v12 offset:49152
  v_add_u32 v11, 0x10000, v11
  v_mfma_f32_16x16x32_bf16 v[88:91], a[48:51], a[24:27], v[88:91]
  ds_read_b64_tr_b16 a[114:115], v12 offset:53248
  s_waitcnt lgkmcnt(14)
  v_mfma_f32_16x16x32_bf16 v[44:47], a[56:59], a[0:3], v[44:47]
  ds_read_b64_tr_b16 a[116:117], v12 offset:57344
  v_mfma_f32_16x16x32_bf16 v[44:47], a[60:63], a[4:7], v[44:47]
  buffer_load_dwordx4 v1, s[40:43], s70 offen offset:0 sc1 lds
  v_mfma_f32_16x16x32_bf16 v[60:63], a[60:63], a[12:15], v[60:63]
  ds_read_b64_tr_b16 a[118:119], v12 offset:61440
  v_mul_f32 v105, v2, v105
  v_mfma_f32_16x16x32_bf16 v[60:63], a[56:59], a[8:11], v[60:63]
  ds_read_b64_tr_b16 a[120:121], v13 offset:49152
  v_add_u32 v12, 0x10000, v12
  v_mfma_f32_16x16x32_bf16 v[76:79], a[56:59], a[16:19], v[76:79]
  ds_read_b64_tr_b16 a[122:123], v13 offset:53248
  v_mfma_f32_16x16x32_bf16 v[76:79], a[60:63], a[20:23], v[76:79]
  buffer_load_dwordx4 v1, s[40:43], s70 offen offset:1024 sc1 lds
  v_mfma_f32_16x16x32_bf16 v[92:95], a[60:63], a[28:31], v[92:95]
  ds_read_b64_tr_b16 a[124:125], v13 offset:57344
  v_mul_f32 v106, v2, v106
  v_mfma_f32_16x16x32_bf16 v[92:95], a[56:59], a[24:27], v[92:95]
  ds_read_b64_tr_b16 a[126:127], v13 offset:61440
  v_add_u32 v13, 0x10000, v13
  s_waitcnt vmcnt(16)
  s_barrier
  s_waitcnt lgkmcnt(12)
  v_mfma_f32_16x16x32_bf16 v[32:35], a[96:99], a[64:67], v[32:35]
  ds_read_b128 a[0:3], v14 offset:0
  s_add_u32 s81, s79, 655360
  s_add_u32 m0, s78, 81920
  v_mfma_f32_16x16x32_bf16 v[32:35], a[100:103], a[68:71], v[32:35]
  buffer_load_dwordx4 v6, s[28:31], s81 offen offset:0 lds
  v_mfma_f32_16x16x32_bf16 v[48:51], a[100:103], a[76:79], v[48:51]
  ds_read_b128 a[4:7], v14 offset:1024
  v_mul_f32 v107, v2, v107
  v_mfma_f32_16x16x32_bf16 v[48:51], a[96:99], a[72:75], v[48:51]
  ds_read_b128 a[8:11], v14 offset:2048
  v_mfma_f32_16x16x32_bf16 v[64:67], a[96:99], a[80:83], v[64:67]
  ds_read_b128 a[12:15], v14 offset:3072
  v_mfma_f32_16x16x32_bf16 v[64:67], a[100:103], a[84:87], v[64:67]
  buffer_load_dwordx4 v7, s[28:31], s81 offen offset:1024 lds
  v_mfma_f32_16x16x32_bf16 v[80:83], a[100:103], a[92:95], v[80:83]
  ds_read_b128 a[16:19], v14 offset:8192
  v_mul_f32 v108, v2, v108
  v_mfma_f32_16x16x32_bf16 v[80:83], a[96:99], a[88:91], v[80:83]
  ds_read_b128 a[20:23], v14 offset:9216
  s_waitcnt lgkmcnt(14)
  v_mfma_f32_16x16x32_bf16 v[36:39], a[104:107], a[64:67], v[36:39]
  ds_read_b128 a[24:27], v14 offset:10240
  v_mfma_f32_16x16x32_bf16 v[36:39], a[108:111], a[68:71], v[36:39]
  buffer_load_dwordx4 v8, s[28:31], s81 offen offset:2048 lds
  v_mfma_f32_16x16x32_bf16 v[52:55], a[108:111], a[76:79], v[52:55]
  ds_read_b128 a[28:31], v14 offset:11264
  v_mul_f32 v109, v2, v109
  v_mfma_f32_16x16x32_bf16 v[52:55], a[104:107], a[72:75], v[52:55]
  ds_read_b64_tr_b16 a[32:33], v10 offset:16384
  v_add_u32 v14, 0xfffe0000, v14
  v_mfma_f32_16x16x32_bf16 v[68:71], a[104:107], a[80:83], v[68:71]
  ds_read_b64_tr_b16 a[34:35], v10 offset:20480
  v_mfma_f32_16x16x32_bf16 v[68:71], a[108:111], a[84:87], v[68:71]
  buffer_load_dwordx4 v9, s[28:31], s81 offen offset:3072 lds
  v_mfma_f32_16x16x32_bf16 v[84:87], a[108:111], a[92:95], v[84:87]
  ds_read_b64_tr_b16 a[36:37], v10 offset:24576
  v_mul_f32 v110, v2, v110
  v_mfma_f32_16x16x32_bf16 v[84:87], a[104:107], a[88:91], v[84:87]
  ds_read_b64_tr_b16 a[38:39], v10 offset:28672
  s_waitcnt lgkmcnt(14)
  v_mfma_f32_16x16x32_bf16 v[40:43], a[112:115], a[64:67], v[40:43]
  ds_read_b64_tr_b16 a[40:41], v11 offset:16384
  s_add_u32 s70, s76, 20480
  s_add_u32 m0, s78, 65536
  v_add_u32 v10, 0xfffe0000, v10
  v_mfma_f32_16x16x32_bf16 v[40:43], a[116:119], a[68:71], v[40:43]
  buffer_load_dwordx4 v1, s[40:43], s70 offen offset:0 sc1 lds
  v_mfma_f32_16x16x32_bf16 v[56:59], a[116:119], a[76:79], v[56:59]
  ds_read_b64_tr_b16 a[42:43], v11 offset:20480
  v_mul_f32 v111, v2, v111
  v_mfma_f32_16x16x32_bf16 v[56:59], a[112:115], a[72:75], v[56:59]
  ds_read_b64_tr_b16 a[44:45], v11 offset:24576
  v_mfma_f32_16x16x32_bf16 v[72:75], a[112:115], a[80:83], v[72:75]
  ds_read_b64_tr_b16 a[46:47], v11 offset:28672
  v_mfma_f32_16x16x32_bf16 v[72:75], a[116:119], a[84:87], v[72:75]
  buffer_load_dwordx4 v1, s[40:43], s70 offen offset:1024 sc1 lds
  s_add_u32 s70, s70, 188416
  s_add_u32 m0, s78, 67584
  v_mfma_f32_16x16x32_bf16 v[88:91], a[116:119], a[92:95], v[88:91]
  ds_read_b64_tr_b16 a[48:49], v12 offset:16384
  v_add_u32 v11, 0xfffe0000, v11
  v_mfma_f32_16x16x32_bf16 v[88:91], a[112:115], a[88:91], v[88:91]
  ds_read_b64_tr_b16 a[50:51], v12 offset:20480
  s_waitcnt lgkmcnt(14)
  v_mfma_f32_16x16x32_bf16 v[44:47], a[120:123], a[64:67], v[44:47]
  ds_read_b64_tr_b16 a[52:53], v12 offset:24576
  v_mfma_f32_16x16x32_bf16 v[44:47], a[124:127], a[68:71], v[44:47]
  buffer_load_dwordx4 v1, s[40:43], s70 offen offset:0 sc1 lds
  v_mfma_f32_16x16x32_bf16 v[60:63], a[124:127], a[76:79], v[60:63]
  ds_read_b64_tr_b16 a[54:55], v12 offset:28672
  v_mul_f32 v112, v3, v112
  v_mfma_f32_16x16x32_bf16 v[60:63], a[120:123], a[72:75], v[60:63]
  ds_read_b64_tr_b16 a[56:57], v13 offset:16384
  v_add_u32 v12, 0xfffe0000, v12
  v_mfma_f32_16x16x32_bf16 v[76:79], a[120:123], a[80:83], v[76:79]
  ds_read_b64_tr_b16 a[58:59], v13 offset:20480
  v_mfma_f32_16x16x32_bf16 v[76:79], a[124:127], a[84:87], v[76:79]
  buffer_load_dwordx4 v1, s[40:43], s70 offen offset:1024 sc1 lds
  v_mfma_f32_16x16x32_bf16 v[92:95], a[124:127], a[92:95], v[92:95]
  ds_read_b64_tr_b16 a[60:61], v13 offset:24576
  v_mul_f32 v113, v3, v113
  v_mfma_f32_16x16x32_bf16 v[92:95], a[120:123], a[88:91], v[92:95]
  ds_read_b64_tr_b16 a[62:63], v13 offset:28672
  v_add_u32 v13, 0xfffe0000, v13
  s_waitcnt vmcnt(16)
  s_barrier
  s_waitcnt lgkmcnt(12)
  v_mfma_f32_16x16x32_bf16 v[32:35], a[32:35], a[0:3], v[32:35]
  ds_read_b128 a[64:67], v14 offset:0
  s_add_u32 s81, s79, 720896
  s_add_u32 m0, s78, 114688
  v_mfma_f32_16x16x32_bf16 v[32:35], a[36:39], a[4:7], v[32:35]
  buffer_load_dwordx4 v6, s[28:31], s81 offen offset:0 lds
  v_mfma_f32_16x16x32_bf16 v[48:51], a[36:39], a[12:15], v[48:51]
  ds_read_b128 a[68:71], v14 offset:1024
  v_mul_f32 v114, v3, v114
  v_mfma_f32_16x16x32_bf16 v[48:51], a[32:35], a[8:11], v[48:51]
  ds_read_b128 a[72:75], v14 offset:2048
  v_mfma_f32_16x16x32_bf16 v[64:67], a[32:35], a[16:19], v[64:67]
  ds_read_b128 a[76:79], v14 offset:3072
  v_mfma_f32_16x16x32_bf16 v[64:67], a[36:39], a[20:23], v[64:67]
  buffer_load_dwordx4 v7, s[28:31], s81 offen offset:1024 lds
  v_mfma_f32_16x16x32_bf16 v[80:83], a[36:39], a[28:31], v[80:83]
  ds_read_b128 a[80:83], v14 offset:8192
  v_mul_f32 v115, v3, v115
  v_mfma_f32_16x16x32_bf16 v[80:83], a[32:35], a[24:27], v[80:83]
  ds_read_b128 a[84:87], v14 offset:9216
  s_waitcnt lgkmcnt(14)
  v_mfma_f32_16x16x32_bf16 v[36:39], a[40:43], a[0:3], v[36:39]
  ds_read_b128 a[88:91], v14 offset:10240
  v_mfma_f32_16x16x32_bf16 v[36:39], a[44:47], a[4:7], v[36:39]
  buffer_load_dwordx4 v8, s[28:31], s81 offen offset:2048 lds
  v_mfma_f32_16x16x32_bf16 v[52:55], a[44:47], a[12:15], v[52:55]
  ds_read_b128 a[92:95], v14 offset:11264
  v_mul_f32 v116, v3, v116
  v_mfma_f32_16x16x32_bf16 v[52:55], a[40:43], a[8:11], v[52:55]
  ds_read_b64_tr_b16 a[96:97], v10 offset:16384
  v_mfma_f32_16x16x32_bf16 v[68:71], a[40:43], a[16:19], v[68:71]
  ds_read_b64_tr_b16 a[98:99], v10 offset:20480
  v_mfma_f32_16x16x32_bf16 v[68:71], a[44:47], a[20:23], v[68:71]
  buffer_load_dwordx4 v9, s[28:31], s81 offen offset:3072 lds
  v_mfma_f32_16x16x32_bf16 v[84:87], a[44:47], a[28:31], v[84:87]
  ds_read_b64_tr_b16 a[100:101], v10 offset:24576
  v_mul_f32 v117, v3, v117
  v_mfma_f32_16x16x32_bf16 v[84:87], a[40:43], a[24:27], v[84:87]
  ds_read_b64_tr_b16 a[102:103], v10 offset:28672
  s_waitcnt lgkmcnt(14)
  v_mfma_f32_16x16x32_bf16 v[40:43], a[48:51], a[0:3], v[40:43]
  ds_read_b64_tr_b16 a[104:105], v11 offset:16384
  s_add_u32 s70, s76, 22528
  s_add_u32 m0, s78, 98304
  v_mfma_f32_16x16x32_bf16 v[40:43], a[52:55], a[4:7], v[40:43]
  buffer_load_dwordx4 v1, s[40:43], s70 offen offset:0 sc1 lds
  v_mfma_f32_16x16x32_bf16 v[56:59], a[52:55], a[12:15], v[56:59]
  ds_read_b64_tr_b16 a[106:107], v11 offset:20480
  v_mul_f32 v118, v3, v118
  v_mfma_f32_16x16x32_bf16 v[56:59], a[48:51], a[8:11], v[56:59]
  ds_read_b64_tr_b16 a[108:109], v11 offset:24576
  v_mfma_f32_16x16x32_bf16 v[72:75], a[48:51], a[16:19], v[72:75]
  ds_read_b64_tr_b16 a[110:111], v11 offset:28672
  v_mfma_f32_16x16x32_bf16 v[72:75], a[52:55], a[20:23], v[72:75]
  buffer_load_dwordx4 v1, s[40:43], s70 offen offset:1024 sc1 lds
  s_add_u32 s70, s70, 188416
  s_add_u32 m0, s78, 100352
  v_mfma_f32_16x16x32_bf16 v[88:91], a[52:55], a[28:31], v[88:91]
  ds_read_b64_tr_b16 a[112:113], v12 offset:16384
  v_mul_f32 v119, v3, v119
  v_mfma_f32_16x16x32_bf16 v[88:91], a[48:51], a[24:27], v[88:91]
  ds_read_b64_tr_b16 a[114:115], v12 offset:20480
  s_waitcnt lgkmcnt(14)
  v_mfma_f32_16x16x32_bf16 v[44:47], a[56:59], a[0:3], v[44:47]
  ds_read_b64_tr_b16 a[116:117], v12 offset:24576
  v_mfma_f32_16x16x32_bf16 v[44:47], a[60:63], a[4:7], v[44:47]
  buffer_load_dwordx4 v1, s[40:43], s70 offen offset:0 sc1 lds
  v_mfma_f32_16x16x32_bf16 v[60:63], a[60:63], a[12:15], v[60:63]
  ds_read_b64_tr_b16 a[118:119], v12 offset:28672
  v_mul_f32 v120, v3, v120
  v_mfma_f32_16x16x32_bf16 v[60:63], a[56:59], a[8:11], v[60:63]
  ds_read_b64_tr_b16 a[120:121], v13 offset:16384
  v_mfma_f32_16x16x32_bf16 v[76:79], a[56:59], a[16:19], v[76:79]
  ds_read_b64_tr_b16 a[122:123], v13 offset:20480
  v_mfma_f32_16x16x32_bf16 v[76:79], a[60:63], a[20:23], v[76:79]
  buffer_load_dwordx4 v1, s[40:43], s70 offen offset:1024 sc1 lds
  v_mfma_f32_16x16x32_bf16 v[92:95], a[60:63], a[28:31], v[92:95]
  ds_read_b64_tr_b16 a[124:125], v13 offset:24576
  v_mul_f32 v121, v3, v121
  v_mfma_f32_16x16x32_bf16 v[92:95], a[56:59], a[24:27], v[92:95]
  ds_read_b64_tr_b16 a[126:127], v13 offset:28672
  s_waitcnt vmcnt(16)
  s_barrier
  s_waitcnt lgkmcnt(12)
  v_mfma_f32_16x16x32_bf16 v[32:35], a[96:99], a[64:67], v[32:35]
  ds_read_b128 a[0:3], v14 offset:32768
  s_add_u32 s81, s79, 786432
  s_add_u32 m0, s78, 147456
  v_mfma_f32_16x16x32_bf16 v[32:35], a[100:103], a[68:71], v[32:35]
  buffer_load_dwordx4 v6, s[28:31], s81 offen offset:0 lds
  v_mfma_f32_16x16x32_bf16 v[48:51], a[100:103], a[76:79], v[48:51]
  ds_read_b128 a[4:7], v14 offset:33792
  v_mul_f32 v122, v3, v122
  v_mfma_f32_16x16x32_bf16 v[48:51], a[96:99], a[72:75], v[48:51]
  ds_read_b128 a[8:11], v14 offset:34816
  v_mfma_f32_16x16x32_bf16 v[64:67], a[96:99], a[80:83], v[64:67]
  ds_read_b128 a[12:15], v14 offset:35840
  v_mfma_f32_16x16x32_bf16 v[64:67], a[100:103], a[84:87], v[64:67]
  buffer_load_dwordx4 v7, s[28:31], s81 offen offset:1024 lds
  v_mfma_f32_16x16x32_bf16 v[80:83], a[100:103], a[92:95], v[80:83]
  ds_read_b128 a[16:19], v14 offset:40960
  v_mul_f32 v123, v3, v123
  v_mfma_f32_16x16x32_bf16 v[80:83], a[96:99], a[88:91], v[80:83]
  ds_read_b128 a[20:23], v14 offset:41984
  s_waitcnt lgkmcnt(14)
  v_mfma_f32_16x16x32_bf16 v[36:39], a[104:107], a[64:67], v[36:39]
  ds_read_b128 a[24:27], v14 offset:43008
  v_mfma_f32_16x16x32_bf16 v[36:39], a[108:111], a[68:71], v[36:39]
  buffer_load_dwordx4 v8, s[28:31], s81 offen offset:2048 lds
  v_mfma_f32_16x16x32_bf16 v[52:55], a[108:111], a[76:79], v[52:55]
  ds_read_b128 a[28:31], v14 offset:44032
  v_mul_f32 v124, v3, v124
  v_mfma_f32_16x16x32_bf16 v[52:55], a[104:107], a[72:75], v[52:55]
  ds_read_b64_tr_b16 a[32:33], v10 offset:49152
  v_add_u32 v14, 0x10000, v14
  v_mfma_f32_16x16x32_bf16 v[68:71], a[104:107], a[80:83], v[68:71]
  ds_read_b64_tr_b16 a[34:35], v10 offset:53248
  v_mfma_f32_16x16x32_bf16 v[68:71], a[108:111], a[84:87], v[68:71]
  buffer_load_dwordx4 v9, s[28:31], s81 offen offset:3072 lds
  v_mfma_f32_16x16x32_bf16 v[84:87], a[108:111], a[92:95], v[84:87]
  ds_read_b64_tr_b16 a[36:37], v10 offset:57344
  v_mul_f32 v125, v3, v125
  v_mfma_f32_16x16x32_bf16 v[84:87], a[104:107], a[88:91], v[84:87]
  ds_read_b64_tr_b16 a[38:39], v10 offset:61440
  s_waitcnt lgkmcnt(14)
  v_mfma_f32_16x16x32_bf16 v[40:43], a[112:115], a[64:67], v[40:43]
  ds_read_b64_tr_b16 a[40:41], v11 offset:49152
  s_add_u32 s70, s76, 24576
  s_add_u32 m0, s78, 131072
  v_add_u32 v10, 0x10000, v10
  v_mfma_f32_16x16x32_bf16 v[40:43], a[116:119], a[68:71], v[40:43]
  buffer_load_dwordx4 v1, s[40:43], s70 offen offset:0 sc1 lds
  v_mfma_f32_16x16x32_bf16 v[56:59], a[116:119], a[76:79], v[56:59]
  ds_read_b64_tr_b16 a[42:43], v11 offset:53248
  v_mul_f32 v126, v3, v126
  v_mfma_f32_16x16x32_bf16 v[56:59], a[112:115], a[72:75], v[56:59]
  ds_read_b64_tr_b16 a[44:45], v11 offset:57344
  v_mfma_f32_16x16x32_bf16 v[72:75], a[112:115], a[80:83], v[72:75]
  ds_read_b64_tr_b16 a[46:47], v11 offset:61440
  v_mfma_f32_16x16x32_bf16 v[72:75], a[116:119], a[84:87], v[72:75]
  buffer_load_dwordx4 v1, s[40:43], s70 offen offset:1024 sc1 lds
  s_add_u32 s70, s70, 188416
  s_add_u32 m0, s78, 133120
  v_mfma_f32_16x16x32_bf16 v[88:91], a[116:119], a[92:95], v[88:91]
  ds_read_b64_tr_b16 a[48:49], v12 offset:49152
  v_add_u32 v11, 0x10000, v11
  v_mfma_f32_16x16x32_bf16 v[88:91], a[112:115], a[88:91], v[88:91]
  ds_read_b64_tr_b16 a[50:51], v12 offset:53248
  s_waitcnt lgkmcnt(14)
  v_mfma_f32_16x16x32_bf16 v[44:47], a[120:123], a[64:67], v[44:47]
  ds_read_b64_tr_b16 a[52:53], v12 offset:57344
  v_mfma_f32_16x16x32_bf16 v[44:47], a[124:127], a[68:71], v[44:47]
  buffer_load_dwordx4 v1, s[40:43], s70 offen offset:0 sc1 lds
  v_mfma_f32_16x16x32_bf16 v[60:63], a[124:127], a[76:79], v[60:63]
  ds_read_b64_tr_b16 a[54:55], v12 offset:61440
  v_mul_f32 v127, v3, v127
  v_mfma_f32_16x16x32_bf16 v[60:63], a[120:123], a[72:75], v[60:63]
  ds_read_b64_tr_b16 a[56:57], v13 offset:49152
  v_add_u32 v12, 0x10000, v12
  v_mfma_f32_16x16x32_bf16 v[76:79], a[120:123], a[80:83], v[76:79]
  ds_read_b64_tr_b16 a[58:59], v13 offset:53248
  v_mfma_f32_16x16x32_bf16 v[76:79], a[124:127], a[84:87], v[76:79]
  buffer_load_dwordx4 v1, s[40:43], s70 offen offset:1024 sc1 lds
  v_mfma_f32_16x16x32_bf16 v[92:95], a[124:127], a[92:95], v[92:95]
  ds_read_b64_tr_b16 a[60:61], v13 offset:57344
  v_mul_f32 v128, v4, v128
  v_mfma_f32_16x16x32_bf16 v[92:95], a[120:123], a[88:91], v[92:95]
  ds_read_b64_tr_b16 a[62:63], v13 offset:61440
  v_add_u32 v13, 0x10000, v13
  s_waitcnt vmcnt(16)
  s_barrier
  s_waitcnt lgkmcnt(12)
  v_mfma_f32_16x16x32_bf16 v[32:35], a[32:35], a[0:3], v[32:35]
  ds_read_b128 a[128:131], v14 offset:0
  s_add_u32 s81, s79, 851968
  s_add_u32 m0, s78, 16384
  v_mfma_f32_16x16x32_bf16 v[32:35], a[36:39], a[4:7], v[32:35]
  buffer_load_dwordx4 v6, s[28:31], s81 offen offset:0 lds
  v_mfma_f32_16x16x32_bf16 v[48:51], a[36:39], a[12:15], v[48:51]
  ds_read_b128 a[132:135], v14 offset:1024
  v_mul_f32 v129, v4, v129
  v_mfma_f32_16x16x32_bf16 v[48:51], a[32:35], a[8:11], v[48:51]
  ds_read_b128 a[136:139], v14 offset:2048
  v_mfma_f32_16x16x32_bf16 v[64:67], a[32:35], a[16:19], v[64:67]
  ds_read_b128 a[140:143], v14 offset:3072
  v_mfma_f32_16x16x32_bf16 v[64:67], a[36:39], a[20:23], v[64:67]
  buffer_load_dwordx4 v7, s[28:31], s81 offen offset:1024 lds
  v_mfma_f32_16x16x32_bf16 v[80:83], a[36:39], a[28:31], v[80:83]
  ds_read_b128 a[80:83], v14 offset:8192
  v_mul_f32 v130, v4, v130
  v_mfma_f32_16x16x32_bf16 v[80:83], a[32:35], a[24:27], v[80:83]
  ds_read_b128 a[84:87], v14 offset:9216
  s_waitcnt lgkmcnt(14)
  v_mfma_f32_16x16x32_bf16 v[36:39], a[40:43], a[0:3], v[36:39]
  ds_read_b128 a[88:91], v14 offset:10240
  v_mfma_f32_16x16x32_bf16 v[36:39], a[44:47], a[4:7], v[36:39]
  buffer_load_dwordx4 v8, s[28:31], s81 offen offset:2048 lds
  v_mfma_f32_16x16x32_bf16 v[52:55], a[44:47], a[12:15], v[52:55]
  ds_read_b128 a[92:95], v14 offset:11264
  v_mul_f32 v131, v4, v131
  v_mfma_f32_16x16x32_bf16 v[52:55], a[40:43], a[8:11], v[52:55]
  ds_read_b64_tr_b16 a[144:145], v10 offset:16384
  v_mfma_f32_16x16x32_bf16 v[68:71], a[40:43], a[16:19], v[68:71]
  ds_read_b64_tr_b16 a[146:147], v10 offset:20480
  v_mfma_f32_16x16x32_bf16 v[68:71], a[44:47], a[20:23], v[68:71]
  buffer_load_dwordx4 v9, s[28:31], s81 offen offset:3072 lds
  v_mfma_f32_16x16x32_bf16 v[84:87], a[44:47], a[28:31], v[84:87]
  ds_read_b64_tr_b16 a[148:149], v10 offset:24576
  v_mul_f32 v132, v4, v132
  v_mfma_f32_16x16x32_bf16 v[84:87], a[40:43], a[24:27], v[84:87]
  ds_read_b64_tr_b16 a[150:151], v10 offset:28672
  s_waitcnt lgkmcnt(14)
  v_mfma_f32_16x16x32_bf16 v[40:43], a[48:51], a[0:3], v[40:43]
  ds_read_b64_tr_b16 a[152:153], v11 offset:16384
  s_add_u32 s70, s76, 26624
  s_add_u32 m0, s78, 0
  v_mfma_f32_16x16x32_bf16 v[40:43], a[52:55], a[4:7], v[40:43]
  buffer_load_dwordx4 v1, s[40:43], s70 offen offset:0 sc1 lds
  v_mfma_f32_16x16x32_bf16 v[56:59], a[52:55], a[12:15], v[56:59]
  ds_read_b64_tr_b16 a[154:155], v11 offset:20480
  v_mul_f32 v133, v4, v133
  v_mfma_f32_16x16x32_bf16 v[56:59], a[48:51], a[8:11], v[56:59]
  ds_read_b64_tr_b16 a[156:157], v11 offset:24576
  v_mfma_f32_16x16x32_bf16 v[72:75], a[48:51], a[16:19], v[72:75]
  ds_read_b64_tr_b16 a[158:159], v11 offset:28672
  v_mfma_f32_16x16x32_bf16 v[72:75], a[52:55], a[20:23], v[72:75]
  buffer_load_dwordx4 v1, s[40:43], s70 offen offset:1024 sc1 lds
  s_add_u32 s70, s70, 188416
  s_add_u32 m0, s78, 2048
  v_mfma_f32_16x16x32_bf16 v[88:91], a[52:55], a[28:31], v[88:91]
  ds_read_b64_tr_b16 a[112:113], v12 offset:16384
  v_mul_f32 v134, v4, v134
  v_mfma_f32_16x16x32_bf16 v[88:91], a[48:51], a[24:27], v[88:91]
  ds_read_b64_tr_b16 a[114:115], v12 offset:20480
  s_waitcnt lgkmcnt(14)
  v_mfma_f32_16x16x32_bf16 v[44:47], a[56:59], a[0:3], v[44:47]
  ds_read_b64_tr_b16 a[116:117], v12 offset:24576
  v_mfma_f32_16x16x32_bf16 v[44:47], a[60:63], a[4:7], v[44:47]
  buffer_load_dwordx4 v1, s[40:43], s70 offen offset:0 sc1 lds
  v_mfma_f32_16x16x32_bf16 v[60:63], a[60:63], a[12:15], v[60:63]
  ds_read_b64_tr_b16 a[118:119], v12 offset:28672
  v_mul_f32 v135, v4, v135
  v_mfma_f32_16x16x32_bf16 v[60:63], a[56:59], a[8:11], v[60:63]
  ds_read_b64_tr_b16 a[120:121], v13 offset:16384
  v_mfma_f32_16x16x32_bf16 v[76:79], a[56:59], a[16:19], v[76:79]
  ds_read_b64_tr_b16 a[122:123], v13 offset:20480
  v_mfma_f32_16x16x32_bf16 v[76:79], a[60:63], a[20:23], v[76:79]
  buffer_load_dwordx4 v1, s[40:43], s70 offen offset:1024 sc1 lds
  v_mfma_f32_16x16x32_bf16 v[92:95], a[60:63], a[28:31], v[92:95]
  ds_read_b64_tr_b16 a[124:125], v13 offset:24576
  v_mul_f32 v136, v4, v136
  v_mfma_f32_16x16x32_bf16 v[92:95], a[56:59], a[24:27], v[92:95]
  ds_read_b64_tr_b16 a[126:127], v13 offset:28672
  s_waitcnt vmcnt(16)
  s_barrier
  s_waitcnt lgkmcnt(12)
  v_mfma_f32_16x16x32_bf16 v[64:67], a[144:147], a[80:83], v[64:67]
  ds_read_b128 a[160:163], v14 offset:32768
  s_add_u32 s81, s79, 917504
  s_add_u32 m0, s78, 49152
  v_mul_f32 v137, v4, v137
  v_mfma_f32_16x16x32_bf16 v[64:67], a[148:151], a[84:87], v[64:67]
  ds_read_b128 a[164:167], v14 offset:33792
  buffer_load_dwordx4 v6, s[28:31], s81 offen offset:0 lds
  v_mul_f32 v138, v4, v138
  v_mfma_f32_16x16x32_bf16 v[80:83], a[148:151], a[92:95], v[80:83]
  ds_read_b128 a[168:171], v14 offset:34816
  v_mul_f32 v139, v4, v139
  v_mfma_f32_16x16x32_bf16 v[80:83], a[144:147], a[88:91], v[80:83]
  ds_read_b128 a[172:175], v14 offset:35840
  v_mul_f32 v140, v4, v140
  s_waitcnt lgkmcnt(12)
  v_mfma_f32_16x16x32_bf16 v[68:71], a[152:155], a[80:83], v[68:71]
  ds_read_b128 a[16:19], v14 offset:40960
  buffer_load_dwordx4 v7, s[28:31], s81 offen offset:1024 lds
  v_mul_f32 v141, v4, v141
  v_mfma_f32_16x16x32_bf16 v[68:71], a[156:159], a[84:87], v[68:71]
  ds_read_b128 a[20:23], v14 offset:41984
  v_mul_f32 v142, v4, v142
  v_mfma_f32_16x16x32_bf16 v[84:87], a[156:159], a[92:95], v[84:87]
  ds_read_b128 a[24:27], v14 offset:43008
  v_mul_f32 v143, v4, v143
  v_mfma_f32_16x16x32_bf16 v[84:87], a[152:155], a[88:91], v[84:87]
  ds_read_b128 a[28:31], v14 offset:44032
  buffer_load_dwordx4 v8, s[28:31], s81 offen offset:2048 lds
  v_add_u32 v14, 0x10000, v14
  s_waitcnt lgkmcnt(12)
  v_mfma_f32_16x16x32_bf16 v[40:43], a[112:115], a[128:131], v[40:43]
  ds_read_b64_tr_b16 a[176:177], v10 offset:49152
  v_mul_f32 v144, v5, v144
  v_mfma_f32_16x16x32_bf16 v[40:43], a[116:119], a[132:135], v[40:43]
  ds_read_b64_tr_b16 a[178:179], v10 offset:53248
  v_mul_f32 v145, v5, v145
  v_mfma_f32_16x16x32_bf16 v[56:59], a[116:119], a[140:143], v[56:59]
  ds_read_b64_tr_b16 a[180:181], v10 offset:57344
  buffer_load_dwordx4 v9, s[28:31], s81 offen offset:3072 lds
  s_add_u32 s70, s76, 28672
  s_add_u32 m0, s78, 32768
  v_mul_f32 v146, v5, v146
  v_mfma_f32_16x16x32_bf16 v[56:59], a[112:115], a[136:139], v[56:59]
  ds_read_b64_tr_b16 a[182:183], v10 offset:61440
  v_add_u32 v10, 0x10000, v10
  v_mfma_f32_16x16x32_bf16 v[72:75], a[112:115], a[80:83], v[72:75]
  ds_read_b64_tr_b16 a[184:185], v11 offset:49152
  v_mul_f32 v147, v5, v147
  v_mfma_f32_16x16x32_bf16 v[72:75], a[116:119], a[84:87], v[72:75]
  ds_read_b64_tr_b16 a[186:187], v11 offset:53248
  buffer_load_dwordx4 v1, s[40:43], s70 offen offset:0 sc1 lds
  v_mul_f32 v148, v5, v148
  v_mfma_f32_16x16x32_bf16 v[88:91], a[116:119], a[92:95], v[88:91]
  ds_read_b64_tr_b16 a[188:189], v11 offset:57344
  v_mul_f32 v149, v5, v149
  v_mfma_f32_16x16x32_bf16 v[88:91], a[112:115], a[88:91], v[88:91]
  ds_read_b64_tr_b16 a[190:191], v11 offset:61440
  v_add_u32 v11, 0x10000, v11
  s_waitcnt lgkmcnt(14)
  v_mfma_f32_16x16x32_bf16 v[44:47], a[120:123], a[128:131], v[44:47]
  ds_read_b64_tr_b16 a[48:49], v12 offset:49152
  buffer_load_dwordx4 v1, s[40:43], s70 offen offset:1024 sc1 lds
  s_add_u32 s70, s70, 188416
  s_add_u32 m0, s78, 34816
  v_mul_f32 v150, v5, v150
  v_mfma_f32_16x16x32_bf16 v[44:47], a[124:127], a[132:135], v[44:47]
  ds_read_b64_tr_b16 a[50:51], v12 offset:53248
  v_mul_f32 v151, v5, v151
  v_mfma_f32_16x16x32_bf16 v[60:63], a[124:127], a[140:143], v[60:63]
  ds_read_b64_tr_b16 a[52:53], v12 offset:57344
  v_mul_f32 v152, v5, v152
  v_mfma_f32_16x16x32_bf16 v[60:63], a[120:123], a[136:139], v[60:63]
  ds_read_b64_tr_b16 a[54:55], v12 offset:61440
  buffer_load_dwordx4 v1, s[40:43], s70 offen offset:0 sc1 lds
  v_add_u32 v12, 0x10000, v12
  v_mfma_f32_16x16x32_bf16 v[76:79], a[120:123], a[80:83], v[76:79]
  ds_read_b64_tr_b16 a[56:57], v13 offset:49152
  v_mul_f32 v153, v5, v153
  v_mfma_f32_16x16x32_bf16 v[76:79], a[124:127], a[84:87], v[76:79]
  ds_read_b64_tr_b16 a[58:59], v13 offset:53248
  v_mul_f32 v154, v5, v154
  v_mfma_f32_16x16x32_bf16 v[92:95], a[124:127], a[92:95], v[92:95]
  ds_read_b64_tr_b16 a[60:61], v13 offset:57344
  buffer_load_dwordx4 v1, s[40:43], s70 offen offset:1024 sc1 lds
  v_mul_f32 v155, v5, v155
  v_mfma_f32_16x16x32_bf16 v[92:95], a[120:123], a[88:91], v[92:95]
  ds_read_b64_tr_b16 a[62:63], v13 offset:61440
  v_add_u32 v13, 0x10000, v13
  s_waitcnt vmcnt(16)
  s_barrier
  s_waitcnt lgkmcnt(12)
  v_mfma_f32_16x16x32_bf16 v[64:67], a[176:179], a[16:19], v[64:67]
  ds_read_b128 a[192:195], v14 offset:0
  s_add_u32 s81, s79, 983040
  s_add_u32 m0, s78, 81920
  v_mul_f32 v156, v5, v156
  v_mfma_f32_16x16x32_bf16 v[64:67], a[180:183], a[20:23], v[64:67]
  ds_read_b128 a[196:199], v14 offset:1024
  buffer_load_dwordx4 v6, s[28:31], s81 offen offset:0 lds
  v_mul_f32 v157, v5, v157
  v_mfma_f32_16x16x32_bf16 v[80:83], a[180:183], a[28:31], v[80:83]
  ds_read_b128 a[200:203], v14 offset:2048
  v_mul_f32 v158, v5, v158
  v_mfma_f32_16x16x32_bf16 v[80:83], a[176:179], a[24:27], v[80:83]
  ds_read_b128 a[204:207], v14 offset:3072
  v_mul_f32 v159, v5, v159
  s_waitcnt lgkmcnt(12)
  v_mfma_f32_16x16x32_bf16 v[68:71], a[184:187], a[16:19], v[68:71]
  ds_read_b128 a[80:83], v14 offset:8192
  buffer_load_dwordx4 v7, s[28:31], s81 offen offset:1024 lds
  v_mfma_f32_16x16x32_bf16 v[68:71], a[188:191], a[20:23], v[68:71]
  ds_read_b128 a[84:87], v14 offset:9216
  v_mfma_f32_16x16x32_bf16 v[84:87], a[188:191], a[28:31], v[84:87]
  ds_read_b128 a[88:91], v14 offset:10240
  v_mfma_f32_16x16x32_bf16 v[84:87], a[184:187], a[24:27], v[84:87]
  ds_read_b128 a[92:95], v14 offset:11264
  buffer_load_dwordx4 v8, s[28:31], s81 offen offset:2048 lds
  v_add_u32 v14, 0xfffe0000, v14
  s_waitcnt lgkmcnt(12)
  v_mfma_f32_16x16x32_bf16 v[40:43], a[48:51], a[160:163], v[40:43]
  ds_read_b64_tr_b16 a[208:209], v10 offset:16384
  v_mfma_f32_16x16x32_bf16 v[40:43], a[52:55], a[164:167], v[40:43]
  ds_read_b64_tr_b16 a[210:211], v10 offset:20480
  v_mfma_f32_16x16x32_bf16 v[56:59], a[52:55], a[172:175], v[56:59]
  ds_read_b64_tr_b16 a[212:213], v10 offset:24576
  buffer_load_dwordx4 v9, s[28:31], s81 offen offset:3072 lds
  s_add_u32 s70, s76, 30720
  s_add_u32 m0, s78, 65536
  v_mfma_f32_16x16x32_bf16 v[56:59], a[48:51], a[168:171], v[56:59]
  ds_read_b64_tr_b16 a[214:215], v10 offset:28672
  v_add_u32 v10, 0xfffe0000, v10
  v_mfma_f32_16x16x32_bf16 v[72:75], a[48:51], a[16:19], v[72:75]
  ds_read_b64_tr_b16 a[216:217], v11 offset:16384
  v_mfma_f32_16x16x32_bf16 v[72:75], a[52:55], a[20:23], v[72:75]
  ds_read_b64_tr_b16 a[218:219], v11 offset:20480
  buffer_load_dwordx4 v1, s[40:43], s70 offen offset:0 sc1 lds
  v_mfma_f32_16x16x32_bf16 v[88:91], a[52:55], a[28:31], v[88:91]
  ds_read_b64_tr_b16 a[220:221], v11 offset:24576
  v_mfma_f32_16x16x32_bf16 v[88:91], a[48:51], a[24:27], v[88:91]
  ds_read_b64_tr_b16 a[222:223], v11 offset:28672
  v_add_u32 v11, 0xfffe0000, v11
  s_waitcnt lgkmcnt(14)
  v_mfma_f32_16x16x32_bf16 v[44:47], a[56:59], a[160:163], v[44:47]
  ds_read_b64_tr_b16 a[112:113], v12 offset:16384
  buffer_load_dwordx4 v1, s[40:43], s70 offen offset:1024 sc1 lds
  s_add_u32 s70, s70, 188416
  s_add_u32 m0, s78, 67584
  v_mfma_f32_16x16x32_bf16 v[44:47], a[60:63], a[164:167], v[44:47]
  ds_read_b64_tr_b16 a[114:115], v12 offset:20480
  v_mfma_f32_16x16x32_bf16 v[60:63], a[60:63], a[172:175], v[60:63]
  ds_read_b64_tr_b16 a[116:117], v12 offset:24576
  v_mfma_f32_16x16x32_bf16 v[60:63], a[56:59], a[168:171], v[60:63]
  ds_read_b64_tr_b16 a[118:119], v12 offset:28672
  buffer_load_dwordx4 v1, s[40:43], s70 offen offset:0 sc1 lds
  v_add_u32 v12, 0xfffe0000, v12
  v_mfma_f32_16x16x32_bf16 v[76:79], a[56:59], a[16:19], v[76:79]
  ds_read_b64_tr_b16 a[120:121], v13 offset:16384
  v_mfma_f32_16x16x32_bf16 v[76:79], a[60:63], a[20:23], v[76:79]
  ds_read_b64_tr_b16 a[122:123], v13 offset:20480
  v_mfma_f32_16x16x32_bf16 v[92:95], a[60:63], a[28:31], v[92:95]
  ds_read_b64_tr_b16 a[124:125], v13 offset:24576
  buffer_load_dwordx4 v1, s[40:43], s70 offen offset:1024 sc1 lds
  v_mfma_f32_16x16x32_bf16 v[92:95], a[56:59], a[24:27], v[92:95]
  ds_read_b64_tr_b16 a[126:127], v13 offset:28672
  v_add_u32 v13, 0xfffe0000, v13
  s_waitcnt vmcnt(16)
  s_barrier
  s_waitcnt lgkmcnt(12)
  v_mfma_f32_16x16x32_bf16 v[64:67], a[208:211], a[80:83], v[64:67]
  ds_read_b128 a[224:227], v14 offset:0
  v_mfma_f32_16x16x32_bf16 v[64:67], a[212:215], a[84:87], v[64:67]
  ds_read_b128 a[228:231], v14 offset:1024
  buffer_load_dword v25, v0, s[40:43], s12 offen sc1
  v_mfma_f32_16x16x32_bf16 v[80:83], a[212:215], a[92:95], v[80:83]
  ds_read_b128 a[232:235], v14 offset:2048
  v_mfma_f32_16x16x32_bf16 v[80:83], a[208:211], a[88:91], v[80:83]
  ds_read_b128 a[236:239], v14 offset:3072
  s_waitcnt lgkmcnt(12)
  v_mfma_f32_16x16x32_bf16 v[68:71], a[216:219], a[80:83], v[68:71]
  ds_read_b128 a[16:19], v14 offset:8192
  v_mfma_f32_16x16x32_bf16 v[68:71], a[220:223], a[84:87], v[68:71]
  ds_read_b128 a[20:23], v14 offset:9216
  v_mfma_f32_16x16x32_bf16 v[84:87], a[220:223], a[92:95], v[84:87]
  ds_read_b128 a[24:27], v14 offset:10240
  v_mfma_f32_16x16x32_bf16 v[84:87], a[216:219], a[88:91], v[84:87]
  ds_read_b128 a[28:31], v14 offset:11264
  s_waitcnt lgkmcnt(12)
  v_mfma_f32_16x16x32_bf16 v[40:43], a[112:115], a[192:195], v[40:43]
  ds_read_b64_tr_b16 a[240:241], v10 offset:16384
  v_mfma_f32_16x16x32_bf16 v[40:43], a[116:119], a[196:199], v[40:43]
  ds_read_b64_tr_b16 a[242:243], v10 offset:20480
  v_mfma_f32_16x16x32_bf16 v[56:59], a[116:119], a[204:207], v[56:59]
  ds_read_b64_tr_b16 a[244:245], v10 offset:24576
  v_mfma_f32_16x16x32_bf16 v[56:59], a[112:115], a[200:203], v[56:59]
  ds_read_b64_tr_b16 a[246:247], v10 offset:28672
  v_mfma_f32_16x16x32_bf16 v[72:75], a[112:115], a[80:83], v[72:75]
  ds_read_b64_tr_b16 a[248:249], v11 offset:16384
  v_mfma_f32_16x16x32_bf16 v[72:75], a[116:119], a[84:87], v[72:75]
  ds_read_b64_tr_b16 a[250:251], v11 offset:20480
  v_mfma_f32_16x16x32_bf16 v[88:91], a[116:119], a[92:95], v[88:91]
  ds_read_b64_tr_b16 a[252:253], v11 offset:24576
  v_mfma_f32_16x16x32_bf16 v[88:91], a[112:115], a[88:91], v[88:91]
  ds_read_b64_tr_b16 a[254:255], v11 offset:28672
  s_waitcnt lgkmcnt(14)
  v_mfma_f32_16x16x32_bf16 v[44:47], a[120:123], a[192:195], v[44:47]
  ds_read_b64_tr_b16 a[48:49], v12 offset:16384
  v_mfma_f32_16x16x32_bf16 v[44:47], a[124:127], a[196:199], v[44:47]
  ds_read_b64_tr_b16 a[50:51], v12 offset:20480
  v_mfma_f32_16x16x32_bf16 v[60:63], a[124:127], a[204:207], v[60:63]
  ds_read_b64_tr_b16 a[52:53], v12 offset:24576
  v_mfma_f32_16x16x32_bf16 v[60:63], a[120:123], a[200:203], v[60:63]
  ds_read_b64_tr_b16 a[54:55], v12 offset:28672
  v_mfma_f32_16x16x32_bf16 v[76:79], a[120:123], a[80:83], v[76:79]
  ds_read_b64_tr_b16 a[56:57], v13 offset:16384
  v_mfma_f32_16x16x32_bf16 v[76:79], a[124:127], a[84:87], v[76:79]
  ds_read_b64_tr_b16 a[58:59], v13 offset:20480
  v_mfma_f32_16x16x32_bf16 v[92:95], a[124:127], a[92:95], v[92:95]
  ds_read_b64_tr_b16 a[60:61], v13 offset:24576
  v_mfma_f32_16x16x32_bf16 v[92:95], a[120:123], a[88:91], v[92:95]
  ds_read_b64_tr_b16 a[62:63], v13 offset:28672
  s_waitcnt vmcnt(9)
  s_barrier
  s_waitcnt lgkmcnt(12)
  v_mfma_f32_16x16x32_bf16 v[64:67], a[240:243], a[16:19], v[64:67]
  ds_read_b128 v[160:163], v14 offset:32768
  v_mfma_f32_16x16x32_bf16 v[64:67], a[244:247], a[20:23], v[64:67]
  ds_read_b128 v[164:167], v14 offset:33792
  v_mfma_f32_16x16x32_bf16 v[80:83], a[244:247], a[28:31], v[80:83]
  ds_read_b128 v[168:171], v14 offset:34816
  v_mfma_f32_16x16x32_bf16 v[80:83], a[240:243], a[24:27], v[80:83]
  ds_read_b128 v[172:175], v14 offset:35840
  s_waitcnt lgkmcnt(12)
  v_mfma_f32_16x16x32_bf16 v[68:71], a[248:251], a[16:19], v[68:71]
  ds_read_b128 a[80:83], v14 offset:40960
  v_mfma_f32_16x16x32_bf16 v[68:71], a[252:255], a[20:23], v[68:71]
  ds_read_b128 a[84:87], v14 offset:41984
  v_mfma_f32_16x16x32_bf16 v[84:87], a[252:255], a[28:31], v[84:87]
  ds_read_b128 a[88:91], v14 offset:43008
  v_mfma_f32_16x16x32_bf16 v[84:87], a[248:251], a[24:27], v[84:87]
  ds_read_b128 a[92:95], v14 offset:44032
  v_add_u32 v14, 0x10000, v14
  s_waitcnt lgkmcnt(12)
  v_mfma_f32_16x16x32_bf16 v[40:43], a[48:51], a[224:227], v[40:43]
  ds_read_b64_tr_b16 v[176:177], v10 offset:49152
  v_mfma_f32_16x16x32_bf16 v[40:43], a[52:55], a[228:231], v[40:43]
  ds_read_b64_tr_b16 v[178:179], v10 offset:53248
  v_mfma_f32_16x16x32_bf16 v[56:59], a[52:55], a[236:239], v[56:59]
  ds_read_b64_tr_b16 v[180:181], v10 offset:57344
  v_mfma_f32_16x16x32_bf16 v[56:59], a[48:51], a[232:235], v[56:59]
  ds_read_b64_tr_b16 v[182:183], v10 offset:61440
  v_add_u32 v10, 0x10000, v10
  v_mfma_f32_16x16x32_bf16 v[72:75], a[48:51], a[16:19], v[72:75]
  ds_read_b64_tr_b16 v[184:185], v11 offset:49152
  v_mfma_f32_16x16x32_bf16 v[72:75], a[52:55], a[20:23], v[72:75]
  ds_read_b64_tr_b16 v[186:187], v11 offset:53248
  v_mfma_f32_16x16x32_bf16 v[88:91], a[52:55], a[28:31], v[88:91]
  ds_read_b64_tr_b16 v[188:189], v11 offset:57344
  v_mfma_f32_16x16x32_bf16 v[88:91], a[48:51], a[24:27], v[88:91]
  ds_read_b64_tr_b16 v[190:191], v11 offset:61440
  v_add_u32 v11, 0x10000, v11
  s_waitcnt lgkmcnt(14)
  v_mfma_f32_16x16x32_bf16 v[44:47], a[56:59], a[224:227], v[44:47]
  ds_read_b64_tr_b16 a[112:113], v12 offset:49152
  v_mfma_f32_16x16x32_bf16 v[44:47], a[60:63], a[228:231], v[44:47]
  ds_read_b64_tr_b16 a[114:115], v12 offset:53248
  v_mfma_f32_16x16x32_bf16 v[60:63], a[60:63], a[236:239], v[60:63]
  ds_read_b64_tr_b16 a[116:117], v12 offset:57344
  v_mfma_f32_16x16x32_bf16 v[60:63], a[56:59], a[232:235], v[60:63]
  ds_read_b64_tr_b16 a[118:119], v12 offset:61440
  v_add_u32 v12, 0x10000, v12
  v_mfma_f32_16x16x32_bf16 v[76:79], a[56:59], a[16:19], v[76:79]
  ds_read_b64_tr_b16 a[120:121], v13 offset:49152
  v_mfma_f32_16x16x32_bf16 v[76:79], a[60:63], a[20:23], v[76:79]
  ds_read_b64_tr_b16 a[122:123], v13 offset:53248
  v_mfma_f32_16x16x32_bf16 v[92:95], a[60:63], a[28:31], v[92:95]
  ds_read_b64_tr_b16 a[124:125], v13 offset:57344
  v_mfma_f32_16x16x32_bf16 v[92:95], a[56:59], a[24:27], v[92:95]
  ds_read_b64_tr_b16 a[126:127], v13 offset:61440
  v_add_u32 v13, 0x10000, v13
  s_waitcnt vmcnt(1)
  s_barrier
  s_lshl_b32 s64, s0, 13
  s_add_u32 s64, s64, s13
  s_lshl_b32 s63, s60, 11
  s_add_u32 s64, s64, s63
  s_xor_b32 s63, s0, 1
  s_lshl_b32 s63, s63, 15
  s_add_u32 s56, s63, s64
  s_xor_b32 s63, s0, 2
  s_lshl_b32 s63, s63, 15
  s_add_u32 s57, s63, s64
  s_xor_b32 s63, s0, 3
  s_lshl_b32 s63, s63, 15
  s_add_u32 s58, s63, s64
  s_mov_b32 s85, 15
  s_waitcnt vmcnt(0)
  v_cmp_eq_u32 vcc, 0, v25
  s_and_b32 s63, vcc_lo, s85
  s_cbranch_scc1 Lspin7
Lpok7:
  s_waitcnt lgkmcnt(12)
  v_mfma_f32_16x16x32_bf16 v[64:67], v[176:179], a[80:83], v[64:67]
  ds_read_b128 v[192:195], v14 offset:0
  v_mfma_f32_16x16x32_bf16 v[64:67], v[180:183], a[84:87], v[64:67]
  ds_read_b128 v[196:199], v14 offset:1024
  v_mfma_f32_16x16x32_bf16 v[80:83], v[180:183], a[92:95], v[80:83]
  ds_read_b128 v[200:203], v14 offset:2048
  v_mfma_f32_16x16x32_bf16 v[80:83], v[176:179], a[88:91], v[80:83]
  ds_read_b128 v[204:207], v14 offset:3072
  s_waitcnt lgkmcnt(12)
  v_mfma_f32_16x16x32_bf16 v[68:71], v[184:187], a[80:83], v[68:71]
  ds_read_b128 a[16:19], v14 offset:8192
  v_mfma_f32_16x16x32_bf16 v[68:71], v[188:191], a[84:87], v[68:71]
  ds_read_b128 a[20:23], v14 offset:9216
  v_mfma_f32_16x16x32_bf16 v[84:87], v[188:191], a[92:95], v[84:87]
  ds_read_b128 a[24:27], v14 offset:10240
  v_mfma_f32_16x16x32_bf16 v[84:87], v[184:187], a[88:91], v[84:87]
  ds_read_b128 a[28:31], v14 offset:11264
  s_waitcnt lgkmcnt(12)
  v_mfma_f32_16x16x32_bf16 v[40:43], a[112:115], v[160:163], v[40:43]
  ds_read_b64_tr_b16 v[208:209], v10 offset:16384
  v_mfma_f32_16x16x32_bf16 v[40:43], a[116:119], v[164:167], v[40:43]
  ds_read_b64_tr_b16 v[210:211], v10 offset:20480
  v_mfma_f32_16x16x32_bf16 v[56:59], a[116:119], v[172:175], v[56:59]
  ds_read_b64_tr_b16 v[212:213], v10 offset:24576
  v_mfma_f32_16x16x32_bf16 v[56:59], a[112:115], v[168:171], v[56:59]
  ds_read_b64_tr_b16 v[214:215], v10 offset:28672
  v_mfma_f32_16x16x32_bf16 v[72:75], a[112:115], a[80:83], v[72:75]
  ds_read_b64_tr_b16 v[216:217], v11 offset:16384
  v_mfma_f32_16x16x32_bf16 v[72:75], a[116:119], a[84:87], v[72:75]
  ds_read_b64_tr_b16 v[218:219], v11 offset:20480
  v_mfma_f32_16x16x32_bf16 v[88:91], a[116:119], a[92:95], v[88:91]
  ds_read_b64_tr_b16 v[220:221], v11 offset:24576
  v_mfma_f32_16x16x32_bf16 v[88:91], a[112:115], a[88:91], v[88:91]
  ds_read_b64_tr_b16 v[222:223], v11 offset:28672
  s_waitcnt lgkmcnt(14)
  v_mfma_f32_16x16x32_bf16 v[44:47], a[120:123], v[160:163], v[44:47]
  ds_read_b64_tr_b16 a[48:49], v12 offset:16384
  v_mfma_f32_16x16x32_bf16 v[44:47], a[124:127], v[164:167], v[44:47]
  ds_read_b64_tr_b16 a[50:51], v12 offset:20480
  v_mfma_f32_16x16x32_bf16 v[60:63], a[124:127], v[172:175], v[60:63]
  ds_read_b64_tr_b16 a[52:53], v12 offset:24576
  v_mfma_f32_16x16x32_bf16 v[60:63], a[120:123], v[168:171], v[60:63]
  ds_read_b64_tr_b16 a[54:55], v12 offset:28672
  v_mfma_f32_16x16x32_bf16 v[76:79], a[120:123], a[80:83], v[76:79]
  ds_read_b64_tr_b16 a[56:57], v13 offset:16384
  v_mfma_f32_16x16x32_bf16 v[76:79], a[124:127], a[84:87], v[76:79]
  ds_read_b64_tr_b16 a[58:59], v13 offset:20480
  v_mfma_f32_16x16x32_bf16 v[92:95], a[124:127], a[92:95], v[92:95]
  ds_read_b64_tr_b16 a[60:61], v13 offset:24576
  v_mfma_f32_16x16x32_bf16 v[92:95], a[120:123], a[88:91], v[92:95]
  ds_read_b64_tr_b16 a[62:63], v13 offset:28672
  s_waitcnt lgkmcnt(12)
  v_mfma_f32_16x16x32_bf16 v[64:67], v[208:211], a[16:19], v[64:67]
  v_mfma_f32_16x16x32_bf16 v[64:67], v[212:215], a[20:23], v[64:67]
  v_mfma_f32_16x16x32_bf16 v[80:83], v[212:215], a[28:31], v[80:83]
  v_mfma_f32_16x16x32_bf16 v[80:83], v[208:211], a[24:27], v[80:83]
  s_waitcnt lgkmcnt(8)
  v_mfma_f32_16x16x32_bf16 v[68:71], v[216:219], a[16:19], v[68:71]
  v_mfma_f32_16x16x32_bf16 v[68:71], v[220:223], a[20:23], v[68:71]
  v_mfma_f32_16x16x32_bf16 v[84:87], v[220:223], a[28:31], v[84:87]
  v_mfma_f32_16x16x32_bf16 v[84:87], v[216:219], a[24:27], v[84:87]
  s_waitcnt lgkmcnt(4)
  v_mfma_f32_16x16x32_bf16 v[40:43], a[48:51], v[192:195], v[40:43]
  v_mfma_f32_16x16x32_bf16 v[40:43], a[52:55], v[196:199], v[40:43]
  v_mfma_f32_16x16x32_bf16 v[56:59], a[52:55], v[204:207], v[56:59]
  v_mfma_f32_16x16x32_bf16 v[56:59], a[48:51], v[200:203], v[56:59]
  v_mfma_f32_16x16x32_bf16 v[72:75], a[48:51], a[16:19], v[72:75]
  v_mfma_f32_16x16x32_bf16 v[72:75], a[52:55], a[20:23], v[72:75]
  v_mfma_f32_16x16x32_bf16 v[88:91], a[52:55], a[28:31], v[88:91]
  v_mfma_f32_16x16x32_bf16 v[88:91], a[48:51], a[24:27], v[88:91]
  s_waitcnt lgkmcnt(0)
  v_mfma_f32_16x16x32_bf16 v[44:47], a[56:59], v[192:195], v[44:47]
  v_mfma_f32_16x16x32_bf16 v[44:47], a[60:63], v[196:199], v[44:47]
  v_mfma_f32_16x16x32_bf16 v[60:63], a[60:63], v[204:207], v[60:63]
  v_mfma_f32_16x16x32_bf16 v[60:63], a[56:59], v[200:203], v[60:63]
  v_mfma_f32_16x16x32_bf16 v[76:79], a[56:59], a[16:19], v[76:79]
  v_mfma_f32_16x16x32_bf16 v[76:79], a[60:63], a[20:23], v[76:79]
  v_mfma_f32_16x16x32_bf16 v[92:95], a[60:63], a[28:31], v[92:95]
  v_mfma_f32_16x16x32_bf16 v[92:95], a[56:59], a[24:27], v[92:95]
.p2align 3
  v_pk_fma_f32 v[128:129], v[64:65], v[20:21], v[128:129] op_sel:[0,0,0] op_sel_hi:[1,0,1]
  v_pk_fma_f32 v[130:131], v[66:67], v[20:21], v[130:131] op_sel:[0,0,0] op_sel_hi:[1,0,1]
  v_pk_fma_f32 v[132:133], v[68:69], v[20:21], v[132:133] op_sel:[0,0,0] op_sel_hi:[1,0,1]
  v_pk_fma_f32 v[134:135], v[70:71], v[20:21], v[134:135] op_sel:[0,0,0] op_sel_hi:[1,0,1]
  v_cvt_pk_bf16_f32 v64, v128, v129
  v_cvt_pk_bf16_f32 v65, v130, v131
  v_cvt_pk_bf16_f32 v66, v132, v133
  v_cvt_pk_bf16_f32 v67, v134, v135
  buffer_store_dwordx4 v[64:67], v1, s[40:43], s57 offen offset:0 sc1
  v_pk_fma_f32 v[144:145], v[80:81], v[20:21], v[144:145] op_sel:[0,1,0] op_sel_hi:[1,1,1]
  v_pk_fma_f32 v[146:147], v[82:83], v[20:21], v[146:147] op_sel:[0,1,0] op_sel_hi:[1,1,1]
  v_pk_fma_f32 v[148:149], v[84:85], v[20:21], v[148:149] op_sel:[0,1,0] op_sel_hi:[1,1,1]
  v_pk_fma_f32 v[150:151], v[86:87], v[20:21], v[150:151] op_sel:[0,1,0] op_sel_hi:[1,1,1]
  v_cvt_pk_bf16_f32 v80, v144, v145
  v_cvt_pk_bf16_f32 v81, v146, v147
  v_cvt_pk_bf16_f32 v82, v148, v149
  v_cvt_pk_bf16_f32 v83, v150, v151
  buffer_store_dwordx4 v[80:83], v1, s[40:43], s57 offen offset:1024 sc1
  v_pk_fma_f32 v[104:105], v[40:41], v[18:19], v[104:105] op_sel:[0,0,0] op_sel_hi:[1,0,1]
  v_pk_fma_f32 v[106:107], v[42:43], v[18:19], v[106:107] op_sel:[0,0,0] op_sel_hi:[1,0,1]
  v_pk_fma_f32 v[108:109], v[44:45], v[18:19], v[108:109] op_sel:[0,0,0] op_sel_hi:[1,0,1]
  v_pk_fma_f32 v[110:111], v[46:47], v[18:19], v[110:111] op_sel:[0,0,0] op_sel_hi:[1,0,1]
  v_cvt_pk_bf16_f32 v40, v104, v105
  v_cvt_pk_bf16_f32 v41, v106, v107
  v_cvt_pk_bf16_f32 v42, v108, v109
  v_cvt_pk_bf16_f32 v43, v110, v111
  buffer_store_dwordx4 v[40:43], v1, s[40:43], s56 offen offset:0 sc1
  v_pk_fma_f32 v[120:121], v[56:57], v[18:19], v[120:121] op_sel:[0,1,0] op_sel_hi:[1,1,1]
  v_pk_fma_f32 v[122:123], v[58:59], v[18:19], v[122:123] op_sel:[0,1,0] op_sel_hi:[1,1,1]
  v_pk_fma_f32 v[124:125], v[60:61], v[18:19], v[124:125] op_sel:[0,1,0] op_sel_hi:[1,1,1]
  v_pk_fma_f32 v[126:127], v[62:63], v[18:19], v[126:127] op_sel:[0,1,0] op_sel_hi:[1,1,1]
  v_cvt_pk_bf16_f32 v56, v120, v121
  v_cvt_pk_bf16_f32 v57, v122, v123
  v_cvt_pk_bf16_f32 v58, v124, v125
  v_cvt_pk_bf16_f32 v59, v126, v127
  buffer_store_dwordx4 v[56:59], v1, s[40:43], s56 offen offset:1024 sc1
  v_pk_fma_f32 v[136:137], v[72:73], v[20:21], v[136:137] op_sel:[0,0,0] op_sel_hi:[1,0,1]
  v_pk_fma_f32 v[138:139], v[74:75], v[20:21], v[138:139] op_sel:[0,0,0] op_sel_hi:[1,0,1]
  v_pk_fma_f32 v[140:141], v[76:77], v[20:21], v[140:141] op_sel:[0,0,0] op_sel_hi:[1,0,1]
  v_pk_fma_f32 v[142:143], v[78:79], v[20:21], v[142:143] op_sel:[0,0,0] op_sel_hi:[1,0,1]
  v_cvt_pk_bf16_f32 v72, v136, v137
  v_cvt_pk_bf16_f32 v73, v138, v139
  v_cvt_pk_bf16_f32 v74, v140, v141
  v_cvt_pk_bf16_f32 v75, v142, v143
  buffer_store_dwordx4 v[72:75], v1, s[40:43], s58 offen offset:0 sc1
  v_pk_fma_f32 v[152:153], v[88:89], v[20:21], v[152:153] op_sel:[0,1,0] op_sel_hi:[1,1,1]
  v_pk_fma_f32 v[154:155], v[90:91], v[20:21], v[154:155] op_sel:[0,1,0] op_sel_hi:[1,1,1]
  v_pk_fma_f32 v[156:157], v[92:93], v[20:21], v[156:157] op_sel:[0,1,0] op_sel_hi:[1,1,1]
  v_pk_fma_f32 v[158:159], v[94:95], v[20:21], v[158:159] op_sel:[0,1,0] op_sel_hi:[1,1,1]
  v_cvt_pk_bf16_f32 v88, v152, v153
  v_cvt_pk_bf16_f32 v89, v154, v155
  v_cvt_pk_bf16_f32 v90, v156, v157
  v_cvt_pk_bf16_f32 v91, v158, v159
  buffer_store_dwordx4 v[88:91], v1, s[40:43], s58 offen offset:1024 sc1
  v_mfma_f32_16x16x32_bf16 v[32:35], a[144:147], a[128:131], v[32:35]
  s_mov_b32 s70, 0x3f80
  v_mfma_f32_16x16x32_bf16 v[32:35], a[148:151], a[132:135], v[32:35]
  s_mov_b32 s71, 0x3f800000
  v_mfma_f32_16x16x32_bf16 v[32:35], a[176:179], a[160:163], v[32:35]
  s_lshl_b32 s63, s7, 15
  v_mfma_f32_16x16x32_bf16 v[32:35], a[180:183], a[164:167], v[32:35]
  s_lshl_b32 s64, s1, 8
  v_mfma_f32_16x16x32_bf16 v[32:35], a[208:211], a[192:195], v[32:35]
  s_add_u32 s63, s63, s64
  v_mfma_f32_16x16x32_bf16 v[32:35], a[212:215], a[196:199], v[32:35]
  s_and_b32 s64, s0, 1
  v_mfma_f32_16x16x32_bf16 v[32:35], a[240:243], a[224:227], v[32:35]
  s_lshl_b32 s64, s64, 7
  v_mfma_f32_16x16x32_bf16 v[32:35], a[244:247], a[228:231], v[32:35]
  s_add_u32 s63, s63, s64
  v_mfma_f32_16x16x32_bf16 v[32:35], v[176:179], v[160:163], v[32:35]
  s_and_b32 s64, s60, 1
  v_mfma_f32_16x16x32_bf16 v[32:35], v[180:183], v[164:167], v[32:35]
  s_lshl_b32 s64, s64, 6
  v_mfma_f32_16x16x32_bf16 v[32:35], v[208:211], v[192:195], v[32:35]
  s_add_u32 s63, s63, s64
  v_mfma_f32_16x16x32_bf16 v[32:35], v[212:215], v[196:199], v[32:35]
  s_add_u32 s65, s63, 16384
  v_mfma_f32_16x16x32_bf16 v[36:39], a[152:155], a[128:131], v[36:39]
  v_lshlrev_b32 v22, 10, v16
  v_mfma_f32_16x16x32_bf16 v[36:39], a[156:159], a[132:135], v[36:39]
  v_and_b32 v24, 1, v15
  v_mfma_f32_16x16x32_bf16 v[36:39], a[184:187], a[160:163], v[36:39]
  v_lshl_add_u32 v22, v24, 5, v22
  v_mfma_f32_16x16x32_bf16 v[36:39], a[188:191], a[164:167], v[36:39]
  v_lshrrev_b32 v24, 1, v15
  v_mfma_f32_16x16x32_bf16 v[36:39], a[216:219], a[192:195], v[36:39]
  v_lshl_add_u32 v22, v24, 4, v22
  v_mfma_f32_16x16x32_bf16 v[36:39], a[220:223], a[196:199], v[36:39]
  v_mfma_f32_16x16x32_bf16 v[36:39], a[248:251], a[224:227], v[36:39]
  v_mfma_f32_16x16x32_bf16 v[36:39], a[252:255], a[228:231], v[36:39]
  v_mfma_f32_16x16x32_bf16 v[36:39], v[184:187], v[160:163], v[36:39]
  v_mfma_f32_16x16x32_bf16 v[36:39], v[188:191], v[164:167], v[36:39]
  v_mfma_f32_16x16x32_bf16 v[36:39], v[216:219], v[192:195], v[36:39]
  v_mfma_f32_16x16x32_bf16 v[36:39], v[220:223], v[196:199], v[36:39]
  v_mfma_f32_16x16x32_bf16 v[48:51], a[144:147], a[136:139], v[48:51]
  v_mfma_f32_16x16x32_bf16 v[48:51], a[148:151], a[140:143], v[48:51]
  v_mfma_f32_16x16x32_bf16 v[48:51], a[176:179], a[168:171], v[48:51]
  v_mfma_f32_16x16x32_bf16 v[48:51], a[180:183], a[172:175], v[48:51]
  v_mfma_f32_16x16x32_bf16 v[48:51], a[208:211], a[200:203], v[48:51]
  v_mfma_f32_16x16x32_bf16 v[48:51], a[212:215], a[204:207], v[48:51]
  v_mfma_f32_16x16x32_bf16 v[48:51], a[240:243], a[232:235], v[48:51]
  v_mfma_f32_16x16x32_bf16 v[48:51], a[244:247], a[236:239], v[48:51]
  v_mfma_f32_16x16x32_bf16 v[48:51], v[176:179], v[168:171], v[48:51]
  v_mfma_f32_16x16x32_bf16 v[48:51], v[180:183], v[172:175], v[48:51]
  v_mfma_f32_16x16x32_bf16 v[48:51], v[208:211], v[200:203], v[48:51]
  v_mfma_f32_16x16x32_bf16 v[48:51], v[212:215], v[204:207], v[48:51]
  v_mfma_f32_16x16x32_bf16 v[52:55], a[152:155], a[136:139], v[52:55]
  v_mfma_f32_16x16x32_bf16 v[52:55], a[156:159], a[140:143], v[52:55]
  v_mfma_f32_16x16x32_bf16 v[52:55], a[184:187], a[168:171], v[52:55]
  v_mfma_f32_16x16x32_bf16 v[52:55], a[188:191], a[172:175], v[52:55]
  v_mfma_f32_16x16x32_bf16 v[52:55], a[216:219], a[200:203], v[52:55]
  v_mfma_f32_16x16x32_bf16 v[52:55], a[220:223], a[204:207], v[52:55]
  v_mfma_f32_16x16x32_bf16 v[52:55], a[248:251], a[232:235], v[52:55]
  v_mfma_f32_16x16x32_bf16 v[52:55], a[252:255], a[236:239], v[52:55]
  v_mfma_f32_16x16x32_bf16 v[52:55], v[184:187], v[168:171], v[52:55]
  v_mfma_f32_16x16x32_bf16 v[52:55], v[188:191], v[172:175], v[52:55]
  v_mfma_f32_16x16x32_bf16 v[52:55], v[216:219], v[200:203], v[52:55]
  v_mfma_f32_16x16x32_bf16 v[52:55], v[220:223], v[204:207], v[52:55]
  s_nop 3
.p2align 3
  v_pk_fma_f32 v[96:97], v[32:33], v[18:19], v[96:97] op_sel:[0,0,0] op_sel_hi:[1,0,1]
  v_pk_fma_f32 v[98:99], v[34:35], v[18:19], v[98:99] op_sel:[0,0,0] op_sel_hi:[1,0,1]
  v_pk_fma_f32 v[100:101], v[36:37], v[18:19], v[100:101] op_sel:[0,0,0] op_sel_hi:[1,0,1]
  v_pk_fma_f32 v[102:103], v[38:39], v[18:19], v[102:103] op_sel:[0,0,0] op_sel_hi:[1,0,1]
  v_pk_fma_f32 v[112:113], v[48:49], v[18:19], v[112:113] op_sel:[0,1,0] op_sel_hi:[1,1,1]
  v_pk_fma_f32 v[114:115], v[50:51], v[18:19], v[114:115] op_sel:[0,1,0] op_sel_hi:[1,1,1]
  v_pk_fma_f32 v[116:117], v[52:53], v[18:19], v[116:117] op_sel:[0,1,0] op_sel_hi:[1,1,1]
  v_pk_fma_f32 v[118:119], v[54:55], v[18:19], v[118:119] op_sel:[0,1,0] op_sel_hi:[1,1,1]
  s_mov_b32 s64, 200000
  s_waitcnt vmcnt(0)
Linbox:
  buffer_load_dwordx4 v[176:179], v1, s[40:43], s14 offen offset:0 sc1
  buffer_load_dwordx4 v[180:183], v1, s[40:43], s14 offen offset:1024 sc1
  buffer_load_dwordx4 v[184:187], v1, s[40:43], s15 offen offset:0 sc1
  buffer_load_dwordx4 v[188:191], v1, s[40:43], s15 offen offset:1024 sc1
  buffer_load_dwordx4 v[192:195], v1, s[40:43], s16 offen offset:0 sc1
  buffer_load_dwordx4 v[196:199], v1, s[40:43], s16 offen offset:1024 sc1
  s_waitcnt vmcnt(4)
  v_max3_u32 v208, v176, v177, v178
  v_max3_u32 v208, v208, v179, v180
  v_max3_u32 v208, v208, v181, v182
  s_waitcnt vmcnt(2)
  v_max3_u32 v208, v208, v183, v184
  v_max3_u32 v208, v208, v185, v186
  v_max3_u32 v208, v208, v187, v188
  v_max3_u32 v208, v208, v189, v190
  s_waitcnt vmcnt(0)
  v_max3_u32 v208, v208, v191, v192
  v_max3_u32 v208, v208, v193, v194
  v_max3_u32 v208, v208, v195, v196
  v_max3_u32 v208, v208, v197, v198
  v_max3_u32 v208, v208, v199, v199
  v_cmp_eq_u32 vcc, -1, v208
  s_sub_u32 s64, s64, 1
  s_cselect_b64 vcc, 0, vcc
  s_cmp_lg_u64 vcc, 0
  s_cbranch_scc1 Linbox
.p2align 3
  v_dot2_f32_bf16 v96, v176, s70, v96
  v_dot2_f32_bf16 v97, v176, s71, v97
  v_dot2_f32_bf16 v98, v177, s70, v98
  v_dot2_f32_bf16 v99, v177, s71, v99
  v_dot2_f32_bf16 v100, v178, s70, v100
  v_dot2_f32_bf16 v101, v178, s71, v101
  v_dot2_f32_bf16 v102, v179, s70, v102
  v_dot2_f32_bf16 v103, v179, s71, v103
  v_dot2_f32_bf16 v112, v180, s70, v112
  v_dot2_f32_bf16 v113, v180, s71, v113
  v_dot2_f32_bf16 v114, v181, s70, v114
  v_dot2_f32_bf16 v115, v181, s71, v115
  v_dot2_f32_bf16 v116, v182, s70, v116
  v_dot2_f32_bf16 v117, v182, s71, v117
  v_dot2_f32_bf16 v118, v183, s70, v118
  v_dot2_f32_bf16 v119, v183, s71, v119
  v_dot2_f32_bf16 v96, v184, s70, v96
  v_dot2_f32_bf16 v97, v184, s71, v97
  v_dot2_f32_bf16 v98, v185, s70, v98
  v_dot2_f32_bf16 v99, v185, s71, v99
  v_dot2_f32_bf16 v100, v186, s70, v100
  v_dot2_f32_bf16 v101, v186, s71, v101
  v_dot2_f32_bf16 v102, v187, s70, v102
  v_dot2_f32_bf16 v103, v187, s71, v103
  v_dot2_f32_bf16 v112, v188, s70, v112
  v_dot2_f32_bf16 v113, v188, s71, v113
  v_dot2_f32_bf16 v114, v189, s70, v114
  v_dot2_f32_bf16 v115, v189, s71, v115
  v_dot2_f32_bf16 v116, v190, s70, v116
  v_dot2_f32_bf16 v117, v190, s71, v117
  v_dot2_f32_bf16 v118, v191, s70, v118
  v_dot2_f32_bf16 v119, v191, s71, v119
  v_dot2_f32_bf16 v96, v192, s70, v96
  v_dot2_f32_bf16 v97, v192, s71, v97
  v_dot2_f32_bf16 v98, v193, s70, v98
  v_dot2_f32_bf16 v99, v193, s71, v99
  v_dot2_f32_bf16 v100, v194, s70, v100
  v_dot2_f32_bf16 v101, v194, s71, v101
  v_dot2_f32_bf16 v102, v195, s70, v102
  v_dot2_f32_bf16 v103, v195, s71, v103
  v_dot2_f32_bf16 v112, v196, s70, v112
  v_dot2_f32_bf16 v113, v196, s71, v113
  v_dot2_f32_bf16 v114, v197, s70, v114
  v_dot2_f32_bf16 v115, v197, s71, v115
  v_dot2_f32_bf16 v116, v198, s70, v116
  v_dot2_f32_bf16 v117, v198, s71, v117
  v_dot2_f32_bf16 v118, v199, s70, v118
  v_dot2_f32_bf16 v119, v199, s71, v119
  s_nop 2
.p2align 3
  v_cvt_pk_bf16_f32 v200, v96, v97
  v_cvt_pk_bf16_f32 v201, v98, v99
  v_cvt_pk_bf16_f32 v202, v100, v101
  v_cvt_pk_bf16_f32 v203, v102, v103
  v_cvt_pk_bf16_f32 v204, v112, v113
  v_cvt_pk_bf16_f32 v205, v114, v115
  v_cvt_pk_bf16_f32 v206, v116, v117
  v_cvt_pk_bf16_f32 v207, v118, v119
  v_permlane16_swap_b32 v200, v202
  v_permlane16_swap_b32 v201, v203
  buffer_store_dwordx4 v[200:203], v22, s[44:47], s63 offen
  v_permlane16_swap_b32 v204, v206
  v_permlane16_swap_b32 v205, v207
  buffer_store_dwordx4 v[204:207], v22, s[44:47], s65 offen
Lend:
  s_endpgm
.p2align 5
Lnomish:
  s_waitcnt vmcnt(0)
  v_cmp_eq_u32 vcc, 0, v25
  s_and_b32 s63, vcc_lo, 0xff
  s_cbranch_scc1 Lspin8
Lpok8:
  s_mov_b32 s92, s78
  s_mov_b32 s93, s78
  s_and_b32 m0, s92, 0xffff
  s_nop 0
  buffer_load_dwordx4 v1, s[20:23], s92 offen offset:0 sc1 lds
  buffer_load_dwordx4 v1, s[20:23], s92 offen offset:1024 sc1 lds
  buffer_load_dwordx4 v1, s[20:23], s92 offen offset:2048 sc1 lds
  buffer_load_dwordx4 v1, s[20:23], s92 offen offset:3072 sc1 lds
  s_add_u32 s92, s92, 16384
  s_and_b32 s65, s93, 0xffff
  s_add_u32 m0, s65, 65536
  s_nop 0
  buffer_load_dwordx4 v1, s[24:27], s93 offen offset:0 sc1 lds
  buffer_load_dwordx4 v1, s[24:27], s93 offen offset:1024 sc1 lds
  buffer_load_dwordx4 v1, s[24:27], s93 offen offset:2048 sc1 lds
  buffer_load_dwordx4 v1, s[24:27], s93 offen offset:3072 sc1 lds
  s_add_u32 s93, s93, 16384
  s_and_b32 m0, s92, 0xffff
  s_nop 0
  buffer_load_dwordx4 v1, s[20:23], s92 offen offset:0 sc1 lds
  buffer_load_dwordx4 v1, s[20:23], s92 offen offset:1024 sc1 lds
  buffer_load_dwordx4 v1, s[20:23], s92 offen offset:2048 sc1 lds
  buffer_load_dwordx4 v1, s[20:23], s92 offen offset:3072 sc1 lds
  s_add_u32 s92, s92, 16384
  s_and_b32 s65, s93, 0xffff
  s_add_u32 m0, s65, 65536
  s_nop 0
  buffer_load_dwordx4 v1, s[24:27], s93 offen offset:0 sc1 lds
  buffer_load_dwordx4 v1, s[24:27], s93 offen offset:1024 sc1 lds
  buffer_load_dwordx4 v1, s[24:27], s93 offen offset:2048 sc1 lds
  buffer_load_dwordx4 v1, s[24:27], s93 offen offset:3072 sc1 lds
  s_add_u32 s93, s93, 16384
  s_branch Lp2done
.p2align 5
LW0:
  s_waitcnt lgkmcnt(0)
  v_mfma_f32_16x16x32_bf16 v[64:67], a[160:163], a[64:67], v[224:227]
  v_accvgpr_write_b32 a244, -1
  v_exp_f32 v128, v32
  v_mfma_f32_16x16x32_bf16 v[64:67], a[168:171], a[72:75], v[64:67]
  v_accvgpr_write_b32 a245, -1
  v_exp_f32 v129, v33
  v_mfma_f32_16x16x32_bf16 v[64:67], a[176:179], a[80:83], v[64:67]
  ds_read_b128 a[192:195], v3 offset:0
  v_accvgpr_write_b32 a246, -1
  v_cvt_pk_bf16_f32 v96, v128, v129
  v_mfma_f32_16x16x32_bf16 v[64:67], a[184:187], a[88:91], v[64:67]
  ds_read_b128 a[196:199], v3 offset:1024
  v_accvgpr_write_b32 a247, -1
  v_mfma_f32_16x16x32_bf16 v[72:75], a[184:187], a[92:95], v[232:235]
  v_exp_f32 v130, v34
  v_mfma_f32_16x16x32_bf16 v[72:75], a[176:179], a[84:87], v[72:75]
  v_exp_f32 v131, v35
  v_mfma_f32_16x16x32_bf16 v[72:75], a[168:171], a[76:79], v[72:75]
  ds_read_b128 a[200:203], v3 offset:2048
  v_cvt_pk_bf16_f32 v97, v130, v131
  v_mfma_f32_16x16x32_bf16 v[72:75], a[160:163], a[68:71], v[72:75]
  ds_read_b128 a[204:207], v3 offset:3072
  v_mfma_f32_16x16x32_bf16 v[80:83], a[160:163], a[96:99], v[240:243]
  v_exp_f32 v132, v36
  v_mfma_f32_16x16x32_bf16 v[80:83], a[168:171], a[104:107], v[80:83]
  v_exp_f32 v133, v37
  v_mfma_f32_16x16x32_bf16 v[80:83], a[176:179], a[112:115], v[80:83]
  ds_read_b128 a[208:211], v3 offset:4096
  v_cvt_pk_bf16_f32 v98, v132, v133
  v_mfma_f32_16x16x32_bf16 v[80:83], a[184:187], a[120:123], v[80:83]
  v_lshlrev_b32 v22, 2, v23
  v_mfma_f32_16x16x32_bf16 v[88:91], a[184:187], a[124:127], v[248:251]
  v_sub_u32 v156, v5, v1
  v_exp_f32 v134, v38
  v_mfma_f32_16x16x32_bf16 v[88:91], a[176:179], a[116:119], v[88:91]
  v_add_u32 v156, v156, v0
  v_exp_f32 v135, v39
  v_mfma_f32_16x16x32_bf16 v[88:91], a[168:171], a[108:111], v[88:91]
  ds_read_b128 a[212:215], v3 offset:5120
  v_cvt_pk_bf16_f32 v99, v134, v135
  v_mfma_f32_16x16x32_bf16 v[88:91], a[160:163], a[100:103], v[88:91]
  buffer_load_dword v26, v22, s[28:31], 0 offen
  v_mfma_f32_16x16x32_bf16 v[92:95], a[164:167], a[100:103], v[252:255]
  v_exp_f32 v128, v40
  v_mfma_f32_16x16x32_bf16 v[92:95], a[172:175], a[108:111], v[92:95]
  v_exp_f32 v129, v41
  v_mfma_f32_16x16x32_bf16 v[92:95], a[180:183], a[116:119], v[92:95]
  ds_read_b128 a[216:219], v3 offset:6144
  v_cvt_pk_bf16_f32 v100, v128, v129
  v_mfma_f32_16x16x32_bf16 v[92:95], a[188:191], a[124:127], v[92:95]
  buffer_load_dword v26, v22, s[36:39], 0 offen
  v_mfma_f32_16x16x32_bf16 v[84:87], a[188:191], a[120:123], v[244:247]
  v_exp_f32 v130, v42
  v_mfma_f32_16x16x32_bf16 v[84:87], a[180:183], a[112:115], v[84:87]
  v_exp_f32 v131, v43
  v_mfma_f32_16x16x32_bf16 v[84:87], a[172:175], a[104:107], v[84:87]
  ds_read_b128 a[220:223], v3 offset:7168
  s_add_u32 s63, s61, 0
  v_cvt_pk_bf16_f32 v101, v130, v131
  v_mfma_f32_16x16x32_bf16 v[84:87], a[164:167], a[96:99], v[84:87]
  s_lshl_b64 exec, s[94:95], s63
  buffer_store_dword v27, v0, s[40:43], s82 offen sc1
  s_mov_b64 exec, -1
  v_mfma_f32_16x16x32_bf16 v[76:79], a[164:167], a[68:71], v[236:239]
  s_add_u32 s88, s88, s4
  v_exp_f32 v132, v44
  v_mfma_f32_16x16x32_bf16 v[76:79], a[172:175], a[76:79], v[76:79]
  v_exp_f32 v133, v45
  v_mfma_f32_16x16x32_bf16 v[76:79], a[180:183], a[84:87], v[76:79]
  ds_read2st64_b32 v[138:139], v156 offset1:1
  v_cvt_pk_bf16_f32 v102, v132, v133
  v_mfma_f32_16x16x32_bf16 v[76:79], a[188:191], a[92:95], v[76:79]
  v_add_u32 v2, s88, v1
  v_mfma_f32_16x16x32_bf16 v[68:71], a[188:191], a[88:91], v[228:231]
  s_add_u32 s88, s88, 16384
  v_exp_f32 v134, v46
  v_mfma_f32_16x16x32_bf16 v[68:71], a[180:183], a[80:83], v[68:71]
  s_and_b32 s88, s88, 0xffff
  v_exp_f32 v135, v47
  v_mfma_f32_16x16x32_bf16 v[68:71], a[172:175], a[72:75], v[68:71]
  v_cvt_pk_bf16_f32 v103, v134, v135
  v_mfma_f32_16x16x32_bf16 v[68:71], a[164:167], a[64:67], v[68:71]
  buffer_store_dwordx4 a[244:247], v1, s[40:43], s14 offen offset:0 sc1
  s_waitcnt vmcnt(17) lgkmcnt(0)
  s_barrier
  v_mfma_f32_16x16x32_bf16 a[224:227], a[240:243], v[112:115], a[224:227]
  ds_read_b128 a[160:163], v2 offset:0
  s_bfe_u32 s63, s72, 0x2000f
  s_and_b32 s3, s60, 1
  s_sub_u32 s3, s3, s63
  s_cmp_lt_i32 s3, 0
  s_cselect_b32 s100, s90, s91
  s_cmp_gt_i32 s3, 0
  s_cselect_b32 s101, s91, s90
  v_max_f32 v144, s100, v140
  v_max_f32 v145, s100, v141
  v_mfma_f32_16x16x32_bf16 a[228:231], a[240:243], v[116:119], a[228:231]
  ds_read_b128 a[164:167], v2 offset:1024
  v_max_f32 v146, s100, v142
  v_max_f32 v147, s100, v143
  v_mfma_f32_16x16x32_bf16 a[232:235], a[240:243], v[120:123], a[232:235]
  ds_read_b128 a[168:171], v2 offset:2048
  v_min_f32 v228, s100, v136
  v_min_f32 v229, s100, v136
  v_mfma_f32_16x16x32_bf16 a[236:239], a[240:243], v[124:127], a[236:239]
  ds_read_b128 a[172:175], v2 offset:3072
  v_min_f32 v230, s100, v136
  v_mfma_f32_16x16x32_bf16 v[164:167], a[192:195], v[124:127], v[164:167]
  s_add_u32 s89, s89, 8192
  v_exp_f32 v128, v48
  v_min_f32 v231, s100, v136
  v_mfma_f32_16x16x32_bf16 v[160:163], a[192:195], v[120:123], v[160:163]
  s_and_b32 s89, s89, 0xffff
  v_exp_f32 v129, v49
  v_min3_f32 v224, v136, v144, s101
  v_mfma_f32_16x16x32_bf16 a[4:7], a[192:195], v[116:119], a[4:7]
  ds_read_b128 a[176:179], v2 offset:4096
  v_cvt_pk_bf16_f32 v104, v128, v129
  v_min3_f32 v225, v136, v145, s101
  v_mfma_f32_16x16x32_bf16 a[0:3], a[192:195], v[112:115], a[0:3]
  ds_read_b128 a[180:183], v2 offset:5120
  v_min3_f32 v226, v136, v146, s101
  v_mfma_f32_16x16x32_bf16 a[8:11], a[196:199], v[112:115], a[8:11]
  s_or_b32 s89, s89, 0x10000
  v_exp_f32 v130, v50
  v_min3_f32 v227, v136, v147, s101
  v_mfma_f32_16x16x32_bf16 a[12:15], a[196:199], v[116:119], a[12:15]
  v_exp_f32 v131, v51
  v_min3_f32 v236, v137, v144, s101
  v_mfma_f32_16x16x32_bf16 v[168:171], a[196:199], v[120:123], v[168:171]
  ds_read_b128 a[184:187], v2 offset:6144
  v_cvt_pk_bf16_f32 v105, v130, v131
  v_min3_f32 v237, v137, v145, s101
  v_mfma_f32_16x16x32_bf16 v[172:175], a[196:199], v[124:127], v[172:175]
  ds_read_b128 a[188:191], v2 offset:7168
  v_min3_f32 v238, v137, v146, s101
  v_mfma_f32_16x16x32_bf16 v[180:183], a[200:203], v[124:127], v[180:183]
  v_exp_f32 v132, v52
  v_min3_f32 v239, v137, v147, s101
  v_mfma_f32_16x16x32_bf16 v[176:179], a[200:203], v[120:123], v[176:179]
  v_exp_f32 v133, v53
  v_min_f32 v232, s101, v137
  v_mfma_f32_16x16x32_bf16 a[20:23], a[200:203], v[116:119], a[20:23]
  v_cvt_pk_bf16_f32 v106, v132, v133
  v_min_f32 v233, s101, v137
  v_min_f32 v234, s101, v137
  v_mfma_f32_16x16x32_bf16 a[16:19], a[200:203], v[112:115], a[16:19]
  buffer_store_dwordx4 a[244:247], v1, s[40:43], s14 offen offset:1024 sc1
  v_mfma_f32_16x16x32_bf16 a[24:27], a[204:207], v[112:115], a[24:27]
  v_exp_f32 v134, v54
  v_min_f32 v235, s101, v137
  s_bfe_u32 s63, s72, 0x2000f
  s_xor_b32 s63, s63, 3
  s_and_b32 s3, s60, 1
  s_sub_u32 s3, s3, s63
  s_cmp_lt_i32 s3, 0
  s_cselect_b32 s100, s90, s91
  s_cmp_gt_i32 s3, 0
  s_cselect_b32 s101, s91, s90
  v_mfma_f32_16x16x32_bf16 a[28:31], a[204:207], v[116:119], a[28:31]
  v_exp_f32 v135, v55
  v_max_f32 v144, s100, v140
  v_mfma_f32_16x16x32_bf16 v[184:187], a[204:207], v[120:123], v[184:187]
  v_cvt_pk_bf16_f32 v107, v134, v135
  v_max_f32 v145, s100, v141
  v_max_f32 v146, s100, v142
  v_mfma_f32_16x16x32_bf16 v[188:191], a[204:207], v[124:127], v[188:191]
  buffer_store_dwordx4 a[244:247], v1, s[40:43], s15 offen offset:0 sc1
  v_mfma_f32_16x16x32_bf16 v[196:199], a[208:211], v[124:127], v[196:199]
  v_exp_f32 v128, v56
  v_max_f32 v147, s100, v143
  v_mfma_f32_16x16x32_bf16 v[192:195], a[208:211], v[120:123], v[192:195]
  v_exp_f32 v129, v57
  v_min_f32 v244, s100, v138
  v_mfma_f32_16x16x32_bf16 a[36:39], a[208:211], v[116:119], a[36:39]
  v_cvt_pk_bf16_f32 v108, v128, v129
  v_min_f32 v245, s100, v138
  v_min_f32 v246, s100, v138
  v_mfma_f32_16x16x32_bf16 a[32:35], a[208:211], v[112:115], a[32:35]
  buffer_store_dwordx4 a[244:247], v1, s[40:43], s15 offen offset:1024 sc1
  v_mfma_f32_16x16x32_bf16 a[40:43], a[212:215], v[112:115], a[40:43]
  v_exp_f32 v130, v58
  v_min_f32 v247, s100, v138
  v_mfma_f32_16x16x32_bf16 a[44:47], a[212:215], v[116:119], a[44:47]
  v_exp_f32 v131, v59
  v_min3_f32 v240, v138, v144, s101
  v_mfma_f32_16x16x32_bf16 v[200:203], a[212:215], v[120:123], v[200:203]
  v_cvt_pk_bf16_f32 v109, v130, v131
  v_min3_f32 v241, v138, v145, s101
  v_min3_f32 v242, v138, v146, s101
  v_mfma_f32_16x16x32_bf16 v[204:207], a[212:215], v[124:127], v[204:207]
  buffer_store_dwordx4 a[244:247], v1, s[40:43], s16 offen offset:0 sc1
  v_mfma_f32_16x16x32_bf16 v[212:215], a[216:219], v[124:127], v[212:215]
  v_exp_f32 v132, v60
  v_min3_f32 v243, v138, v147, s101
  v_mfma_f32_16x16x32_bf16 v[208:211], a[216:219], v[120:123], v[208:211]
  v_exp_f32 v133, v61
  v_min3_f32 v252, v139, v144, s101
  v_mfma_f32_16x16x32_bf16 a[52:55], a[216:219], v[116:119], a[52:55]
  v_cvt_pk_bf16_f32 v110, v132, v133
  v_min3_f32 v253, v139, v145, s101
  v_min3_f32 v254, v139, v146, s101
  v_mfma_f32_16x16x32_bf16 a[48:51], a[216:219], v[112:115], a[48:51]
  v_add_u32 v3, s89, v1
  v_min3_f32 v255, v139, v147, s101
  v_mfma_f32_16x16x32_bf16 a[56:59], a[220:223], v[112:115], a[56:59]
  v_exp_f32 v134, v62
  v_min_f32 v248, s101, v139
  v_mfma_f32_16x16x32_bf16 a[60:63], a[220:223], v[116:119], a[60:63]
  v_exp_f32 v135, v63
  v_min_f32 v249, s101, v139
  v_mfma_f32_16x16x32_bf16 v[216:219], a[220:223], v[120:123], v[216:219]
  v_cvt_pk_bf16_f32 v111, v134, v135
  v_min_f32 v250, s101, v139
  v_min_f32 v251, s101, v139
  v_mfma_f32_16x16x32_bf16 v[220:223], a[220:223], v[124:127], v[220:223]
  buffer_store_dwordx4 a[244:247], v1, s[40:43], s16 offen offset:1024 sc1
  s_branch LY1
.p2align 5
Llow_o:
  s_mov_b32 s65, 0x4e800000
  v_accvgpr_read_b32 v152, a232
  v_accvgpr_read_b32 v153, a236
  v_rcp_f32 v148, v152
  v_rcp_f32 v150, v153
  v_cmp_nge_f32 vcc, s65, v152
  s_or_b64 s[68:69], s[68:69], vcc
  v_cmp_nge_f32 vcc, s65, v153
  s_or_b64 s[68:69], s[68:69], vcc
  v_mov_b32 v149, v148
  v_mov_b32 v151, v150
.p2align 3
  v_pk_mul_f32 v[160:161], v[160:161], v[148:149]
  v_pk_mul_f32 v[162:163], v[162:163], v[148:149]
  v_pk_mul_f32 v[168:169], v[168:169], v[148:149]
  v_pk_mul_f32 v[170:171], v[170:171], v[148:149]
  v_cvt_pk_bf16_f32 v160, v160, v161
  v_cvt_pk_bf16_f32 v161, v162, v163
  v_cvt_pk_bf16_f32 v162, v168, v169
  v_cvt_pk_bf16_f32 v163, v170, v171
  s_lshr_b32 s63, s74, 14
  s_mul_i32 s63, s63, 188416
  s_lshl_b32 s64, s61, 12
  s_add_u32 s63, s63, s64
  s_add_u32 s63, s63, 33554432
.p2align 3
  buffer_store_dwordx4 v[160:163], v1, s[40:43], s63 offen offset:0 sc1
  v_pk_mul_f32 v[176:177], v[176:177], v[148:149]
  v_pk_mul_f32 v[178:179], v[178:179], v[148:149]
  v_pk_mul_f32 v[184:185], v[184:185], v[148:149]
  v_pk_mul_f32 v[186:187], v[186:187], v[148:149]
  v_cvt_pk_bf16_f32 v176, v176, v177
  v_cvt_pk_bf16_f32 v177, v178, v179
  v_cvt_pk_bf16_f32 v178, v184, v185
  v_cvt_pk_bf16_f32 v179, v186, v187
  buffer_store_dwordx4 v[176:179], v1, s[40:43], s63 offen offset:1024 sc1
  v_pk_mul_f32 v[192:193], v[192:193], v[148:149]
  v_pk_mul_f32 v[194:195], v[194:195], v[148:149]
  v_pk_mul_f32 v[200:201], v[200:201], v[148:149]
  v_pk_mul_f32 v[202:203], v[202:203], v[148:149]
  v_cvt_pk_bf16_f32 v192, v192, v193
  v_cvt_pk_bf16_f32 v193, v194, v195
  v_cvt_pk_bf16_f32 v194, v200, v201
  v_cvt_pk_bf16_f32 v195, v202, v203
  buffer_store_dwordx4 v[192:195], v1, s[40:43], s63 offen offset:2048 sc1
  v_pk_mul_f32 v[208:209], v[208:209], v[148:149]
  v_pk_mul_f32 v[210:211], v[210:211], v[148:149]
  v_pk_mul_f32 v[216:217], v[216:217], v[148:149]
  v_pk_mul_f32 v[218:219], v[218:219], v[148:149]
  v_cvt_pk_bf16_f32 v208, v208, v209
  v_cvt_pk_bf16_f32 v209, v210, v211
  v_cvt_pk_bf16_f32 v210, v216, v217
  v_cvt_pk_bf16_f32 v211, v218, v219
  buffer_store_dwordx4 v[208:211], v1, s[40:43], s63 offen offset:3072 sc1
  v_pk_mul_f32 v[164:165], v[164:165], v[150:151]
  v_pk_mul_f32 v[166:167], v[166:167], v[150:151]
  v_pk_mul_f32 v[172:173], v[172:173], v[150:151]
  v_pk_mul_f32 v[174:175], v[174:175], v[150:151]
  v_cvt_pk_bf16_f32 v164, v164, v165
  v_cvt_pk_bf16_f32 v165, v166, v167
  v_cvt_pk_bf16_f32 v166, v172, v173
  v_cvt_pk_bf16_f32 v167, v174, v175
  s_lshr_b32 s63, s75, 14
  s_mul_i32 s63, s63, 188416
  s_lshl_b32 s64, s61, 12
  s_add_u32 s63, s63, s64
  s_add_u32 s63, s63, 33554432
.p2align 3
  buffer_store_dwordx4 v[164:167], v1, s[40:43], s63 offen offset:0 sc1
  v_pk_mul_f32 v[180:181], v[180:181], v[150:151]
  v_pk_mul_f32 v[182:183], v[182:183], v[150:151]
  v_pk_mul_f32 v[188:189], v[188:189], v[150:151]
  v_pk_mul_f32 v[190:191], v[190:191], v[150:151]
  v_cvt_pk_bf16_f32 v180, v180, v181
  v_cvt_pk_bf16_f32 v181, v182, v183
  v_cvt_pk_bf16_f32 v182, v188, v189
  v_cvt_pk_bf16_f32 v183, v190, v191
  buffer_store_dwordx4 v[180:183], v1, s[40:43], s63 offen offset:1024 sc1
  v_pk_mul_f32 v[196:197], v[196:197], v[150:151]
  v_pk_mul_f32 v[198:199], v[198:199], v[150:151]
  v_pk_mul_f32 v[204:205], v[204:205], v[150:151]
  v_pk_mul_f32 v[206:207], v[206:207], v[150:151]
  v_cvt_pk_bf16_f32 v196, v196, v197
  v_cvt_pk_bf16_f32 v197, v198, v199
  v_cvt_pk_bf16_f32 v198, v204, v205
  v_cvt_pk_bf16_f32 v199, v206, v207
  buffer_store_dwordx4 v[196:199], v1, s[40:43], s63 offen offset:2048 sc1
  v_pk_mul_f32 v[212:213], v[212:213], v[150:151]
  v_pk_mul_f32 v[214:215], v[214:215], v[150:151]
  v_pk_mul_f32 v[220:221], v[220:221], v[150:151]
  v_pk_mul_f32 v[222:223], v[222:223], v[150:151]
  v_cvt_pk_bf16_f32 v212, v212, v213
  v_cvt_pk_bf16_f32 v213, v214, v215
  v_cvt_pk_bf16_f32 v214, v220, v221
  v_cvt_pk_bf16_f32 v215, v222, v223
  buffer_store_dwordx4 v[212:215], v1, s[40:43], s63 offen offset:3072 sc1
  v_accvgpr_write_b32 a232, 0
  v_accvgpr_write_b32 a233, 0
  v_accvgpr_write_b32 a234, 0
  v_accvgpr_write_b32 a235, 0
  v_accvgpr_write_b32 a236, 0
  v_accvgpr_write_b32 a237, 0
  v_accvgpr_write_b32 a238, 0
  v_accvgpr_write_b32 a239, 0
  v_mov_b32 v160, 0
  v_mov_b32 v161, 0
  v_mov_b32 v162, 0
  v_mov_b32 v163, 0
  v_mov_b32 v164, 0
  v_mov_b32 v165, 0
  v_mov_b32 v166, 0
  v_mov_b32 v167, 0
  v_mov_b32 v168, 0
  v_mov_b32 v169, 0
  v_mov_b32 v170, 0
  v_mov_b32 v171, 0
  v_mov_b32 v172, 0
  v_mov_b32 v173, 0
  v_mov_b32 v174, 0
  v_mov_b32 v175, 0
  v_mov_b32 v176, 0
  v_mov_b32 v177, 0
  v_mov_b32 v178, 0
  v_mov_b32 v179, 0
  v_mov_b32 v180, 0
  v_mov_b32 v181, 0
  v_mov_b32 v182, 0
  v_mov_b32 v183, 0
  v_mov_b32 v184, 0
  v_mov_b32 v185, 0
  v_mov_b32 v186, 0
  v_mov_b32 v187, 0
  v_mov_b32 v188, 0
  v_mov_b32 v189, 0
  v_mov_b32 v190, 0
  v_mov_b32 v191, 0
  v_mov_b32 v192, 0
  v_mov_b32 v193, 0
  v_mov_b32 v194, 0
  v_mov_b32 v195, 0
  v_mov_b32 v196, 0
  v_mov_b32 v197, 0
  v_mov_b32 v198, 0
  v_mov_b32 v199, 0
  v_mov_b32 v200, 0
  v_mov_b32 v201, 0
  v_mov_b32 v202, 0
  v_mov_b32 v203, 0
  v_mov_b32 v204, 0
  v_mov_b32 v205, 0
  v_mov_b32 v206, 0
  v_mov_b32 v207, 0
  v_mov_b32 v208, 0
  v_mov_b32 v209, 0
  v_mov_b32 v210, 0
  v_mov_b32 v211, 0
  v_mov_b32 v212, 0
  v_mov_b32 v213, 0
  v_mov_b32 v214, 0
  v_mov_b32 v215, 0
  v_mov_b32 v216, 0
  v_mov_b32 v217, 0
  v_mov_b32 v218, 0
  v_mov_b32 v219, 0
  v_mov_b32 v220, 0
  v_mov_b32 v221, 0
  v_mov_b32 v222, 0
  v_mov_b32 v223, 0
  s_branch Llowb_o
.p2align 5
Llow_e:
  s_mov_b32 s65, 0x4e800000
  v_accvgpr_read_b32 v152, a232
  v_accvgpr_read_b32 v153, a236
  v_rcp_f32 v148, v152
  v_rcp_f32 v150, v153
  v_cmp_nge_f32 vcc, s65, v152
  s_or_b64 s[68:69], s[68:69], vcc
  v_cmp_nge_f32 vcc, s65, v153
  s_or_b64 s[68:69], s[68:69], vcc
  v_mov_b32 v149, v148
  v_mov_b32 v151, v150
.p2align 3
  v_pk_mul_f32 v[160:161], v[160:161], v[148:149]
  v_pk_mul_f32 v[162:163], v[162:163], v[148:149]
  v_pk_mul_f32 v[168:169], v[168:169], v[148:149]
  v_pk_mul_f32 v[170:171], v[170:171], v[148:149]
  v_cvt_pk_bf16_f32 v160, v160, v161
  v_cvt_pk_bf16_f32 v161, v162, v163
  v_cvt_pk_bf16_f32 v162, v168, v169
  v_cvt_pk_bf16_f32 v163, v170, v171
  s_lshr_b32 s63, s74, 14
  s_mul_i32 s63, s63, 188416
  s_lshl_b32 s64, s61, 12
  s_add_u32 s63, s63, s64
  s_add_u32 s63, s63, 33554432
.p2align 3
  buffer_store_dwordx4 v[160:163], v1, s[40:43], s63 offen offset:0 sc1
  v_pk_mul_f32 v[176:177], v[176:177], v[148:149]
  v_pk_mul_f32 v[178:179], v[178:179], v[148:149]
  v_pk_mul_f32 v[184:185], v[184:185], v[148:149]
  v_pk_mul_f32 v[186:187], v[186:187], v[148:149]
  v_cvt_pk_bf16_f32 v176, v176, v177
  v_cvt_pk_bf16_f32 v177, v178, v179
  v_cvt_pk_bf16_f32 v178, v184, v185
  v_cvt_pk_bf16_f32 v179, v186, v187
  buffer_store_dwordx4 v[176:179], v1, s[40:43], s63 offen offset:1024 sc1
  v_pk_mul_f32 v[192:193], v[192:193], v[148:149]
  v_pk_mul_f32 v[194:195], v[194:195], v[148:149]
  v_pk_mul_f32 v[200:201], v[200:201], v[148:149]
  v_pk_mul_f32 v[202:203], v[202:203], v[148:149]
  v_cvt_pk_bf16_f32 v192, v192, v193
  v_cvt_pk_bf16_f32 v193, v194, v195
  v_cvt_pk_bf16_f32 v194, v200, v201
  v_cvt_pk_bf16_f32 v195, v202, v203
  buffer_store_dwordx4 v[192:195], v1, s[40:43], s63 offen offset:2048 sc1
  v_pk_mul_f32 v[208:209], v[208:209], v[148:149]
  v_pk_mul_f32 v[210:211], v[210:211], v[148:149]
  v_pk_mul_f32 v[216:217], v[216:217], v[148:149]
  v_pk_mul_f32 v[218:219], v[218:219], v[148:149]
  v_cvt_pk_bf16_f32 v208, v208, v209
  v_cvt_pk_bf16_f32 v209, v210, v211
  v_cvt_pk_bf16_f32 v210, v216, v217
  v_cvt_pk_bf16_f32 v211, v218, v219
  buffer_store_dwordx4 v[208:211], v1, s[40:43], s63 offen offset:3072 sc1
  v_pk_mul_f32 v[164:165], v[164:165], v[150:151]
  v_pk_mul_f32 v[166:167], v[166:167], v[150:151]
  v_pk_mul_f32 v[172:173], v[172:173], v[150:151]
  v_pk_mul_f32 v[174:175], v[174:175], v[150:151]
  v_cvt_pk_bf16_f32 v164, v164, v165
  v_cvt_pk_bf16_f32 v165, v166, v167
  v_cvt_pk_bf16_f32 v166, v172, v173
  v_cvt_pk_bf16_f32 v167, v174, v175
  s_lshr_b32 s63, s75, 14
  s_mul_i32 s63, s63, 188416
  s_lshl_b32 s64, s61, 12
  s_add_u32 s63, s63, s64
  s_add_u32 s63, s63, 33554432
.p2align 3
  buffer_store_dwordx4 v[164:167], v1, s[40:43], s63 offen offset:0 sc1
  v_pk_mul_f32 v[180:181], v[180:181], v[150:151]
  v_pk_mul_f32 v[182:183], v[182:183], v[150:151]
  v_pk_mul_f32 v[188:189], v[188:189], v[150:151]
  v_pk_mul_f32 v[190:191], v[190:191], v[150:151]
  v_cvt_pk_bf16_f32 v180, v180, v181
  v_cvt_pk_bf16_f32 v181, v182, v183
  v_cvt_pk_bf16_f32 v182, v188, v189
  v_cvt_pk_bf16_f32 v183, v190, v191
  buffer_store_dwordx4 v[180:183], v1, s[40:43], s63 offen offset:1024 sc1
  v_pk_mul_f32 v[196:197], v[196:197], v[150:151]
  v_pk_mul_f32 v[198:199], v[198:199], v[150:151]
  v_pk_mul_f32 v[204:205], v[204:205], v[150:151]
  v_pk_mul_f32 v[206:207], v[206:207], v[150:151]
  v_cvt_pk_bf16_f32 v196, v196, v197
  v_cvt_pk_bf16_f32 v197, v198, v199
  v_cvt_pk_bf16_f32 v198, v204, v205
  v_cvt_pk_bf16_f32 v199, v206, v207
  buffer_store_dwordx4 v[196:199], v1, s[40:43], s63 offen offset:2048 sc1
  v_pk_mul_f32 v[212:213], v[212:213], v[150:151]
  v_pk_mul_f32 v[214:215], v[214:215], v[150:151]
  v_pk_mul_f32 v[220:221], v[220:221], v[150:151]
  v_pk_mul_f32 v[222:223], v[222:223], v[150:151]
  v_cvt_pk_bf16_f32 v212, v212, v213
  v_cvt_pk_bf16_f32 v213, v214, v215
  v_cvt_pk_bf16_f32 v214, v220, v221
  v_cvt_pk_bf16_f32 v215, v222, v223
  buffer_store_dwordx4 v[212:215], v1, s[40:43], s63 offen offset:3072 sc1
  v_accvgpr_write_b32 a232, 0
  v_accvgpr_write_b32 a233, 0
  v_accvgpr_write_b32 a234, 0
  v_accvgpr_write_b32 a235, 0
  v_accvgpr_write_b32 a236, 0
  v_accvgpr_write_b32 a237, 0
  v_accvgpr_write_b32 a238, 0
  v_accvgpr_write_b32 a239, 0
  v_mov_b32 v160, 0
  v_mov_b32 v161, 0
  v_mov_b32 v162, 0
  v_mov_b32 v163, 0
  v_mov_b32 v164, 0
  v_mov_b32 v165, 0
  v_mov_b32 v166, 0
  v_mov_b32 v167, 0
  v_mov_b32 v168, 0
  v_mov_b32 v169, 0
  v_mov_b32 v170, 0
  v_mov_b32 v171, 0
  v_mov_b32 v172, 0
  v_mov_b32 v173, 0
  v_mov_b32 v174, 0
  v_mov_b32 v175, 0
  v_mov_b32 v176, 0
  v_mov_b32 v177, 0
  v_mov_b32 v178, 0
  v_mov_b32 v179, 0
  v_mov_b32 v180, 0
  v_mov_b32 v181, 0
  v_mov_b32 v182, 0
  v_mov_b32 v183, 0
  v_mov_b32 v184, 0
  v_mov_b32 v185, 0
  v_mov_b32 v186, 0
  v_mov_b32 v187, 0
  v_mov_b32 v188, 0
  v_mov_b32 v189, 0
  v_mov_b32 v190, 0
  v_mov_b32 v191, 0
  v_mov_b32 v192, 0
  v_mov_b32 v193, 0
  v_mov_b32 v194, 0
  v_mov_b32 v195, 0
  v_mov_b32 v196, 0
  v_mov_b32 v197, 0
  v_mov_b32 v198, 0
  v_mov_b32 v199, 0
  v_mov_b32 v200, 0
  v_mov_b32 v201, 0
  v_mov_b32 v202, 0
  v_mov_b32 v203, 0
  v_mov_b32 v204, 0
  v_mov_b32 v205, 0
  v_mov_b32 v206, 0
  v_mov_b32 v207, 0
  v_mov_b32 v208, 0
  v_mov_b32 v209, 0
  v_mov_b32 v210, 0
  v_mov_b32 v211, 0
  v_mov_b32 v212, 0
  v_mov_b32 v213, 0
  v_mov_b32 v214, 0
  v_mov_b32 v215, 0
  v_mov_b32 v216, 0
  v_mov_b32 v217, 0
  v_mov_b32 v218, 0
  v_mov_b32 v219, 0
  v_mov_b32 v220, 0
  v_mov_b32 v221, 0
  v_mov_b32 v222, 0
  v_mov_b32 v223, 0
  s_branch Llowb_e
Lslow_A0:
  v_cmp_eq_u32 vcc, 0, v25
  s_and_b32 s63, vcc_lo, 0xff00
  s_cbranch_scc1 Lspin9
Lpok9:
  s_branch Lback_A0
Lslow_Z0:
  v_cmp_eq_u32 vcc, 0, v25
  s_and_b32 s63, vcc_lo, 0xff00
  s_cbranch_scc1 Lspin10
Lpok10:
  s_branch Lback_Z0
Lslow_Z4:
  v_cmp_eq_u32 vcc, 0, v25
  s_and_b32 s63, vcc_lo, 0xff00
  s_cbranch_scc1 Lspin11
Lpok11:
  s_branch Lback_Z4
Lslow_B0:
  v_cmp_eq_u32 vcc, 0, v25
  s_and_b32 s63, vcc_lo, 0xff00
  s_cbranch_scc1 Lspin12
Lpok12:
  s_branch Lback_B0
Lslow_Te:
  v_cmp_eq_u32 vcc, 0, v25
  s_and_b32 s63, vcc_lo, -1
  s_cbranch_scc1 Lspin13
Lpok13:
  s_branch Lback_Te
Lslow_To:
  v_cmp_eq_u32 vcc, 0, v25
  s_and_b32 s63, vcc_lo, -1
  s_cbranch_scc1 Lspin14
Lpok14:
  s_branch Lback_To
Lredo:
  s_mov_b32 s5, 1
  s_mov_b32 s10, 0
  v_mov_b32 v5, v144
  s_waitcnt vmcnt(0) lgkmcnt(0)
  s_barrier
  buffer_load_dword v25, v0, s[40:43], s66 offen sc1
  s_mov_b32 s92, s78
  s_mov_b32 s93, s78
  s_and_b32 m0, s92, 0xffff
  s_nop 0
  buffer_load_dwordx4 v1, s[20:23], s92 offen offset:0 sc1 lds
  buffer_load_dwordx4 v1, s[20:23], s92 offen offset:1024 sc1 lds
  buffer_load_dwordx4 v1, s[20:23], s92 offen offset:2048 sc1 lds
  buffer_load_dwordx4 v1, s[20:23], s92 offen offset:3072 sc1 lds
  s_add_u32 s92, s92, 16384
  s_and_b32 s65, s93, 0xffff
  s_add_u32 m0, s65, 65536
  s_nop 0
  buffer_load_dwordx4 v1, s[24:27], s93 offen offset:0 sc1 lds
  buffer_load_dwordx4 v1, s[24:27], s93 offen offset:1024 sc1 lds
  buffer_load_dwordx4 v1, s[24:27], s93 offen offset:2048 sc1 lds
  buffer_load_dwordx4 v1, s[24:27], s93 offen offset:3072 sc1 lds
  s_add_u32 s93, s93, 16384
  s_and_b32 m0, s92, 0xffff
  s_nop 0
  buffer_load_dwordx4 v1, s[20:23], s92 offen offset:0 sc1 lds
  buffer_load_dwordx4 v1, s[20:23], s92 offen offset:1024 sc1 lds
  buffer_load_dwordx4 v1, s[20:23], s92 offen offset:2048 sc1 lds
  buffer_load_dwordx4 v1, s[20:23], s92 offen offset:3072 sc1 lds
  s_add_u32 s92, s92, 16384
  s_and_b32 s65, s93, 0xffff
  s_add_u32 m0, s65, 65536
  s_nop 0
  buffer_load_dwordx4 v1, s[24:27], s93 offen offset:0 sc1 lds
  buffer_load_dwordx4 v1, s[24:27], s93 offen offset:1024 sc1 lds
  buffer_load_dwordx4 v1, s[24:27], s93 offen offset:2048 sc1 lds
  buffer_load_dwordx4 v1, s[24:27], s93 offen offset:3072 sc1 lds
  s_add_u32 s93, s93, 16384
  v_mov_b32 v136, 0
  v_mov_b32 v152, s91
  v_mov_b32 v137, 0
  v_mov_b32 v153, s91
  v_mov_b32 v138, 0
  v_mov_b32 v154, s91
  v_mov_b32 v139, 0
  v_mov_b32 v155, s91
  s_mov_b32 s6, 0
  s_lshr_b32 s7, s72, 15
Lmaxloop:
  s_lshl_b32 s65, s6, 13
  s_add_u32 s64, s65, 4096
  buffer_load_dwordx4 a[160:163], v1, s[20:23], s65 offen offset:0 sc1
  buffer_load_dwordx4 a[164:167], v1, s[20:23], s65 offen offset:1024 sc1
  buffer_load_dwordx4 a[168:171], v1, s[20:23], s65 offen offset:2048 sc1
  buffer_load_dwordx4 a[172:175], v1, s[20:23], s65 offen offset:3072 sc1
  buffer_load_dwordx4 a[176:179], v1, s[20:23], s64 offen offset:0 sc1
  buffer_load_dwordx4 a[180:183], v1, s[20:23], s64 offen offset:1024 sc1
  buffer_load_dwordx4 a[184:187], v1, s[20:23], s64 offen offset:2048 sc1
  buffer_load_dwordx4 a[188:191], v1, s[20:23], s64 offen offset:3072 sc1
  s_sub_u32 s3, s6, s7
  s_cmp_lt_i32 s3, 0
  s_cselect_b32 s100, s90, s91
  s_cmp_gt_i32 s3, 0
  s_cselect_b32 s101, s91, s90
  v_max_f32 v144, s100, v140
  v_max_f32 v145, s100, v141
  v_max_f32 v146, s100, v142
  v_max_f32 v147, s100, v143
  v_min_f32 v228, s100, v136
  v_min_f32 v229, s100, v136
  v_min_f32 v230, s100, v136
  v_min_f32 v231, s100, v136
.p2align 3
  v_min3_f32 v224, v136, v144, s101
  v_min3_f32 v225, v136, v145, s101
  v_min3_f32 v226, v136, v146, s101
  v_min3_f32 v227, v136, v147, s101
  v_min3_f32 v236, v137, v144, s101
  v_min3_f32 v237, v137, v145, s101
  v_min3_f32 v238, v137, v146, s101
  v_min3_f32 v239, v137, v147, s101
  v_min_f32 v232, s101, v137
  v_min_f32 v233, s101, v137
  v_min_f32 v234, s101, v137
  v_min_f32 v235, s101, v137
  s_sub_u32 s3, s6, s67
  s_cmp_lt_i32 s3, 0
  s_cselect_b32 s100, s90, s91
  s_cmp_gt_i32 s3, 0
  s_cselect_b32 s101, s91, s90
  v_max_f32 v144, s100, v140
  v_max_f32 v145, s100, v141
  v_max_f32 v146, s100, v142
  v_max_f32 v147, s100, v143
  v_min_f32 v244, s100, v138
  v_min_f32 v245, s100, v138
  v_min_f32 v246, s100, v138
  v_min_f32 v247, s100, v138
.p2align 3
  v_min3_f32 v240, v138, v144, s101
  v_min3_f32 v241, v138, v145, s101
  v_min3_f32 v242, v138, v146, s101
  v_min3_f32 v243, v138, v147, s101
  v_min3_f32 v252, v139, v144, s101
  v_min3_f32 v253, v139, v145, s101
  v_min3_f32 v254, v139, v146, s101
  v_min3_f32 v255, v139, v147, s101
  v_min_f32 v248, s101, v139
  v_min_f32 v249, s101, v139
  v_min_f32 v250, s101, v139
  v_min_f32 v251, s101, v139
  s_waitcnt vmcnt(0)
  s_nop 0
  v_mfma_f32_16x16x32_bf16 v[32:35], a[160:163], a[64:67], v[224:227]
  v_mfma_f32_16x16x32_bf16 v[40:43], a[160:163], a[68:71], v[232:235]
  v_mfma_f32_16x16x32_bf16 v[48:51], a[160:163], a[96:99], v[240:243]
  v_mfma_f32_16x16x32_bf16 v[56:59], a[160:163], a[100:103], v[248:251]
  v_mfma_f32_16x16x32_bf16 v[36:39], a[164:167], a[64:67], v[228:231]
  v_mfma_f32_16x16x32_bf16 v[44:47], a[164:167], a[68:71], v[236:239]
  v_mfma_f32_16x16x32_bf16 v[52:55], a[164:167], a[96:99], v[244:247]
  v_mfma_f32_16x16x32_bf16 v[60:63], a[164:167], a[100:103], v[252:255]
  v_mfma_f32_16x16x32_bf16 v[32:35], a[168:171], a[72:75], v[32:35]
  v_mfma_f32_16x16x32_bf16 v[40:43], a[168:171], a[76:79], v[40:43]
  v_mfma_f32_16x16x32_bf16 v[48:51], a[168:171], a[104:107], v[48:51]
  v_mfma_f32_16x16x32_bf16 v[56:59], a[168:171], a[108:111], v[56:59]
  v_mfma_f32_16x16x32_bf16 v[36:39], a[172:175], a[72:75], v[36:39]
  v_mfma_f32_16x16x32_bf16 v[44:47], a[172:175], a[76:79], v[44:47]
  v_mfma_f32_16x16x32_bf16 v[52:55], a[172:175], a[104:107], v[52:55]
  v_mfma_f32_16x16x32_bf16 v[60:63], a[172:175], a[108:111], v[60:63]
  v_mfma_f32_16x16x32_bf16 v[32:35], a[176:179], a[80:83], v[32:35]
  v_mfma_f32_16x16x32_bf16 v[40:43], a[176:179], a[84:87], v[40:43]
  v_mfma_f32_16x16x32_bf16 v[48:51], a[176:179], a[112:115], v[48:51]
  v_mfma_f32_16x16x32_bf16 v[56:59], a[176:179], a[116:119], v[56:59]
  v_mfma_f32_16x16x32_bf16 v[36:39], a[180:183], a[80:83], v[36:39]
  v_mfma_f32_16x16x32_bf16 v[44:47], a[180:183], a[84:87], v[44:47]
  v_mfma_f32_16x16x32_bf16 v[52:55], a[180:183], a[112:115], v[52:55]
  v_mfma_f32_16x16x32_bf16 v[60:63], a[180:183], a[116:119], v[60:63]
  v_mfma_f32_16x16x32_bf16 v[32:35], a[184:187], a[88:91], v[32:35]
  v_mfma_f32_16x16x32_bf16 v[40:43], a[184:187], a[92:95], v[40:43]
  v_mfma_f32_16x16x32_bf16 v[48:51], a[184:187], a[120:123], v[48:51]
  v_mfma_f32_16x16x32_bf16 v[56:59], a[184:187], a[124:127], v[56:59]
  v_mfma_f32_16x16x32_bf16 v[36:39], a[188:191], a[88:91], v[36:39]
  v_mfma_f32_16x16x32_bf16 v[44:47], a[188:191], a[92:95], v[44:47]
  v_mfma_f32_16x16x32_bf16 v[52:55], a[188:191], a[120:123], v[52:55]
  v_mfma_f32_16x16x32_bf16 v[60:63], a[188:191], a[124:127], v[60:63]
  s_nop 7
.p2align 3
  v_max3_f32 v152, v32, v33, v152
  v_max3_f32 v152, v34, v35, v152
  v_max3_f32 v152, v36, v37, v152
  v_max3_f32 v152, v38, v39, v152
  v_max3_f32 v153, v40, v41, v153
  v_max3_f32 v153, v42, v43, v153
  v_max3_f32 v153, v44, v45, v153
  v_max3_f32 v153, v46, v47, v153
  v_max3_f32 v154, v48, v49, v154
  v_max3_f32 v154, v50, v51, v154
  v_max3_f32 v154, v52, v53, v154
  v_max3_f32 v154, v54, v55, v154
  v_max3_f32 v155, v56, v57, v155
  v_max3_f32 v155, v58, v59, v155
  v_max3_f32 v155, v60, v61, v155
  v_max3_f32 v155, v62, v63, v155
  s_add_u32 s6, s6, 1
  s_cmp_le_u32 s6, s7
  s_cbranch_scc1 Lmaxloop
  v_mov_b32 v148, v152
  v_mov_b32 v149, v153
  v_mov_b32 v150, v154
  v_mov_b32 v151, v155
  s_nop 0
  v_permlane16_swap_b32 v152, v148
  v_permlane16_swap_b32 v153, v149
  v_permlane16_swap_b32 v154, v150
  v_permlane16_swap_b32 v155, v151
  v_max_f32 v152, v152, v148
  v_max_f32 v153, v153, v149
  v_max_f32 v154, v154, v150
  v_max_f32 v155, v155, v151
  v_mov_b32 v148, v152
  v_mov_b32 v149, v153
  v_mov_b32 v150, v154
  v_mov_b32 v151, v155
  s_nop 0
  v_permlane32_swap_b32 v152, v148
  v_permlane32_swap_b32 v153, v149
  v_permlane32_swap_b32 v154, v150
  v_permlane32_swap_b32 v155, v151
  v_max_f32 v152, v152, v148
  v_max_f32 v153, v153, v149
  v_max_f32 v154, v154, v150
  v_max_f32 v155, v155, v151
  v_sub_f32 v136, 0, v152
  v_sub_f32 v137, 0, v153
  v_sub_f32 v138, 0, v154
  v_sub_f32 v139, 0, v155
  ds_write_b128 v5, a[64:67] offset:0
  ds_write_b128 v5, a[68:71] offset:1024
  ds_write_b128 v5, a[72:75] offset:2048
  ds_write_b128 v5, a[76:79] offset:3072
  ds_write_b128 v5, a[80:83] offset:4096
  ds_write_b128 v5, a[84:87] offset:5120
  ds_write_b128 v5, a[88:91] offset:6144
  ds_write_b128 v5, a[92:95] offset:7168
  s_branch Lp3start
Lspin2:
  s_mov_b32 s64, 200000
Lpoll2:
  s_sleep 2
  buffer_load_dword v25, off, s[48:51], 0 offset:128 sc1
  s_waitcnt vmcnt(0)
  v_cmp_eq_u32 vcc, 0, v25
  s_and_b32 s63, vcc_lo, 1
  s_cbranch_scc0 Lpok2
  s_sub_u32 s64, s64, 1
  s_cbranch_scc0 Lpoll2
  s_branch Lpok2
Lspin4:
  s_mov_b32 s64, 200000
Lpoll4:
  s_sleep 2
  buffer_load_dword v25, v0, s[40:43], s66 offen sc1
  s_waitcnt vmcnt(0)
  v_cmp_eq_u32 vcc, 0, v25
  s_and_b32 s63, vcc_lo, 0xff
  s_cbranch_scc0 Lpok4
  s_sub_u32 s64, s64, 1
  s_cbranch_scc0 Lpoll4
  s_branch Lpok4
Lspin6:
  s_mov_b32 s64, 200000
Lpoll6:
  s_sleep 2
  buffer_load_dword v25, v0, s[40:43], s83 offen sc1
  s_waitcnt vmcnt(0)
  v_cmp_eq_u32 vcc, 0, v25
  s_and_b32 s63, vcc_hi, s85
  s_cbranch_scc0 Lpok6
  s_sub_u32 s64, s64, 1
  s_cbranch_scc0 Lpoll6
  s_branch Lpok6
Lspin7:
  s_mov_b32 s64, 200000
Lpoll7:
  s_sleep 2
  buffer_load_dword v25, v0, s[40:43], s12 offen sc1
  s_waitcnt vmcnt(0)
  v_cmp_eq_u32 vcc, 0, v25
  s_and_b32 s63, vcc_lo, s85
  s_cbranch_scc0 Lpok7
  s_sub_u32 s64, s64, 1
  s_cbranch_scc0 Lpoll7
  s_branch Lpok7
Lspin8:
  s_mov_b32 s64, 200000
Lpoll8:
  s_sleep 2
  buffer_load_dword v25, v0, s[40:43], s66 offen sc1
  s_waitcnt vmcnt(0)
  v_cmp_eq_u32 vcc, 0, v25
  s_and_b32 s63, vcc_lo, 0xff
  s_cbranch_scc0 Lpok8
  s_sub_u32 s64, s64, 1
  s_cbranch_scc0 Lpoll8
  s_branch Lpok8
Lspin9:
  s_mov_b32 s64, 200000
Lpoll9:
  s_sleep 2
  buffer_load_dword v25, v0, s[40:43], s66 offen sc1
  s_waitcnt vmcnt(0)
  v_cmp_eq_u32 vcc, 0, v25
  s_and_b32 s63, vcc_lo, 0xff00
  s_cbranch_scc0 Lpok9
  s_sub_u32 s64, s64, 1
  s_cbranch_scc0 Lpoll9
  s_branch Lpok9
Lspin10:
  s_mov_b32 s64, 200000
Lpoll10:
  s_sleep 2
  buffer_load_dword v25, v0, s[40:43], s66 offen sc1
  s_waitcnt vmcnt(0)
  v_cmp_eq_u32 vcc, 0, v25
  s_and_b32 s63, vcc_lo, 0xff00
  s_cbranch_scc0 Lpok10
  s_sub_u32 s64, s64, 1
  s_cbranch_scc0 Lpoll10
  s_branch Lpok10
Lspin11:
  s_mov_b32 s64, 200000
Lpoll11:
  s_sleep 2
  buffer_load_dword v25, v0, s[40:43], s66 offen sc1
  s_waitcnt vmcnt(0)
  v_cmp_eq_u32 vcc, 0, v25
  s_and_b32 s63, vcc_lo, 0xff00
  s_cbranch_scc0 Lpok11
  s_sub_u32 s64, s64, 1
  s_cbranch_scc0 Lpoll11
  s_branch Lpok11
Lspin12:
  s_mov_b32 s64, 200000
Lpoll12:
  s_sleep 2
  buffer_load_dword v25, v0, s[40:43], s66 offen sc1
  s_waitcnt vmcnt(0)
  v_cmp_eq_u32 vcc, 0, v25
  s_and_b32 s63, vcc_lo, 0xff00
  s_cbranch_scc0 Lpok12
  s_sub_u32 s64, s64, 1
  s_cbranch_scc0 Lpoll12
  s_branch Lpok12
Lspin13:
  s_mov_b32 s64, 200000
Lpoll13:
  s_sleep 2
  buffer_load_dword v25, v0, s[40:43], s83 offen sc1
  s_waitcnt vmcnt(0)
  v_cmp_eq_u32 vcc, 0, v25
  s_and_b32 s63, vcc_lo, -1
  s_cbranch_scc0 Lpok13
  s_sub_u32 s64, s64, 1
  s_cbranch_scc0 Lpoll13
  s_branch Lpok13
Lspin14:
  s_mov_b32 s64, 200000
Lpoll14:
  s_sleep 2
  buffer_load_dword v25, v0, s[40:43], s83 offen sc1
  s_waitcnt vmcnt(0)
  v_cmp_eq_u32 vcc, 0, v25
  s_and_b32 s63, vcc_lo, -1
  s_cbranch_scc0 Lpok14
  s_sub_u32 s64, s64, 1
  s_cbranch_scc0 Lpoll14
  s_branch Lpok14
Lcodeend:
.section .rodata,"a"
.p2align 6
.amdhsa_kernel gated_mix__compressed_kv_cla__dense_activation_mish__prompt_kernel
  .amdhsa_next_free_vgpr 512
  .amdhsa_next_free_sgpr 102
  .amdhsa_accum_offset 256
  .amdhsa_group_segment_fixed_size 0
  .amdhsa_kernarg_size 112
  .amdhsa_user_sgpr_count 2
  .amdhsa_user_sgpr_kernarg_segment_ptr 1
  .amdhsa_system_sgpr_workgroup_id_x 1
.end_amdhsa_kernel
```
